```python
import torch

def _softmax(x, axis=-1):
    return torch.softmax(x, dim=axis)
def _gelu(x):
    return torch.nn.functional.gelu(x, approximate="tanh")
def _silu(x):
    return torch.nn.functional.silu(x)
def _sigmoid(x):
    return torch.sigmoid(x)
def _layernorm(x, axis=-1, eps=1e-5):
    m = x.mean(dim=axis, keepdim=True)
    v = x.var(dim=axis, keepdim=True, unbiased=False)
    return (x - m) / torch.sqrt(v + eps)
def _scatter_add(tgt, idx, src, axis=0):
    return tgt.clone().index_add_(axis, idx, src)
def _segment_sum(src, seg, n):
    out = torch.zeros((n,) + src.shape[1:], dtype=src.dtype)
    return out.index_add_(0, seg, src)
def _pad(x, pw):
    flat = tuple(v for pair in reversed(pw) for v in pair)
    return torch.nn.functional.pad(x, flat)

kernel_name = 'gated_mix__compressed_kv_cla__swiglu_ffn__prompt'

def setup_inputs():

    _w = (lambda a: (lambda t: t.to(torch.bfloat16) if t.is_floating_point() else t)(torch.as_tensor(a)))
    def _A_setup():
        B, H, Sq, Sk, D, M = 1, 32, 2048, 2048, 128, 640
        Dc = 4 * D
        return {
            "x": _w((lambda *s: torch.randn(*s, dtype=torch.bfloat16) * 0.05)(B, Sq, M)),
            "c_kv": _w((lambda *s: torch.randn(*s, dtype=torch.bfloat16) * 0.4)(B, Sk, Dc)),
            "w_q": _w((lambda *s: torch.randn(*s, dtype=torch.bfloat16) * 6.4)(M, H, D) * (M ** -0.5)),
            "w_uk": _w((lambda *s: torch.randn(*s, dtype=torch.bfloat16) * 6.4)(Dc, H, D) * (Dc ** -0.5)),
            "w_uv": _w((lambda *s: torch.randn(*s, dtype=torch.bfloat16) * 0.4)(Dc, H, D) * (Dc ** -0.5)),
            "w_o": _w((lambda *s: torch.randn(*s, dtype=torch.bfloat16) * 0.4)(H, D, M) * ((H * D) ** -0.5)),
        }
    _A_in = _A_setup()

    def _B_setup():
        B, S, D, F = 1, 2048, 640, 1728
        return {
            "x": _w((lambda *s: torch.randn(*s, dtype=torch.bfloat16) * 0.05)(B, S, D)),
            "w_gate": _w((lambda *s: torch.randn(*s, dtype=torch.bfloat16) * 0.05)(D, F)),
            "w_up": _w((lambda *s: torch.randn(*s, dtype=torch.bfloat16) * 0.05)(D, F)),
            "w_down": _w((lambda *s: torch.randn(*s, dtype=torch.bfloat16) * 0.05)(F, D)),
        }
    _B_in = _B_setup()

    return {
        "A_x": _A_in["x"],
        "A_c_kv": _A_in["c_kv"],
        "A_w_q": _A_in["w_q"],
        "A_w_uk": _A_in["w_uk"],
        "A_w_uv": _A_in["w_uv"],
        "A_w_o": _A_in["w_o"],
        "B_x": _B_in["x"],
        "B_w_gate": _B_in["w_gate"],
        "B_w_up": _B_in["w_up"],
        "B_w_down": _B_in["w_down"],
        "gate_w": _w((lambda *s: torch.randn(*s, dtype=torch.bfloat16) * 0.05)(640) * 16.0),
    }

def reference(A_x, A_c_kv, A_w_q, A_w_uk, A_w_uv, A_w_o, B_x, B_w_gate, B_w_up, B_w_down, gate_w):
    def _A_ref(x, c_kv, w_q, w_uk, w_uv, w_o):
        B, Sq, M = x.shape[0], x.shape[1], x.shape[2]
        Sk = c_kv.shape[1]
        H, D = w_q.shape[1], w_q.shape[2]
        q = torch.einsum("bqm,mhd->bhqd", x, w_q)
        k = torch.einsum("bkc,chd->bhkd", c_kv, w_uk)
        v = torch.einsum("bkc,chd->bhkd", c_kv, w_uv)
        scores = torch.einsum("bhqd,bhkd->bhqk", q, k) * (D ** -0.5)
        off = Sk - Sq
        qi = torch.arange(Sq)[:, None]
        kj = torch.arange(Sk)[None, :]
        cmask = kj <= (qi + off)
        scores = torch.where(cmask[None, None], scores, -1e9)
        p = _softmax(scores, axis=-1)
        ctx = torch.einsum("bhqk,bhkd->bhqd", p, v)
        return torch.einsum("bhqd,hdm->bqm", ctx, w_o)

    def _B_ref(x, w_gate, w_up, w_down):
        g = _silu(x @ w_gate)
        u = x @ w_up
        return (g * u) @ w_down

    x = A_x
    g = _sigmoid((x * gate_w).sum(-1, keepdims=True))
    a = _A_ref(x, A_c_kv, A_w_q, A_w_uk, A_w_uv, A_w_o)
    b = _B_ref(x, B_w_gate, B_w_up, B_w_down)
    return g * a + (1 - g) * b
```

```asm
; @launch grid=(256,1,1) block=(256,1,1) lds=163840
.amdgcn_target "amdgcn-amd-amdhsa--gfx950"
.text
.globl gated_mix__compressed_kv_cla__swiglu_ffn__prompt_kernel
.p2align 8
.type gated_mix__compressed_kv_cla__swiglu_ffn__prompt_kernel,@function
gated_mix__compressed_kv_cla__swiglu_ffn__prompt_kernel:
  s_cmp_ge_u32 s2, 256
  s_cbranch_scc1 L_f_exit
  s_load_dwordx16 s[4:19], s[0:1], 0
  s_load_dwordx8 s[20:27], s[0:1], 64
  s_load_dwordx4 s[28:31], s[0:1], 96
  s_getpc_b64 s[56:57]
L_pc0:
  s_mov_b32 s58, L_code_end-L_pc0
  s_mov_b32 s59, 0x20000
  s_bfe_u32 s39, s2, 0x30003
  s_lshl_b32 s39, s39, 13
  v_lshlrev_b32 v13, 5, v0
  buffer_load_dword v13, v13, s[56:59], s39 offen
  v_lshrrev_b32 v16, 6, v0
  v_and_b32 v0, 63, v0
  v_readfirstlane_b32 s36, v16
  v_lshlrev_b32 v10, 4, v0
  s_lshr_b32 s37, s36, 1
  s_and_b32 s38, s36, 1
  v_lshrrev_b32 v16, 3, v0
  v_and_b32 v21, 7, v0
  v_lshrrev_b32 v18, 4, v0
  v_xor_b32 v17, v21, v18
  v_lshlrev_b32 v17, 4, v17
  v_xor_b32 v19, 64, v17
  v_lshl_add_u32 v1, v16, 10, v17
  v_lshl_add_u32 v2, v16, 10, v19
  v_mul_u32_u24 v20, 1280, v16
  v_add_u32 v4, v20, v17
  v_add_u32 v5, v20, v19
  v_and_b32 v16, 8, v0
  v_and_b32 v17, 1, v18
  v_lshl_add_u32 v16, v17, 2, v16
  v_lshrrev_b32 v17, 5, v0
  v_lshl_add_u32 v16, v17, 4, v16
  v_lshlrev_b32 v17, 4, v21
  v_lshl_add_u32 v3, v16, 13, v17
  v_mul_u32_u24 v22, 40, v0
  v_and_b32 v23, 31, v0
  v_mul_u32_u24 v23, 40, v23
  s_lshl_b32 s79, s36, 12
  s_add_u32 s79, s79, 67584
  s_xor_b32 s39, s37, 1
  s_mul_i32 s80, s39, 33792
  s_mul_i32 s39, s38, 8448
  s_add_u32 s80, s80, s39
  s_and_b32 s83, s2, 7
  s_bfe_u32 s39, s2, 0x20003
  s_lshl_b32 s42, s83, 2
  s_add_u32 s42, s42, s39
  s_lshr_b32 s43, s2, 5
  s_lshl_b32 s41, s37, 2
  s_add_u32 s41, s41, s38
  s_lshl_b32 s39, s43, 3
  s_add_u32 s39, s39, s41
  s_lshl_b32 s69, s39, 15
  s_mov_b32 s71, 8192
  s_mov_b32 s72, 40960
  s_mov_b32 s73, 4294877312
  s_and_b32 s40, s42, 15
  s_lshl_b32 s70, s38, 18
  s_lshl_b32 s39, s40, 9
  s_add_u32 s70, s70, s39
  s_lshl_b32 s39, s37, 8
  s_add_u32 s70, s70, s39
  s_mov_b32 s74, 8192
  s_mov_b32 s75, 499712
  s_mov_b32 s46, 2097152
  s_mov_b32 s47, 0x20000
  s_mov_b32 s50, 4194304
  s_mov_b32 s51, 0x20000
  s_mov_b32 s54, 4194176
  s_mov_b32 s55, 0x20000
  s_mov_b32 s58, 2621440
  s_mov_b32 s59, 0x20000
  s_mov_b32 s34, 1280
  s_mov_b32 s35, 0x20000
  s_lshl_b32 s81, s2, 2
  s_add_u32 s81, s81, s36
  s_mul_i32 s39, s81, 2560
  s_cmp_lt_u32 s42, 16
  s_waitcnt lgkmcnt(0)
  s_mov_b32 s56, s4
  s_mov_b32 s57, s5
  s_mov_b32 s32, s24
  s_mov_b32 s33, s25
  s_mov_b32 s44, s6
  s_mov_b32 s45, s7
  s_cselect_b32 s48, s10, s12
  s_cselect_b32 s49, s11, s13
  s_add_u32 s52, s48, 128
  s_addc_u32 s53, s49, 0
  s_add_u32 m0, s79, 0
  s_nop 0
  buffer_load_dwordx4 v1, s[44:47], s69 offen lds
  s_add_u32 s69, s69, s71
  s_add_u32 m0, s80, 0
  s_nop 0
  buffer_load_dwordx4 v3, s[48:51], s70 offen lds
  s_add_u32 m0, s80, 4224
  s_nop 0
  buffer_load_dwordx4 v3, s[52:55], s70 offen lds
  s_add_u32 s70, s70, s74
  s_add_u32 m0, s79, 1024
  s_nop 0
  buffer_load_dwordx4 v2, s[44:47], s69 offen lds
  s_add_u32 s69, s69, s71
  s_add_u32 m0, s80, 1056
  s_nop 0
  buffer_load_dwordx4 v3, s[48:51], s70 offen lds
  s_add_u32 m0, s80, 5280
  s_nop 0
  buffer_load_dwordx4 v3, s[52:55], s70 offen lds
  s_add_u32 s70, s70, s74
  s_add_u32 m0, s79, 2048
  s_nop 0
  buffer_load_dwordx4 v1, s[44:47], s69 offen lds
  s_add_u32 s69, s69, s71
  s_add_u32 m0, s80, 2112
  s_nop 0
  buffer_load_dwordx4 v3, s[48:51], s70 offen lds
  s_add_u32 m0, s80, 6336
  s_nop 0
  buffer_load_dwordx4 v3, s[52:55], s70 offen lds
  s_add_u32 s70, s70, s74
  s_add_u32 m0, s79, 3072
  s_nop 0
  buffer_load_dwordx4 v2, s[44:47], s69 offen lds
  s_add_u32 s69, s69, s72
  s_add_u32 m0, s80, 3168
  s_nop 0
  buffer_load_dwordx4 v3, s[48:51], s70 offen lds
  s_add_u32 m0, s80, 7392
  s_nop 0
  buffer_load_dwordx4 v3, s[52:55], s70 offen lds
  s_add_u32 s70, s70, s75
  buffer_load_dwordx4 v[128:131], v22, s[56:59], s39 offen offset:0
  buffer_load_dwordx4 v[140:143], v23, s[32:35], 0 offen offset:0
  buffer_load_dwordx4 v[132:135], v22, s[56:59], s39 offen offset:16
  buffer_load_dwordx4 v[144:147], v23, s[32:35], 0 offen offset:16
  buffer_load_dwordx2 v[136:137], v22, s[56:59], s39 offen offset:32
  buffer_load_dwordx2 v[148:149], v23, s[32:35], 0 offen offset:32
  s_add_u32 m0, s79, 32768
  s_nop 0
  buffer_load_dwordx4 v1, s[44:47], s69 offen lds
  s_add_u32 s69, s69, s71
  s_add_u32 m0, s79, 33792
  s_nop 0
  buffer_load_dwordx4 v2, s[44:47], s69 offen lds
  s_add_u32 s69, s69, s71
  s_add_u32 m0, s79, 34816
  s_nop 0
  buffer_load_dwordx4 v1, s[44:47], s69 offen lds
  s_add_u32 s69, s69, s71
  s_add_u32 m0, s79, 35840
  s_nop 0
  buffer_load_dwordx4 v2, s[44:47], s69 offen lds
  s_add_u32 s69, s69, s73
  s_mov_b32 s32, s30
  s_mov_b32 s33, s31
  s_mov_b32 s34, 268435456
  s_lshr_b32 s24, s42, 4
  v_and_b32 v18, 15, v0
  v_lshrrev_b32 v19, 1, v18
  v_lshrrev_b32 v20, 4, v0
  v_xor_b32 v19, v19, v20
  v_lshlrev_b32 v19, 4, v19
  v_lshl_add_u32 v7, v18, 7, v19
  s_lshl_b32 s39, s37, 13
  s_add_u32 s39, s39, 67584
  v_add_u32 v7, s39, v7
  v_xor_b32 v8, 64, v7
  v_lshrrev_b32 v18, 2, v18
  v_mul_u32_u24 v18, 1056, v18
  v_and_b32 v19, 1, v20
  v_lshl_add_u32 v18, v19, 7, v18
  v_lshrrev_b32 v19, 1, v20
  v_lshl_add_u32 v18, v19, 9, v18
  v_and_b32 v19, 3, v0
  v_lshl_add_u32 v18, v19, 3, v18
  s_lshl_b32 s39, s38, 6
  v_add_u32 v9, s39, v18
  s_lshl_b32 s82, s42, 20
  s_lshl_b32 s39, s43, 16
  s_add_u32 s82, s82, s39
  s_lshl_b32 s39, s37, 15
  s_add_u32 s82, s82, s39
  s_add_u32 s40, s24, 10
  s_lshl_b32 s39, s38, s40
  s_add_u32 s82, s82, s39
  s_lshr_b32 s39, 2048, s24
  v_add_u32 v11, s39, v10
  s_sub_u32 s39, 15, s43
  s_cmp_eq_u32 s37, 0
  s_cselect_b32 s84, s43, s39
  s_mov_b32 s60, s4
  s_mov_b32 s61, s5
  s_mov_b32 s62, 2621440
  s_lshl_b32 s39, s84, 2
  s_add_u32 s39, s39, s38
  s_mul_i32 s76, s39, 40960
  s_add_u32 s66, s8, 128
  s_addc_u32 s67, s9, 0
  s_cmp_lt_u32 s42, 27
  s_cselect_b32 s40, 2211840, 0
  s_cmp_eq_u32 s37, 0
  s_cselect_b32 s63, s8, s18
  s_cselect_b32 s64, s9, s19
  s_cselect_b32 s65, 5242880, s40
  s_cselect_b32 s66, s66, s20
  s_cselect_b32 s67, s67, s21
  s_cselect_b32 s68, 5242752, s40
  s_mov_b32 s78, 3456
  s_cselect_b32 s78, 8192, s78
  s_cselect_b32 s40, 8, 7
  s_lshl_b32 s40, s42, s40
  s_lshl_b32 s39, s38, 5
  s_mul_i32 s77, s39, s78
  s_add_u32 s77, s77, s40
  v_mad_u32_u24 v6, v16, s78, v17
  s_mul_i32 s4, s84, 1490944
  s_lshl_b32 s39, s42, 1
  s_add_u32 s39, s39, s38
  s_lshl_b32 s39, s39, 10
  s_add_u32 s4, s4, s39
  s_add_u32 s4, s4, 50462720
  s_cmp_lt_u32 s42, 27
  s_cselect_b32 s4, s4, 268435456
  s_cmp_eq_u32 s38, 0
  s_cselect_b32 s56, s18, s20
  s_cselect_b32 s57, s19, s21
  s_mov_b32 s58, 2211840
  s_lshl_b32 s39, s2, 1
  s_add_u32 s39, s39, s38
  s_cmp_eq_u32 s37, 0
  s_cselect_b32 s56, s8, s56
  s_cselect_b32 s57, s9, s57
  s_cselect_b32 s58, 5242880, s58
  s_cselect_b32 s39, s39, s2
  s_mov_b32 s84, 458752
  s_cselect_b32 s84, 917504, s84
  s_mul_i32 s83, s39, 1792
  v_lshlrev_b32 v12, 7, v0
  v_mov_b32 v18, 0x40000000
  v_cmp_gt_u32 vcc, 14, v0
  s_mov_b32 s5, 3216550459
  s_mov_b32 s6, 1040356334
  s_mov_b32 s7, 1040356334
  v_cndmask_b32 v12, v18, v12, vcc
  s_mov_b32 s16, s28
  s_mov_b32 s17, s29
  s_mov_b32 s18, 256
  s_mov_b32 s19, 0x20000
  s_and_b32 s39, s2, 63
  s_lshl_b32 s39, s39, 2
  s_lshl_b32 s40, s36, 14
  s_add_u32 s39, s39, s40
  v_lshlrev_b32 v15, 8, v0
  v_add_u32 v15, s39, v15
  v_mov_b32 v14, 1
  s_lshr_b32 s39, s2, 3
  s_sub_u32 s39, 31, s39
  s_mul_i32 s40, s39, 52
  s_lshr_b32 s40, s40, 8
  s_mul_i32 s41, s40, 5
  s_sub_u32 s41, s39, s41
  s_mov_b32 s28, s40
  s_lshl_b32 s30, s41, 2
  s_add_u32 s30, s30, s36
  s_lshl_b32 s41, s41, 8
  s_mul_i32 s31, s37, 40960
  s_add_u32 s31, s31, s41
  s_lshl_b32 s40, s38, 7
  s_add_u32 s31, s31, s40
  s_mul_i32 s40, s36, 20480
  s_add_u32 s25, s41, s40
  s_mul_i32 s20, s36, 186368
  s_add_u32 s20, s20, 50331648
  s_lshl_b32 s0, s36, 8
  s_add_u32 s0, s0, s2
  s_sub_u32 s39, s0, 640
  s_cmp_ge_u32 s0, 640
  s_cselect_b32 s0, s39, s0
  s_cselect_b32 s8, s22, s14
  s_cselect_b32 s9, s23, s15
  s_mov_b32 s10, 5242880
  s_cselect_b32 s10, 2211840, s10
  s_mov_b32 s11, 0x20000
  s_lshl_b32 s0, s0, 13
  s_add_u32 m0, s79, 16384
  s_nop 0
  buffer_load_dwordx4 v1, s[44:47], s69 offen lds
  s_add_u32 s69, s69, s71
  s_add_u32 m0, s80, 16896
  s_nop 0
  buffer_load_dwordx4 v3, s[48:51], s70 offen lds
  s_add_u32 m0, s80, 21120
  s_nop 0
  buffer_load_dwordx4 v3, s[52:55], s70 offen lds
  s_add_u32 s70, s70, s74
  s_add_u32 m0, s79, 17408
  s_nop 0
  buffer_load_dwordx4 v2, s[44:47], s69 offen lds
  s_add_u32 s69, s69, s71
  s_add_u32 m0, s80, 17952
  s_nop 0
  buffer_load_dwordx4 v3, s[48:51], s70 offen lds
  s_add_u32 m0, s80, 22176
  s_nop 0
  buffer_load_dwordx4 v3, s[52:55], s70 offen lds
  s_add_u32 s70, s70, s74
  s_add_u32 m0, s79, 18432
  s_nop 0
  buffer_load_dwordx4 v1, s[44:47], s69 offen lds
  s_add_u32 s69, s69, s71
  s_add_u32 m0, s80, 19008
  s_nop 0
  buffer_load_dwordx4 v3, s[48:51], s70 offen lds
  s_add_u32 m0, s80, 23232
  s_nop 0
  buffer_load_dwordx4 v3, s[52:55], s70 offen lds
  s_add_u32 s70, s70, s74
  s_add_u32 m0, s79, 19456
  s_nop 0
  buffer_load_dwordx4 v2, s[44:47], s69 offen lds
  s_add_u32 s69, s69, s72
  s_add_u32 m0, s80, 20064
  s_nop 0
  buffer_load_dwordx4 v3, s[48:51], s70 offen lds
  s_add_u32 m0, s80, 24288
  s_nop 0
  buffer_load_dwordx4 v3, s[52:55], s70 offen lds
  s_add_u32 s70, s70, s75
  v_lshlrev_b32 v19, 2, v0
  v_cmp_gt_u32 vcc, 16, v0
  v_mov_b32 v20, 0
  s_lshl_b32 s39, s81, 6
  s_add_u32 s39, s39, 84934656
  v_cndmask_b32 v19, v18, v19, vcc
  buffer_store_dword v20, v19, s[32:35], s39 offen sc1
  v_lshrrev_b32 v154, 3, v0
  v_cmp_eq_u32 vcc, 0, v23
  s_lshl_b32 s3, s81, 3
  s_add_u32 s3, s3, 83886080
  v_cndmask_b32 v154, v18, v154, vcc
  s_waitcnt vmcnt(23)
  s_barrier
  ds_read_b128 a[64:67], v7 offset:0
  ds_read_b128 a[68:71], v7 offset:2048
  ds_read_b128 a[72:75], v7 offset:4096
  ds_read_b128 a[76:79], v7 offset:6144
  ds_read_b128 a[80:83], v8 offset:0
  ds_read_b128 a[84:87], v8 offset:2048
  ds_read_b128 a[88:91], v8 offset:4096
  ds_read_b128 a[92:95], v8 offset:6144
  ds_read_b64_tr_b16 a[0:1], v9 offset:33792
  ds_read_b64_tr_b16 a[2:3], v9 offset:34048
  ds_read_b64_tr_b16 a[4:5], v9 offset:33824
  ds_read_b64_tr_b16 a[6:7], v9 offset:34080
  ds_read_b64_tr_b16 a[8:9], v9 offset:38016
  ds_read_b64_tr_b16 a[10:11], v9 offset:38272
  ds_read_b64_tr_b16 a[12:13], v9 offset:38048
  ds_read_b64_tr_b16 a[14:15], v9 offset:38304
  ds_read_b64_tr_b16 a[16:17], v9 offset:0
  ds_read_b64_tr_b16 a[18:19], v9 offset:256
  ds_read_b64_tr_b16 a[20:21], v9 offset:32
  ds_read_b64_tr_b16 a[22:23], v9 offset:288
  ds_read_b64_tr_b16 a[24:25], v9 offset:4224
  ds_read_b64_tr_b16 a[26:27], v9 offset:4480
  ds_read_b64_tr_b16 a[28:29], v9 offset:4256
  ds_read_b64_tr_b16 a[30:31], v9 offset:4512
  ds_read_b64_tr_b16 a[32:33], v9 offset:42240
  ds_read_b64_tr_b16 a[34:35], v9 offset:42496
  ds_read_b64_tr_b16 a[36:37], v9 offset:42272
  ds_read_b64_tr_b16 a[38:39], v9 offset:42528
  ds_read_b64_tr_b16 a[40:41], v9 offset:46464
  ds_read_b64_tr_b16 a[42:43], v9 offset:46720
  ds_read_b64_tr_b16 a[44:45], v9 offset:46496
  ds_read_b64_tr_b16 a[46:47], v9 offset:46752
  ds_read_b64_tr_b16 a[48:49], v9 offset:8448
  ds_read_b64_tr_b16 a[50:51], v9 offset:8704
  ds_read_b64_tr_b16 a[52:53], v9 offset:8480
  ds_read_b64_tr_b16 a[54:55], v9 offset:8736
  ds_read_b64_tr_b16 a[56:57], v9 offset:12672
  ds_read_b64_tr_b16 a[58:59], v9 offset:12928
  ds_read_b64_tr_b16 a[60:61], v9 offset:12704
  ds_read_b64_tr_b16 a[62:63], v9 offset:12960
  s_mov_b32 s81, 2
  s_cmp_eq_u32 s24, 0
  s_cbranch_scc1 L_f_ns
  s_waitcnt lgkmcnt(15)
  v_mfma_f32_16x16x32_bf16 v[16:19], a[64:67], a[0:3], 0
  s_add_u32 m0, s79, 49152
  s_waitcnt lgkmcnt(14)
  v_mfma_f32_16x16x32_bf16 v[16:19], a[80:83], a[32:35], v[16:19]
  buffer_load_dwordx4 v1, s[44:47], s69 offen lds
  s_add_u32 s69, s69, s71
  v_mfma_f32_16x16x32_bf16 v[20:23], a[68:71], a[0:3], 0
  v_mfma_f32_16x16x32_bf16 v[20:23], a[84:87], a[32:35], v[20:23]
  v_mfma_f32_16x16x32_bf16 v[80:83], a[72:75], a[0:3], 0
  s_add_u32 m0, s79, 50176
  v_mfma_f32_16x16x32_bf16 v[80:83], a[88:91], a[32:35], v[80:83]
  buffer_load_dwordx4 v2, s[44:47], s69 offen lds
  s_add_u32 s69, s69, s71
  v_mfma_f32_16x16x32_bf16 v[84:87], a[76:79], a[0:3], 0
  v_mfma_f32_16x16x32_bf16 v[84:87], a[92:95], a[32:35], v[84:87]
  s_waitcnt vmcnt(15) lgkmcnt(0)
  s_barrier
  v_mfma_f32_16x16x32_bf16 v[92:95], a[76:79], a[4:7], 0
  v_mov_b32 v152, 0
  v_dot2c_f32_bf16 v152, v128, v140
  v_mfma_f32_16x16x32_bf16 v[92:95], a[92:95], a[36:39], v[92:95]
  ds_read_b128 a[96:99], v7 offset:32768
  v_dot2c_f32_bf16 v152, v129, v141
  v_mfma_f32_16x16x32_bf16 v[88:91], a[72:75], a[4:7], 0
  s_add_u32 m0, s79, 51200
  v_dot2c_f32_bf16 v152, v130, v142
  v_mfma_f32_16x16x32_bf16 v[88:91], a[88:91], a[36:39], v[88:91]
  buffer_load_dwordx4 v1, s[44:47], s69 offen lds
  s_add_u32 s69, s69, s71
  v_mfma_f32_16x16x32_bf16 v[28:31], a[68:71], a[4:7], 0
  s_add_u32 m0, s79, 52224
  v_dot2c_f32_bf16 v152, v131, v143
  v_mfma_f32_16x16x32_bf16 v[28:31], a[84:87], a[36:39], v[28:31]
  buffer_load_dwordx4 v2, s[44:47], s69 offen lds
  s_add_u32 s69, s69, s73
  v_mfma_f32_16x16x32_bf16 v[24:27], a[64:67], a[4:7], 0
  ds_read_b128 a[100:103], v7 offset:34816
  v_dot2c_f32_bf16 v152, v132, v144
  v_mfma_f32_16x16x32_bf16 v[24:27], a[80:83], a[36:39], v[24:27]
  v_dot2c_f32_bf16 v152, v133, v145
  v_dot2c_f32_bf16 v152, v134, v146
  v_mfma_f32_16x16x32_bf16 v[32:35], a[64:67], a[8:11], 0
  v_dot2c_f32_bf16 v152, v135, v147
  v_dot2c_f32_bf16 v152, v136, v148
  v_mfma_f32_16x16x32_bf16 v[32:35], a[80:83], a[40:43], v[32:35]
  ds_read_b128 a[104:107], v7 offset:36864
  v_dot2c_f32_bf16 v152, v137, v149
  v_mfma_f32_16x16x32_bf16 v[36:39], a[68:71], a[8:11], 0
  s_nop 2
  v_add_f32_dpp v152, v152, v152 row_ror:8 row_mask:0xf bank_mask:0xf
  v_mfma_f32_16x16x32_bf16 v[36:39], a[84:87], a[40:43], v[36:39]
  ds_read_b128 a[108:111], v7 offset:38912
  s_nop 1
  v_mfma_f32_16x16x32_bf16 v[96:99], a[72:75], a[8:11], 0
  s_add_u32 m0, s79, 0
  v_add_f32_dpp v152, v152, v152 row_ror:4 row_mask:0xf bank_mask:0xf
  v_mfma_f32_16x16x32_bf16 v[96:99], a[88:91], a[40:43], v[96:99]
  buffer_load_dwordx4 v1, s[44:47], s69 offen lds
  s_nop 1
  v_mfma_f32_16x16x32_bf16 v[100:103], a[76:79], a[8:11], 0
  s_add_u32 s69, s69, s71
  v_add_f32_dpp v152, v152, v152 row_ror:2 row_mask:0xf bank_mask:0xf
  v_mfma_f32_16x16x32_bf16 v[100:103], a[92:95], a[40:43], v[100:103]
  ds_read_b128 a[112:115], v8 offset:32768
  s_nop 1
  v_mfma_f32_16x16x32_bf16 v[108:111], a[76:79], a[12:15], 0
  v_add_f32_dpp v152, v152, v152 row_ror:1 row_mask:0xf bank_mask:0xf
  s_nop 1
  v_mfma_f32_16x16x32_bf16 v[108:111], a[92:95], a[44:47], v[108:111]
  ds_read_b128 a[116:119], v8 offset:34816
  v_mov_b32 v153, v152
  v_mfma_f32_16x16x32_bf16 v[104:107], a[72:75], a[12:15], 0
  s_add_u32 m0, s80, 0
  s_nop 1
  v_mfma_f32_16x16x32_bf16 v[104:107], a[88:91], a[44:47], v[104:107]
  buffer_load_dwordx4 v3, s[48:51], s70 offen lds
  v_permlane16_swap_b32 v152, v153
  v_mfma_f32_16x16x32_bf16 v[44:47], a[68:71], a[12:15], 0
  ds_read_b128 a[120:123], v8 offset:36864
  v_add_f32 v152, v152, v153
  v_mfma_f32_16x16x32_bf16 v[44:47], a[84:87], a[44:47], v[44:47]
  v_mul_f32 v152, s5, v152
  v_mfma_f32_16x16x32_bf16 v[40:43], a[64:67], a[12:15], 0
  v_exp_f32 v152, v152
  v_mfma_f32_16x16x32_bf16 v[40:43], a[80:83], a[44:47], v[40:43]
  ds_read_b128 a[124:127], v8 offset:38912
  s_nop 0
  v_mfma_f32_16x16x32_bf16 v[48:51], a[64:67], a[16:19], 0
  s_add_u32 m0, s80, 4224
  v_add_f32 v152, 1.0, v152
  v_mfma_f32_16x16x32_bf16 v[48:51], a[80:83], a[48:51], v[48:51]
  buffer_load_dwordx4 v3, s[52:55], s70 offen lds
  v_mfma_f32_16x16x32_bf16 v[52:55], a[68:71], a[16:19], 0
  s_add_u32 s70, s70, s74
  v_mfma_f32_16x16x32_bf16 v[52:55], a[84:87], a[48:51], v[52:55]
  v_rcp_f32 v152, v152
  v_mfma_f32_16x16x32_bf16 v[112:115], a[72:75], a[16:19], 0
  buffer_store_dword v152, v154, s[32:35], s3 offen sc1
  s_mov_b32 s3, 0
  v_mfma_f32_16x16x32_bf16 v[112:115], a[88:91], a[48:51], v[112:115]
  v_mfma_f32_16x16x32_bf16 v[116:119], a[76:79], a[16:19], 0
  v_mfma_f32_16x16x32_bf16 v[116:119], a[92:95], a[48:51], v[116:119]
  v_mfma_f32_16x16x32_bf16 v[124:127], a[76:79], a[20:23], 0
  s_add_u32 m0, s79, 1024
  v_mfma_f32_16x16x32_bf16 v[124:127], a[92:95], a[52:55], v[124:127]
  buffer_load_dwordx4 v2, s[44:47], s69 offen lds
  v_mfma_f32_16x16x32_bf16 v[120:123], a[72:75], a[20:23], 0
  s_add_u32 s69, s69, s71
  v_mfma_f32_16x16x32_bf16 v[120:123], a[88:91], a[52:55], v[120:123]
  v_mfma_f32_16x16x32_bf16 v[60:63], a[68:71], a[20:23], 0
  v_mfma_f32_16x16x32_bf16 v[60:63], a[84:87], a[52:55], v[60:63]
  v_mfma_f32_16x16x32_bf16 v[56:59], a[64:67], a[20:23], 0
  s_add_u32 m0, s80, 1056
  v_mfma_f32_16x16x32_bf16 v[56:59], a[80:83], a[52:55], v[56:59]
  buffer_load_dwordx4 v3, s[48:51], s70 offen lds
  v_mfma_f32_16x16x32_bf16 v[64:67], a[64:67], a[24:27], 0
  v_mfma_f32_16x16x32_bf16 v[64:67], a[80:83], a[56:59], v[64:67]
  v_mfma_f32_16x16x32_bf16 v[68:71], a[68:71], a[24:27], 0
  v_mfma_f32_16x16x32_bf16 v[68:71], a[84:87], a[56:59], v[68:71]
  v_mfma_f32_16x16x32_bf16 a[128:131], a[72:75], a[24:27], 0
  s_add_u32 m0, s80, 5280
  v_mfma_f32_16x16x32_bf16 a[128:131], a[88:91], a[56:59], a[128:131]
  buffer_load_dwordx4 v3, s[52:55], s70 offen lds
  v_mfma_f32_16x16x32_bf16 a[132:135], a[76:79], a[24:27], 0
  s_add_u32 s70, s70, s74
  v_mfma_f32_16x16x32_bf16 a[132:135], a[92:95], a[56:59], a[132:135]
  v_mfma_f32_16x16x32_bf16 a[140:143], a[76:79], a[28:31], 0
  v_mfma_f32_16x16x32_bf16 a[140:143], a[92:95], a[60:63], a[140:143]
  v_mfma_f32_16x16x32_bf16 a[136:139], a[72:75], a[28:31], 0
  v_mfma_f32_16x16x32_bf16 a[136:139], a[88:91], a[60:63], a[136:139]
  v_mfma_f32_16x16x32_bf16 v[76:79], a[68:71], a[28:31], 0
  s_add_u32 m0, s79, 2048
  v_mfma_f32_16x16x32_bf16 v[76:79], a[84:87], a[60:63], v[76:79]
  buffer_load_dwordx4 v1, s[44:47], s69 offen lds
  v_mfma_f32_16x16x32_bf16 v[72:75], a[64:67], a[28:31], 0
  s_add_u32 s69, s69, s71
  v_mfma_f32_16x16x32_bf16 v[72:75], a[80:83], a[60:63], v[72:75]
  s_waitcnt vmcnt(13) lgkmcnt(0)
  s_barrier
  v_mfma_f32_16x16x32_bf16 v[128:131], a[96:99], a[0:3], 0
  v_mfma_f32_16x16x32_bf16 v[128:131], a[112:115], a[32:35], v[128:131]
  ds_read_b128 a[64:67], v7 offset:16384
  v_mfma_f32_16x16x32_bf16 v[132:135], a[100:103], a[0:3], 0
  s_add_u32 m0, s80, 2112
  v_mfma_f32_16x16x32_bf16 v[132:135], a[116:119], a[32:35], v[132:135]
  buffer_load_dwordx4 v3, s[48:51], s70 offen lds
  v_mfma_f32_16x16x32_bf16 v[192:195], a[104:107], a[0:3], 0
  ds_read_b128 a[68:71], v7 offset:18432
  v_mfma_f32_16x16x32_bf16 v[192:195], a[120:123], a[32:35], v[192:195]
  ds_read_b128 a[72:75], v7 offset:20480
  v_mfma_f32_16x16x32_bf16 v[196:199], a[108:111], a[0:3], 0
  v_mfma_f32_16x16x32_bf16 v[196:199], a[124:127], a[32:35], v[196:199]
  ds_read_b64_tr_b16 a[0:1], v9 offset:50688
  v_mfma_f32_16x16x32_bf16 v[204:207], a[108:111], a[4:7], 0
  s_add_u32 m0, s80, 6336
  v_mfma_f32_16x16x32_bf16 v[204:207], a[124:127], a[36:39], v[204:207]
  buffer_load_dwordx4 v3, s[52:55], s70 offen lds
  v_mfma_f32_16x16x32_bf16 v[200:203], a[104:107], a[4:7], 0
  s_add_u32 s70, s70, s74
  v_mfma_f32_16x16x32_bf16 v[200:203], a[120:123], a[36:39], v[200:203]
  ds_read_b64_tr_b16 a[2:3], v9 offset:50944
  v_mfma_f32_16x16x32_bf16 v[140:143], a[100:103], a[4:7], 0
  ds_read_b128 a[76:79], v7 offset:22528
  v_mfma_f32_16x16x32_bf16 v[140:143], a[116:119], a[36:39], v[140:143]
  ds_read_b64_tr_b16 a[32:33], v9 offset:59136
  v_mfma_f32_16x16x32_bf16 v[136:139], a[96:99], a[4:7], 0
  ds_read_b64_tr_b16 a[34:35], v9 offset:59392
  v_mfma_f32_16x16x32_bf16 v[136:139], a[112:115], a[36:39], v[136:139]
  ds_read_b64_tr_b16 a[4:5], v9 offset:50720
  v_mfma_f32_16x16x32_bf16 v[144:147], a[96:99], a[8:11], 0
  s_add_u32 m0, s79, 3072
  v_mfma_f32_16x16x32_bf16 v[144:147], a[112:115], a[40:43], v[144:147]
  buffer_load_dwordx4 v2, s[44:47], s69 offen lds
  v_mfma_f32_16x16x32_bf16 v[148:151], a[100:103], a[8:11], 0
  s_add_u32 s69, s69, s72
  v_mfma_f32_16x16x32_bf16 v[148:151], a[116:119], a[40:43], v[148:151]
  ds_read_b64_tr_b16 a[6:7], v9 offset:50976
  v_mfma_f32_16x16x32_bf16 v[208:211], a[104:107], a[8:11], 0
  ds_read_b128 a[80:83], v8 offset:16384
  v_mfma_f32_16x16x32_bf16 v[208:211], a[120:123], a[40:43], v[208:211]
  ds_read_b64_tr_b16 a[36:37], v9 offset:59168
  v_mfma_f32_16x16x32_bf16 v[212:215], a[108:111], a[8:11], 0
  s_add_u32 m0, s80, 3168
  v_mfma_f32_16x16x32_bf16 v[212:215], a[124:127], a[40:43], v[212:215]
  buffer_load_dwordx4 v3, s[48:51], s70 offen lds
  v_mfma_f32_16x16x32_bf16 v[220:223], a[108:111], a[12:15], 0
  ds_read_b64_tr_b16 a[38:39], v9 offset:59424
  v_mfma_f32_16x16x32_bf16 v[220:223], a[124:127], a[44:47], v[220:223]
  ds_read_b64_tr_b16 a[8:9], v9 offset:54912
  v_mfma_f32_16x16x32_bf16 v[216:219], a[104:107], a[12:15], 0
  ds_read_b64_tr_b16 a[10:11], v9 offset:55168
  v_mfma_f32_16x16x32_bf16 v[216:219], a[120:123], a[44:47], v[216:219]
  ds_read_b128 a[84:87], v8 offset:18432
  v_mfma_f32_16x16x32_bf16 v[156:159], a[100:103], a[12:15], 0
  s_add_u32 m0, s80, 7392
  v_mfma_f32_16x16x32_bf16 v[156:159], a[116:119], a[44:47], v[156:159]
  buffer_load_dwordx4 v3, s[52:55], s70 offen lds
  v_mfma_f32_16x16x32_bf16 v[152:155], a[96:99], a[12:15], 0
  s_add_u32 s70, s70, s75
  v_mfma_f32_16x16x32_bf16 v[152:155], a[112:115], a[44:47], v[152:155]
  ds_read_b64_tr_b16 a[40:41], v9 offset:63360
  v_mfma_f32_16x16x32_bf16 v[160:163], a[96:99], a[16:19], 0
  ds_read_b64_tr_b16 a[42:43], v9 offset:63616
  v_mfma_f32_16x16x32_bf16 v[160:163], a[112:115], a[48:51], v[160:163]
  ds_read_b64_tr_b16 a[12:13], v9 offset:54944
  v_mfma_f32_16x16x32_bf16 v[164:167], a[100:103], a[16:19], 0
  ds_read_b64_tr_b16 a[14:15], v9 offset:55200
  v_mfma_f32_16x16x32_bf16 v[164:167], a[116:119], a[48:51], v[164:167]
  ds_read_b128 a[88:91], v8 offset:20480
  v_mfma_f32_16x16x32_bf16 v[224:227], a[104:107], a[16:19], 0
  s_add_u32 m0, s79, 32768
  v_mfma_f32_16x16x32_bf16 v[224:227], a[120:123], a[48:51], v[224:227]
  buffer_load_dwordx4 v1, s[44:47], s69 offen lds
  v_mfma_f32_16x16x32_bf16 v[228:231], a[108:111], a[16:19], 0
  s_add_u32 s69, s69, s71
  v_mfma_f32_16x16x32_bf16 v[228:231], a[124:127], a[48:51], v[228:231]
  ds_read_b64_tr_b16 a[44:45], v9 offset:63392
  v_mfma_f32_16x16x32_bf16 v[236:239], a[108:111], a[20:23], 0
  ds_read_b64_tr_b16 a[46:47], v9 offset:63648
  v_mfma_f32_16x16x32_bf16 v[236:239], a[124:127], a[52:55], v[236:239]
  ds_read_b64_tr_b16 a[16:17], v9 offset:16896
  v_mfma_f32_16x16x32_bf16 v[232:235], a[104:107], a[20:23], 0
  s_add_u32 m0, s79, 33792
  v_mfma_f32_16x16x32_bf16 v[232:235], a[120:123], a[52:55], v[232:235]
  buffer_load_dwordx4 v2, s[44:47], s69 offen lds
  v_mfma_f32_16x16x32_bf16 v[172:175], a[100:103], a[20:23], 0
  s_add_u32 s69, s69, s71
  v_mfma_f32_16x16x32_bf16 v[172:175], a[116:119], a[52:55], v[172:175]
  ds_read_b64_tr_b16 a[18:19], v9 offset:17152
  v_mfma_f32_16x16x32_bf16 v[168:171], a[96:99], a[20:23], 0
  ds_read_b128 a[92:95], v8 offset:22528
  v_mfma_f32_16x16x32_bf16 v[168:171], a[112:115], a[52:55], v[168:171]
  ds_read_b64_tr_b16 a[48:49], v9 offset:25344
  v_mfma_f32_16x16x32_bf16 v[176:179], a[96:99], a[24:27], 0
  s_add_u32 m0, s79, 34816
  v_mfma_f32_16x16x32_bf16 v[176:179], a[112:115], a[56:59], v[176:179]
  buffer_load_dwordx4 v1, s[44:47], s69 offen lds
  v_mfma_f32_16x16x32_bf16 v[180:183], a[100:103], a[24:27], 0
  s_add_u32 s69, s69, s71
  v_mfma_f32_16x16x32_bf16 v[180:183], a[116:119], a[56:59], v[180:183]
  ds_read_b64_tr_b16 a[50:51], v9 offset:25600
  v_mfma_f32_16x16x32_bf16 v[240:243], a[104:107], a[24:27], 0
  ds_read_b64_tr_b16 a[20:21], v9 offset:16928
  v_mfma_f32_16x16x32_bf16 v[240:243], a[120:123], a[56:59], v[240:243]
  ds_read_b64_tr_b16 a[22:23], v9 offset:17184
  v_mfma_f32_16x16x32_bf16 v[244:247], a[108:111], a[24:27], 0
  ds_read_b64_tr_b16 a[52:53], v9 offset:25376
  v_mfma_f32_16x16x32_bf16 v[244:247], a[124:127], a[56:59], v[244:247]
  ds_read_b64_tr_b16 a[54:55], v9 offset:25632
  v_mfma_f32_16x16x32_bf16 v[252:255], a[108:111], a[28:31], 0
  s_add_u32 m0, s79, 35840
  v_mfma_f32_16x16x32_bf16 v[248:251], a[104:107], a[28:31], 0
  buffer_load_dwordx4 v2, s[44:47], s69 offen lds
  v_mfma_f32_16x16x32_bf16 v[188:191], a[100:103], a[28:31], 0
  s_add_u32 s69, s69, s73
  v_mfma_f32_16x16x32_bf16 v[184:187], a[96:99], a[28:31], 0
  buffer_load_dword v13, v12, s[56:59], s83 offen
  s_add_u32 s83, s83, s84
  v_mfma_f32_16x16x32_bf16 v[184:187], a[112:115], a[60:63], v[184:187]
  ds_read_b64_tr_b16 a[24:25], v9 offset:21120
  v_mfma_f32_16x16x32_bf16 v[188:191], a[116:119], a[60:63], v[188:191]
  ds_read_b64_tr_b16 a[26:27], v9 offset:21376
  v_mfma_f32_16x16x32_bf16 v[248:251], a[120:123], a[60:63], v[248:251]
  ds_read_b64_tr_b16 a[56:57], v9 offset:29568
  v_mfma_f32_16x16x32_bf16 v[252:255], a[124:127], a[60:63], v[252:255]
  ds_read_b64_tr_b16 a[58:59], v9 offset:29824
  ds_read_b64_tr_b16 a[28:29], v9 offset:21152
  ds_read_b64_tr_b16 a[30:31], v9 offset:21408
  ds_read_b64_tr_b16 a[60:61], v9 offset:29600
  ds_read_b64_tr_b16 a[62:63], v9 offset:29856
.p2align 6
L_loop_sw:
  s_waitcnt lgkmcnt(15)
  v_mfma_f32_16x16x32_bf16 v[16:19], a[64:67], a[0:3], v[16:19]
  v_mfma_f32_16x16x32_bf16 v[16:19], a[80:83], a[32:35], v[16:19]
  v_mfma_f32_16x16x32_bf16 v[20:23], a[68:71], a[0:3], v[20:23]
  v_mfma_f32_16x16x32_bf16 v[20:23], a[84:87], a[32:35], v[20:23]
  v_mfma_f32_16x16x32_bf16 v[80:83], a[72:75], a[0:3], v[80:83]
  v_mfma_f32_16x16x32_bf16 v[80:83], a[88:91], a[32:35], v[80:83]
  v_mfma_f32_16x16x32_bf16 v[84:87], a[76:79], a[0:3], v[84:87]
  s_waitcnt lgkmcnt(14)
  v_mfma_f32_16x16x32_bf16 v[84:87], a[92:95], a[32:35], v[84:87]
  s_waitcnt vmcnt(18) lgkmcnt(0)
  s_barrier
  v_mfma_f32_16x16x32_bf16 v[92:95], a[76:79], a[4:7], v[92:95]
  s_add_u32 m0, s79, 16384
  v_mfma_f32_16x16x32_bf16 v[92:95], a[92:95], a[36:39], v[92:95]
  buffer_load_dwordx4 v1, s[44:47], s69 offen lds
  v_mfma_f32_16x16x32_bf16 v[88:91], a[72:75], a[4:7], v[88:91]
  s_add_u32 s69, s69, s71
  v_mfma_f32_16x16x32_bf16 v[88:91], a[88:91], a[36:39], v[88:91]
  ds_read_b128 a[96:99], v7 offset:49152
  v_mfma_f32_16x16x32_bf16 v[28:31], a[68:71], a[4:7], v[28:31]
  v_mfma_f32_16x16x32_bf16 v[28:31], a[84:87], a[36:39], v[28:31]
  ds_read_b128 a[100:103], v7 offset:51200
  v_mfma_f32_16x16x32_bf16 v[24:27], a[64:67], a[4:7], v[24:27]
  v_mfma_f32_16x16x32_bf16 v[24:27], a[80:83], a[36:39], v[24:27]
  ds_read_b128 a[104:107], v7 offset:53248
  v_mfma_f32_16x16x32_bf16 v[32:35], a[64:67], a[8:11], v[32:35]
  s_add_u32 m0, s80, 16896
  v_mfma_f32_16x16x32_bf16 v[32:35], a[80:83], a[40:43], v[32:35]
  buffer_load_dwordx4 v3, s[48:51], s70 offen lds
  v_mfma_f32_16x16x32_bf16 v[36:39], a[68:71], a[8:11], v[36:39]
  ds_read_b128 a[108:111], v7 offset:55296
  v_mfma_f32_16x16x32_bf16 v[36:39], a[84:87], a[40:43], v[36:39]
  v_mfma_f32_16x16x32_bf16 v[96:99], a[72:75], a[8:11], v[96:99]
  v_mfma_f32_16x16x32_bf16 v[96:99], a[88:91], a[40:43], v[96:99]
  ds_read_b128 a[112:115], v8 offset:49152
  v_mfma_f32_16x16x32_bf16 v[100:103], a[76:79], a[8:11], v[100:103]
  s_add_u32 m0, s80, 21120
  v_mfma_f32_16x16x32_bf16 v[100:103], a[92:95], a[40:43], v[100:103]
  buffer_load_dwordx4 v3, s[52:55], s70 offen lds
  v_mfma_f32_16x16x32_bf16 v[108:111], a[76:79], a[12:15], v[108:111]
  s_add_u32 s70, s70, s74
  v_mfma_f32_16x16x32_bf16 v[108:111], a[92:95], a[44:47], v[108:111]
  ds_read_b128 a[116:119], v8 offset:51200
  v_mfma_f32_16x16x32_bf16 v[104:107], a[72:75], a[12:15], v[104:107]
  v_mfma_f32_16x16x32_bf16 v[104:107], a[88:91], a[44:47], v[104:107]
  ds_read_b128 a[120:123], v8 offset:53248
  v_mfma_f32_16x16x32_bf16 v[44:47], a[68:71], a[12:15], v[44:47]
  v_mfma_f32_16x16x32_bf16 v[44:47], a[84:87], a[44:47], v[44:47]
  ds_read_b128 a[124:127], v8 offset:55296
  v_mfma_f32_16x16x32_bf16 v[40:43], a[64:67], a[12:15], v[40:43]
  s_add_u32 m0, s79, 17408
  v_mfma_f32_16x16x32_bf16 v[40:43], a[80:83], a[44:47], v[40:43]
  buffer_load_dwordx4 v2, s[44:47], s69 offen lds
  v_mfma_f32_16x16x32_bf16 v[48:51], a[64:67], a[16:19], v[48:51]
  s_add_u32 s69, s69, s71
  v_mfma_f32_16x16x32_bf16 v[48:51], a[80:83], a[48:51], v[48:51]
  v_mfma_f32_16x16x32_bf16 v[52:55], a[68:71], a[16:19], v[52:55]
  v_mfma_f32_16x16x32_bf16 v[52:55], a[84:87], a[48:51], v[52:55]
  v_mfma_f32_16x16x32_bf16 v[112:115], a[72:75], a[16:19], v[112:115]
  v_mfma_f32_16x16x32_bf16 v[112:115], a[88:91], a[48:51], v[112:115]
  v_mfma_f32_16x16x32_bf16 v[116:119], a[76:79], a[16:19], v[116:119]
  s_add_u32 m0, s80, 17952
  v_mfma_f32_16x16x32_bf16 v[116:119], a[92:95], a[48:51], v[116:119]
  buffer_load_dwordx4 v3, s[48:51], s70 offen lds
  v_mfma_f32_16x16x32_bf16 v[124:127], a[76:79], a[20:23], v[124:127]
  v_mfma_f32_16x16x32_bf16 v[124:127], a[92:95], a[52:55], v[124:127]
  v_mfma_f32_16x16x32_bf16 v[120:123], a[72:75], a[20:23], v[120:123]
  v_mfma_f32_16x16x32_bf16 v[120:123], a[88:91], a[52:55], v[120:123]
  v_mfma_f32_16x16x32_bf16 v[60:63], a[68:71], a[20:23], v[60:63]
  v_mfma_f32_16x16x32_bf16 v[60:63], a[84:87], a[52:55], v[60:63]
  v_mfma_f32_16x16x32_bf16 v[56:59], a[64:67], a[20:23], v[56:59]
  s_add_u32 m0, s80, 22176
  v_mfma_f32_16x16x32_bf16 v[56:59], a[80:83], a[52:55], v[56:59]
  buffer_load_dwordx4 v3, s[52:55], s70 offen lds
  v_mfma_f32_16x16x32_bf16 v[64:67], a[64:67], a[24:27], v[64:67]
  s_add_u32 s70, s70, s74
  v_mfma_f32_16x16x32_bf16 v[64:67], a[80:83], a[56:59], v[64:67]
  v_mfma_f32_16x16x32_bf16 v[68:71], a[68:71], a[24:27], v[68:71]
  v_mfma_f32_16x16x32_bf16 v[68:71], a[84:87], a[56:59], v[68:71]
  v_mfma_f32_16x16x32_bf16 a[128:131], a[72:75], a[24:27], a[128:131]
  s_add_u32 m0, s79, 18432
  v_mfma_f32_16x16x32_bf16 a[128:131], a[88:91], a[56:59], a[128:131]
  buffer_load_dwordx4 v1, s[44:47], s69 offen lds
  v_mfma_f32_16x16x32_bf16 a[132:135], a[76:79], a[24:27], a[132:135]
  s_add_u32 s69, s69, s71
  v_mfma_f32_16x16x32_bf16 a[132:135], a[92:95], a[56:59], a[132:135]
  v_mfma_f32_16x16x32_bf16 a[140:143], a[76:79], a[28:31], a[140:143]
  v_mfma_f32_16x16x32_bf16 a[140:143], a[92:95], a[60:63], a[140:143]
  v_mfma_f32_16x16x32_bf16 a[136:139], a[72:75], a[28:31], a[136:139]
  v_mfma_f32_16x16x32_bf16 a[136:139], a[88:91], a[60:63], a[136:139]
  v_mfma_f32_16x16x32_bf16 v[76:79], a[68:71], a[28:31], v[76:79]
  s_add_u32 m0, s80, 19008
  v_mfma_f32_16x16x32_bf16 v[76:79], a[84:87], a[60:63], v[76:79]
  buffer_load_dwordx4 v3, s[48:51], s70 offen lds
  v_mfma_f32_16x16x32_bf16 v[72:75], a[64:67], a[28:31], v[72:75]
  v_mfma_f32_16x16x32_bf16 v[72:75], a[80:83], a[60:63], v[72:75]
  s_waitcnt vmcnt(13) lgkmcnt(0)
  s_barrier
  v_mfma_f32_16x16x32_bf16 v[128:131], a[96:99], a[0:3], v[128:131]
  v_mfma_f32_16x16x32_bf16 v[128:131], a[112:115], a[32:35], v[128:131]
  ds_read_b128 a[64:67], v7 offset:0
  v_mfma_f32_16x16x32_bf16 v[132:135], a[100:103], a[0:3], v[132:135]
  v_mfma_f32_16x16x32_bf16 v[132:135], a[116:119], a[32:35], v[132:135]
  ds_read_b128 a[68:71], v7 offset:2048
  v_mfma_f32_16x16x32_bf16 v[192:195], a[104:107], a[0:3], v[192:195]
  s_add_u32 m0, s80, 23232
  v_mfma_f32_16x16x32_bf16 v[192:195], a[120:123], a[32:35], v[192:195]
  buffer_load_dwordx4 v3, s[52:55], s70 offen lds
  v_mfma_f32_16x16x32_bf16 v[196:199], a[108:111], a[0:3], v[196:199]
  s_add_u32 s70, s70, s74
  v_mfma_f32_16x16x32_bf16 v[196:199], a[124:127], a[32:35], v[196:199]
  ds_read_b128 a[72:75], v7 offset:4096
  v_mfma_f32_16x16x32_bf16 v[204:207], a[108:111], a[4:7], v[204:207]
  ds_read_b64_tr_b16 a[0:1], v9 offset:33792
  v_mfma_f32_16x16x32_bf16 v[204:207], a[124:127], a[36:39], v[204:207]
  ds_read_b64_tr_b16 a[2:3], v9 offset:34048
  v_mfma_f32_16x16x32_bf16 v[200:203], a[104:107], a[4:7], v[200:203]
  s_add_u32 m0, s79, 19456
  v_mfma_f32_16x16x32_bf16 v[200:203], a[120:123], a[36:39], v[200:203]
  buffer_load_dwordx4 v2, s[44:47], s69 offen lds
  v_mfma_f32_16x16x32_bf16 v[140:143], a[100:103], a[4:7], v[140:143]
  s_add_u32 s69, s69, s72
  v_mfma_f32_16x16x32_bf16 v[140:143], a[116:119], a[36:39], v[140:143]
  ds_read_b128 a[76:79], v7 offset:6144
  v_mfma_f32_16x16x32_bf16 v[136:139], a[96:99], a[4:7], v[136:139]
  ds_read_b64_tr_b16 a[32:33], v9 offset:42240
  v_mfma_f32_16x16x32_bf16 v[136:139], a[112:115], a[36:39], v[136:139]
  ds_read_b64_tr_b16 a[34:35], v9 offset:42496
  v_mfma_f32_16x16x32_bf16 v[144:147], a[96:99], a[8:11], v[144:147]
  ds_read_b64_tr_b16 a[4:5], v9 offset:33824
  v_mfma_f32_16x16x32_bf16 v[144:147], a[112:115], a[40:43], v[144:147]
  ds_read_b64_tr_b16 a[6:7], v9 offset:34080
  v_mfma_f32_16x16x32_bf16 v[148:151], a[100:103], a[8:11], v[148:151]
  s_add_u32 m0, s80, 20064
  v_mfma_f32_16x16x32_bf16 v[148:151], a[116:119], a[40:43], v[148:151]
  buffer_load_dwordx4 v3, s[48:51], s70 offen lds
  v_mfma_f32_16x16x32_bf16 v[208:211], a[104:107], a[8:11], v[208:211]
  ds_read_b128 a[80:83], v8 offset:0
  v_mfma_f32_16x16x32_bf16 v[208:211], a[120:123], a[40:43], v[208:211]
  ds_read_b64_tr_b16 a[36:37], v9 offset:42272
  v_mfma_f32_16x16x32_bf16 v[212:215], a[108:111], a[8:11], v[212:215]
  ds_read_b64_tr_b16 a[38:39], v9 offset:42528
  v_mfma_f32_16x16x32_bf16 v[212:215], a[124:127], a[40:43], v[212:215]
  ds_read_b64_tr_b16 a[8:9], v9 offset:38016
  v_mfma_f32_16x16x32_bf16 v[220:223], a[108:111], a[12:15], v[220:223]
  v_mfma_f32_16x16x32_bf16 v[220:223], a[124:127], a[44:47], v[220:223]
  ds_read_b64_tr_b16 a[10:11], v9 offset:38272
  v_mfma_f32_16x16x32_bf16 v[216:219], a[104:107], a[12:15], v[216:219]
  s_add_u32 m0, s80, 24288
  v_mfma_f32_16x16x32_bf16 v[216:219], a[120:123], a[44:47], v[216:219]
  buffer_load_dwordx4 v3, s[52:55], s70 offen lds
  v_mfma_f32_16x16x32_bf16 v[156:159], a[100:103], a[12:15], v[156:159]
  s_add_u32 s70, s70, s75
  v_mfma_f32_16x16x32_bf16 v[156:159], a[116:119], a[44:47], v[156:159]
  ds_read_b128 a[84:87], v8 offset:2048
  v_mfma_f32_16x16x32_bf16 v[152:155], a[96:99], a[12:15], v[152:155]
  ds_read_b64_tr_b16 a[40:41], v9 offset:46464
  v_mfma_f32_16x16x32_bf16 v[152:155], a[112:115], a[44:47], v[152:155]
  ds_read_b64_tr_b16 a[42:43], v9 offset:46720
  v_mfma_f32_16x16x32_bf16 v[160:163], a[96:99], a[16:19], v[160:163]
  s_add_u32 m0, s79, 49152
  v_mfma_f32_16x16x32_bf16 v[160:163], a[112:115], a[48:51], v[160:163]
  buffer_load_dwordx4 v1, s[44:47], s69 offen lds
  v_mfma_f32_16x16x32_bf16 v[164:167], a[100:103], a[16:19], v[164:167]
  s_add_u32 s69, s69, s71
  v_mfma_f32_16x16x32_bf16 v[164:167], a[116:119], a[48:51], v[164:167]
  ds_read_b64_tr_b16 a[12:13], v9 offset:38048
  v_mfma_f32_16x16x32_bf16 v[224:227], a[104:107], a[16:19], v[224:227]
  ds_read_b64_tr_b16 a[14:15], v9 offset:38304
  v_mfma_f32_16x16x32_bf16 v[224:227], a[120:123], a[48:51], v[224:227]
  ds_read_b128 a[88:91], v8 offset:4096
  v_mfma_f32_16x16x32_bf16 v[228:231], a[108:111], a[16:19], v[228:231]
  ds_read_b64_tr_b16 a[44:45], v9 offset:46496
  v_mfma_f32_16x16x32_bf16 v[228:231], a[124:127], a[48:51], v[228:231]
  ds_read_b64_tr_b16 a[46:47], v9 offset:46752
  v_mfma_f32_16x16x32_bf16 v[236:239], a[108:111], a[20:23], v[236:239]
  s_add_u32 m0, s79, 50176
  v_mfma_f32_16x16x32_bf16 v[236:239], a[124:127], a[52:55], v[236:239]
  buffer_load_dwordx4 v2, s[44:47], s69 offen lds
  v_mfma_f32_16x16x32_bf16 v[232:235], a[104:107], a[20:23], v[232:235]
  s_add_u32 s69, s69, s71
  v_mfma_f32_16x16x32_bf16 v[232:235], a[120:123], a[52:55], v[232:235]
  ds_read_b64_tr_b16 a[16:17], v9 offset:0
  v_mfma_f32_16x16x32_bf16 v[172:175], a[100:103], a[20:23], v[172:175]
  ds_read_b64_tr_b16 a[18:19], v9 offset:256
  v_mfma_f32_16x16x32_bf16 v[172:175], a[116:119], a[52:55], v[172:175]
  ds_read_b128 a[92:95], v8 offset:6144
  v_mfma_f32_16x16x32_bf16 v[168:171], a[96:99], a[20:23], v[168:171]
  ds_read_b64_tr_b16 a[48:49], v9 offset:8448
  v_mfma_f32_16x16x32_bf16 v[168:171], a[112:115], a[52:55], v[168:171]
  ds_read_b64_tr_b16 a[50:51], v9 offset:8704
  v_mfma_f32_16x16x32_bf16 v[176:179], a[96:99], a[24:27], v[176:179]
  s_add_u32 m0, s79, 51200
  v_mfma_f32_16x16x32_bf16 v[176:179], a[112:115], a[56:59], v[176:179]
  buffer_load_dwordx4 v1, s[44:47], s69 offen lds
  v_mfma_f32_16x16x32_bf16 v[180:183], a[100:103], a[24:27], v[180:183]
  s_add_u32 s69, s69, s71
  v_mfma_f32_16x16x32_bf16 v[180:183], a[116:119], a[56:59], v[180:183]
  ds_read_b64_tr_b16 a[20:21], v9 offset:32
  v_mfma_f32_16x16x32_bf16 v[240:243], a[104:107], a[24:27], v[240:243]
  ds_read_b64_tr_b16 a[22:23], v9 offset:288
  v_mfma_f32_16x16x32_bf16 v[240:243], a[120:123], a[56:59], v[240:243]
  ds_read_b64_tr_b16 a[52:53], v9 offset:8480
  v_mfma_f32_16x16x32_bf16 v[244:247], a[108:111], a[24:27], v[244:247]
  ds_read_b64_tr_b16 a[54:55], v9 offset:8736
  v_mfma_f32_16x16x32_bf16 v[244:247], a[124:127], a[56:59], v[244:247]
  ds_read_b64_tr_b16 a[24:25], v9 offset:4224
  v_mfma_f32_16x16x32_bf16 v[252:255], a[108:111], a[28:31], v[252:255]
  s_add_u32 m0, s79, 52224
  v_mfma_f32_16x16x32_bf16 v[248:251], a[104:107], a[28:31], v[248:251]
  buffer_load_dwordx4 v2, s[44:47], s69 offen lds
  v_mfma_f32_16x16x32_bf16 v[188:191], a[100:103], a[28:31], v[188:191]
  s_add_u32 s69, s69, s73
  v_mfma_f32_16x16x32_bf16 v[184:187], a[96:99], a[28:31], v[184:187]
  buffer_load_dword v13, v12, s[56:59], s83 offen
  s_add_u32 s83, s83, s84
  v_mfma_f32_16x16x32_bf16 v[184:187], a[112:115], a[60:63], v[184:187]
  ds_read_b64_tr_b16 a[26:27], v9 offset:4480
  v_mfma_f32_16x16x32_bf16 v[188:191], a[116:119], a[60:63], v[188:191]
  ds_read_b64_tr_b16 a[56:57], v9 offset:12672
  v_mfma_f32_16x16x32_bf16 v[248:251], a[120:123], a[60:63], v[248:251]
  ds_read_b64_tr_b16 a[58:59], v9 offset:12928
  v_mfma_f32_16x16x32_bf16 v[252:255], a[124:127], a[60:63], v[252:255]
  ds_read_b64_tr_b16 a[28:29], v9 offset:4256
  ds_read_b64_tr_b16 a[30:31], v9 offset:4512
  ds_read_b64_tr_b16 a[60:61], v9 offset:12704
  ds_read_b64_tr_b16 a[62:63], v9 offset:12960
  s_waitcnt lgkmcnt(15)
  v_mfma_f32_16x16x32_bf16 v[16:19], a[64:67], a[0:3], v[16:19]
  v_mfma_f32_16x16x32_bf16 v[16:19], a[80:83], a[32:35], v[16:19]
  v_mfma_f32_16x16x32_bf16 v[20:23], a[68:71], a[0:3], v[20:23]
  v_mfma_f32_16x16x32_bf16 v[20:23], a[84:87], a[32:35], v[20:23]
  v_mfma_f32_16x16x32_bf16 v[80:83], a[72:75], a[0:3], v[80:83]
  v_mfma_f32_16x16x32_bf16 v[80:83], a[88:91], a[32:35], v[80:83]
  v_mfma_f32_16x16x32_bf16 v[84:87], a[76:79], a[0:3], v[84:87]
  s_waitcnt lgkmcnt(14)
  v_mfma_f32_16x16x32_bf16 v[84:87], a[92:95], a[32:35], v[84:87]
  s_waitcnt vmcnt(18) lgkmcnt(0)
  s_barrier
  s_cmp_lg_u32 s81, 0
  s_cbranch_scc1 L_nosw_sw
  s_mov_b32 s44, s60
  s_mov_b32 s48, s63
  s_mov_b32 s52, s66
  s_mov_b32 s45, s61
  s_mov_b32 s49, s64
  s_mov_b32 s53, s67
  s_mov_b32 s46, s62
  s_mov_b32 s50, s65
  s_mov_b32 s54, s68
  s_mov_b32 s69, s76
  s_mov_b32 s70, s77
  s_mov_b32 s71, 10240
  s_mov_b32 s72, 51200
  s_mov_b32 s73, 4294854784
  s_mov_b32 s74, s78
  s_mul_i32 s75, s78, 61
  v_mov_b32 v1, v4
  v_mov_b32 v2, v5
  v_mov_b32 v3, v6
L_nosw_sw:
  v_mfma_f32_16x16x32_bf16 v[92:95], a[76:79], a[4:7], v[92:95]
  s_add_u32 m0, s79, 0
  v_mfma_f32_16x16x32_bf16 v[92:95], a[92:95], a[36:39], v[92:95]
  buffer_load_dwordx4 v1, s[44:47], s69 offen lds
  v_mfma_f32_16x16x32_bf16 v[88:91], a[72:75], a[4:7], v[88:91]
  s_add_u32 s69, s69, s71
  v_mfma_f32_16x16x32_bf16 v[88:91], a[88:91], a[36:39], v[88:91]
  ds_read_b128 a[96:99], v7 offset:32768
  v_mfma_f32_16x16x32_bf16 v[28:31], a[68:71], a[4:7], v[28:31]
  v_mfma_f32_16x16x32_bf16 v[28:31], a[84:87], a[36:39], v[28:31]
  ds_read_b128 a[100:103], v7 offset:34816
  v_mfma_f32_16x16x32_bf16 v[24:27], a[64:67], a[4:7], v[24:27]
  v_mfma_f32_16x16x32_bf16 v[24:27], a[80:83], a[36:39], v[24:27]
  ds_read_b128 a[104:107], v7 offset:36864
  v_mfma_f32_16x16x32_bf16 v[32:35], a[64:67], a[8:11], v[32:35]
  s_add_u32 m0, s80, 0
  v_mfma_f32_16x16x32_bf16 v[32:35], a[80:83], a[40:43], v[32:35]
  buffer_load_dwordx4 v3, s[48:51], s70 offen lds
  v_mfma_f32_16x16x32_bf16 v[36:39], a[68:71], a[8:11], v[36:39]
  ds_read_b128 a[108:111], v7 offset:38912
  v_mfma_f32_16x16x32_bf16 v[36:39], a[84:87], a[40:43], v[36:39]
  v_mfma_f32_16x16x32_bf16 v[96:99], a[72:75], a[8:11], v[96:99]
  v_mfma_f32_16x16x32_bf16 v[96:99], a[88:91], a[40:43], v[96:99]
  ds_read_b128 a[112:115], v8 offset:32768
  v_mfma_f32_16x16x32_bf16 v[100:103], a[76:79], a[8:11], v[100:103]
  s_add_u32 m0, s80, 4224
  v_mfma_f32_16x16x32_bf16 v[100:103], a[92:95], a[40:43], v[100:103]
  buffer_load_dwordx4 v3, s[52:55], s70 offen lds
  v_mfma_f32_16x16x32_bf16 v[108:111], a[76:79], a[12:15], v[108:111]
  s_add_u32 s70, s70, s74
  v_mfma_f32_16x16x32_bf16 v[108:111], a[92:95], a[44:47], v[108:111]
  ds_read_b128 a[116:119], v8 offset:34816
  v_mfma_f32_16x16x32_bf16 v[104:107], a[72:75], a[12:15], v[104:107]
  v_mfma_f32_16x16x32_bf16 v[104:107], a[88:91], a[44:47], v[104:107]
  ds_read_b128 a[120:123], v8 offset:36864
  v_mfma_f32_16x16x32_bf16 v[44:47], a[68:71], a[12:15], v[44:47]
  v_mfma_f32_16x16x32_bf16 v[44:47], a[84:87], a[44:47], v[44:47]
  ds_read_b128 a[124:127], v8 offset:38912
  v_mfma_f32_16x16x32_bf16 v[40:43], a[64:67], a[12:15], v[40:43]
  s_add_u32 m0, s79, 1024
  v_mfma_f32_16x16x32_bf16 v[40:43], a[80:83], a[44:47], v[40:43]
  buffer_load_dwordx4 v2, s[44:47], s69 offen lds
  v_mfma_f32_16x16x32_bf16 v[48:51], a[64:67], a[16:19], v[48:51]
  s_add_u32 s69, s69, s71
  v_mfma_f32_16x16x32_bf16 v[48:51], a[80:83], a[48:51], v[48:51]
  v_mfma_f32_16x16x32_bf16 v[52:55], a[68:71], a[16:19], v[52:55]
  v_mfma_f32_16x16x32_bf16 v[52:55], a[84:87], a[48:51], v[52:55]
  v_mfma_f32_16x16x32_bf16 v[112:115], a[72:75], a[16:19], v[112:115]
  v_mfma_f32_16x16x32_bf16 v[112:115], a[88:91], a[48:51], v[112:115]
  v_mfma_f32_16x16x32_bf16 v[116:119], a[76:79], a[16:19], v[116:119]
  s_add_u32 m0, s80, 1056
  v_mfma_f32_16x16x32_bf16 v[116:119], a[92:95], a[48:51], v[116:119]
  buffer_load_dwordx4 v3, s[48:51], s70 offen lds
  v_mfma_f32_16x16x32_bf16 v[124:127], a[76:79], a[20:23], v[124:127]
  v_mfma_f32_16x16x32_bf16 v[124:127], a[92:95], a[52:55], v[124:127]
  v_mfma_f32_16x16x32_bf16 v[120:123], a[72:75], a[20:23], v[120:123]
  v_mfma_f32_16x16x32_bf16 v[120:123], a[88:91], a[52:55], v[120:123]
  v_mfma_f32_16x16x32_bf16 v[60:63], a[68:71], a[20:23], v[60:63]
  v_mfma_f32_16x16x32_bf16 v[60:63], a[84:87], a[52:55], v[60:63]
  v_mfma_f32_16x16x32_bf16 v[56:59], a[64:67], a[20:23], v[56:59]
  s_add_u32 m0, s80, 5280
  v_mfma_f32_16x16x32_bf16 v[56:59], a[80:83], a[52:55], v[56:59]
  buffer_load_dwordx4 v3, s[52:55], s70 offen lds
  v_mfma_f32_16x16x32_bf16 v[64:67], a[64:67], a[24:27], v[64:67]
  s_add_u32 s70, s70, s74
  v_mfma_f32_16x16x32_bf16 v[64:67], a[80:83], a[56:59], v[64:67]
  v_mfma_f32_16x16x32_bf16 v[68:71], a[68:71], a[24:27], v[68:71]
  v_mfma_f32_16x16x32_bf16 v[68:71], a[84:87], a[56:59], v[68:71]
  v_mfma_f32_16x16x32_bf16 a[128:131], a[72:75], a[24:27], a[128:131]
  s_add_u32 m0, s79, 2048
  v_mfma_f32_16x16x32_bf16 a[128:131], a[88:91], a[56:59], a[128:131]
  buffer_load_dwordx4 v1, s[44:47], s69 offen lds
  v_mfma_f32_16x16x32_bf16 a[132:135], a[76:79], a[24:27], a[132:135]
  s_add_u32 s69, s69, s71
  v_mfma_f32_16x16x32_bf16 a[132:135], a[92:95], a[56:59], a[132:135]
  v_mfma_f32_16x16x32_bf16 a[140:143], a[76:79], a[28:31], a[140:143]
  v_mfma_f32_16x16x32_bf16 a[140:143], a[92:95], a[60:63], a[140:143]
  v_mfma_f32_16x16x32_bf16 a[136:139], a[72:75], a[28:31], a[136:139]
  v_mfma_f32_16x16x32_bf16 a[136:139], a[88:91], a[60:63], a[136:139]
  v_mfma_f32_16x16x32_bf16 v[76:79], a[68:71], a[28:31], v[76:79]
  s_add_u32 m0, s80, 2112
  v_mfma_f32_16x16x32_bf16 v[76:79], a[84:87], a[60:63], v[76:79]
  buffer_load_dwordx4 v3, s[48:51], s70 offen lds
  v_mfma_f32_16x16x32_bf16 v[72:75], a[64:67], a[28:31], v[72:75]
  v_mfma_f32_16x16x32_bf16 v[72:75], a[80:83], a[60:63], v[72:75]
  s_waitcnt vmcnt(13) lgkmcnt(0)
  s_barrier
  v_mfma_f32_16x16x32_bf16 v[128:131], a[96:99], a[0:3], v[128:131]
  v_mfma_f32_16x16x32_bf16 v[128:131], a[112:115], a[32:35], v[128:131]
  ds_read_b128 a[64:67], v7 offset:16384
  v_mfma_f32_16x16x32_bf16 v[132:135], a[100:103], a[0:3], v[132:135]
  v_mfma_f32_16x16x32_bf16 v[132:135], a[116:119], a[32:35], v[132:135]
  ds_read_b128 a[68:71], v7 offset:18432
  v_mfma_f32_16x16x32_bf16 v[192:195], a[104:107], a[0:3], v[192:195]
  s_add_u32 m0, s80, 6336
  v_mfma_f32_16x16x32_bf16 v[192:195], a[120:123], a[32:35], v[192:195]
  buffer_load_dwordx4 v3, s[52:55], s70 offen lds
  v_mfma_f32_16x16x32_bf16 v[196:199], a[108:111], a[0:3], v[196:199]
  s_add_u32 s70, s70, s74
  v_mfma_f32_16x16x32_bf16 v[196:199], a[124:127], a[32:35], v[196:199]
  ds_read_b128 a[72:75], v7 offset:20480
  v_mfma_f32_16x16x32_bf16 v[204:207], a[108:111], a[4:7], v[204:207]
  ds_read_b64_tr_b16 a[0:1], v9 offset:50688
  v_mfma_f32_16x16x32_bf16 v[204:207], a[124:127], a[36:39], v[204:207]
  ds_read_b64_tr_b16 a[2:3], v9 offset:50944
  v_mfma_f32_16x16x32_bf16 v[200:203], a[104:107], a[4:7], v[200:203]
  s_add_u32 m0, s79, 3072
  v_mfma_f32_16x16x32_bf16 v[200:203], a[120:123], a[36:39], v[200:203]
  buffer_load_dwordx4 v2, s[44:47], s69 offen lds
  v_mfma_f32_16x16x32_bf16 v[140:143], a[100:103], a[4:7], v[140:143]
  s_add_u32 s69, s69, s72
  v_mfma_f32_16x16x32_bf16 v[140:143], a[116:119], a[36:39], v[140:143]
  ds_read_b128 a[76:79], v7 offset:22528
  v_mfma_f32_16x16x32_bf16 v[136:139], a[96:99], a[4:7], v[136:139]
  ds_read_b64_tr_b16 a[32:33], v9 offset:59136
  v_mfma_f32_16x16x32_bf16 v[136:139], a[112:115], a[36:39], v[136:139]
  ds_read_b64_tr_b16 a[34:35], v9 offset:59392
  v_mfma_f32_16x16x32_bf16 v[144:147], a[96:99], a[8:11], v[144:147]
  ds_read_b64_tr_b16 a[4:5], v9 offset:50720
  v_mfma_f32_16x16x32_bf16 v[144:147], a[112:115], a[40:43], v[144:147]
  ds_read_b64_tr_b16 a[6:7], v9 offset:50976
  v_mfma_f32_16x16x32_bf16 v[148:151], a[100:103], a[8:11], v[148:151]
  s_add_u32 m0, s80, 3168
  v_mfma_f32_16x16x32_bf16 v[148:151], a[116:119], a[40:43], v[148:151]
  buffer_load_dwordx4 v3, s[48:51], s70 offen lds
  v_mfma_f32_16x16x32_bf16 v[208:211], a[104:107], a[8:11], v[208:211]
  ds_read_b128 a[80:83], v8 offset:16384
  v_mfma_f32_16x16x32_bf16 v[208:211], a[120:123], a[40:43], v[208:211]
  ds_read_b64_tr_b16 a[36:37], v9 offset:59168
  v_mfma_f32_16x16x32_bf16 v[212:215], a[108:111], a[8:11], v[212:215]
  ds_read_b64_tr_b16 a[38:39], v9 offset:59424
  v_mfma_f32_16x16x32_bf16 v[212:215], a[124:127], a[40:43], v[212:215]
  ds_read_b64_tr_b16 a[8:9], v9 offset:54912
  v_mfma_f32_16x16x32_bf16 v[220:223], a[108:111], a[12:15], v[220:223]
  v_mfma_f32_16x16x32_bf16 v[220:223], a[124:127], a[44:47], v[220:223]
  ds_read_b64_tr_b16 a[10:11], v9 offset:55168
  v_mfma_f32_16x16x32_bf16 v[216:219], a[104:107], a[12:15], v[216:219]
  s_add_u32 m0, s80, 7392
  v_mfma_f32_16x16x32_bf16 v[216:219], a[120:123], a[44:47], v[216:219]
  buffer_load_dwordx4 v3, s[52:55], s70 offen lds
  v_mfma_f32_16x16x32_bf16 v[156:159], a[100:103], a[12:15], v[156:159]
  s_add_u32 s70, s70, s75
  v_mfma_f32_16x16x32_bf16 v[156:159], a[116:119], a[44:47], v[156:159]
  ds_read_b128 a[84:87], v8 offset:18432
  v_mfma_f32_16x16x32_bf16 v[152:155], a[96:99], a[12:15], v[152:155]
  ds_read_b64_tr_b16 a[40:41], v9 offset:63360
  v_mfma_f32_16x16x32_bf16 v[152:155], a[112:115], a[44:47], v[152:155]
  ds_read_b64_tr_b16 a[42:43], v9 offset:63616
  v_mfma_f32_16x16x32_bf16 v[160:163], a[96:99], a[16:19], v[160:163]
  s_add_u32 m0, s79, 32768
  v_mfma_f32_16x16x32_bf16 v[160:163], a[112:115], a[48:51], v[160:163]
  buffer_load_dwordx4 v1, s[44:47], s69 offen lds
  v_mfma_f32_16x16x32_bf16 v[164:167], a[100:103], a[16:19], v[164:167]
  s_add_u32 s69, s69, s71
  v_mfma_f32_16x16x32_bf16 v[164:167], a[116:119], a[48:51], v[164:167]
  ds_read_b64_tr_b16 a[12:13], v9 offset:54944
  v_mfma_f32_16x16x32_bf16 v[224:227], a[104:107], a[16:19], v[224:227]
  ds_read_b64_tr_b16 a[14:15], v9 offset:55200
  v_mfma_f32_16x16x32_bf16 v[224:227], a[120:123], a[48:51], v[224:227]
  ds_read_b128 a[88:91], v8 offset:20480
  v_mfma_f32_16x16x32_bf16 v[228:231], a[108:111], a[16:19], v[228:231]
  ds_read_b64_tr_b16 a[44:45], v9 offset:63392
  v_mfma_f32_16x16x32_bf16 v[228:231], a[124:127], a[48:51], v[228:231]
  ds_read_b64_tr_b16 a[46:47], v9 offset:63648
  v_mfma_f32_16x16x32_bf16 v[236:239], a[108:111], a[20:23], v[236:239]
  s_add_u32 m0, s79, 33792
  v_mfma_f32_16x16x32_bf16 v[236:239], a[124:127], a[52:55], v[236:239]
  buffer_load_dwordx4 v2, s[44:47], s69 offen lds
  v_mfma_f32_16x16x32_bf16 v[232:235], a[104:107], a[20:23], v[232:235]
  s_add_u32 s69, s69, s71
  v_mfma_f32_16x16x32_bf16 v[232:235], a[120:123], a[52:55], v[232:235]
  ds_read_b64_tr_b16 a[16:17], v9 offset:16896
  v_mfma_f32_16x16x32_bf16 v[172:175], a[100:103], a[20:23], v[172:175]
  ds_read_b64_tr_b16 a[18:19], v9 offset:17152
  v_mfma_f32_16x16x32_bf16 v[172:175], a[116:119], a[52:55], v[172:175]
  ds_read_b128 a[92:95], v8 offset:22528
  v_mfma_f32_16x16x32_bf16 v[168:171], a[96:99], a[20:23], v[168:171]
  ds_read_b64_tr_b16 a[48:49], v9 offset:25344
  v_mfma_f32_16x16x32_bf16 v[168:171], a[112:115], a[52:55], v[168:171]
  ds_read_b64_tr_b16 a[50:51], v9 offset:25600
  v_mfma_f32_16x16x32_bf16 v[176:179], a[96:99], a[24:27], v[176:179]
  s_add_u32 m0, s79, 34816
  v_mfma_f32_16x16x32_bf16 v[176:179], a[112:115], a[56:59], v[176:179]
  buffer_load_dwordx4 v1, s[44:47], s69 offen lds
  v_mfma_f32_16x16x32_bf16 v[180:183], a[100:103], a[24:27], v[180:183]
  s_add_u32 s69, s69, s71
  v_mfma_f32_16x16x32_bf16 v[180:183], a[116:119], a[56:59], v[180:183]
  ds_read_b64_tr_b16 a[20:21], v9 offset:16928
  v_mfma_f32_16x16x32_bf16 v[240:243], a[104:107], a[24:27], v[240:243]
  ds_read_b64_tr_b16 a[22:23], v9 offset:17184
  v_mfma_f32_16x16x32_bf16 v[240:243], a[120:123], a[56:59], v[240:243]
  ds_read_b64_tr_b16 a[52:53], v9 offset:25376
  v_mfma_f32_16x16x32_bf16 v[244:247], a[108:111], a[24:27], v[244:247]
  ds_read_b64_tr_b16 a[54:55], v9 offset:25632
  v_mfma_f32_16x16x32_bf16 v[244:247], a[124:127], a[56:59], v[244:247]
  ds_read_b64_tr_b16 a[24:25], v9 offset:21120
  v_mfma_f32_16x16x32_bf16 v[252:255], a[108:111], a[28:31], v[252:255]
  s_add_u32 m0, s79, 35840
  v_mfma_f32_16x16x32_bf16 v[248:251], a[104:107], a[28:31], v[248:251]
  buffer_load_dwordx4 v2, s[44:47], s69 offen lds
  v_mfma_f32_16x16x32_bf16 v[188:191], a[100:103], a[28:31], v[188:191]
  s_add_u32 s69, s69, s73
  v_mfma_f32_16x16x32_bf16 v[184:187], a[96:99], a[28:31], v[184:187]
  buffer_load_dword v13, v12, s[56:59], s83 offen
  s_add_u32 s83, s83, s84
  v_mfma_f32_16x16x32_bf16 v[184:187], a[112:115], a[60:63], v[184:187]
  ds_read_b64_tr_b16 a[26:27], v9 offset:21376
  v_mfma_f32_16x16x32_bf16 v[188:191], a[116:119], a[60:63], v[188:191]
  ds_read_b64_tr_b16 a[56:57], v9 offset:29568
  v_mfma_f32_16x16x32_bf16 v[248:251], a[120:123], a[60:63], v[248:251]
  ds_read_b64_tr_b16 a[58:59], v9 offset:29824
  v_mfma_f32_16x16x32_bf16 v[252:255], a[124:127], a[60:63], v[252:255]
  ds_read_b64_tr_b16 a[28:29], v9 offset:21152
  ds_read_b64_tr_b16 a[30:31], v9 offset:21408
  ds_read_b64_tr_b16 a[60:61], v9 offset:29600
  ds_read_b64_tr_b16 a[62:63], v9 offset:29856
  s_sub_u32 s81, s81, 1
  s_cbranch_scc0 L_loop_sw
  s_waitcnt lgkmcnt(15)
  v_mfma_f32_16x16x32_bf16 v[16:19], a[64:67], a[0:3], v[16:19]
  v_mfma_f32_16x16x32_bf16 v[16:19], a[80:83], a[32:35], v[16:19]
  v_mfma_f32_16x16x32_bf16 v[20:23], a[68:71], a[0:3], v[20:23]
  v_mfma_f32_16x16x32_bf16 v[20:23], a[84:87], a[32:35], v[20:23]
  v_mfma_f32_16x16x32_bf16 v[80:83], a[72:75], a[0:3], v[80:83]
  v_mfma_f32_16x16x32_bf16 v[80:83], a[88:91], a[32:35], v[80:83]
  v_mfma_f32_16x16x32_bf16 v[84:87], a[76:79], a[0:3], v[84:87]
  s_waitcnt lgkmcnt(14)
  v_mfma_f32_16x16x32_bf16 v[84:87], a[92:95], a[32:35], v[84:87]
  s_waitcnt vmcnt(18) lgkmcnt(0)
  s_barrier
  v_mfma_f32_16x16x32_bf16 v[92:95], a[76:79], a[4:7], v[92:95]
  s_add_u32 m0, s79, 16384
  v_mfma_f32_16x16x32_bf16 v[92:95], a[92:95], a[36:39], v[92:95]
  buffer_load_dwordx4 v1, s[44:47], s69 offen lds
  v_mfma_f32_16x16x32_bf16 v[88:91], a[72:75], a[4:7], v[88:91]
  s_add_u32 s69, s69, s71
  v_mfma_f32_16x16x32_bf16 v[88:91], a[88:91], a[36:39], v[88:91]
  ds_read_b128 a[96:99], v7 offset:49152
  v_mfma_f32_16x16x32_bf16 v[28:31], a[68:71], a[4:7], v[28:31]
  v_mfma_f32_16x16x32_bf16 v[28:31], a[84:87], a[36:39], v[28:31]
  ds_read_b128 a[100:103], v7 offset:51200
  v_mfma_f32_16x16x32_bf16 v[24:27], a[64:67], a[4:7], v[24:27]
  v_mfma_f32_16x16x32_bf16 v[24:27], a[80:83], a[36:39], v[24:27]
  ds_read_b128 a[104:107], v7 offset:53248
  v_mfma_f32_16x16x32_bf16 v[32:35], a[64:67], a[8:11], v[32:35]
  s_add_u32 m0, s80, 16896
  v_mfma_f32_16x16x32_bf16 v[32:35], a[80:83], a[40:43], v[32:35]
  buffer_load_dwordx4 v3, s[48:51], s70 offen lds
  v_mfma_f32_16x16x32_bf16 v[36:39], a[68:71], a[8:11], v[36:39]
  ds_read_b128 a[108:111], v7 offset:55296
  v_mfma_f32_16x16x32_bf16 v[36:39], a[84:87], a[40:43], v[36:39]
  v_mfma_f32_16x16x32_bf16 v[96:99], a[72:75], a[8:11], v[96:99]
  v_mfma_f32_16x16x32_bf16 v[96:99], a[88:91], a[40:43], v[96:99]
  ds_read_b128 a[112:115], v8 offset:49152
  v_mfma_f32_16x16x32_bf16 v[100:103], a[76:79], a[8:11], v[100:103]
  s_add_u32 m0, s80, 21120
  v_mfma_f32_16x16x32_bf16 v[100:103], a[92:95], a[40:43], v[100:103]
  buffer_load_dwordx4 v3, s[52:55], s70 offen lds
  v_mfma_f32_16x16x32_bf16 v[108:111], a[76:79], a[12:15], v[108:111]
  s_add_u32 s70, s70, s74
  v_mfma_f32_16x16x32_bf16 v[108:111], a[92:95], a[44:47], v[108:111]
  s_getpc_b64 s[60:61]
L_pcs_sw:
  s_add_u32 s60, s60, L_f_t1-L_pcs_sw
  s_addc_u32 s61, s61, 0
  v_mfma_f32_16x16x32_bf16 v[104:107], a[72:75], a[12:15], v[104:107]
  ds_read_b128 a[116:119], v8 offset:51200
  v_mfma_f32_16x16x32_bf16 v[104:107], a[88:91], a[44:47], v[104:107]
  v_mfma_f32_16x16x32_bf16 v[44:47], a[68:71], a[12:15], v[44:47]
  v_mfma_f32_16x16x32_bf16 v[44:47], a[84:87], a[44:47], v[44:47]
  ds_read_b128 a[120:123], v8 offset:53248
  v_mfma_f32_16x16x32_bf16 v[40:43], a[64:67], a[12:15], v[40:43]
  s_add_u32 m0, s79, 17408
  v_mfma_f32_16x16x32_bf16 v[40:43], a[80:83], a[44:47], v[40:43]
  buffer_load_dwordx4 v2, s[44:47], s69 offen lds
  v_mfma_f32_16x16x32_bf16 v[48:51], a[64:67], a[16:19], v[48:51]
  s_add_u32 s69, s69, s71
  v_mfma_f32_16x16x32_bf16 v[48:51], a[80:83], a[48:51], v[48:51]
  s_mov_b32 s62, L_code_end-L_f_t1
  s_mov_b32 s63, 0x20000
  v_mfma_f32_16x16x32_bf16 v[52:55], a[68:71], a[16:19], v[52:55]
  ds_read_b128 a[124:127], v8 offset:55296
  v_mfma_f32_16x16x32_bf16 v[52:55], a[84:87], a[48:51], v[52:55]
  v_mfma_f32_16x16x32_bf16 v[112:115], a[72:75], a[16:19], v[112:115]
  v_mfma_f32_16x16x32_bf16 v[112:115], a[88:91], a[48:51], v[112:115]
  v_mfma_f32_16x16x32_bf16 v[116:119], a[76:79], a[16:19], v[116:119]
  s_add_u32 m0, s80, 17952
  v_mfma_f32_16x16x32_bf16 v[116:119], a[92:95], a[48:51], v[116:119]
  buffer_load_dwordx4 v3, s[48:51], s70 offen lds
  v_mfma_f32_16x16x32_bf16 v[124:127], a[76:79], a[20:23], v[124:127]
  v_mfma_f32_16x16x32_bf16 v[124:127], a[92:95], a[52:55], v[124:127]
  s_lshl_b32 s64, s36, 11
  v_and_b32 v5, 48, v0
  v_mfma_f32_16x16x32_bf16 v[120:123], a[72:75], a[20:23], v[120:123]
  v_mfma_f32_16x16x32_bf16 v[120:123], a[88:91], a[52:55], v[120:123]
  v_mfma_f32_16x16x32_bf16 v[60:63], a[68:71], a[20:23], v[60:63]
  v_mfma_f32_16x16x32_bf16 v[60:63], a[84:87], a[52:55], v[60:63]
  v_mfma_f32_16x16x32_bf16 v[56:59], a[64:67], a[20:23], v[56:59]
  s_add_u32 m0, s80, 22176
  v_mfma_f32_16x16x32_bf16 v[56:59], a[80:83], a[52:55], v[56:59]
  buffer_load_dwordx4 v3, s[52:55], s70 offen lds
  v_mfma_f32_16x16x32_bf16 v[64:67], a[64:67], a[24:27], v[64:67]
  s_add_u32 s70, s70, s74
  v_mfma_f32_16x16x32_bf16 v[64:67], a[80:83], a[56:59], v[64:67]
  v_lshl_add_u32 v5, v5, 9, v0
  v_mfma_f32_16x16x32_bf16 v[68:71], a[68:71], a[24:27], v[68:71]
  v_mfma_f32_16x16x32_bf16 v[68:71], a[84:87], a[56:59], v[68:71]
  v_mfma_f32_16x16x32_bf16 a[128:131], a[72:75], a[24:27], a[128:131]
  s_add_u32 m0, s79, 18432
  v_mfma_f32_16x16x32_bf16 a[128:131], a[88:91], a[56:59], a[128:131]
  buffer_load_dwordx4 v1, s[44:47], s69 offen lds
  v_mfma_f32_16x16x32_bf16 a[132:135], a[76:79], a[24:27], a[132:135]
  s_add_u32 s69, s69, s71
  v_mfma_f32_16x16x32_bf16 a[132:135], a[92:95], a[56:59], a[132:135]
  v_lshlrev_b32 v4, 7, v5
  v_mfma_f32_16x16x32_bf16 a[140:143], a[76:79], a[28:31], a[140:143]
  v_mfma_f32_16x16x32_bf16 a[140:143], a[92:95], a[60:63], a[140:143]
  v_mfma_f32_16x16x32_bf16 a[136:139], a[72:75], a[28:31], a[136:139]
  v_mfma_f32_16x16x32_bf16 a[136:139], a[88:91], a[60:63], a[136:139]
  v_mfma_f32_16x16x32_bf16 v[76:79], a[68:71], a[28:31], v[76:79]
  s_add_u32 m0, s80, 19008
  v_mfma_f32_16x16x32_bf16 v[76:79], a[84:87], a[60:63], v[76:79]
  buffer_load_dwordx4 v3, s[48:51], s70 offen lds
  v_mfma_f32_16x16x32_bf16 v[72:75], a[64:67], a[28:31], v[72:75]
  v_mfma_f32_16x16x32_bf16 v[72:75], a[80:83], a[60:63], v[72:75]
  s_waitcnt vmcnt(13) lgkmcnt(0)
  s_barrier
  v_mfma_f32_16x16x32_bf16 v[128:131], a[96:99], a[0:3], v[128:131]
  v_mfma_f32_16x16x32_bf16 v[128:131], a[112:115], a[32:35], v[128:131]
  ds_read_b128 a[64:67], v7 offset:0
  v_mfma_f32_16x16x32_bf16 v[132:135], a[100:103], a[0:3], v[132:135]
  v_mfma_f32_16x16x32_bf16 v[132:135], a[116:119], a[32:35], v[132:135]
  ds_read_b128 a[68:71], v7 offset:2048
  v_cvt_pk_bf16_f32 v16, v16, v17
  v_cvt_pk_bf16_f32 v17, v18, v19
  v_mfma_f32_16x16x32_bf16 v[192:195], a[104:107], a[0:3], v[192:195]
  s_add_u32 m0, s80, 23232
  v_cvt_pk_bf16_f32 v18, v20, v21
  v_mfma_f32_16x16x32_bf16 v[192:195], a[120:123], a[32:35], v[192:195]
  buffer_load_dwordx4 v3, s[52:55], s70 offen lds
  v_cvt_pk_bf16_f32 v19, v22, v23
  v_cvt_pk_bf16_f32 v20, v24, v25
  v_mfma_f32_16x16x32_bf16 v[196:199], a[108:111], a[0:3], v[196:199]
  s_add_u32 s70, s70, s74
  v_cvt_pk_bf16_f32 v21, v26, v27
  v_mfma_f32_16x16x32_bf16 v[196:199], a[124:127], a[32:35], v[196:199]
  ds_read_b128 a[72:75], v7 offset:4096
  v_cvt_pk_bf16_f32 v22, v28, v29
  v_cvt_pk_bf16_f32 v23, v30, v31
  v_mfma_f32_16x16x32_bf16 v[204:207], a[108:111], a[4:7], v[204:207]
  ds_read_b64_tr_b16 a[0:1], v9 offset:33792
  v_cvt_pk_bf16_f32 v24, v32, v33
  v_mfma_f32_16x16x32_bf16 v[204:207], a[124:127], a[36:39], v[204:207]
  ds_read_b64_tr_b16 a[2:3], v9 offset:34048
  v_cvt_pk_bf16_f32 v25, v34, v35
  v_cvt_pk_bf16_f32 v26, v36, v37
  v_mfma_f32_16x16x32_bf16 v[200:203], a[104:107], a[4:7], v[200:203]
  s_add_u32 m0, s79, 19456
  v_cvt_pk_bf16_f32 v27, v38, v39
  v_mfma_f32_16x16x32_bf16 v[200:203], a[120:123], a[36:39], v[200:203]
  buffer_load_dwordx4 v2, s[44:47], s69 offen lds
  v_cvt_pk_bf16_f32 v28, v40, v41
  v_cvt_pk_bf16_f32 v29, v42, v43
  v_mfma_f32_16x16x32_bf16 v[140:143], a[100:103], a[4:7], v[140:143]
  s_add_u32 s69, s69, s72
  v_cvt_pk_bf16_f32 v30, v44, v45
  v_mfma_f32_16x16x32_bf16 v[140:143], a[116:119], a[36:39], v[140:143]
  ds_read_b128 a[76:79], v7 offset:6144
  v_cvt_pk_bf16_f32 v31, v46, v47
  v_cvt_pk_bf16_f32 v32, v48, v49
  v_mfma_f32_16x16x32_bf16 v[136:139], a[96:99], a[4:7], v[136:139]
  ds_read_b64_tr_b16 a[32:33], v9 offset:42240
  v_cvt_pk_bf16_f32 v33, v50, v51
  v_mfma_f32_16x16x32_bf16 v[136:139], a[112:115], a[36:39], v[136:139]
  ds_read_b64_tr_b16 a[34:35], v9 offset:42496
  v_cvt_pk_bf16_f32 v34, v52, v53
  v_cvt_pk_bf16_f32 v35, v54, v55
  v_mfma_f32_16x16x32_bf16 v[144:147], a[96:99], a[8:11], v[144:147]
  ds_read_b64_tr_b16 a[4:5], v9 offset:33824
  v_cvt_pk_bf16_f32 v36, v56, v57
  v_mfma_f32_16x16x32_bf16 v[144:147], a[112:115], a[40:43], v[144:147]
  ds_read_b64_tr_b16 a[6:7], v9 offset:34080
  v_cvt_pk_bf16_f32 v37, v58, v59
  v_cvt_pk_bf16_f32 v38, v60, v61
  v_mfma_f32_16x16x32_bf16 v[148:151], a[100:103], a[8:11], v[148:151]
  s_add_u32 m0, s80, 20064
  v_cvt_pk_bf16_f32 v39, v62, v63
  v_mfma_f32_16x16x32_bf16 v[148:151], a[116:119], a[40:43], v[148:151]
  buffer_load_dwordx4 v3, s[48:51], s70 offen lds
  v_cvt_pk_bf16_f32 v40, v64, v65
  v_cvt_pk_bf16_f32 v41, v66, v67
  v_mfma_f32_16x16x32_bf16 v[208:211], a[104:107], a[8:11], v[208:211]
  ds_read_b128 a[80:83], v8 offset:0
  v_cvt_pk_bf16_f32 v42, v68, v69
  v_mfma_f32_16x16x32_bf16 v[208:211], a[120:123], a[40:43], v[208:211]
  ds_read_b64_tr_b16 a[36:37], v9 offset:42272
  v_cvt_pk_bf16_f32 v43, v70, v71
  v_cvt_pk_bf16_f32 v44, v72, v73
  v_mfma_f32_16x16x32_bf16 v[212:215], a[108:111], a[8:11], v[212:215]
  ds_read_b64_tr_b16 a[38:39], v9 offset:42528
  v_cvt_pk_bf16_f32 v45, v74, v75
  v_mfma_f32_16x16x32_bf16 v[212:215], a[124:127], a[40:43], v[212:215]
  ds_read_b64_tr_b16 a[8:9], v9 offset:38016
  v_cvt_pk_bf16_f32 v46, v76, v77
  v_cvt_pk_bf16_f32 v47, v78, v79
  v_mfma_f32_16x16x32_bf16 v[220:223], a[108:111], a[12:15], v[220:223]
  v_cvt_pk_bf16_f32 v48, v80, v81
  v_cvt_pk_bf16_f32 v49, v82, v83
  v_mfma_f32_16x16x32_bf16 v[220:223], a[124:127], a[44:47], v[220:223]
  ds_read_b64_tr_b16 a[10:11], v9 offset:38272
  v_cvt_pk_bf16_f32 v50, v84, v85
  v_cvt_pk_bf16_f32 v51, v86, v87
  v_mfma_f32_16x16x32_bf16 v[216:219], a[104:107], a[12:15], v[216:219]
  s_add_u32 m0, s80, 24288
  v_cvt_pk_bf16_f32 v52, v88, v89
  v_mfma_f32_16x16x32_bf16 v[216:219], a[120:123], a[44:47], v[216:219]
  buffer_load_dwordx4 v3, s[52:55], s70 offen lds
  v_cvt_pk_bf16_f32 v53, v90, v91
  v_cvt_pk_bf16_f32 v54, v92, v93
  v_mfma_f32_16x16x32_bf16 v[156:159], a[100:103], a[12:15], v[156:159]
  s_add_u32 s70, s70, s75
  v_cvt_pk_bf16_f32 v55, v94, v95
  v_mfma_f32_16x16x32_bf16 v[156:159], a[116:119], a[44:47], v[156:159]
  ds_read_b128 a[84:87], v8 offset:2048
  v_cvt_pk_bf16_f32 v56, v96, v97
  v_cvt_pk_bf16_f32 v57, v98, v99
  v_mfma_f32_16x16x32_bf16 v[152:155], a[96:99], a[12:15], v[152:155]
  ds_read_b64_tr_b16 a[40:41], v9 offset:46464
  v_cvt_pk_bf16_f32 v58, v100, v101
  v_mfma_f32_16x16x32_bf16 v[152:155], a[112:115], a[44:47], v[152:155]
  ds_read_b64_tr_b16 a[42:43], v9 offset:46720
  v_cvt_pk_bf16_f32 v59, v102, v103
  v_cvt_pk_bf16_f32 v60, v104, v105
  v_mfma_f32_16x16x32_bf16 v[160:163], a[96:99], a[16:19], v[160:163]
  s_add_u32 m0, s79, 49152
  v_cvt_pk_bf16_f32 v61, v106, v107
  v_mfma_f32_16x16x32_bf16 v[160:163], a[112:115], a[48:51], v[160:163]
  buffer_load_dwordx4 v1, s[44:47], s69 offen lds
  v_cvt_pk_bf16_f32 v62, v108, v109
  v_cvt_pk_bf16_f32 v63, v110, v111
  v_mfma_f32_16x16x32_bf16 v[164:167], a[100:103], a[16:19], v[164:167]
  s_add_u32 s69, s69, s71
  v_cvt_pk_bf16_f32 v64, v112, v113
  v_mfma_f32_16x16x32_bf16 v[164:167], a[116:119], a[48:51], v[164:167]
  ds_read_b64_tr_b16 a[12:13], v9 offset:38048
  v_cvt_pk_bf16_f32 v65, v114, v115
  v_cvt_pk_bf16_f32 v66, v116, v117
  v_mfma_f32_16x16x32_bf16 v[224:227], a[104:107], a[16:19], v[224:227]
  ds_read_b64_tr_b16 a[14:15], v9 offset:38304
  v_cvt_pk_bf16_f32 v67, v118, v119
  v_mfma_f32_16x16x32_bf16 v[224:227], a[120:123], a[48:51], v[224:227]
  ds_read_b128 a[88:91], v8 offset:4096
  v_cvt_pk_bf16_f32 v68, v120, v121
  v_cvt_pk_bf16_f32 v69, v122, v123
  v_mfma_f32_16x16x32_bf16 v[228:231], a[108:111], a[16:19], v[228:231]
  ds_read_b64_tr_b16 a[44:45], v9 offset:46496
  v_cvt_pk_bf16_f32 v70, v124, v125
  v_mfma_f32_16x16x32_bf16 v[228:231], a[124:127], a[48:51], v[228:231]
  ds_read_b64_tr_b16 a[46:47], v9 offset:46752
  v_cvt_pk_bf16_f32 v71, v126, v127
  v_accvgpr_read_b32 v112, a128
  v_mfma_f32_16x16x32_bf16 v[236:239], a[108:111], a[20:23], v[236:239]
  s_add_u32 m0, s79, 50176
  v_accvgpr_read_b32 v113, a129
  v_mfma_f32_16x16x32_bf16 v[236:239], a[124:127], a[52:55], v[236:239]
  buffer_load_dwordx4 v2, s[44:47], s69 offen lds
  v_accvgpr_read_b32 v114, a130
  v_accvgpr_read_b32 v115, a131
  v_mfma_f32_16x16x32_bf16 v[232:235], a[104:107], a[20:23], v[232:235]
  s_add_u32 s69, s69, s71
  v_accvgpr_read_b32 v116, a132
  v_mfma_f32_16x16x32_bf16 v[232:235], a[120:123], a[52:55], v[232:235]
  ds_read_b64_tr_b16 a[16:17], v9 offset:0
  v_accvgpr_read_b32 v117, a133
  v_accvgpr_read_b32 v118, a134
  v_mfma_f32_16x16x32_bf16 v[172:175], a[100:103], a[20:23], v[172:175]
  ds_read_b64_tr_b16 a[18:19], v9 offset:256
  v_accvgpr_read_b32 v119, a135
  v_mfma_f32_16x16x32_bf16 v[172:175], a[116:119], a[52:55], v[172:175]
  ds_read_b128 a[92:95], v8 offset:6144
  v_cvt_pk_bf16_f32 v112, v112, v113
  v_cvt_pk_bf16_f32 v113, v114, v115
  v_mfma_f32_16x16x32_bf16 v[168:171], a[96:99], a[20:23], v[168:171]
  ds_read_b64_tr_b16 a[48:49], v9 offset:8448
  v_cvt_pk_bf16_f32 v114, v116, v117
  v_mfma_f32_16x16x32_bf16 v[168:171], a[112:115], a[52:55], v[168:171]
  ds_read_b64_tr_b16 a[50:51], v9 offset:8704
  v_cvt_pk_bf16_f32 v115, v118, v119
  s_add_u32 s85, s82, 536576
  v_mfma_f32_16x16x32_bf16 v[176:179], a[96:99], a[24:27], v[176:179]
  s_add_u32 m0, s79, 51200
  buffer_store_dwordx4 v[112:115], v10, s[32:35], s85 offen sc1
  v_mfma_f32_16x16x32_bf16 v[176:179], a[112:115], a[56:59], v[176:179]
  buffer_load_dwordx4 v1, s[44:47], s69 offen lds
  v_accvgpr_read_b32 v120, a136
  v_accvgpr_read_b32 v121, a137
  v_mfma_f32_16x16x32_bf16 v[180:183], a[100:103], a[24:27], v[180:183]
  s_add_u32 s69, s69, s71
  v_accvgpr_read_b32 v122, a138
  v_mfma_f32_16x16x32_bf16 v[180:183], a[116:119], a[56:59], v[180:183]
  ds_read_b64_tr_b16 a[20:21], v9 offset:32
  v_accvgpr_read_b32 v123, a139
  v_accvgpr_read_b32 v124, a140
  v_mfma_f32_16x16x32_bf16 v[240:243], a[104:107], a[24:27], v[240:243]
  ds_read_b64_tr_b16 a[22:23], v9 offset:288
  v_accvgpr_read_b32 v125, a141
  v_mfma_f32_16x16x32_bf16 v[240:243], a[120:123], a[56:59], v[240:243]
  ds_read_b64_tr_b16 a[52:53], v9 offset:8480
  v_accvgpr_read_b32 v126, a142
  v_accvgpr_read_b32 v127, a143
  v_mfma_f32_16x16x32_bf16 v[244:247], a[108:111], a[24:27], v[244:247]
  ds_read_b64_tr_b16 a[54:55], v9 offset:8736
  v_cvt_pk_bf16_f32 v120, v120, v121
  v_mfma_f32_16x16x32_bf16 v[244:247], a[124:127], a[56:59], v[244:247]
  ds_read_b64_tr_b16 a[24:25], v9 offset:4224
  v_cvt_pk_bf16_f32 v121, v122, v123
  v_cvt_pk_bf16_f32 v122, v124, v125
  v_mfma_f32_16x16x32_bf16 v[252:255], a[108:111], a[28:31], v[252:255]
  s_add_u32 m0, s79, 52224
  v_cvt_pk_bf16_f32 v123, v126, v127
  v_mfma_f32_16x16x32_bf16 v[248:251], a[104:107], a[28:31], v[248:251]
  buffer_load_dwordx4 v2, s[44:47], s69 offen lds
  s_add_u32 s85, s82, 536576
  buffer_store_dwordx4 v[120:123], v11, s[32:35], s85 offen sc1
  v_mfma_f32_16x16x32_bf16 v[188:191], a[100:103], a[28:31], v[188:191]
  s_add_u32 s69, s69, s73
  v_mfma_f32_16x16x32_bf16 v[184:187], a[96:99], a[28:31], v[184:187]
  buffer_load_dword v13, v12, s[56:59], s83 offen
  s_add_u32 s83, s83, s84
  v_mfma_f32_16x16x32_bf16 v[184:187], a[112:115], a[60:63], v[184:187]
  ds_read_b64_tr_b16 a[26:27], v9 offset:4480
  v_mfma_f32_16x16x32_bf16 v[188:191], a[116:119], a[60:63], v[188:191]
  s_add_u32 s65, s64, 0
  buffer_load_dword v5, v4, s[60:63], s65 offen
  v_mfma_f32_16x16x32_bf16 v[248:251], a[120:123], a[60:63], v[248:251]
  ds_read_b64_tr_b16 a[56:57], v9 offset:12672
  v_mfma_f32_16x16x32_bf16 v[252:255], a[124:127], a[60:63], v[252:255]
  ds_read_b64_tr_b16 a[58:59], v9 offset:12928
  ds_read_b64_tr_b16 a[28:29], v9 offset:4256
  ds_read_b64_tr_b16 a[30:31], v9 offset:4512
  ds_read_b64_tr_b16 a[60:61], v9 offset:12704
  ds_read_b64_tr_b16 a[62:63], v9 offset:12960
  s_branch L_f_t1
L_f_ns:
  s_waitcnt lgkmcnt(15)
  v_mfma_f32_16x16x32_bf16 v[16:19], a[0:3], a[64:67], 0
  s_add_u32 m0, s79, 49152
  s_waitcnt lgkmcnt(14)
  v_mfma_f32_16x16x32_bf16 v[16:19], a[32:35], a[80:83], v[16:19]
  buffer_load_dwordx4 v1, s[44:47], s69 offen lds
  s_add_u32 s69, s69, s71
  v_mfma_f32_16x16x32_bf16 v[32:35], a[0:3], a[68:71], 0
  v_mfma_f32_16x16x32_bf16 v[32:35], a[32:35], a[84:87], v[32:35]
  v_mfma_f32_16x16x32_bf16 v[80:83], a[0:3], a[72:75], 0
  s_add_u32 m0, s79, 50176
  v_mfma_f32_16x16x32_bf16 v[80:83], a[32:35], a[88:91], v[80:83]
  buffer_load_dwordx4 v2, s[44:47], s69 offen lds
  s_add_u32 s69, s69, s71
  v_mfma_f32_16x16x32_bf16 v[96:99], a[0:3], a[76:79], 0
  v_mfma_f32_16x16x32_bf16 v[96:99], a[32:35], a[92:95], v[96:99]
  s_waitcnt vmcnt(15) lgkmcnt(0)
  s_barrier
  v_mfma_f32_16x16x32_bf16 v[100:103], a[4:7], a[76:79], 0
  v_mov_b32 v152, 0
  v_dot2c_f32_bf16 v152, v128, v140
  v_mfma_f32_16x16x32_bf16 v[100:103], a[36:39], a[92:95], v[100:103]
  ds_read_b128 a[96:99], v7 offset:32768
  v_dot2c_f32_bf16 v152, v129, v141
  v_mfma_f32_16x16x32_bf16 v[84:87], a[4:7], a[72:75], 0
  s_add_u32 m0, s79, 51200
  v_dot2c_f32_bf16 v152, v130, v142
  v_mfma_f32_16x16x32_bf16 v[84:87], a[36:39], a[88:91], v[84:87]
  buffer_load_dwordx4 v1, s[44:47], s69 offen lds
  s_add_u32 s69, s69, s71
  v_mfma_f32_16x16x32_bf16 v[36:39], a[4:7], a[68:71], 0
  s_add_u32 m0, s79, 52224
  v_dot2c_f32_bf16 v152, v131, v143
  v_mfma_f32_16x16x32_bf16 v[36:39], a[36:39], a[84:87], v[36:39]
  buffer_load_dwordx4 v2, s[44:47], s69 offen lds
  s_add_u32 s69, s69, s73
  v_mfma_f32_16x16x32_bf16 v[20:23], a[4:7], a[64:67], 0
  ds_read_b128 a[100:103], v7 offset:34816
  v_dot2c_f32_bf16 v152, v132, v144
  v_mfma_f32_16x16x32_bf16 v[20:23], a[36:39], a[80:83], v[20:23]
  v_dot2c_f32_bf16 v152, v133, v145
  v_dot2c_f32_bf16 v152, v134, v146
  v_mfma_f32_16x16x32_bf16 v[24:27], a[8:11], a[64:67], 0
  v_dot2c_f32_bf16 v152, v135, v147
  v_dot2c_f32_bf16 v152, v136, v148
  v_mfma_f32_16x16x32_bf16 v[24:27], a[40:43], a[80:83], v[24:27]
  ds_read_b128 a[104:107], v7 offset:36864
  v_dot2c_f32_bf16 v152, v137, v149
  v_mfma_f32_16x16x32_bf16 v[40:43], a[8:11], a[68:71], 0
  s_nop 2
  v_add_f32_dpp v152, v152, v152 row_ror:8 row_mask:0xf bank_mask:0xf
  v_mfma_f32_16x16x32_bf16 v[40:43], a[40:43], a[84:87], v[40:43]
  ds_read_b128 a[108:111], v7 offset:38912
  s_nop 1
  v_mfma_f32_16x16x32_bf16 v[88:91], a[8:11], a[72:75], 0
  s_add_u32 m0, s79, 0
  v_add_f32_dpp v152, v152, v152 row_ror:4 row_mask:0xf bank_mask:0xf
  v_mfma_f32_16x16x32_bf16 v[88:91], a[40:43], a[88:91], v[88:91]
  buffer_load_dwordx4 v1, s[44:47], s69 offen lds
  s_nop 1
  v_mfma_f32_16x16x32_bf16 v[104:107], a[8:11], a[76:79], 0
  s_add_u32 s69, s69, s71
  v_add_f32_dpp v152, v152, v152 row_ror:2 row_mask:0xf bank_mask:0xf
  v_mfma_f32_16x16x32_bf16 v[104:107], a[40:43], a[92:95], v[104:107]
  ds_read_b128 a[112:115], v8 offset:32768
  s_nop 1
  v_mfma_f32_16x16x32_bf16 v[108:111], a[12:15], a[76:79], 0
  v_add_f32_dpp v152, v152, v152 row_ror:1 row_mask:0xf bank_mask:0xf
  s_nop 1
  v_mfma_f32_16x16x32_bf16 v[108:111], a[44:47], a[92:95], v[108:111]
  ds_read_b128 a[116:119], v8 offset:34816
  v_mov_b32 v153, v152
  v_mfma_f32_16x16x32_bf16 v[92:95], a[12:15], a[72:75], 0
  s_add_u32 m0, s80, 0
  s_nop 1
  v_mfma_f32_16x16x32_bf16 v[92:95], a[44:47], a[88:91], v[92:95]
  buffer_load_dwordx4 v3, s[48:51], s70 offen lds
  v_permlane16_swap_b32 v152, v153
  v_mfma_f32_16x16x32_bf16 v[44:47], a[12:15], a[68:71], 0
  ds_read_b128 a[120:123], v8 offset:36864
  v_add_f32 v152, v152, v153
  v_mfma_f32_16x16x32_bf16 v[44:47], a[44:47], a[84:87], v[44:47]
  v_mul_f32 v152, s5, v152
  v_mfma_f32_16x16x32_bf16 v[28:31], a[12:15], a[64:67], 0
  v_exp_f32 v152, v152
  v_mfma_f32_16x16x32_bf16 v[28:31], a[44:47], a[80:83], v[28:31]
  ds_read_b128 a[124:127], v8 offset:38912
  s_nop 0
  v_mfma_f32_16x16x32_bf16 v[48:51], a[16:19], a[64:67], 0
  s_add_u32 m0, s80, 4224
  v_add_f32 v152, 1.0, v152
  v_mfma_f32_16x16x32_bf16 v[48:51], a[48:51], a[80:83], v[48:51]
  buffer_load_dwordx4 v3, s[52:55], s70 offen lds
  v_mfma_f32_16x16x32_bf16 v[64:67], a[16:19], a[68:71], 0
  s_add_u32 s70, s70, s74
  v_mfma_f32_16x16x32_bf16 v[64:67], a[48:51], a[84:87], v[64:67]
  v_rcp_f32 v152, v152
  v_mfma_f32_16x16x32_bf16 v[112:115], a[16:19], a[72:75], 0
  buffer_store_dword v152, v154, s[32:35], s3 offen sc1
  s_mov_b32 s3, 0
  v_mfma_f32_16x16x32_bf16 v[112:115], a[48:51], a[88:91], v[112:115]
  v_mfma_f32_16x16x32_bf16 a[128:131], a[16:19], a[76:79], 0
  v_mfma_f32_16x16x32_bf16 a[128:131], a[48:51], a[92:95], a[128:131]
  v_mfma_f32_16x16x32_bf16 a[132:135], a[20:23], a[76:79], 0
  s_add_u32 m0, s79, 1024
  v_mfma_f32_16x16x32_bf16 a[132:135], a[52:55], a[92:95], a[132:135]
  buffer_load_dwordx4 v2, s[44:47], s69 offen lds
  v_mfma_f32_16x16x32_bf16 v[116:119], a[20:23], a[72:75], 0
  s_add_u32 s69, s69, s71
  v_mfma_f32_16x16x32_bf16 v[116:119], a[52:55], a[88:91], v[116:119]
  v_mfma_f32_16x16x32_bf16 v[68:71], a[20:23], a[68:71], 0
  v_mfma_f32_16x16x32_bf16 v[68:71], a[52:55], a[84:87], v[68:71]
  v_mfma_f32_16x16x32_bf16 v[52:55], a[20:23], a[64:67], 0
  s_add_u32 m0, s80, 1056
  v_mfma_f32_16x16x32_bf16 v[52:55], a[52:55], a[80:83], v[52:55]
  buffer_load_dwordx4 v3, s[48:51], s70 offen lds
  v_mfma_f32_16x16x32_bf16 v[56:59], a[24:27], a[64:67], 0
  v_mfma_f32_16x16x32_bf16 v[56:59], a[56:59], a[80:83], v[56:59]
  v_mfma_f32_16x16x32_bf16 v[72:75], a[24:27], a[68:71], 0
  v_mfma_f32_16x16x32_bf16 v[72:75], a[56:59], a[84:87], v[72:75]
  v_mfma_f32_16x16x32_bf16 v[120:123], a[24:27], a[72:75], 0
  s_add_u32 m0, s80, 5280
  v_mfma_f32_16x16x32_bf16 v[120:123], a[56:59], a[88:91], v[120:123]
  buffer_load_dwordx4 v3, s[52:55], s70 offen lds
  v_mfma_f32_16x16x32_bf16 a[136:139], a[24:27], a[76:79], 0
  s_add_u32 s70, s70, s74
  v_mfma_f32_16x16x32_bf16 a[136:139], a[56:59], a[92:95], a[136:139]
  v_mfma_f32_16x16x32_bf16 a[140:143], a[28:31], a[76:79], 0
  v_mfma_f32_16x16x32_bf16 a[140:143], a[60:63], a[92:95], a[140:143]
  v_mfma_f32_16x16x32_bf16 v[124:127], a[28:31], a[72:75], 0
  v_mfma_f32_16x16x32_bf16 v[124:127], a[60:63], a[88:91], v[124:127]
  v_mfma_f32_16x16x32_bf16 v[76:79], a[28:31], a[68:71], 0
  s_add_u32 m0, s79, 2048
  v_mfma_f32_16x16x32_bf16 v[76:79], a[60:63], a[84:87], v[76:79]
  buffer_load_dwordx4 v1, s[44:47], s69 offen lds
  v_mfma_f32_16x16x32_bf16 v[60:63], a[28:31], a[64:67], 0
  s_add_u32 s69, s69, s71
  v_mfma_f32_16x16x32_bf16 v[60:63], a[60:63], a[80:83], v[60:63]
  s_waitcnt vmcnt(13) lgkmcnt(0)
  s_barrier
  v_mfma_f32_16x16x32_bf16 v[128:131], a[0:3], a[96:99], 0
  v_mfma_f32_16x16x32_bf16 v[128:131], a[32:35], a[112:115], v[128:131]
  ds_read_b128 a[64:67], v7 offset:16384
  v_mfma_f32_16x16x32_bf16 v[144:147], a[0:3], a[100:103], 0
  s_add_u32 m0, s80, 2112
  v_mfma_f32_16x16x32_bf16 v[144:147], a[32:35], a[116:119], v[144:147]
  buffer_load_dwordx4 v3, s[48:51], s70 offen lds
  v_mfma_f32_16x16x32_bf16 v[192:195], a[0:3], a[104:107], 0
  ds_read_b128 a[68:71], v7 offset:18432
  v_mfma_f32_16x16x32_bf16 v[192:195], a[32:35], a[120:123], v[192:195]
  ds_read_b128 a[72:75], v7 offset:20480
  v_mfma_f32_16x16x32_bf16 v[208:211], a[0:3], a[108:111], 0
  v_mfma_f32_16x16x32_bf16 v[208:211], a[32:35], a[124:127], v[208:211]
  ds_read_b64_tr_b16 a[0:1], v9 offset:50688
  v_mfma_f32_16x16x32_bf16 v[212:215], a[4:7], a[108:111], 0
  s_add_u32 m0, s80, 6336
  v_mfma_f32_16x16x32_bf16 v[212:215], a[36:39], a[124:127], v[212:215]
  buffer_load_dwordx4 v3, s[52:55], s70 offen lds
  v_mfma_f32_16x16x32_bf16 v[196:199], a[4:7], a[104:107], 0
  s_add_u32 s70, s70, s74
  v_mfma_f32_16x16x32_bf16 v[196:199], a[36:39], a[120:123], v[196:199]
  ds_read_b64_tr_b16 a[2:3], v9 offset:50944
  v_mfma_f32_16x16x32_bf16 v[148:151], a[4:7], a[100:103], 0
  ds_read_b128 a[76:79], v7 offset:22528
  v_mfma_f32_16x16x32_bf16 v[148:151], a[36:39], a[116:119], v[148:151]
  ds_read_b64_tr_b16 a[32:33], v9 offset:59136
  v_mfma_f32_16x16x32_bf16 v[132:135], a[4:7], a[96:99], 0
  ds_read_b64_tr_b16 a[34:35], v9 offset:59392
  v_mfma_f32_16x16x32_bf16 v[132:135], a[36:39], a[112:115], v[132:135]
  ds_read_b64_tr_b16 a[4:5], v9 offset:50720
  v_mfma_f32_16x16x32_bf16 v[136:139], a[8:11], a[96:99], 0
  s_add_u32 m0, s79, 3072
  v_mfma_f32_16x16x32_bf16 v[136:139], a[40:43], a[112:115], v[136:139]
  buffer_load_dwordx4 v2, s[44:47], s69 offen lds
  v_mfma_f32_16x16x32_bf16 v[152:155], a[8:11], a[100:103], 0
  s_add_u32 s69, s69, s72
  v_mfma_f32_16x16x32_bf16 v[152:155], a[40:43], a[116:119], v[152:155]
  ds_read_b64_tr_b16 a[6:7], v9 offset:50976
  v_mfma_f32_16x16x32_bf16 v[200:203], a[8:11], a[104:107], 0
  ds_read_b128 a[80:83], v8 offset:16384
  v_mfma_f32_16x16x32_bf16 v[200:203], a[40:43], a[120:123], v[200:203]
  ds_read_b64_tr_b16 a[36:37], v9 offset:59168
  v_mfma_f32_16x16x32_bf16 v[216:219], a[8:11], a[108:111], 0
  s_add_u32 m0, s80, 3168
  v_mfma_f32_16x16x32_bf16 v[216:219], a[40:43], a[124:127], v[216:219]
  buffer_load_dwordx4 v3, s[48:51], s70 offen lds
  v_mfma_f32_16x16x32_bf16 v[220:223], a[12:15], a[108:111], 0
  ds_read_b64_tr_b16 a[38:39], v9 offset:59424
  v_mfma_f32_16x16x32_bf16 v[220:223], a[44:47], a[124:127], v[220:223]
  ds_read_b64_tr_b16 a[8:9], v9 offset:54912
  v_mfma_f32_16x16x32_bf16 v[204:207], a[12:15], a[104:107], 0
  ds_read_b64_tr_b16 a[10:11], v9 offset:55168
  v_mfma_f32_16x16x32_bf16 v[204:207], a[44:47], a[120:123], v[204:207]
  ds_read_b128 a[84:87], v8 offset:18432
  v_mfma_f32_16x16x32_bf16 v[156:159], a[12:15], a[100:103], 0
  s_add_u32 m0, s80, 7392
  v_mfma_f32_16x16x32_bf16 v[156:159], a[44:47], a[116:119], v[156:159]
  buffer_load_dwordx4 v3, s[52:55], s70 offen lds
  v_mfma_f32_16x16x32_bf16 v[140:143], a[12:15], a[96:99], 0
  s_add_u32 s70, s70, s75
  v_mfma_f32_16x16x32_bf16 v[140:143], a[44:47], a[112:115], v[140:143]
  ds_read_b64_tr_b16 a[40:41], v9 offset:63360
  v_mfma_f32_16x16x32_bf16 v[160:163], a[16:19], a[96:99], 0
  ds_read_b64_tr_b16 a[42:43], v9 offset:63616
  v_mfma_f32_16x16x32_bf16 v[160:163], a[48:51], a[112:115], v[160:163]
  ds_read_b64_tr_b16 a[12:13], v9 offset:54944
  v_mfma_f32_16x16x32_bf16 v[176:179], a[16:19], a[100:103], 0
  ds_read_b64_tr_b16 a[14:15], v9 offset:55200
  v_mfma_f32_16x16x32_bf16 v[176:179], a[48:51], a[116:119], v[176:179]
  ds_read_b128 a[88:91], v8 offset:20480
  v_mfma_f32_16x16x32_bf16 v[224:227], a[16:19], a[104:107], 0
  s_add_u32 m0, s79, 32768
  v_mfma_f32_16x16x32_bf16 v[224:227], a[48:51], a[120:123], v[224:227]
  buffer_load_dwordx4 v1, s[44:47], s69 offen lds
  v_mfma_f32_16x16x32_bf16 v[240:243], a[16:19], a[108:111], 0
  s_add_u32 s69, s69, s71
  v_mfma_f32_16x16x32_bf16 v[240:243], a[48:51], a[124:127], v[240:243]
  ds_read_b64_tr_b16 a[44:45], v9 offset:63392
  v_mfma_f32_16x16x32_bf16 v[244:247], a[20:23], a[108:111], 0
  ds_read_b64_tr_b16 a[46:47], v9 offset:63648
  v_mfma_f32_16x16x32_bf16 v[244:247], a[52:55], a[124:127], v[244:247]
  ds_read_b64_tr_b16 a[16:17], v9 offset:16896
  v_mfma_f32_16x16x32_bf16 v[228:231], a[20:23], a[104:107], 0
  s_add_u32 m0, s79, 33792
  v_mfma_f32_16x16x32_bf16 v[228:231], a[52:55], a[120:123], v[228:231]
  buffer_load_dwordx4 v2, s[44:47], s69 offen lds
  v_mfma_f32_16x16x32_bf16 v[180:183], a[20:23], a[100:103], 0
  s_add_u32 s69, s69, s71
  v_mfma_f32_16x16x32_bf16 v[180:183], a[52:55], a[116:119], v[180:183]
  ds_read_b64_tr_b16 a[18:19], v9 offset:17152
  v_mfma_f32_16x16x32_bf16 v[164:167], a[20:23], a[96:99], 0
  ds_read_b128 a[92:95], v8 offset:22528
  v_mfma_f32_16x16x32_bf16 v[164:167], a[52:55], a[112:115], v[164:167]
  ds_read_b64_tr_b16 a[48:49], v9 offset:25344
  v_mfma_f32_16x16x32_bf16 v[168:171], a[24:27], a[96:99], 0
  s_add_u32 m0, s79, 34816
  v_mfma_f32_16x16x32_bf16 v[168:171], a[56:59], a[112:115], v[168:171]
  buffer_load_dwordx4 v1, s[44:47], s69 offen lds
  v_mfma_f32_16x16x32_bf16 v[184:187], a[24:27], a[100:103], 0
  s_add_u32 s69, s69, s71
  v_mfma_f32_16x16x32_bf16 v[184:187], a[56:59], a[116:119], v[184:187]
  ds_read_b64_tr_b16 a[50:51], v9 offset:25600
  v_mfma_f32_16x16x32_bf16 v[232:235], a[24:27], a[104:107], 0
  ds_read_b64_tr_b16 a[20:21], v9 offset:16928
  v_mfma_f32_16x16x32_bf16 v[232:235], a[56:59], a[120:123], v[232:235]
  ds_read_b64_tr_b16 a[22:23], v9 offset:17184
  v_mfma_f32_16x16x32_bf16 v[248:251], a[24:27], a[108:111], 0
  ds_read_b64_tr_b16 a[52:53], v9 offset:25376
  v_mfma_f32_16x16x32_bf16 v[248:251], a[56:59], a[124:127], v[248:251]
  ds_read_b64_tr_b16 a[54:55], v9 offset:25632
  v_mfma_f32_16x16x32_bf16 v[252:255], a[28:31], a[108:111], 0
  s_add_u32 m0, s79, 35840
  v_mfma_f32_16x16x32_bf16 v[236:239], a[28:31], a[104:107], 0
  buffer_load_dwordx4 v2, s[44:47], s69 offen lds
  v_mfma_f32_16x16x32_bf16 v[188:191], a[28:31], a[100:103], 0
  s_add_u32 s69, s69, s73
  v_mfma_f32_16x16x32_bf16 v[172:175], a[28:31], a[96:99], 0
  buffer_load_dword v13, v12, s[56:59], s83 offen
  s_add_u32 s83, s83, s84
  v_mfma_f32_16x16x32_bf16 v[172:175], a[60:63], a[112:115], v[172:175]
  ds_read_b64_tr_b16 a[24:25], v9 offset:21120
  v_mfma_f32_16x16x32_bf16 v[188:191], a[60:63], a[116:119], v[188:191]
  ds_read_b64_tr_b16 a[26:27], v9 offset:21376
  v_mfma_f32_16x16x32_bf16 v[236:239], a[60:63], a[120:123], v[236:239]
  ds_read_b64_tr_b16 a[56:57], v9 offset:29568
  v_mfma_f32_16x16x32_bf16 v[252:255], a[60:63], a[124:127], v[252:255]
  ds_read_b64_tr_b16 a[58:59], v9 offset:29824
  ds_read_b64_tr_b16 a[28:29], v9 offset:21152
  ds_read_b64_tr_b16 a[30:31], v9 offset:21408
  ds_read_b64_tr_b16 a[60:61], v9 offset:29600
  ds_read_b64_tr_b16 a[62:63], v9 offset:29856
.p2align 6
L_loop_ns:
  s_waitcnt lgkmcnt(15)
  v_mfma_f32_16x16x32_bf16 v[16:19], a[0:3], a[64:67], v[16:19]
  v_mfma_f32_16x16x32_bf16 v[16:19], a[32:35], a[80:83], v[16:19]
  v_mfma_f32_16x16x32_bf16 v[32:35], a[0:3], a[68:71], v[32:35]
  v_mfma_f32_16x16x32_bf16 v[32:35], a[32:35], a[84:87], v[32:35]
  v_mfma_f32_16x16x32_bf16 v[80:83], a[0:3], a[72:75], v[80:83]
  v_mfma_f32_16x16x32_bf16 v[80:83], a[32:35], a[88:91], v[80:83]
  v_mfma_f32_16x16x32_bf16 v[96:99], a[0:3], a[76:79], v[96:99]
  s_waitcnt lgkmcnt(14)
  v_mfma_f32_16x16x32_bf16 v[96:99], a[32:35], a[92:95], v[96:99]
  s_waitcnt vmcnt(18) lgkmcnt(0)
  s_barrier
  v_mfma_f32_16x16x32_bf16 v[100:103], a[4:7], a[76:79], v[100:103]
  s_add_u32 m0, s79, 16384
  v_mfma_f32_16x16x32_bf16 v[100:103], a[36:39], a[92:95], v[100:103]
  buffer_load_dwordx4 v1, s[44:47], s69 offen lds
  v_mfma_f32_16x16x32_bf16 v[84:87], a[4:7], a[72:75], v[84:87]
  s_add_u32 s69, s69, s71
  v_mfma_f32_16x16x32_bf16 v[84:87], a[36:39], a[88:91], v[84:87]
  ds_read_b128 a[96:99], v7 offset:49152
  v_mfma_f32_16x16x32_bf16 v[36:39], a[4:7], a[68:71], v[36:39]
  v_mfma_f32_16x16x32_bf16 v[36:39], a[36:39], a[84:87], v[36:39]
  ds_read_b128 a[100:103], v7 offset:51200
  v_mfma_f32_16x16x32_bf16 v[20:23], a[4:7], a[64:67], v[20:23]
  v_mfma_f32_16x16x32_bf16 v[20:23], a[36:39], a[80:83], v[20:23]
  ds_read_b128 a[104:107], v7 offset:53248
  v_mfma_f32_16x16x32_bf16 v[24:27], a[8:11], a[64:67], v[24:27]
  s_add_u32 m0, s80, 16896
  v_mfma_f32_16x16x32_bf16 v[24:27], a[40:43], a[80:83], v[24:27]
  buffer_load_dwordx4 v3, s[48:51], s70 offen lds
  v_mfma_f32_16x16x32_bf16 v[40:43], a[8:11], a[68:71], v[40:43]
  ds_read_b128 a[108:111], v7 offset:55296
  v_mfma_f32_16x16x32_bf16 v[40:43], a[40:43], a[84:87], v[40:43]
  v_mfma_f32_16x16x32_bf16 v[88:91], a[8:11], a[72:75], v[88:91]
  v_mfma_f32_16x16x32_bf16 v[88:91], a[40:43], a[88:91], v[88:91]
  ds_read_b128 a[112:115], v8 offset:49152
  v_mfma_f32_16x16x32_bf16 v[104:107], a[8:11], a[76:79], v[104:107]
  s_add_u32 m0, s80, 21120
  v_mfma_f32_16x16x32_bf16 v[104:107], a[40:43], a[92:95], v[104:107]
  buffer_load_dwordx4 v3, s[52:55], s70 offen lds
  v_mfma_f32_16x16x32_bf16 v[108:111], a[12:15], a[76:79], v[108:111]
  s_add_u32 s70, s70, s74
  v_mfma_f32_16x16x32_bf16 v[108:111], a[44:47], a[92:95], v[108:111]
  ds_read_b128 a[116:119], v8 offset:51200
  v_mfma_f32_16x16x32_bf16 v[92:95], a[12:15], a[72:75], v[92:95]
  v_mfma_f32_16x16x32_bf16 v[92:95], a[44:47], a[88:91], v[92:95]
  ds_read_b128 a[120:123], v8 offset:53248
  v_mfma_f32_16x16x32_bf16 v[44:47], a[12:15], a[68:71], v[44:47]
  v_mfma_f32_16x16x32_bf16 v[44:47], a[44:47], a[84:87], v[44:47]
  ds_read_b128 a[124:127], v8 offset:55296
  v_mfma_f32_16x16x32_bf16 v[28:31], a[12:15], a[64:67], v[28:31]
  s_add_u32 m0, s79, 17408
  v_mfma_f32_16x16x32_bf16 v[28:31], a[44:47], a[80:83], v[28:31]
  buffer_load_dwordx4 v2, s[44:47], s69 offen lds
  v_mfma_f32_16x16x32_bf16 v[48:51], a[16:19], a[64:67], v[48:51]
  s_add_u32 s69, s69, s71
  v_mfma_f32_16x16x32_bf16 v[48:51], a[48:51], a[80:83], v[48:51]
  v_mfma_f32_16x16x32_bf16 v[64:67], a[16:19], a[68:71], v[64:67]
  v_mfma_f32_16x16x32_bf16 v[64:67], a[48:51], a[84:87], v[64:67]
  v_mfma_f32_16x16x32_bf16 v[112:115], a[16:19], a[72:75], v[112:115]
  v_mfma_f32_16x16x32_bf16 v[112:115], a[48:51], a[88:91], v[112:115]
  v_mfma_f32_16x16x32_bf16 a[128:131], a[16:19], a[76:79], a[128:131]
  s_add_u32 m0, s80, 17952
  v_mfma_f32_16x16x32_bf16 a[128:131], a[48:51], a[92:95], a[128:131]
  buffer_load_dwordx4 v3, s[48:51], s70 offen lds
  v_mfma_f32_16x16x32_bf16 a[132:135], a[20:23], a[76:79], a[132:135]
  v_mfma_f32_16x16x32_bf16 a[132:135], a[52:55], a[92:95], a[132:135]
  v_mfma_f32_16x16x32_bf16 v[116:119], a[20:23], a[72:75], v[116:119]
  v_mfma_f32_16x16x32_bf16 v[116:119], a[52:55], a[88:91], v[116:119]
  v_mfma_f32_16x16x32_bf16 v[68:71], a[20:23], a[68:71], v[68:71]
  v_mfma_f32_16x16x32_bf16 v[68:71], a[52:55], a[84:87], v[68:71]
  v_mfma_f32_16x16x32_bf16 v[52:55], a[20:23], a[64:67], v[52:55]
  s_add_u32 m0, s80, 22176
  v_mfma_f32_16x16x32_bf16 v[52:55], a[52:55], a[80:83], v[52:55]
  buffer_load_dwordx4 v3, s[52:55], s70 offen lds
  v_mfma_f32_16x16x32_bf16 v[56:59], a[24:27], a[64:67], v[56:59]
  s_add_u32 s70, s70, s74
  v_mfma_f32_16x16x32_bf16 v[56:59], a[56:59], a[80:83], v[56:59]
  v_mfma_f32_16x16x32_bf16 v[72:75], a[24:27], a[68:71], v[72:75]
  v_mfma_f32_16x16x32_bf16 v[72:75], a[56:59], a[84:87], v[72:75]
  v_mfma_f32_16x16x32_bf16 v[120:123], a[24:27], a[72:75], v[120:123]
  s_add_u32 m0, s79, 18432
  v_mfma_f32_16x16x32_bf16 v[120:123], a[56:59], a[88:91], v[120:123]
  buffer_load_dwordx4 v1, s[44:47], s69 offen lds
  v_mfma_f32_16x16x32_bf16 a[136:139], a[24:27], a[76:79], a[136:139]
  s_add_u32 s69, s69, s71
  v_mfma_f32_16x16x32_bf16 a[136:139], a[56:59], a[92:95], a[136:139]
  v_mfma_f32_16x16x32_bf16 a[140:143], a[28:31], a[76:79], a[140:143]
  v_mfma_f32_16x16x32_bf16 a[140:143], a[60:63], a[92:95], a[140:143]
  v_mfma_f32_16x16x32_bf16 v[124:127], a[28:31], a[72:75], v[124:127]
  v_mfma_f32_16x16x32_bf16 v[124:127], a[60:63], a[88:91], v[124:127]
  v_mfma_f32_16x16x32_bf16 v[76:79], a[28:31], a[68:71], v[76:79]
  s_add_u32 m0, s80, 19008
  v_mfma_f32_16x16x32_bf16 v[76:79], a[60:63], a[84:87], v[76:79]
  buffer_load_dwordx4 v3, s[48:51], s70 offen lds
  v_mfma_f32_16x16x32_bf16 v[60:63], a[28:31], a[64:67], v[60:63]
  v_mfma_f32_16x16x32_bf16 v[60:63], a[60:63], a[80:83], v[60:63]
  s_waitcnt vmcnt(13) lgkmcnt(0)
  s_barrier
  v_mfma_f32_16x16x32_bf16 v[128:131], a[0:3], a[96:99], v[128:131]
  v_mfma_f32_16x16x32_bf16 v[128:131], a[32:35], a[112:115], v[128:131]
  ds_read_b128 a[64:67], v7 offset:0
  v_mfma_f32_16x16x32_bf16 v[144:147], a[0:3], a[100:103], v[144:147]
  v_mfma_f32_16x16x32_bf16 v[144:147], a[32:35], a[116:119], v[144:147]
  ds_read_b128 a[68:71], v7 offset:2048
  v_mfma_f32_16x16x32_bf16 v[192:195], a[0:3], a[104:107], v[192:195]
  s_add_u32 m0, s80, 23232
  v_mfma_f32_16x16x32_bf16 v[192:195], a[32:35], a[120:123], v[192:195]
  buffer_load_dwordx4 v3, s[52:55], s70 offen lds
  v_mfma_f32_16x16x32_bf16 v[208:211], a[0:3], a[108:111], v[208:211]
  s_add_u32 s70, s70, s74
  v_mfma_f32_16x16x32_bf16 v[208:211], a[32:35], a[124:127], v[208:211]
  ds_read_b128 a[72:75], v7 offset:4096
  v_mfma_f32_16x16x32_bf16 v[212:215], a[4:7], a[108:111], v[212:215]
  ds_read_b64_tr_b16 a[0:1], v9 offset:33792
  v_mfma_f32_16x16x32_bf16 v[212:215], a[36:39], a[124:127], v[212:215]
  ds_read_b64_tr_b16 a[2:3], v9 offset:34048
  v_mfma_f32_16x16x32_bf16 v[196:199], a[4:7], a[104:107], v[196:199]
  s_add_u32 m0, s79, 19456
  v_mfma_f32_16x16x32_bf16 v[196:199], a[36:39], a[120:123], v[196:199]
  buffer_load_dwordx4 v2, s[44:47], s69 offen lds
  v_mfma_f32_16x16x32_bf16 v[148:151], a[4:7], a[100:103], v[148:151]
  s_add_u32 s69, s69, s72
  v_mfma_f32_16x16x32_bf16 v[148:151], a[36:39], a[116:119], v[148:151]
  ds_read_b128 a[76:79], v7 offset:6144
  v_mfma_f32_16x16x32_bf16 v[132:135], a[4:7], a[96:99], v[132:135]
  ds_read_b64_tr_b16 a[32:33], v9 offset:42240
  v_mfma_f32_16x16x32_bf16 v[132:135], a[36:39], a[112:115], v[132:135]
  ds_read_b64_tr_b16 a[34:35], v9 offset:42496
  v_mfma_f32_16x16x32_bf16 v[136:139], a[8:11], a[96:99], v[136:139]
  ds_read_b64_tr_b16 a[4:5], v9 offset:33824
  v_mfma_f32_16x16x32_bf16 v[136:139], a[40:43], a[112:115], v[136:139]
  ds_read_b64_tr_b16 a[6:7], v9 offset:34080
  v_mfma_f32_16x16x32_bf16 v[152:155], a[8:11], a[100:103], v[152:155]
  s_add_u32 m0, s80, 20064
  v_mfma_f32_16x16x32_bf16 v[152:155], a[40:43], a[116:119], v[152:155]
  buffer_load_dwordx4 v3, s[48:51], s70 offen lds
  v_mfma_f32_16x16x32_bf16 v[200:203], a[8:11], a[104:107], v[200:203]
  ds_read_b128 a[80:83], v8 offset:0
  v_mfma_f32_16x16x32_bf16 v[200:203], a[40:43], a[120:123], v[200:203]
  ds_read_b64_tr_b16 a[36:37], v9 offset:42272
  v_mfma_f32_16x16x32_bf16 v[216:219], a[8:11], a[108:111], v[216:219]
  ds_read_b64_tr_b16 a[38:39], v9 offset:42528
  v_mfma_f32_16x16x32_bf16 v[216:219], a[40:43], a[124:127], v[216:219]
  ds_read_b64_tr_b16 a[8:9], v9 offset:38016
  v_mfma_f32_16x16x32_bf16 v[220:223], a[12:15], a[108:111], v[220:223]
  v_mfma_f32_16x16x32_bf16 v[220:223], a[44:47], a[124:127], v[220:223]
  ds_read_b64_tr_b16 a[10:11], v9 offset:38272
  v_mfma_f32_16x16x32_bf16 v[204:207], a[12:15], a[104:107], v[204:207]
  s_add_u32 m0, s80, 24288
  v_mfma_f32_16x16x32_bf16 v[204:207], a[44:47], a[120:123], v[204:207]
  buffer_load_dwordx4 v3, s[52:55], s70 offen lds
  v_mfma_f32_16x16x32_bf16 v[156:159], a[12:15], a[100:103], v[156:159]
  s_add_u32 s70, s70, s75
  v_mfma_f32_16x16x32_bf16 v[156:159], a[44:47], a[116:119], v[156:159]
  ds_read_b128 a[84:87], v8 offset:2048
  v_mfma_f32_16x16x32_bf16 v[140:143], a[12:15], a[96:99], v[140:143]
  ds_read_b64_tr_b16 a[40:41], v9 offset:46464
  v_mfma_f32_16x16x32_bf16 v[140:143], a[44:47], a[112:115], v[140:143]
  ds_read_b64_tr_b16 a[42:43], v9 offset:46720
  v_mfma_f32_16x16x32_bf16 v[160:163], a[16:19], a[96:99], v[160:163]
  s_add_u32 m0, s79, 49152
  v_mfma_f32_16x16x32_bf16 v[160:163], a[48:51], a[112:115], v[160:163]
  buffer_load_dwordx4 v1, s[44:47], s69 offen lds
  v_mfma_f32_16x16x32_bf16 v[176:179], a[16:19], a[100:103], v[176:179]
  s_add_u32 s69, s69, s71
  v_mfma_f32_16x16x32_bf16 v[176:179], a[48:51], a[116:119], v[176:179]
  ds_read_b64_tr_b16 a[12:13], v9 offset:38048
  v_mfma_f32_16x16x32_bf16 v[224:227], a[16:19], a[104:107], v[224:227]
  ds_read_b64_tr_b16 a[14:15], v9 offset:38304
  v_mfma_f32_16x16x32_bf16 v[224:227], a[48:51], a[120:123], v[224:227]
  ds_read_b128 a[88:91], v8 offset:4096
  v_mfma_f32_16x16x32_bf16 v[240:243], a[16:19], a[108:111], v[240:243]
  ds_read_b64_tr_b16 a[44:45], v9 offset:46496
  v_mfma_f32_16x16x32_bf16 v[240:243], a[48:51], a[124:127], v[240:243]
  ds_read_b64_tr_b16 a[46:47], v9 offset:46752
  v_mfma_f32_16x16x32_bf16 v[244:247], a[20:23], a[108:111], v[244:247]
  s_add_u32 m0, s79, 50176
  v_mfma_f32_16x16x32_bf16 v[244:247], a[52:55], a[124:127], v[244:247]
  buffer_load_dwordx4 v2, s[44:47], s69 offen lds
  v_mfma_f32_16x16x32_bf16 v[228:231], a[20:23], a[104:107], v[228:231]
  s_add_u32 s69, s69, s71
  v_mfma_f32_16x16x32_bf16 v[228:231], a[52:55], a[120:123], v[228:231]
  ds_read_b64_tr_b16 a[16:17], v9 offset:0
  v_mfma_f32_16x16x32_bf16 v[180:183], a[20:23], a[100:103], v[180:183]
  ds_read_b64_tr_b16 a[18:19], v9 offset:256
  v_mfma_f32_16x16x32_bf16 v[180:183], a[52:55], a[116:119], v[180:183]
  ds_read_b128 a[92:95], v8 offset:6144
  v_mfma_f32_16x16x32_bf16 v[164:167], a[20:23], a[96:99], v[164:167]
  ds_read_b64_tr_b16 a[48:49], v9 offset:8448
  v_mfma_f32_16x16x32_bf16 v[164:167], a[52:55], a[112:115], v[164:167]
  ds_read_b64_tr_b16 a[50:51], v9 offset:8704
  v_mfma_f32_16x16x32_bf16 v[168:171], a[24:27], a[96:99], v[168:171]
  s_add_u32 m0, s79, 51200
  v_mfma_f32_16x16x32_bf16 v[168:171], a[56:59], a[112:115], v[168:171]
  buffer_load_dwordx4 v1, s[44:47], s69 offen lds
  v_mfma_f32_16x16x32_bf16 v[184:187], a[24:27], a[100:103], v[184:187]
  s_add_u32 s69, s69, s71
  v_mfma_f32_16x16x32_bf16 v[184:187], a[56:59], a[116:119], v[184:187]
  ds_read_b64_tr_b16 a[20:21], v9 offset:32
  v_mfma_f32_16x16x32_bf16 v[232:235], a[24:27], a[104:107], v[232:235]
  ds_read_b64_tr_b16 a[22:23], v9 offset:288
  v_mfma_f32_16x16x32_bf16 v[232:235], a[56:59], a[120:123], v[232:235]
  ds_read_b64_tr_b16 a[52:53], v9 offset:8480
  v_mfma_f32_16x16x32_bf16 v[248:251], a[24:27], a[108:111], v[248:251]
  ds_read_b64_tr_b16 a[54:55], v9 offset:8736
  v_mfma_f32_16x16x32_bf16 v[248:251], a[56:59], a[124:127], v[248:251]
  ds_read_b64_tr_b16 a[24:25], v9 offset:4224
  v_mfma_f32_16x16x32_bf16 v[252:255], a[28:31], a[108:111], v[252:255]
  s_add_u32 m0, s79, 52224
  v_mfma_f32_16x16x32_bf16 v[236:239], a[28:31], a[104:107], v[236:239]
  buffer_load_dwordx4 v2, s[44:47], s69 offen lds
  v_mfma_f32_16x16x32_bf16 v[188:191], a[28:31], a[100:103], v[188:191]
  s_add_u32 s69, s69, s73
  v_mfma_f32_16x16x32_bf16 v[172:175], a[28:31], a[96:99], v[172:175]
  buffer_load_dword v13, v12, s[56:59], s83 offen
  s_add_u32 s83, s83, s84
  v_mfma_f32_16x16x32_bf16 v[172:175], a[60:63], a[112:115], v[172:175]
  ds_read_b64_tr_b16 a[26:27], v9 offset:4480
  v_mfma_f32_16x16x32_bf16 v[188:191], a[60:63], a[116:119], v[188:191]
  ds_read_b64_tr_b16 a[56:57], v9 offset:12672
  v_mfma_f32_16x16x32_bf16 v[236:239], a[60:63], a[120:123], v[236:239]
  ds_read_b64_tr_b16 a[58:59], v9 offset:12928
  v_mfma_f32_16x16x32_bf16 v[252:255], a[60:63], a[124:127], v[252:255]
  ds_read_b64_tr_b16 a[28:29], v9 offset:4256
  ds_read_b64_tr_b16 a[30:31], v9 offset:4512
  ds_read_b64_tr_b16 a[60:61], v9 offset:12704
  ds_read_b64_tr_b16 a[62:63], v9 offset:12960
  s_waitcnt lgkmcnt(15)
  v_mfma_f32_16x16x32_bf16 v[16:19], a[0:3], a[64:67], v[16:19]
  v_mfma_f32_16x16x32_bf16 v[16:19], a[32:35], a[80:83], v[16:19]
  v_mfma_f32_16x16x32_bf16 v[32:35], a[0:3], a[68:71], v[32:35]
  v_mfma_f32_16x16x32_bf16 v[32:35], a[32:35], a[84:87], v[32:35]
  v_mfma_f32_16x16x32_bf16 v[80:83], a[0:3], a[72:75], v[80:83]
  v_mfma_f32_16x16x32_bf16 v[80:83], a[32:35], a[88:91], v[80:83]
  v_mfma_f32_16x16x32_bf16 v[96:99], a[0:3], a[76:79], v[96:99]
  s_waitcnt lgkmcnt(14)
  v_mfma_f32_16x16x32_bf16 v[96:99], a[32:35], a[92:95], v[96:99]
  s_waitcnt vmcnt(18) lgkmcnt(0)
  s_barrier
  s_cmp_lg_u32 s81, 0
  s_cbranch_scc1 L_nosw_ns
  s_mov_b32 s44, s60
  s_mov_b32 s48, s63
  s_mov_b32 s52, s66
  s_mov_b32 s45, s61
  s_mov_b32 s49, s64
  s_mov_b32 s53, s67
  s_mov_b32 s46, s62
  s_mov_b32 s50, s65
  s_mov_b32 s54, s68
  s_mov_b32 s69, s76
  s_mov_b32 s70, s77
  s_mov_b32 s71, 10240
  s_mov_b32 s72, 51200
  s_mov_b32 s73, 4294854784
  s_mov_b32 s74, s78
  s_mul_i32 s75, s78, 61
  v_mov_b32 v1, v4
  v_mov_b32 v2, v5
  v_mov_b32 v3, v6
L_nosw_ns:
  v_mfma_f32_16x16x32_bf16 v[100:103], a[4:7], a[76:79], v[100:103]
  s_add_u32 m0, s79, 0
  v_mfma_f32_16x16x32_bf16 v[100:103], a[36:39], a[92:95], v[100:103]
  buffer_load_dwordx4 v1, s[44:47], s69 offen lds
  v_mfma_f32_16x16x32_bf16 v[84:87], a[4:7], a[72:75], v[84:87]
  s_add_u32 s69, s69, s71
  v_mfma_f32_16x16x32_bf16 v[84:87], a[36:39], a[88:91], v[84:87]
  ds_read_b128 a[96:99], v7 offset:32768
  v_mfma_f32_16x16x32_bf16 v[36:39], a[4:7], a[68:71], v[36:39]
  v_mfma_f32_16x16x32_bf16 v[36:39], a[36:39], a[84:87], v[36:39]
  ds_read_b128 a[100:103], v7 offset:34816
  v_mfma_f32_16x16x32_bf16 v[20:23], a[4:7], a[64:67], v[20:23]
  v_mfma_f32_16x16x32_bf16 v[20:23], a[36:39], a[80:83], v[20:23]
  ds_read_b128 a[104:107], v7 offset:36864
  v_mfma_f32_16x16x32_bf16 v[24:27], a[8:11], a[64:67], v[24:27]
  s_add_u32 m0, s80, 0
  v_mfma_f32_16x16x32_bf16 v[24:27], a[40:43], a[80:83], v[24:27]
  buffer_load_dwordx4 v3, s[48:51], s70 offen lds
  v_mfma_f32_16x16x32_bf16 v[40:43], a[8:11], a[68:71], v[40:43]
  ds_read_b128 a[108:111], v7 offset:38912
  v_mfma_f32_16x16x32_bf16 v[40:43], a[40:43], a[84:87], v[40:43]
  v_mfma_f32_16x16x32_bf16 v[88:91], a[8:11], a[72:75], v[88:91]
  v_mfma_f32_16x16x32_bf16 v[88:91], a[40:43], a[88:91], v[88:91]
  ds_read_b128 a[112:115], v8 offset:32768
  v_mfma_f32_16x16x32_bf16 v[104:107], a[8:11], a[76:79], v[104:107]
  s_add_u32 m0, s80, 4224
  v_mfma_f32_16x16x32_bf16 v[104:107], a[40:43], a[92:95], v[104:107]
  buffer_load_dwordx4 v3, s[52:55], s70 offen lds
  v_mfma_f32_16x16x32_bf16 v[108:111], a[12:15], a[76:79], v[108:111]
  s_add_u32 s70, s70, s74
  v_mfma_f32_16x16x32_bf16 v[108:111], a[44:47], a[92:95], v[108:111]
  ds_read_b128 a[116:119], v8 offset:34816
  v_mfma_f32_16x16x32_bf16 v[92:95], a[12:15], a[72:75], v[92:95]
  v_mfma_f32_16x16x32_bf16 v[92:95], a[44:47], a[88:91], v[92:95]
  ds_read_b128 a[120:123], v8 offset:36864
  v_mfma_f32_16x16x32_bf16 v[44:47], a[12:15], a[68:71], v[44:47]
  v_mfma_f32_16x16x32_bf16 v[44:47], a[44:47], a[84:87], v[44:47]
  ds_read_b128 a[124:127], v8 offset:38912
  v_mfma_f32_16x16x32_bf16 v[28:31], a[12:15], a[64:67], v[28:31]
  s_add_u32 m0, s79, 1024
  v_mfma_f32_16x16x32_bf16 v[28:31], a[44:47], a[80:83], v[28:31]
  buffer_load_dwordx4 v2, s[44:47], s69 offen lds
  v_mfma_f32_16x16x32_bf16 v[48:51], a[16:19], a[64:67], v[48:51]
  s_add_u32 s69, s69, s71
  v_mfma_f32_16x16x32_bf16 v[48:51], a[48:51], a[80:83], v[48:51]
  v_mfma_f32_16x16x32_bf16 v[64:67], a[16:19], a[68:71], v[64:67]
  v_mfma_f32_16x16x32_bf16 v[64:67], a[48:51], a[84:87], v[64:67]
  v_mfma_f32_16x16x32_bf16 v[112:115], a[16:19], a[72:75], v[112:115]
  v_mfma_f32_16x16x32_bf16 v[112:115], a[48:51], a[88:91], v[112:115]
  v_mfma_f32_16x16x32_bf16 a[128:131], a[16:19], a[76:79], a[128:131]
  s_add_u32 m0, s80, 1056
  v_mfma_f32_16x16x32_bf16 a[128:131], a[48:51], a[92:95], a[128:131]
  buffer_load_dwordx4 v3, s[48:51], s70 offen lds
  v_mfma_f32_16x16x32_bf16 a[132:135], a[20:23], a[76:79], a[132:135]
  v_mfma_f32_16x16x32_bf16 a[132:135], a[52:55], a[92:95], a[132:135]
  v_mfma_f32_16x16x32_bf16 v[116:119], a[20:23], a[72:75], v[116:119]
  v_mfma_f32_16x16x32_bf16 v[116:119], a[52:55], a[88:91], v[116:119]
  v_mfma_f32_16x16x32_bf16 v[68:71], a[20:23], a[68:71], v[68:71]
  v_mfma_f32_16x16x32_bf16 v[68:71], a[52:55], a[84:87], v[68:71]
  v_mfma_f32_16x16x32_bf16 v[52:55], a[20:23], a[64:67], v[52:55]
  s_add_u32 m0, s80, 5280
  v_mfma_f32_16x16x32_bf16 v[52:55], a[52:55], a[80:83], v[52:55]
  buffer_load_dwordx4 v3, s[52:55], s70 offen lds
  v_mfma_f32_16x16x32_bf16 v[56:59], a[24:27], a[64:67], v[56:59]
  s_add_u32 s70, s70, s74
  v_mfma_f32_16x16x32_bf16 v[56:59], a[56:59], a[80:83], v[56:59]
  v_mfma_f32_16x16x32_bf16 v[72:75], a[24:27], a[68:71], v[72:75]
  v_mfma_f32_16x16x32_bf16 v[72:75], a[56:59], a[84:87], v[72:75]
  v_mfma_f32_16x16x32_bf16 v[120:123], a[24:27], a[72:75], v[120:123]
  s_add_u32 m0, s79, 2048
  v_mfma_f32_16x16x32_bf16 v[120:123], a[56:59], a[88:91], v[120:123]
  buffer_load_dwordx4 v1, s[44:47], s69 offen lds
  v_mfma_f32_16x16x32_bf16 a[136:139], a[24:27], a[76:79], a[136:139]
  s_add_u32 s69, s69, s71
  v_mfma_f32_16x16x32_bf16 a[136:139], a[56:59], a[92:95], a[136:139]
  v_mfma_f32_16x16x32_bf16 a[140:143], a[28:31], a[76:79], a[140:143]
  v_mfma_f32_16x16x32_bf16 a[140:143], a[60:63], a[92:95], a[140:143]
  v_mfma_f32_16x16x32_bf16 v[124:127], a[28:31], a[72:75], v[124:127]
  v_mfma_f32_16x16x32_bf16 v[124:127], a[60:63], a[88:91], v[124:127]
  v_mfma_f32_16x16x32_bf16 v[76:79], a[28:31], a[68:71], v[76:79]
  s_add_u32 m0, s80, 2112
  v_mfma_f32_16x16x32_bf16 v[76:79], a[60:63], a[84:87], v[76:79]
  buffer_load_dwordx4 v3, s[48:51], s70 offen lds
  v_mfma_f32_16x16x32_bf16 v[60:63], a[28:31], a[64:67], v[60:63]
  v_mfma_f32_16x16x32_bf16 v[60:63], a[60:63], a[80:83], v[60:63]
  s_waitcnt vmcnt(13) lgkmcnt(0)
  s_barrier
  v_mfma_f32_16x16x32_bf16 v[128:131], a[0:3], a[96:99], v[128:131]
  v_mfma_f32_16x16x32_bf16 v[128:131], a[32:35], a[112:115], v[128:131]
  ds_read_b128 a[64:67], v7 offset:16384
  v_mfma_f32_16x16x32_bf16 v[144:147], a[0:3], a[100:103], v[144:147]
  v_mfma_f32_16x16x32_bf16 v[144:147], a[32:35], a[116:119], v[144:147]
  ds_read_b128 a[68:71], v7 offset:18432
  v_mfma_f32_16x16x32_bf16 v[192:195], a[0:3], a[104:107], v[192:195]
  s_add_u32 m0, s80, 6336
  v_mfma_f32_16x16x32_bf16 v[192:195], a[32:35], a[120:123], v[192:195]
  buffer_load_dwordx4 v3, s[52:55], s70 offen lds
  v_mfma_f32_16x16x32_bf16 v[208:211], a[0:3], a[108:111], v[208:211]
  s_add_u32 s70, s70, s74
  v_mfma_f32_16x16x32_bf16 v[208:211], a[32:35], a[124:127], v[208:211]
  ds_read_b128 a[72:75], v7 offset:20480
  v_mfma_f32_16x16x32_bf16 v[212:215], a[4:7], a[108:111], v[212:215]
  ds_read_b64_tr_b16 a[0:1], v9 offset:50688
  v_mfma_f32_16x16x32_bf16 v[212:215], a[36:39], a[124:127], v[212:215]
  ds_read_b64_tr_b16 a[2:3], v9 offset:50944
  v_mfma_f32_16x16x32_bf16 v[196:199], a[4:7], a[104:107], v[196:199]
  s_add_u32 m0, s79, 3072
  v_mfma_f32_16x16x32_bf16 v[196:199], a[36:39], a[120:123], v[196:199]
  buffer_load_dwordx4 v2, s[44:47], s69 offen lds
  v_mfma_f32_16x16x32_bf16 v[148:151], a[4:7], a[100:103], v[148:151]
  s_add_u32 s69, s69, s72
  v_mfma_f32_16x16x32_bf16 v[148:151], a[36:39], a[116:119], v[148:151]
  ds_read_b128 a[76:79], v7 offset:22528
  v_mfma_f32_16x16x32_bf16 v[132:135], a[4:7], a[96:99], v[132:135]
  ds_read_b64_tr_b16 a[32:33], v9 offset:59136
  v_mfma_f32_16x16x32_bf16 v[132:135], a[36:39], a[112:115], v[132:135]
  ds_read_b64_tr_b16 a[34:35], v9 offset:59392
  v_mfma_f32_16x16x32_bf16 v[136:139], a[8:11], a[96:99], v[136:139]
  ds_read_b64_tr_b16 a[4:5], v9 offset:50720
  v_mfma_f32_16x16x32_bf16 v[136:139], a[40:43], a[112:115], v[136:139]
  ds_read_b64_tr_b16 a[6:7], v9 offset:50976
  v_mfma_f32_16x16x32_bf16 v[152:155], a[8:11], a[100:103], v[152:155]
  s_add_u32 m0, s80, 3168
  v_mfma_f32_16x16x32_bf16 v[152:155], a[40:43], a[116:119], v[152:155]
  buffer_load_dwordx4 v3, s[48:51], s70 offen lds
  v_mfma_f32_16x16x32_bf16 v[200:203], a[8:11], a[104:107], v[200:203]
  ds_read_b128 a[80:83], v8 offset:16384
  v_mfma_f32_16x16x32_bf16 v[200:203], a[40:43], a[120:123], v[200:203]
  ds_read_b64_tr_b16 a[36:37], v9 offset:59168
  v_mfma_f32_16x16x32_bf16 v[216:219], a[8:11], a[108:111], v[216:219]
  ds_read_b64_tr_b16 a[38:39], v9 offset:59424
  v_mfma_f32_16x16x32_bf16 v[216:219], a[40:43], a[124:127], v[216:219]
  ds_read_b64_tr_b16 a[8:9], v9 offset:54912
  v_mfma_f32_16x16x32_bf16 v[220:223], a[12:15], a[108:111], v[220:223]
  v_mfma_f32_16x16x32_bf16 v[220:223], a[44:47], a[124:127], v[220:223]
  ds_read_b64_tr_b16 a[10:11], v9 offset:55168
  v_mfma_f32_16x16x32_bf16 v[204:207], a[12:15], a[104:107], v[204:207]
  s_add_u32 m0, s80, 7392
  v_mfma_f32_16x16x32_bf16 v[204:207], a[44:47], a[120:123], v[204:207]
  buffer_load_dwordx4 v3, s[52:55], s70 offen lds
  v_mfma_f32_16x16x32_bf16 v[156:159], a[12:15], a[100:103], v[156:159]
  s_add_u32 s70, s70, s75
  v_mfma_f32_16x16x32_bf16 v[156:159], a[44:47], a[116:119], v[156:159]
  ds_read_b128 a[84:87], v8 offset:18432
  v_mfma_f32_16x16x32_bf16 v[140:143], a[12:15], a[96:99], v[140:143]
  ds_read_b64_tr_b16 a[40:41], v9 offset:63360
  v_mfma_f32_16x16x32_bf16 v[140:143], a[44:47], a[112:115], v[140:143]
  ds_read_b64_tr_b16 a[42:43], v9 offset:63616
  v_mfma_f32_16x16x32_bf16 v[160:163], a[16:19], a[96:99], v[160:163]
  s_add_u32 m0, s79, 32768
  v_mfma_f32_16x16x32_bf16 v[160:163], a[48:51], a[112:115], v[160:163]
  buffer_load_dwordx4 v1, s[44:47], s69 offen lds
  v_mfma_f32_16x16x32_bf16 v[176:179], a[16:19], a[100:103], v[176:179]
  s_add_u32 s69, s69, s71
  v_mfma_f32_16x16x32_bf16 v[176:179], a[48:51], a[116:119], v[176:179]
  ds_read_b64_tr_b16 a[12:13], v9 offset:54944
  v_mfma_f32_16x16x32_bf16 v[224:227], a[16:19], a[104:107], v[224:227]
  ds_read_b64_tr_b16 a[14:15], v9 offset:55200
  v_mfma_f32_16x16x32_bf16 v[224:227], a[48:51], a[120:123], v[224:227]
  ds_read_b128 a[88:91], v8 offset:20480
  v_mfma_f32_16x16x32_bf16 v[240:243], a[16:19], a[108:111], v[240:243]
  ds_read_b64_tr_b16 a[44:45], v9 offset:63392
  v_mfma_f32_16x16x32_bf16 v[240:243], a[48:51], a[124:127], v[240:243]
  ds_read_b64_tr_b16 a[46:47], v9 offset:63648
  v_mfma_f32_16x16x32_bf16 v[244:247], a[20:23], a[108:111], v[244:247]
  s_add_u32 m0, s79, 33792
  v_mfma_f32_16x16x32_bf16 v[244:247], a[52:55], a[124:127], v[244:247]
  buffer_load_dwordx4 v2, s[44:47], s69 offen lds
  v_mfma_f32_16x16x32_bf16 v[228:231], a[20:23], a[104:107], v[228:231]
  s_add_u32 s69, s69, s71
  v_mfma_f32_16x16x32_bf16 v[228:231], a[52:55], a[120:123], v[228:231]
  ds_read_b64_tr_b16 a[16:17], v9 offset:16896
  v_mfma_f32_16x16x32_bf16 v[180:183], a[20:23], a[100:103], v[180:183]
  ds_read_b64_tr_b16 a[18:19], v9 offset:17152
  v_mfma_f32_16x16x32_bf16 v[180:183], a[52:55], a[116:119], v[180:183]
  ds_read_b128 a[92:95], v8 offset:22528
  v_mfma_f32_16x16x32_bf16 v[164:167], a[20:23], a[96:99], v[164:167]
  ds_read_b64_tr_b16 a[48:49], v9 offset:25344
  v_mfma_f32_16x16x32_bf16 v[164:167], a[52:55], a[112:115], v[164:167]
  ds_read_b64_tr_b16 a[50:51], v9 offset:25600
  v_mfma_f32_16x16x32_bf16 v[168:171], a[24:27], a[96:99], v[168:171]
  s_add_u32 m0, s79, 34816
  v_mfma_f32_16x16x32_bf16 v[168:171], a[56:59], a[112:115], v[168:171]
  buffer_load_dwordx4 v1, s[44:47], s69 offen lds
  v_mfma_f32_16x16x32_bf16 v[184:187], a[24:27], a[100:103], v[184:187]
  s_add_u32 s69, s69, s71
  v_mfma_f32_16x16x32_bf16 v[184:187], a[56:59], a[116:119], v[184:187]
  ds_read_b64_tr_b16 a[20:21], v9 offset:16928
  v_mfma_f32_16x16x32_bf16 v[232:235], a[24:27], a[104:107], v[232:235]
  ds_read_b64_tr_b16 a[22:23], v9 offset:17184
  v_mfma_f32_16x16x32_bf16 v[232:235], a[56:59], a[120:123], v[232:235]
  ds_read_b64_tr_b16 a[52:53], v9 offset:25376
  v_mfma_f32_16x16x32_bf16 v[248:251], a[24:27], a[108:111], v[248:251]
  ds_read_b64_tr_b16 a[54:55], v9 offset:25632
  v_mfma_f32_16x16x32_bf16 v[248:251], a[56:59], a[124:127], v[248:251]
  ds_read_b64_tr_b16 a[24:25], v9 offset:21120
  v_mfma_f32_16x16x32_bf16 v[252:255], a[28:31], a[108:111], v[252:255]
  s_add_u32 m0, s79, 35840
  v_mfma_f32_16x16x32_bf16 v[236:239], a[28:31], a[104:107], v[236:239]
  buffer_load_dwordx4 v2, s[44:47], s69 offen lds
  v_mfma_f32_16x16x32_bf16 v[188:191], a[28:31], a[100:103], v[188:191]
  s_add_u32 s69, s69, s73
  v_mfma_f32_16x16x32_bf16 v[172:175], a[28:31], a[96:99], v[172:175]
  buffer_load_dword v13, v12, s[56:59], s83 offen
  s_add_u32 s83, s83, s84
  v_mfma_f32_16x16x32_bf16 v[172:175], a[60:63], a[112:115], v[172:175]
  ds_read_b64_tr_b16 a[26:27], v9 offset:21376
  v_mfma_f32_16x16x32_bf16 v[188:191], a[60:63], a[116:119], v[188:191]
  ds_read_b64_tr_b16 a[56:57], v9 offset:29568
  v_mfma_f32_16x16x32_bf16 v[236:239], a[60:63], a[120:123], v[236:239]
  ds_read_b64_tr_b16 a[58:59], v9 offset:29824
  v_mfma_f32_16x16x32_bf16 v[252:255], a[60:63], a[124:127], v[252:255]
  ds_read_b64_tr_b16 a[28:29], v9 offset:21152
  ds_read_b64_tr_b16 a[30:31], v9 offset:21408
  ds_read_b64_tr_b16 a[60:61], v9 offset:29600
  ds_read_b64_tr_b16 a[62:63], v9 offset:29856
  s_sub_u32 s81, s81, 1
  s_cbranch_scc0 L_loop_ns
  s_waitcnt lgkmcnt(15)
  v_mfma_f32_16x16x32_bf16 v[16:19], a[0:3], a[64:67], v[16:19]
  v_mfma_f32_16x16x32_bf16 v[16:19], a[32:35], a[80:83], v[16:19]
  v_mfma_f32_16x16x32_bf16 v[32:35], a[0:3], a[68:71], v[32:35]
  v_mfma_f32_16x16x32_bf16 v[32:35], a[32:35], a[84:87], v[32:35]
  v_mfma_f32_16x16x32_bf16 v[80:83], a[0:3], a[72:75], v[80:83]
  v_mfma_f32_16x16x32_bf16 v[80:83], a[32:35], a[88:91], v[80:83]
  v_mfma_f32_16x16x32_bf16 v[96:99], a[0:3], a[76:79], v[96:99]
  s_waitcnt lgkmcnt(14)
  v_mfma_f32_16x16x32_bf16 v[96:99], a[32:35], a[92:95], v[96:99]
  s_waitcnt vmcnt(18) lgkmcnt(0)
  s_barrier
  v_mfma_f32_16x16x32_bf16 v[100:103], a[4:7], a[76:79], v[100:103]
  s_add_u32 m0, s79, 16384
  v_mfma_f32_16x16x32_bf16 v[100:103], a[36:39], a[92:95], v[100:103]
  buffer_load_dwordx4 v1, s[44:47], s69 offen lds
  v_mfma_f32_16x16x32_bf16 v[84:87], a[4:7], a[72:75], v[84:87]
  s_add_u32 s69, s69, s71
  v_mfma_f32_16x16x32_bf16 v[84:87], a[36:39], a[88:91], v[84:87]
  ds_read_b128 a[96:99], v7 offset:49152
  v_mfma_f32_16x16x32_bf16 v[36:39], a[4:7], a[68:71], v[36:39]
  v_mfma_f32_16x16x32_bf16 v[36:39], a[36:39], a[84:87], v[36:39]
  ds_read_b128 a[100:103], v7 offset:51200
  v_mfma_f32_16x16x32_bf16 v[20:23], a[4:7], a[64:67], v[20:23]
  v_mfma_f32_16x16x32_bf16 v[20:23], a[36:39], a[80:83], v[20:23]
  ds_read_b128 a[104:107], v7 offset:53248
  v_mfma_f32_16x16x32_bf16 v[24:27], a[8:11], a[64:67], v[24:27]
  s_add_u32 m0, s80, 16896
  v_mfma_f32_16x16x32_bf16 v[24:27], a[40:43], a[80:83], v[24:27]
  buffer_load_dwordx4 v3, s[48:51], s70 offen lds
  v_mfma_f32_16x16x32_bf16 v[40:43], a[8:11], a[68:71], v[40:43]
  ds_read_b128 a[108:111], v7 offset:55296
  v_mfma_f32_16x16x32_bf16 v[40:43], a[40:43], a[84:87], v[40:43]
  v_mfma_f32_16x16x32_bf16 v[88:91], a[8:11], a[72:75], v[88:91]
  v_mfma_f32_16x16x32_bf16 v[88:91], a[40:43], a[88:91], v[88:91]
  ds_read_b128 a[112:115], v8 offset:49152
  v_mfma_f32_16x16x32_bf16 v[104:107], a[8:11], a[76:79], v[104:107]
  s_add_u32 m0, s80, 21120
  v_mfma_f32_16x16x32_bf16 v[104:107], a[40:43], a[92:95], v[104:107]
  buffer_load_dwordx4 v3, s[52:55], s70 offen lds
  v_mfma_f32_16x16x32_bf16 v[108:111], a[12:15], a[76:79], v[108:111]
  s_add_u32 s70, s70, s74
  v_mfma_f32_16x16x32_bf16 v[108:111], a[44:47], a[92:95], v[108:111]
  s_getpc_b64 s[60:61]
L_pcs_ns:
  s_add_u32 s60, s60, L_f_t1-L_pcs_ns
  s_addc_u32 s61, s61, 0
  v_mfma_f32_16x16x32_bf16 v[92:95], a[12:15], a[72:75], v[92:95]
  ds_read_b128 a[116:119], v8 offset:51200
  v_mfma_f32_16x16x32_bf16 v[92:95], a[44:47], a[88:91], v[92:95]
  v_mfma_f32_16x16x32_bf16 v[44:47], a[12:15], a[68:71], v[44:47]
  v_mfma_f32_16x16x32_bf16 v[44:47], a[44:47], a[84:87], v[44:47]
  ds_read_b128 a[120:123], v8 offset:53248
  v_mfma_f32_16x16x32_bf16 v[28:31], a[12:15], a[64:67], v[28:31]
  s_add_u32 m0, s79, 17408
  v_mfma_f32_16x16x32_bf16 v[28:31], a[44:47], a[80:83], v[28:31]
  buffer_load_dwordx4 v2, s[44:47], s69 offen lds
  v_mfma_f32_16x16x32_bf16 v[48:51], a[16:19], a[64:67], v[48:51]
  s_add_u32 s69, s69, s71
  v_mfma_f32_16x16x32_bf16 v[48:51], a[48:51], a[80:83], v[48:51]
  s_mov_b32 s62, L_code_end-L_f_t1
  s_mov_b32 s63, 0x20000
  v_mfma_f32_16x16x32_bf16 v[64:67], a[16:19], a[68:71], v[64:67]
  ds_read_b128 a[124:127], v8 offset:55296
  v_mfma_f32_16x16x32_bf16 v[64:67], a[48:51], a[84:87], v[64:67]
  v_mfma_f32_16x16x32_bf16 v[112:115], a[16:19], a[72:75], v[112:115]
  v_mfma_f32_16x16x32_bf16 v[112:115], a[48:51], a[88:91], v[112:115]
  v_mfma_f32_16x16x32_bf16 a[128:131], a[16:19], a[76:79], a[128:131]
  s_add_u32 m0, s80, 17952
  v_mfma_f32_16x16x32_bf16 a[128:131], a[48:51], a[92:95], a[128:131]
  buffer_load_dwordx4 v3, s[48:51], s70 offen lds
  v_mfma_f32_16x16x32_bf16 a[132:135], a[20:23], a[76:79], a[132:135]
  v_mfma_f32_16x16x32_bf16 a[132:135], a[52:55], a[92:95], a[132:135]
  s_lshl_b32 s64, s36, 11
  v_and_b32 v5, 48, v0
  v_mfma_f32_16x16x32_bf16 v[116:119], a[20:23], a[72:75], v[116:119]
  v_mfma_f32_16x16x32_bf16 v[116:119], a[52:55], a[88:91], v[116:119]
  v_mfma_f32_16x16x32_bf16 v[68:71], a[20:23], a[68:71], v[68:71]
  v_mfma_f32_16x16x32_bf16 v[68:71], a[52:55], a[84:87], v[68:71]
  v_mfma_f32_16x16x32_bf16 v[52:55], a[20:23], a[64:67], v[52:55]
  s_add_u32 m0, s80, 22176
  v_mfma_f32_16x16x32_bf16 v[52:55], a[52:55], a[80:83], v[52:55]
  buffer_load_dwordx4 v3, s[52:55], s70 offen lds
  v_mfma_f32_16x16x32_bf16 v[56:59], a[24:27], a[64:67], v[56:59]
  s_add_u32 s70, s70, s74
  v_mfma_f32_16x16x32_bf16 v[56:59], a[56:59], a[80:83], v[56:59]
  v_lshl_add_u32 v5, v5, 9, v0
  v_mfma_f32_16x16x32_bf16 v[72:75], a[24:27], a[68:71], v[72:75]
  v_mfma_f32_16x16x32_bf16 v[72:75], a[56:59], a[84:87], v[72:75]
  v_mfma_f32_16x16x32_bf16 v[120:123], a[24:27], a[72:75], v[120:123]
  s_add_u32 m0, s79, 18432
  v_mfma_f32_16x16x32_bf16 v[120:123], a[56:59], a[88:91], v[120:123]
  buffer_load_dwordx4 v1, s[44:47], s69 offen lds
  v_mfma_f32_16x16x32_bf16 a[136:139], a[24:27], a[76:79], a[136:139]
  s_add_u32 s69, s69, s71
  v_mfma_f32_16x16x32_bf16 a[136:139], a[56:59], a[92:95], a[136:139]
  v_lshlrev_b32 v4, 7, v5
  v_mfma_f32_16x16x32_bf16 a[140:143], a[28:31], a[76:79], a[140:143]
  v_mfma_f32_16x16x32_bf16 a[140:143], a[60:63], a[92:95], a[140:143]
  v_mfma_f32_16x16x32_bf16 v[124:127], a[28:31], a[72:75], v[124:127]
  v_mfma_f32_16x16x32_bf16 v[124:127], a[60:63], a[88:91], v[124:127]
  v_mfma_f32_16x16x32_bf16 v[76:79], a[28:31], a[68:71], v[76:79]
  s_add_u32 m0, s80, 19008
  v_mfma_f32_16x16x32_bf16 v[76:79], a[60:63], a[84:87], v[76:79]
  buffer_load_dwordx4 v3, s[48:51], s70 offen lds
  v_mfma_f32_16x16x32_bf16 v[60:63], a[28:31], a[64:67], v[60:63]
  v_mfma_f32_16x16x32_bf16 v[60:63], a[60:63], a[80:83], v[60:63]
  s_waitcnt vmcnt(13) lgkmcnt(0)
  s_barrier
  v_mfma_f32_16x16x32_bf16 v[128:131], a[0:3], a[96:99], v[128:131]
  v_mfma_f32_16x16x32_bf16 v[128:131], a[32:35], a[112:115], v[128:131]
  ds_read_b128 a[64:67], v7 offset:0
  v_mfma_f32_16x16x32_bf16 v[144:147], a[0:3], a[100:103], v[144:147]
  v_mfma_f32_16x16x32_bf16 v[144:147], a[32:35], a[116:119], v[144:147]
  ds_read_b128 a[68:71], v7 offset:2048
  v_cvt_pk_bf16_f32 v16, v16, v17
  v_cvt_pk_bf16_f32 v17, v18, v19
  v_mfma_f32_16x16x32_bf16 v[192:195], a[0:3], a[104:107], v[192:195]
  s_add_u32 m0, s80, 23232
  v_cvt_pk_bf16_f32 v18, v20, v21
  v_mfma_f32_16x16x32_bf16 v[192:195], a[32:35], a[120:123], v[192:195]
  buffer_load_dwordx4 v3, s[52:55], s70 offen lds
  v_cvt_pk_bf16_f32 v19, v22, v23
  v_cvt_pk_bf16_f32 v20, v24, v25
  v_mfma_f32_16x16x32_bf16 v[208:211], a[0:3], a[108:111], v[208:211]
  s_add_u32 s70, s70, s74
  v_cvt_pk_bf16_f32 v21, v26, v27
  v_mfma_f32_16x16x32_bf16 v[208:211], a[32:35], a[124:127], v[208:211]
  ds_read_b128 a[72:75], v7 offset:4096
  v_cvt_pk_bf16_f32 v22, v28, v29
  v_cvt_pk_bf16_f32 v23, v30, v31
  v_mfma_f32_16x16x32_bf16 v[212:215], a[4:7], a[108:111], v[212:215]
  ds_read_b64_tr_b16 a[0:1], v9 offset:33792
  v_cvt_pk_bf16_f32 v24, v32, v33
  v_mfma_f32_16x16x32_bf16 v[212:215], a[36:39], a[124:127], v[212:215]
  ds_read_b64_tr_b16 a[2:3], v9 offset:34048
  v_cvt_pk_bf16_f32 v25, v34, v35
  v_cvt_pk_bf16_f32 v26, v36, v37
  v_mfma_f32_16x16x32_bf16 v[196:199], a[4:7], a[104:107], v[196:199]
  s_add_u32 m0, s79, 19456
  v_cvt_pk_bf16_f32 v27, v38, v39
  v_mfma_f32_16x16x32_bf16 v[196:199], a[36:39], a[120:123], v[196:199]
  buffer_load_dwordx4 v2, s[44:47], s69 offen lds
  v_cvt_pk_bf16_f32 v28, v40, v41
  v_cvt_pk_bf16_f32 v29, v42, v43
  v_mfma_f32_16x16x32_bf16 v[148:151], a[4:7], a[100:103], v[148:151]
  s_add_u32 s69, s69, s72
  v_cvt_pk_bf16_f32 v30, v44, v45
  v_mfma_f32_16x16x32_bf16 v[148:151], a[36:39], a[116:119], v[148:151]
  ds_read_b128 a[76:79], v7 offset:6144
  v_cvt_pk_bf16_f32 v31, v46, v47
  v_cvt_pk_bf16_f32 v32, v48, v49
  v_mfma_f32_16x16x32_bf16 v[132:135], a[4:7], a[96:99], v[132:135]
  ds_read_b64_tr_b16 a[32:33], v9 offset:42240
  v_cvt_pk_bf16_f32 v33, v50, v51
  v_mfma_f32_16x16x32_bf16 v[132:135], a[36:39], a[112:115], v[132:135]
  ds_read_b64_tr_b16 a[34:35], v9 offset:42496
  v_cvt_pk_bf16_f32 v34, v52, v53
  v_cvt_pk_bf16_f32 v35, v54, v55
  v_mfma_f32_16x16x32_bf16 v[136:139], a[8:11], a[96:99], v[136:139]
  ds_read_b64_tr_b16 a[4:5], v9 offset:33824
  v_cvt_pk_bf16_f32 v36, v56, v57
  v_mfma_f32_16x16x32_bf16 v[136:139], a[40:43], a[112:115], v[136:139]
  ds_read_b64_tr_b16 a[6:7], v9 offset:34080
  v_cvt_pk_bf16_f32 v37, v58, v59
  v_cvt_pk_bf16_f32 v38, v60, v61
  v_mfma_f32_16x16x32_bf16 v[152:155], a[8:11], a[100:103], v[152:155]
  s_add_u32 m0, s80, 20064
  v_cvt_pk_bf16_f32 v39, v62, v63
  v_mfma_f32_16x16x32_bf16 v[152:155], a[40:43], a[116:119], v[152:155]
  buffer_load_dwordx4 v3, s[48:51], s70 offen lds
  v_cvt_pk_bf16_f32 v40, v64, v65
  v_cvt_pk_bf16_f32 v41, v66, v67
  v_mfma_f32_16x16x32_bf16 v[200:203], a[8:11], a[104:107], v[200:203]
  ds_read_b128 a[80:83], v8 offset:0
  v_cvt_pk_bf16_f32 v42, v68, v69
  v_mfma_f32_16x16x32_bf16 v[200:203], a[40:43], a[120:123], v[200:203]
  ds_read_b64_tr_b16 a[36:37], v9 offset:42272
  v_cvt_pk_bf16_f32 v43, v70, v71
  v_cvt_pk_bf16_f32 v44, v72, v73
  v_mfma_f32_16x16x32_bf16 v[216:219], a[8:11], a[108:111], v[216:219]
  ds_read_b64_tr_b16 a[38:39], v9 offset:42528
  v_cvt_pk_bf16_f32 v45, v74, v75
  v_mfma_f32_16x16x32_bf16 v[216:219], a[40:43], a[124:127], v[216:219]
  ds_read_b64_tr_b16 a[8:9], v9 offset:38016
  v_cvt_pk_bf16_f32 v46, v76, v77
  v_cvt_pk_bf16_f32 v47, v78, v79
  v_mfma_f32_16x16x32_bf16 v[220:223], a[12:15], a[108:111], v[220:223]
  v_cvt_pk_bf16_f32 v48, v80, v81
  v_cvt_pk_bf16_f32 v49, v82, v83
  v_mfma_f32_16x16x32_bf16 v[220:223], a[44:47], a[124:127], v[220:223]
  ds_read_b64_tr_b16 a[10:11], v9 offset:38272
  v_cvt_pk_bf16_f32 v50, v84, v85
  v_cvt_pk_bf16_f32 v51, v86, v87
  v_mfma_f32_16x16x32_bf16 v[204:207], a[12:15], a[104:107], v[204:207]
  s_add_u32 m0, s80, 24288
  v_cvt_pk_bf16_f32 v52, v88, v89
  v_mfma_f32_16x16x32_bf16 v[204:207], a[44:47], a[120:123], v[204:207]
  buffer_load_dwordx4 v3, s[52:55], s70 offen lds
  v_cvt_pk_bf16_f32 v53, v90, v91
  v_cvt_pk_bf16_f32 v54, v92, v93
  v_mfma_f32_16x16x32_bf16 v[156:159], a[12:15], a[100:103], v[156:159]
  s_add_u32 s70, s70, s75
  v_cvt_pk_bf16_f32 v55, v94, v95
  v_mfma_f32_16x16x32_bf16 v[156:159], a[44:47], a[116:119], v[156:159]
  ds_read_b128 a[84:87], v8 offset:2048
  v_cvt_pk_bf16_f32 v56, v96, v97
  v_cvt_pk_bf16_f32 v57, v98, v99
  v_mfma_f32_16x16x32_bf16 v[140:143], a[12:15], a[96:99], v[140:143]
  ds_read_b64_tr_b16 a[40:41], v9 offset:46464
  v_cvt_pk_bf16_f32 v58, v100, v101
  v_mfma_f32_16x16x32_bf16 v[140:143], a[44:47], a[112:115], v[140:143]
  ds_read_b64_tr_b16 a[42:43], v9 offset:46720
  v_cvt_pk_bf16_f32 v59, v102, v103
  v_cvt_pk_bf16_f32 v60, v104, v105
  v_mfma_f32_16x16x32_bf16 v[160:163], a[16:19], a[96:99], v[160:163]
  s_add_u32 m0, s79, 49152
  v_cvt_pk_bf16_f32 v61, v106, v107
  v_mfma_f32_16x16x32_bf16 v[160:163], a[48:51], a[112:115], v[160:163]
  buffer_load_dwordx4 v1, s[44:47], s69 offen lds
  v_cvt_pk_bf16_f32 v62, v108, v109
  v_cvt_pk_bf16_f32 v63, v110, v111
  v_mfma_f32_16x16x32_bf16 v[176:179], a[16:19], a[100:103], v[176:179]
  s_add_u32 s69, s69, s71
  v_cvt_pk_bf16_f32 v64, v112, v113
  v_mfma_f32_16x16x32_bf16 v[176:179], a[48:51], a[116:119], v[176:179]
  ds_read_b64_tr_b16 a[12:13], v9 offset:38048
  v_cvt_pk_bf16_f32 v65, v114, v115
  v_cvt_pk_bf16_f32 v66, v116, v117
  v_mfma_f32_16x16x32_bf16 v[224:227], a[16:19], a[104:107], v[224:227]
  ds_read_b64_tr_b16 a[14:15], v9 offset:38304
  v_cvt_pk_bf16_f32 v67, v118, v119
  v_mfma_f32_16x16x32_bf16 v[224:227], a[48:51], a[120:123], v[224:227]
  ds_read_b128 a[88:91], v8 offset:4096
  v_cvt_pk_bf16_f32 v68, v120, v121
  v_cvt_pk_bf16_f32 v69, v122, v123
  v_mfma_f32_16x16x32_bf16 v[240:243], a[16:19], a[108:111], v[240:243]
  ds_read_b64_tr_b16 a[44:45], v9 offset:46496
  v_cvt_pk_bf16_f32 v70, v124, v125
  v_mfma_f32_16x16x32_bf16 v[240:243], a[48:51], a[124:127], v[240:243]
  ds_read_b64_tr_b16 a[46:47], v9 offset:46752
  v_cvt_pk_bf16_f32 v71, v126, v127
  v_accvgpr_read_b32 v112, a128
  v_mfma_f32_16x16x32_bf16 v[244:247], a[20:23], a[108:111], v[244:247]
  s_add_u32 m0, s79, 50176
  v_accvgpr_read_b32 v113, a129
  v_mfma_f32_16x16x32_bf16 v[244:247], a[52:55], a[124:127], v[244:247]
  buffer_load_dwordx4 v2, s[44:47], s69 offen lds
  v_accvgpr_read_b32 v114, a130
  v_accvgpr_read_b32 v115, a131
  v_mfma_f32_16x16x32_bf16 v[228:231], a[20:23], a[104:107], v[228:231]
  s_add_u32 s69, s69, s71
  v_accvgpr_read_b32 v116, a132
  v_mfma_f32_16x16x32_bf16 v[228:231], a[52:55], a[120:123], v[228:231]
  ds_read_b64_tr_b16 a[16:17], v9 offset:0
  v_accvgpr_read_b32 v117, a133
  v_accvgpr_read_b32 v118, a134
  v_mfma_f32_16x16x32_bf16 v[180:183], a[20:23], a[100:103], v[180:183]
  ds_read_b64_tr_b16 a[18:19], v9 offset:256
  v_accvgpr_read_b32 v119, a135
  v_mfma_f32_16x16x32_bf16 v[180:183], a[52:55], a[116:119], v[180:183]
  ds_read_b128 a[92:95], v8 offset:6144
  v_cvt_pk_bf16_f32 v112, v112, v113
  v_cvt_pk_bf16_f32 v113, v114, v115
  v_mfma_f32_16x16x32_bf16 v[164:167], a[20:23], a[96:99], v[164:167]
  ds_read_b64_tr_b16 a[48:49], v9 offset:8448
  v_cvt_pk_bf16_f32 v114, v116, v117
  v_mfma_f32_16x16x32_bf16 v[164:167], a[52:55], a[112:115], v[164:167]
  ds_read_b64_tr_b16 a[50:51], v9 offset:8704
  v_cvt_pk_bf16_f32 v115, v118, v119
  s_add_u32 s85, s82, 536576
  v_mfma_f32_16x16x32_bf16 v[168:171], a[24:27], a[96:99], v[168:171]
  s_add_u32 m0, s79, 51200
  buffer_store_dwordx4 v[112:115], v10, s[32:35], s85 offen sc1
  v_mfma_f32_16x16x32_bf16 v[168:171], a[56:59], a[112:115], v[168:171]
  buffer_load_dwordx4 v1, s[44:47], s69 offen lds
  v_accvgpr_read_b32 v120, a136
  v_accvgpr_read_b32 v121, a137
  v_mfma_f32_16x16x32_bf16 v[184:187], a[24:27], a[100:103], v[184:187]
  s_add_u32 s69, s69, s71
  v_accvgpr_read_b32 v122, a138
  v_mfma_f32_16x16x32_bf16 v[184:187], a[56:59], a[116:119], v[184:187]
  ds_read_b64_tr_b16 a[20:21], v9 offset:32
  v_accvgpr_read_b32 v123, a139
  v_accvgpr_read_b32 v124, a140
  v_mfma_f32_16x16x32_bf16 v[232:235], a[24:27], a[104:107], v[232:235]
  ds_read_b64_tr_b16 a[22:23], v9 offset:288
  v_accvgpr_read_b32 v125, a141
  v_mfma_f32_16x16x32_bf16 v[232:235], a[56:59], a[120:123], v[232:235]
  ds_read_b64_tr_b16 a[52:53], v9 offset:8480
  v_accvgpr_read_b32 v126, a142
  v_accvgpr_read_b32 v127, a143
  v_mfma_f32_16x16x32_bf16 v[248:251], a[24:27], a[108:111], v[248:251]
  ds_read_b64_tr_b16 a[54:55], v9 offset:8736
  v_cvt_pk_bf16_f32 v120, v120, v121
  v_mfma_f32_16x16x32_bf16 v[248:251], a[56:59], a[124:127], v[248:251]
  ds_read_b64_tr_b16 a[24:25], v9 offset:4224
  v_cvt_pk_bf16_f32 v121, v122, v123
  v_cvt_pk_bf16_f32 v122, v124, v125
  v_mfma_f32_16x16x32_bf16 v[252:255], a[28:31], a[108:111], v[252:255]
  s_add_u32 m0, s79, 52224
  v_cvt_pk_bf16_f32 v123, v126, v127
  v_mfma_f32_16x16x32_bf16 v[236:239], a[28:31], a[104:107], v[236:239]
  buffer_load_dwordx4 v2, s[44:47], s69 offen lds
  s_add_u32 s85, s82, 536576
  buffer_store_dwordx4 v[120:123], v11, s[32:35], s85 offen sc1
  v_mfma_f32_16x16x32_bf16 v[188:191], a[28:31], a[100:103], v[188:191]
  s_add_u32 s69, s69, s73
  v_mfma_f32_16x16x32_bf16 v[172:175], a[28:31], a[96:99], v[172:175]
  buffer_load_dword v13, v12, s[56:59], s83 offen
  s_add_u32 s83, s83, s84
  v_mfma_f32_16x16x32_bf16 v[172:175], a[60:63], a[112:115], v[172:175]
  ds_read_b64_tr_b16 a[26:27], v9 offset:4480
  v_mfma_f32_16x16x32_bf16 v[188:191], a[60:63], a[116:119], v[188:191]
  s_add_u32 s65, s64, 0
  buffer_load_dword v5, v4, s[60:63], s65 offen
  v_mfma_f32_16x16x32_bf16 v[236:239], a[60:63], a[120:123], v[236:239]
  ds_read_b64_tr_b16 a[56:57], v9 offset:12672
  v_mfma_f32_16x16x32_bf16 v[252:255], a[60:63], a[124:127], v[252:255]
  ds_read_b64_tr_b16 a[58:59], v9 offset:12928
  ds_read_b64_tr_b16 a[28:29], v9 offset:4256
  ds_read_b64_tr_b16 a[30:31], v9 offset:4512
  ds_read_b64_tr_b16 a[60:61], v9 offset:12704
  ds_read_b64_tr_b16 a[62:63], v9 offset:12960
L_f_t1:
  s_waitcnt lgkmcnt(15)
  v_mfma_f32_16x16x32_bf16 a[128:131], a[0:3], a[64:67], 0
  v_mfma_f32_16x16x32_bf16 a[128:131], a[32:35], a[80:83], a[128:131]
  v_mfma_f32_16x16x32_bf16 a[144:147], a[0:3], a[68:71], 0
  v_mfma_f32_16x16x32_bf16 a[144:147], a[32:35], a[84:87], a[144:147]
  v_cvt_pk_bf16_f32 v72, v128, v129
  v_cvt_pk_bf16_f32 v73, v130, v131
  v_mfma_f32_16x16x32_bf16 a[160:163], a[0:3], a[72:75], 0
  v_cvt_pk_bf16_f32 v74, v132, v133
  v_cvt_pk_bf16_f32 v75, v134, v135
  v_mfma_f32_16x16x32_bf16 a[160:163], a[32:35], a[88:91], a[160:163]
  v_cvt_pk_bf16_f32 v76, v136, v137
  v_cvt_pk_bf16_f32 v77, v138, v139
  v_mfma_f32_16x16x32_bf16 a[176:179], a[0:3], a[76:79], 0
  v_cvt_pk_bf16_f32 v78, v140, v141
  v_cvt_pk_bf16_f32 v79, v142, v143
  s_waitcnt lgkmcnt(14)
  v_mfma_f32_16x16x32_bf16 a[176:179], a[32:35], a[92:95], a[176:179]
  v_cvt_pk_bf16_f32 v80, v144, v145
  v_cvt_pk_bf16_f32 v81, v146, v147
  s_waitcnt vmcnt(21) lgkmcnt(0)
  s_barrier
  v_mfma_f32_16x16x32_bf16 a[180:183], a[4:7], a[76:79], 0
  s_add_u32 m0, s79, 0
  v_cvt_pk_bf16_f32 v82, v148, v149
  v_mfma_f32_16x16x32_bf16 a[180:183], a[36:39], a[92:95], a[180:183]
  buffer_load_dwordx4 v1, s[44:47], s69 offen lds
  v_cvt_pk_bf16_f32 v83, v150, v151
  v_mfma_f32_16x16x32_bf16 a[164:167], a[4:7], a[72:75], 0
  s_add_u32 s69, s69, s71
  v_cvt_pk_bf16_f32 v84, v152, v153
  v_mfma_f32_16x16x32_bf16 a[164:167], a[36:39], a[88:91], a[164:167]
  ds_read_b128 a[96:99], v7 offset:32768
  v_cvt_pk_bf16_f32 v85, v154, v155
  v_mfma_f32_16x16x32_bf16 a[148:151], a[4:7], a[68:71], 0
  v_cvt_pk_bf16_f32 v86, v156, v157
  v_cvt_pk_bf16_f32 v87, v158, v159
  v_mfma_f32_16x16x32_bf16 a[148:151], a[36:39], a[84:87], a[148:151]
  ds_read_b128 a[100:103], v7 offset:34816
  v_cvt_pk_bf16_f32 v88, v160, v161
  v_mfma_f32_16x16x32_bf16 a[132:135], a[4:7], a[64:67], 0
  v_cvt_pk_bf16_f32 v89, v162, v163
  v_cvt_pk_bf16_f32 v90, v164, v165
  v_mfma_f32_16x16x32_bf16 a[132:135], a[36:39], a[80:83], a[132:135]
  ds_read_b128 a[104:107], v7 offset:36864
  v_cvt_pk_bf16_f32 v91, v166, v167
  v_mfma_f32_16x16x32_bf16 a[136:139], a[8:11], a[64:67], 0
  s_add_u32 m0, s80, 0
  v_cvt_pk_bf16_f32 v92, v168, v169
  v_mfma_f32_16x16x32_bf16 a[136:139], a[40:43], a[80:83], a[136:139]
  buffer_load_dwordx4 v3, s[48:51], s70 offen lds
  v_cvt_pk_bf16_f32 v93, v170, v171
  v_mfma_f32_16x16x32_bf16 a[152:155], a[8:11], a[68:71], 0
  ds_read_b128 a[108:111], v7 offset:38912
  v_cvt_pk_bf16_f32 v94, v172, v173
  v_mfma_f32_16x16x32_bf16 a[152:155], a[40:43], a[84:87], a[152:155]
  s_add_u32 s85, s82, 0
  buffer_store_dwordx4 v[16:19], v10, s[32:35], s85 offen sc1
  v_mfma_f32_16x16x32_bf16 a[168:171], a[8:11], a[72:75], 0
  v_cvt_pk_bf16_f32 v95, v174, v175
  v_cvt_pk_bf16_f32 v96, v176, v177
  v_mfma_f32_16x16x32_bf16 a[168:171], a[40:43], a[88:91], a[168:171]
  ds_read_b128 a[112:115], v8 offset:32768
  v_cvt_pk_bf16_f32 v97, v178, v179
  v_mfma_f32_16x16x32_bf16 a[184:187], a[8:11], a[76:79], 0
  s_add_u32 m0, s80, 4224
  v_cvt_pk_bf16_f32 v98, v180, v181
  v_mfma_f32_16x16x32_bf16 a[184:187], a[40:43], a[92:95], a[184:187]
  buffer_load_dwordx4 v3, s[52:55], s70 offen lds
  v_cvt_pk_bf16_f32 v99, v182, v183
  v_mfma_f32_16x16x32_bf16 a[188:191], a[12:15], a[76:79], 0
  s_add_u32 s70, s70, s74
  v_cvt_pk_bf16_f32 v100, v184, v185
  v_mfma_f32_16x16x32_bf16 a[188:191], a[44:47], a[92:95], a[188:191]
  ds_read_b128 a[116:119], v8 offset:34816
  v_cvt_pk_bf16_f32 v101, v186, v187
  v_mfma_f32_16x16x32_bf16 a[172:175], a[12:15], a[72:75], 0
  v_cvt_pk_bf16_f32 v102, v188, v189
  v_cvt_pk_bf16_f32 v103, v190, v191
  v_mfma_f32_16x16x32_bf16 a[172:175], a[44:47], a[88:91], a[172:175]
  ds_read_b128 a[120:123], v8 offset:36864
  v_cvt_pk_bf16_f32 v104, v192, v193
  v_mfma_f32_16x16x32_bf16 a[156:159], a[12:15], a[68:71], 0
  v_cvt_pk_bf16_f32 v105, v194, v195
  v_cvt_pk_bf16_f32 v106, v196, v197
  v_mfma_f32_16x16x32_bf16 a[156:159], a[44:47], a[84:87], a[156:159]
  ds_read_b128 a[124:127], v8 offset:38912
  v_cvt_pk_bf16_f32 v107, v198, v199
  v_mfma_f32_16x16x32_bf16 a[140:143], a[12:15], a[64:67], 0
  s_add_u32 m0, s79, 1024
  v_cvt_pk_bf16_f32 v108, v200, v201
  v_mfma_f32_16x16x32_bf16 a[140:143], a[44:47], a[80:83], a[140:143]
  buffer_load_dwordx4 v2, s[44:47], s69 offen lds
  v_cvt_pk_bf16_f32 v109, v202, v203
  v_mfma_f32_16x16x32_bf16 a[192:195], a[16:19], a[64:67], 0
  s_add_u32 s69, s69, s71
  v_cvt_pk_bf16_f32 v110, v204, v205
  v_mfma_f32_16x16x32_bf16 a[192:195], a[48:51], a[80:83], a[192:195]
  v_cvt_pk_bf16_f32 v111, v206, v207
  v_cvt_pk_bf16_f32 v112, v208, v209
  v_mfma_f32_16x16x32_bf16 a[208:211], a[16:19], a[68:71], 0
  v_cvt_pk_bf16_f32 v113, v210, v211
  v_cvt_pk_bf16_f32 v114, v212, v213
  v_mfma_f32_16x16x32_bf16 a[208:211], a[48:51], a[84:87], a[208:211]
  v_cvt_pk_bf16_f32 v115, v214, v215
  v_cvt_pk_bf16_f32 v116, v216, v217
  v_mfma_f32_16x16x32_bf16 a[224:227], a[16:19], a[72:75], 0
  v_cvt_pk_bf16_f32 v117, v218, v219
  v_cvt_pk_bf16_f32 v118, v220, v221
  v_mfma_f32_16x16x32_bf16 a[224:227], a[48:51], a[88:91], a[224:227]
  v_cvt_pk_bf16_f32 v119, v222, v223
  v_cvt_pk_bf16_f32 v120, v224, v225
  v_mfma_f32_16x16x32_bf16 a[240:243], a[16:19], a[76:79], 0
  s_add_u32 m0, s80, 1056
  v_cvt_pk_bf16_f32 v121, v226, v227
  v_mfma_f32_16x16x32_bf16 a[240:243], a[48:51], a[92:95], a[240:243]
  buffer_load_dwordx4 v3, s[48:51], s70 offen lds
  v_cvt_pk_bf16_f32 v122, v228, v229
  v_mfma_f32_16x16x32_bf16 a[244:247], a[20:23], a[76:79], 0
  v_cvt_pk_bf16_f32 v123, v230, v231
  v_cvt_pk_bf16_f32 v124, v232, v233
  v_mfma_f32_16x16x32_bf16 a[244:247], a[52:55], a[92:95], a[244:247]
  s_add_u32 s85, s82, 0
  buffer_store_dwordx4 v[20:23], v11, s[32:35], s85 offen sc1
  v_mfma_f32_16x16x32_bf16 a[228:231], a[20:23], a[72:75], 0
  v_cvt_pk_bf16_f32 v125, v234, v235
  v_cvt_pk_bf16_f32 v126, v236, v237
  v_mfma_f32_16x16x32_bf16 a[228:231], a[52:55], a[88:91], a[228:231]
  v_cvt_pk_bf16_f32 v127, v238, v239
  v_cvt_pk_bf16_f32 v240, v240, v241
  v_mfma_f32_16x16x32_bf16 a[212:215], a[20:23], a[68:71], 0
  v_cvt_pk_bf16_f32 v241, v242, v243
  v_cvt_pk_bf16_f32 v242, v244, v245
  v_mfma_f32_16x16x32_bf16 a[212:215], a[52:55], a[84:87], a[212:215]
  v_cvt_pk_bf16_f32 v243, v246, v247
  s_add_u32 s85, s82, 552960
  v_mfma_f32_16x16x32_bf16 a[196:199], a[20:23], a[64:67], 0
  s_add_u32 m0, s80, 5280
  buffer_store_dwordx4 v[240:243], v10, s[32:35], s85 offen sc1
  v_mfma_f32_16x16x32_bf16 a[196:199], a[52:55], a[80:83], a[196:199]
  buffer_load_dwordx4 v3, s[52:55], s70 offen lds
  v_cvt_pk_bf16_f32 v248, v248, v249
  v_mfma_f32_16x16x32_bf16 a[200:203], a[24:27], a[64:67], 0
  s_add_u32 s70, s70, s74
  v_cvt_pk_bf16_f32 v249, v250, v251
  v_mfma_f32_16x16x32_bf16 a[200:203], a[56:59], a[80:83], a[200:203]
  v_cvt_pk_bf16_f32 v250, v252, v253
  v_cvt_pk_bf16_f32 v251, v254, v255
  v_mfma_f32_16x16x32_bf16 a[216:219], a[24:27], a[68:71], 0
  s_add_u32 s85, s82, 552960
  buffer_store_dwordx4 v[248:251], v11, s[32:35], s85 offen sc1
  v_mfma_f32_16x16x32_bf16 a[216:219], a[56:59], a[84:87], a[216:219]
  v_mfma_f32_16x16x32_bf16 a[232:235], a[24:27], a[72:75], 0
  s_add_u32 m0, s79, 2048
  v_mfma_f32_16x16x32_bf16 a[232:235], a[56:59], a[88:91], a[232:235]
  buffer_load_dwordx4 v1, s[44:47], s69 offen lds
  v_mfma_f32_16x16x32_bf16 a[248:251], a[24:27], a[76:79], 0
  s_add_u32 s69, s69, s71
  v_mfma_f32_16x16x32_bf16 a[248:251], a[56:59], a[92:95], a[248:251]
  v_mfma_f32_16x16x32_bf16 a[252:255], a[28:31], a[76:79], 0
  v_mfma_f32_16x16x32_bf16 a[252:255], a[60:63], a[92:95], a[252:255]
  v_mfma_f32_16x16x32_bf16 a[236:239], a[28:31], a[72:75], 0
  v_mfma_f32_16x16x32_bf16 a[236:239], a[60:63], a[88:91], a[236:239]
  v_mfma_f32_16x16x32_bf16 a[220:223], a[28:31], a[68:71], 0
  s_add_u32 m0, s80, 2112
  v_mfma_f32_16x16x32_bf16 a[220:223], a[60:63], a[84:87], a[220:223]
  buffer_load_dwordx4 v3, s[48:51], s70 offen lds
  v_mfma_f32_16x16x32_bf16 a[204:207], a[28:31], a[64:67], 0
  v_mfma_f32_16x16x32_bf16 a[204:207], a[60:63], a[80:83], a[204:207]
  s_add_u32 s85, s82, 4096
  buffer_store_dwordx4 v[24:27], v10, s[32:35], s85 offen sc1
  s_waitcnt vmcnt(21) lgkmcnt(0)
  s_barrier
  v_mfma_f32_16x16x32_bf16 v[192:195], a[0:3], a[96:99], 0
  v_mfma_f32_16x16x32_bf16 v[192:195], a[32:35], a[112:115], v[192:195]
  ds_read_b128 a[64:67], v7 offset:16384
  v_mfma_f32_16x16x32_bf16 v[208:211], a[0:3], a[100:103], 0
  v_mfma_f32_16x16x32_bf16 v[208:211], a[32:35], a[116:119], v[208:211]
  ds_read_b128 a[68:71], v7 offset:18432
  v_mfma_f32_16x16x32_bf16 v[224:227], a[0:3], a[104:107], 0
  s_add_u32 m0, s80, 6336
  v_mfma_f32_16x16x32_bf16 v[224:227], a[32:35], a[120:123], v[224:227]
  buffer_load_dwordx4 v3, s[52:55], s70 offen lds
  v_mfma_f32_16x16x32_bf16 v[240:243], a[0:3], a[108:111], 0
  s_add_u32 s70, s70, s74
  v_mfma_f32_16x16x32_bf16 v[240:243], a[32:35], a[124:127], v[240:243]
  ds_read_b128 a[72:75], v7 offset:20480
  v_mfma_f32_16x16x32_bf16 v[244:247], a[4:7], a[108:111], 0
  ds_read_b64_tr_b16 a[0:1], v9 offset:50688
  v_mfma_f32_16x16x32_bf16 v[244:247], a[36:39], a[124:127], v[244:247]
  ds_read_b64_tr_b16 a[2:3], v9 offset:50944
  v_mfma_f32_16x16x32_bf16 v[228:231], a[4:7], a[104:107], 0
  s_add_u32 m0, s79, 3072
  v_mfma_f32_16x16x32_bf16 v[228:231], a[36:39], a[120:123], v[228:231]
  buffer_load_dwordx4 v2, s[44:47], s69 offen lds
  v_mfma_f32_16x16x32_bf16 v[212:215], a[4:7], a[100:103], 0
  s_add_u32 s69, s69, s72
  v_mfma_f32_16x16x32_bf16 v[212:215], a[36:39], a[116:119], v[212:215]
  ds_read_b128 a[76:79], v7 offset:22528
  v_mfma_f32_16x16x32_bf16 v[196:199], a[4:7], a[96:99], 0
  ds_read_b64_tr_b16 a[32:33], v9 offset:59136
  v_mfma_f32_16x16x32_bf16 v[196:199], a[36:39], a[112:115], v[196:199]
  ds_read_b64_tr_b16 a[34:35], v9 offset:59392
  v_mfma_f32_16x16x32_bf16 v[200:203], a[8:11], a[96:99], 0
  ds_read_b64_tr_b16 a[4:5], v9 offset:50720
  v_mfma_f32_16x16x32_bf16 v[200:203], a[40:43], a[112:115], v[200:203]
  ds_read_b64_tr_b16 a[6:7], v9 offset:50976
  v_mfma_f32_16x16x32_bf16 v[216:219], a[8:11], a[100:103], 0
  s_add_u32 m0, s80, 3168
  v_mfma_f32_16x16x32_bf16 v[216:219], a[40:43], a[116:119], v[216:219]
  buffer_load_dwordx4 v3, s[48:51], s70 offen lds
  v_mfma_f32_16x16x32_bf16 v[232:235], a[8:11], a[104:107], 0
  ds_read_b128 a[80:83], v8 offset:16384
  v_mfma_f32_16x16x32_bf16 v[232:235], a[40:43], a[120:123], v[232:235]
  s_add_u32 s85, s82, 4096
  buffer_store_dwordx4 v[28:31], v11, s[32:35], s85 offen sc1
  v_mfma_f32_16x16x32_bf16 v[248:251], a[8:11], a[108:111], 0
  ds_read_b64_tr_b16 a[36:37], v9 offset:59168
  v_mfma_f32_16x16x32_bf16 v[248:251], a[40:43], a[124:127], v[248:251]
  ds_read_b64_tr_b16 a[38:39], v9 offset:59424
  v_mfma_f32_16x16x32_bf16 v[252:255], a[12:15], a[108:111], 0
  ds_read_b64_tr_b16 a[8:9], v9 offset:54912
  v_mfma_f32_16x16x32_bf16 v[252:255], a[44:47], a[124:127], v[252:255]
  ds_read_b64_tr_b16 a[10:11], v9 offset:55168
  v_mfma_f32_16x16x32_bf16 v[236:239], a[12:15], a[104:107], 0
  s_add_u32 m0, s80, 7392
  v_mfma_f32_16x16x32_bf16 v[236:239], a[44:47], a[120:123], v[236:239]
  buffer_load_dwordx4 v3, s[52:55], s70 offen lds
  v_mfma_f32_16x16x32_bf16 v[220:223], a[12:15], a[100:103], 0
  s_add_u32 s70, s70, s75
  v_mfma_f32_16x16x32_bf16 v[220:223], a[44:47], a[116:119], v[220:223]
  ds_read_b128 a[84:87], v8 offset:18432
  v_mfma_f32_16x16x32_bf16 v[204:207], a[12:15], a[96:99], 0
  ds_read_b64_tr_b16 a[40:41], v9 offset:63360
  v_mfma_f32_16x16x32_bf16 v[204:207], a[44:47], a[112:115], v[204:207]
  ds_read_b64_tr_b16 a[42:43], v9 offset:63616
  v_mfma_f32_16x16x32_bf16 v[128:131], a[16:19], a[96:99], 0
  s_add_u32 m0, s79, 32768
  v_mfma_f32_16x16x32_bf16 v[128:131], a[48:51], a[112:115], v[128:131]
  buffer_load_dwordx4 v1, s[44:47], s69 offen lds
  v_mfma_f32_16x16x32_bf16 v[144:147], a[16:19], a[100:103], 0
  s_add_u32 s69, s69, s71
  v_mfma_f32_16x16x32_bf16 v[144:147], a[48:51], a[116:119], v[144:147]
  ds_read_b64_tr_b16 a[12:13], v9 offset:54944
  v_mfma_f32_16x16x32_bf16 v[160:163], a[16:19], a[104:107], 0
  ds_read_b64_tr_b16 a[14:15], v9 offset:55200
  v_mfma_f32_16x16x32_bf16 v[160:163], a[48:51], a[120:123], v[160:163]
  ds_read_b128 a[88:91], v8 offset:20480
  v_mfma_f32_16x16x32_bf16 v[176:179], a[16:19], a[108:111], 0
  ds_read_b64_tr_b16 a[44:45], v9 offset:63392
  v_mfma_f32_16x16x32_bf16 v[176:179], a[48:51], a[124:127], v[176:179]
  ds_read_b64_tr_b16 a[46:47], v9 offset:63648
  v_mfma_f32_16x16x32_bf16 v[180:183], a[20:23], a[108:111], 0
  s_add_u32 m0, s79, 33792
  v_mfma_f32_16x16x32_bf16 v[180:183], a[52:55], a[124:127], v[180:183]
  buffer_load_dwordx4 v2, s[44:47], s69 offen lds
  v_mfma_f32_16x16x32_bf16 v[164:167], a[20:23], a[104:107], 0
  s_add_u32 s69, s69, s71
  v_mfma_f32_16x16x32_bf16 v[164:167], a[52:55], a[120:123], v[164:167]
  s_add_u32 s85, s82, 524288
  buffer_store_dwordx4 v[32:35], v10, s[32:35], s85 offen sc1
  v_mfma_f32_16x16x32_bf16 v[148:151], a[20:23], a[100:103], 0
  ds_read_b64_tr_b16 a[16:17], v9 offset:16896
  v_mfma_f32_16x16x32_bf16 v[148:151], a[52:55], a[116:119], v[148:151]
  ds_read_b64_tr_b16 a[18:19], v9 offset:17152
  v_mfma_f32_16x16x32_bf16 v[132:135], a[20:23], a[96:99], 0
  ds_read_b128 a[92:95], v8 offset:22528
  v_mfma_f32_16x16x32_bf16 v[132:135], a[52:55], a[112:115], v[132:135]
  ds_read_b64_tr_b16 a[48:49], v9 offset:25344
  v_mfma_f32_16x16x32_bf16 v[136:139], a[24:27], a[96:99], 0
  s_add_u32 m0, s79, 34816
  v_mfma_f32_16x16x32_bf16 v[136:139], a[56:59], a[112:115], v[136:139]
  buffer_load_dwordx4 v1, s[44:47], s69 offen lds
  v_mfma_f32_16x16x32_bf16 v[152:155], a[24:27], a[100:103], 0
  s_add_u32 s69, s69, s71
  v_mfma_f32_16x16x32_bf16 v[152:155], a[56:59], a[116:119], v[152:155]
  ds_read_b64_tr_b16 a[50:51], v9 offset:25600
  v_mfma_f32_16x16x32_bf16 v[168:171], a[24:27], a[104:107], 0
  ds_read_b64_tr_b16 a[20:21], v9 offset:16928
  v_mfma_f32_16x16x32_bf16 v[168:171], a[56:59], a[120:123], v[168:171]
  ds_read_b64_tr_b16 a[22:23], v9 offset:17184
  v_mfma_f32_16x16x32_bf16 v[184:187], a[24:27], a[108:111], 0
  ds_read_b64_tr_b16 a[52:53], v9 offset:25376
  v_mfma_f32_16x16x32_bf16 v[184:187], a[56:59], a[124:127], v[184:187]
  ds_read_b64_tr_b16 a[54:55], v9 offset:25632
  v_mfma_f32_16x16x32_bf16 v[188:191], a[28:31], a[108:111], 0
  s_add_u32 m0, s79, 35840
  v_mfma_f32_16x16x32_bf16 v[172:175], a[28:31], a[104:107], 0
  buffer_load_dwordx4 v2, s[44:47], s69 offen lds
  v_mfma_f32_16x16x32_bf16 v[156:159], a[28:31], a[100:103], 0
  s_add_u32 s69, s69, s73
  v_mfma_f32_16x16x32_bf16 v[140:143], a[28:31], a[96:99], 0
  ds_read_b64_tr_b16 a[24:25], v9 offset:21120
  v_mfma_f32_16x16x32_bf16 v[140:143], a[60:63], a[112:115], v[140:143]
  ds_read_b64_tr_b16 a[26:27], v9 offset:21376
  v_mfma_f32_16x16x32_bf16 v[156:159], a[60:63], a[116:119], v[156:159]
  ds_read_b64_tr_b16 a[56:57], v9 offset:29568
  v_mfma_f32_16x16x32_bf16 v[172:175], a[60:63], a[120:123], v[172:175]
  ds_read_b64_tr_b16 a[58:59], v9 offset:29824
  v_mfma_f32_16x16x32_bf16 v[188:191], a[60:63], a[124:127], v[188:191]
  ds_read_b64_tr_b16 a[28:29], v9 offset:21152
  ds_read_b64_tr_b16 a[30:31], v9 offset:21408
  ds_read_b64_tr_b16 a[60:61], v9 offset:29600
  ds_read_b64_tr_b16 a[62:63], v9 offset:29856
  s_waitcnt lgkmcnt(15)
  v_mfma_f32_16x16x32_bf16 a[128:131], a[0:3], a[64:67], a[128:131]
  v_mfma_f32_16x16x32_bf16 a[128:131], a[32:35], a[80:83], a[128:131]
  v_mfma_f32_16x16x32_bf16 a[144:147], a[0:3], a[68:71], a[144:147]
  v_mfma_f32_16x16x32_bf16 a[144:147], a[32:35], a[84:87], a[144:147]
  v_mfma_f32_16x16x32_bf16 a[160:163], a[0:3], a[72:75], a[160:163]
  v_mfma_f32_16x16x32_bf16 a[160:163], a[32:35], a[88:91], a[160:163]
  v_mfma_f32_16x16x32_bf16 a[176:179], a[0:3], a[76:79], a[176:179]
  s_waitcnt lgkmcnt(14)
  v_mfma_f32_16x16x32_bf16 a[176:179], a[32:35], a[92:95], a[176:179]
  s_waitcnt vmcnt(26) lgkmcnt(0)
  s_barrier
  v_mfma_f32_16x16x32_bf16 a[180:183], a[4:7], a[76:79], a[180:183]
  s_add_u32 m0, s79, 16384
  v_mfma_f32_16x16x32_bf16 a[180:183], a[36:39], a[92:95], a[180:183]
  buffer_load_dwordx4 v1, s[44:47], s69 offen lds
  v_mfma_f32_16x16x32_bf16 a[164:167], a[4:7], a[72:75], a[164:167]
  s_add_u32 s69, s69, s71
  v_mfma_f32_16x16x32_bf16 a[164:167], a[36:39], a[88:91], a[164:167]
  ds_read_b128 a[96:99], v7 offset:49152
  v_mfma_f32_16x16x32_bf16 a[148:151], a[4:7], a[68:71], a[148:151]
  v_mfma_f32_16x16x32_bf16 a[148:151], a[36:39], a[84:87], a[148:151]
  ds_read_b128 a[100:103], v7 offset:51200
  v_mfma_f32_16x16x32_bf16 a[132:135], a[4:7], a[64:67], a[132:135]
  v_mfma_f32_16x16x32_bf16 a[132:135], a[36:39], a[80:83], a[132:135]
  ds_read_b128 a[104:107], v7 offset:53248
  v_mfma_f32_16x16x32_bf16 a[136:139], a[8:11], a[64:67], a[136:139]
  s_add_u32 m0, s80, 16896
  v_mfma_f32_16x16x32_bf16 a[136:139], a[40:43], a[80:83], a[136:139]
  buffer_load_dwordx4 v3, s[48:51], s70 offen lds
  v_mfma_f32_16x16x32_bf16 a[152:155], a[8:11], a[68:71], a[152:155]
  ds_read_b128 a[108:111], v7 offset:55296
  v_mfma_f32_16x16x32_bf16 a[152:155], a[40:43], a[84:87], a[152:155]
  s_add_u32 s85, s82, 524288
  buffer_store_dwordx4 v[36:39], v11, s[32:35], s85 offen sc1
  v_mfma_f32_16x16x32_bf16 a[168:171], a[8:11], a[72:75], a[168:171]
  v_mfma_f32_16x16x32_bf16 a[168:171], a[40:43], a[88:91], a[168:171]
  ds_read_b128 a[112:115], v8 offset:49152
  v_mfma_f32_16x16x32_bf16 a[184:187], a[8:11], a[76:79], a[184:187]
  s_add_u32 m0, s80, 21120
  v_mfma_f32_16x16x32_bf16 a[184:187], a[40:43], a[92:95], a[184:187]
  buffer_load_dwordx4 v3, s[52:55], s70 offen lds
  v_mfma_f32_16x16x32_bf16 a[188:191], a[12:15], a[76:79], a[188:191]
  s_add_u32 s70, s70, s74
  v_mfma_f32_16x16x32_bf16 a[188:191], a[44:47], a[92:95], a[188:191]
  ds_read_b128 a[116:119], v8 offset:51200
  v_mfma_f32_16x16x32_bf16 a[172:175], a[12:15], a[72:75], a[172:175]
  v_mfma_f32_16x16x32_bf16 a[172:175], a[44:47], a[88:91], a[172:175]
  ds_read_b128 a[120:123], v8 offset:53248
  v_mfma_f32_16x16x32_bf16 a[156:159], a[12:15], a[68:71], a[156:159]
  v_mfma_f32_16x16x32_bf16 a[156:159], a[44:47], a[84:87], a[156:159]
  ds_read_b128 a[124:127], v8 offset:55296
  v_mfma_f32_16x16x32_bf16 a[140:143], a[12:15], a[64:67], a[140:143]
  s_add_u32 m0, s79, 17408
  v_mfma_f32_16x16x32_bf16 a[140:143], a[44:47], a[80:83], a[140:143]
  buffer_load_dwordx4 v2, s[44:47], s69 offen lds
  v_mfma_f32_16x16x32_bf16 a[192:195], a[16:19], a[64:67], a[192:195]
  s_add_u32 s69, s69, s71
  v_mfma_f32_16x16x32_bf16 a[192:195], a[48:51], a[80:83], a[192:195]
  v_mfma_f32_16x16x32_bf16 a[208:211], a[16:19], a[68:71], a[208:211]
  v_mfma_f32_16x16x32_bf16 a[208:211], a[48:51], a[84:87], a[208:211]
  v_mfma_f32_16x16x32_bf16 a[224:227], a[16:19], a[72:75], a[224:227]
  v_mfma_f32_16x16x32_bf16 a[224:227], a[48:51], a[88:91], a[224:227]
  v_mfma_f32_16x16x32_bf16 a[240:243], a[16:19], a[76:79], a[240:243]
  s_add_u32 m0, s80, 17952
  v_mfma_f32_16x16x32_bf16 a[240:243], a[48:51], a[92:95], a[240:243]
  buffer_load_dwordx4 v3, s[48:51], s70 offen lds
  v_mfma_f32_16x16x32_bf16 a[244:247], a[20:23], a[76:79], a[244:247]
  v_mfma_f32_16x16x32_bf16 a[244:247], a[52:55], a[92:95], a[244:247]
  s_add_u32 s85, s82, 528384
  buffer_store_dwordx4 v[40:43], v10, s[32:35], s85 offen sc1
  v_mfma_f32_16x16x32_bf16 a[228:231], a[20:23], a[72:75], a[228:231]
  v_mfma_f32_16x16x32_bf16 a[228:231], a[52:55], a[88:91], a[228:231]
  v_mfma_f32_16x16x32_bf16 a[212:215], a[20:23], a[68:71], a[212:215]
  v_mfma_f32_16x16x32_bf16 a[212:215], a[52:55], a[84:87], a[212:215]
  v_mfma_f32_16x16x32_bf16 a[196:199], a[20:23], a[64:67], a[196:199]
  s_add_u32 m0, s80, 22176
  v_mfma_f32_16x16x32_bf16 a[196:199], a[52:55], a[80:83], a[196:199]
  buffer_load_dwordx4 v3, s[52:55], s70 offen lds
  v_mfma_f32_16x16x32_bf16 a[200:203], a[24:27], a[64:67], a[200:203]
  s_add_u32 s70, s70, s74
  v_mfma_f32_16x16x32_bf16 a[200:203], a[56:59], a[80:83], a[200:203]
  v_mfma_f32_16x16x32_bf16 a[216:219], a[24:27], a[68:71], a[216:219]
  v_mfma_f32_16x16x32_bf16 a[216:219], a[56:59], a[84:87], a[216:219]
  v_mfma_f32_16x16x32_bf16 a[232:235], a[24:27], a[72:75], a[232:235]
  s_add_u32 m0, s79, 18432
  v_mfma_f32_16x16x32_bf16 a[232:235], a[56:59], a[88:91], a[232:235]
  buffer_load_dwordx4 v1, s[44:47], s69 offen lds
  v_mfma_f32_16x16x32_bf16 a[248:251], a[24:27], a[76:79], a[248:251]
  s_add_u32 s69, s69, s71
  v_mfma_f32_16x16x32_bf16 a[248:251], a[56:59], a[92:95], a[248:251]
  v_mfma_f32_16x16x32_bf16 a[252:255], a[28:31], a[76:79], a[252:255]
  v_mfma_f32_16x16x32_bf16 a[252:255], a[60:63], a[92:95], a[252:255]
  v_mfma_f32_16x16x32_bf16 a[236:239], a[28:31], a[72:75], a[236:239]
  v_mfma_f32_16x16x32_bf16 a[236:239], a[60:63], a[88:91], a[236:239]
  v_mfma_f32_16x16x32_bf16 a[220:223], a[28:31], a[68:71], a[220:223]
  s_add_u32 m0, s80, 19008
  v_mfma_f32_16x16x32_bf16 a[220:223], a[60:63], a[84:87], a[220:223]
  buffer_load_dwordx4 v3, s[48:51], s70 offen lds
  v_mfma_f32_16x16x32_bf16 a[204:207], a[28:31], a[64:67], a[204:207]
  v_mfma_f32_16x16x32_bf16 a[204:207], a[60:63], a[80:83], a[204:207]
  s_add_u32 s85, s82, 528384
  buffer_store_dwordx4 v[44:47], v11, s[32:35], s85 offen sc1
  s_waitcnt vmcnt(16) lgkmcnt(0)
  s_barrier
  v_mfma_f32_16x16x32_bf16 v[192:195], a[0:3], a[96:99], v[192:195]
  v_mfma_f32_16x16x32_bf16 v[192:195], a[32:35], a[112:115], v[192:195]
  ds_read_b128 a[64:67], v7 offset:0
  v_mfma_f32_16x16x32_bf16 v[208:211], a[0:3], a[100:103], v[208:211]
  v_mfma_f32_16x16x32_bf16 v[208:211], a[32:35], a[116:119], v[208:211]
  ds_read_b128 a[68:71], v7 offset:2048
  v_mfma_f32_16x16x32_bf16 v[224:227], a[0:3], a[104:107], v[224:227]
  s_add_u32 m0, s80, 23232
  v_mfma_f32_16x16x32_bf16 v[224:227], a[32:35], a[120:123], v[224:227]
  buffer_load_dwordx4 v3, s[52:55], s70 offen lds
  v_mfma_f32_16x16x32_bf16 v[240:243], a[0:3], a[108:111], v[240:243]
  s_add_u32 s70, s70, s74
  v_mfma_f32_16x16x32_bf16 v[240:243], a[32:35], a[124:127], v[240:243]
  ds_read_b128 a[72:75], v7 offset:4096
  v_mfma_f32_16x16x32_bf16 v[244:247], a[4:7], a[108:111], v[244:247]
  ds_read_b64_tr_b16 a[0:1], v9 offset:33792
  v_mfma_f32_16x16x32_bf16 v[244:247], a[36:39], a[124:127], v[244:247]
  ds_read_b64_tr_b16 a[2:3], v9 offset:34048
  v_mfma_f32_16x16x32_bf16 v[228:231], a[4:7], a[104:107], v[228:231]
  s_add_u32 m0, s79, 19456
  v_mfma_f32_16x16x32_bf16 v[228:231], a[36:39], a[120:123], v[228:231]
  buffer_load_dwordx4 v2, s[44:47], s69 offen lds
  v_mfma_f32_16x16x32_bf16 v[212:215], a[4:7], a[100:103], v[212:215]
  s_add_u32 s69, s69, s72
  v_mfma_f32_16x16x32_bf16 v[212:215], a[36:39], a[116:119], v[212:215]
  ds_read_b128 a[76:79], v7 offset:6144
  v_mfma_f32_16x16x32_bf16 v[196:199], a[4:7], a[96:99], v[196:199]
  ds_read_b64_tr_b16 a[32:33], v9 offset:42240
  v_mfma_f32_16x16x32_bf16 v[196:199], a[36:39], a[112:115], v[196:199]
  ds_read_b64_tr_b16 a[34:35], v9 offset:42496
  v_mfma_f32_16x16x32_bf16 v[200:203], a[8:11], a[96:99], v[200:203]
  ds_read_b64_tr_b16 a[4:5], v9 offset:33824
  v_mfma_f32_16x16x32_bf16 v[200:203], a[40:43], a[112:115], v[200:203]
  ds_read_b64_tr_b16 a[6:7], v9 offset:34080
  v_mfma_f32_16x16x32_bf16 v[216:219], a[8:11], a[100:103], v[216:219]
  s_add_u32 m0, s80, 20064
  v_mfma_f32_16x16x32_bf16 v[216:219], a[40:43], a[116:119], v[216:219]
  buffer_load_dwordx4 v3, s[48:51], s70 offen lds
  v_mfma_f32_16x16x32_bf16 v[232:235], a[8:11], a[104:107], v[232:235]
  ds_read_b128 a[80:83], v8 offset:0
  v_mfma_f32_16x16x32_bf16 v[232:235], a[40:43], a[120:123], v[232:235]
  s_add_u32 s85, s82, 8192
  buffer_store_dwordx4 v[48:51], v10, s[32:35], s85 offen sc1
  v_mfma_f32_16x16x32_bf16 v[248:251], a[8:11], a[108:111], v[248:251]
  ds_read_b64_tr_b16 a[36:37], v9 offset:42272
  v_mfma_f32_16x16x32_bf16 v[248:251], a[40:43], a[124:127], v[248:251]
  ds_read_b64_tr_b16 a[38:39], v9 offset:42528
  v_mfma_f32_16x16x32_bf16 v[252:255], a[12:15], a[108:111], v[252:255]
  ds_read_b64_tr_b16 a[8:9], v9 offset:38016
  v_mfma_f32_16x16x32_bf16 v[252:255], a[44:47], a[124:127], v[252:255]
  ds_read_b64_tr_b16 a[10:11], v9 offset:38272
  v_mfma_f32_16x16x32_bf16 v[236:239], a[12:15], a[104:107], v[236:239]
  s_add_u32 m0, s80, 24288
  v_mfma_f32_16x16x32_bf16 v[236:239], a[44:47], a[120:123], v[236:239]
  buffer_load_dwordx4 v3, s[52:55], s70 offen lds
  v_mfma_f32_16x16x32_bf16 v[220:223], a[12:15], a[100:103], v[220:223]
  s_add_u32 s70, s70, s75
  v_mfma_f32_16x16x32_bf16 v[220:223], a[44:47], a[116:119], v[220:223]
  ds_read_b128 a[84:87], v8 offset:2048
  v_mfma_f32_16x16x32_bf16 v[204:207], a[12:15], a[96:99], v[204:207]
  ds_read_b64_tr_b16 a[40:41], v9 offset:46464
  v_mfma_f32_16x16x32_bf16 v[204:207], a[44:47], a[112:115], v[204:207]
  ds_read_b64_tr_b16 a[42:43], v9 offset:46720
  v_mfma_f32_16x16x32_bf16 v[128:131], a[16:19], a[96:99], v[128:131]
  s_add_u32 m0, s79, 49152
  v_mfma_f32_16x16x32_bf16 v[128:131], a[48:51], a[112:115], v[128:131]
  buffer_load_dwordx4 v1, s[44:47], s69 offen lds
  v_mfma_f32_16x16x32_bf16 v[144:147], a[16:19], a[100:103], v[144:147]
  s_add_u32 s69, s69, s71
  v_mfma_f32_16x16x32_bf16 v[144:147], a[48:51], a[116:119], v[144:147]
  ds_read_b64_tr_b16 a[12:13], v9 offset:38048
  v_mfma_f32_16x16x32_bf16 v[160:163], a[16:19], a[104:107], v[160:163]
  ds_read_b64_tr_b16 a[14:15], v9 offset:38304
  v_mfma_f32_16x16x32_bf16 v[160:163], a[48:51], a[120:123], v[160:163]
  ds_read_b128 a[88:91], v8 offset:4096
  v_mfma_f32_16x16x32_bf16 v[176:179], a[16:19], a[108:111], v[176:179]
  ds_read_b64_tr_b16 a[44:45], v9 offset:46496
  v_mfma_f32_16x16x32_bf16 v[176:179], a[48:51], a[124:127], v[176:179]
  ds_read_b64_tr_b16 a[46:47], v9 offset:46752
  v_mfma_f32_16x16x32_bf16 v[180:183], a[20:23], a[108:111], v[180:183]
  s_add_u32 m0, s79, 50176
  v_mfma_f32_16x16x32_bf16 v[180:183], a[52:55], a[124:127], v[180:183]
  buffer_load_dwordx4 v2, s[44:47], s69 offen lds
  v_mfma_f32_16x16x32_bf16 v[164:167], a[20:23], a[104:107], v[164:167]
  s_add_u32 s69, s69, s71
  v_mfma_f32_16x16x32_bf16 v[164:167], a[52:55], a[120:123], v[164:167]
  s_add_u32 s85, s82, 8192
  buffer_store_dwordx4 v[52:55], v11, s[32:35], s85 offen sc1
  v_mfma_f32_16x16x32_bf16 v[148:151], a[20:23], a[100:103], v[148:151]
  ds_read_b64_tr_b16 a[16:17], v9 offset:0
  v_mfma_f32_16x16x32_bf16 v[148:151], a[52:55], a[116:119], v[148:151]
  ds_read_b64_tr_b16 a[18:19], v9 offset:256
  v_mfma_f32_16x16x32_bf16 v[132:135], a[20:23], a[96:99], v[132:135]
  ds_read_b128 a[92:95], v8 offset:6144
  v_mfma_f32_16x16x32_bf16 v[132:135], a[52:55], a[112:115], v[132:135]
  ds_read_b64_tr_b16 a[48:49], v9 offset:8448
  v_mfma_f32_16x16x32_bf16 v[136:139], a[24:27], a[96:99], v[136:139]
  s_add_u32 m0, s79, 51200
  v_mfma_f32_16x16x32_bf16 v[136:139], a[56:59], a[112:115], v[136:139]
  buffer_load_dwordx4 v1, s[44:47], s69 offen lds
  v_mfma_f32_16x16x32_bf16 v[152:155], a[24:27], a[100:103], v[152:155]
  s_add_u32 s69, s69, s71
  v_mfma_f32_16x16x32_bf16 v[152:155], a[56:59], a[116:119], v[152:155]
  ds_read_b64_tr_b16 a[50:51], v9 offset:8704
  v_mfma_f32_16x16x32_bf16 v[168:171], a[24:27], a[104:107], v[168:171]
  ds_read_b64_tr_b16 a[20:21], v9 offset:32
  v_mfma_f32_16x16x32_bf16 v[168:171], a[56:59], a[120:123], v[168:171]
  ds_read_b64_tr_b16 a[22:23], v9 offset:288
  v_mfma_f32_16x16x32_bf16 v[184:187], a[24:27], a[108:111], v[184:187]
  ds_read_b64_tr_b16 a[52:53], v9 offset:8480
  v_mfma_f32_16x16x32_bf16 v[184:187], a[56:59], a[124:127], v[184:187]
  ds_read_b64_tr_b16 a[54:55], v9 offset:8736
  v_mfma_f32_16x16x32_bf16 v[188:191], a[28:31], a[108:111], v[188:191]
  s_add_u32 m0, s79, 52224
  v_mfma_f32_16x16x32_bf16 v[172:175], a[28:31], a[104:107], v[172:175]
  buffer_load_dwordx4 v2, s[44:47], s69 offen lds
  v_mfma_f32_16x16x32_bf16 v[156:159], a[28:31], a[100:103], v[156:159]
  s_add_u32 s69, s69, s73
  v_mfma_f32_16x16x32_bf16 v[140:143], a[28:31], a[96:99], v[140:143]
  s_add_u32 s65, s64, 8192
  buffer_load_dword v5, v4, s[60:63], s65 offen
  v_mfma_f32_16x16x32_bf16 v[140:143], a[60:63], a[112:115], v[140:143]
  ds_read_b64_tr_b16 a[24:25], v9 offset:4224
  v_mfma_f32_16x16x32_bf16 v[156:159], a[60:63], a[116:119], v[156:159]
  ds_read_b64_tr_b16 a[26:27], v9 offset:4480
  v_mfma_f32_16x16x32_bf16 v[172:175], a[60:63], a[120:123], v[172:175]
  ds_read_b64_tr_b16 a[56:57], v9 offset:12672
  v_mfma_f32_16x16x32_bf16 v[188:191], a[60:63], a[124:127], v[188:191]
  ds_read_b64_tr_b16 a[58:59], v9 offset:12928
  ds_read_b64_tr_b16 a[28:29], v9 offset:4256
  ds_read_b64_tr_b16 a[30:31], v9 offset:4512
  ds_read_b64_tr_b16 a[60:61], v9 offset:12704
  ds_read_b64_tr_b16 a[62:63], v9 offset:12960
  s_waitcnt lgkmcnt(15)
  v_mfma_f32_16x16x32_bf16 a[128:131], a[0:3], a[64:67], a[128:131]
  v_mfma_f32_16x16x32_bf16 a[128:131], a[32:35], a[80:83], a[128:131]
  v_mfma_f32_16x16x32_bf16 a[144:147], a[0:3], a[68:71], a[144:147]
  v_mfma_f32_16x16x32_bf16 a[144:147], a[32:35], a[84:87], a[144:147]
  v_mfma_f32_16x16x32_bf16 a[160:163], a[0:3], a[72:75], a[160:163]
  v_mfma_f32_16x16x32_bf16 a[160:163], a[32:35], a[88:91], a[160:163]
  v_mfma_f32_16x16x32_bf16 a[176:179], a[0:3], a[76:79], a[176:179]
  s_waitcnt lgkmcnt(14)
  v_mfma_f32_16x16x32_bf16 a[176:179], a[32:35], a[92:95], a[176:179]
  s_waitcnt vmcnt(22) lgkmcnt(0)
  s_barrier
  v_mfma_f32_16x16x32_bf16 a[180:183], a[4:7], a[76:79], a[180:183]
  s_add_u32 m0, s79, 0
  v_mfma_f32_16x16x32_bf16 a[180:183], a[36:39], a[92:95], a[180:183]
  buffer_load_dwordx4 v1, s[44:47], s69 offen lds
  v_mfma_f32_16x16x32_bf16 a[164:167], a[4:7], a[72:75], a[164:167]
  s_add_u32 s69, s69, s71
  v_mfma_f32_16x16x32_bf16 a[164:167], a[36:39], a[88:91], a[164:167]
  ds_read_b128 a[96:99], v7 offset:32768
  v_mfma_f32_16x16x32_bf16 a[148:151], a[4:7], a[68:71], a[148:151]
  v_mfma_f32_16x16x32_bf16 a[148:151], a[36:39], a[84:87], a[148:151]
  ds_read_b128 a[100:103], v7 offset:34816
  v_mfma_f32_16x16x32_bf16 a[132:135], a[4:7], a[64:67], a[132:135]
  v_mfma_f32_16x16x32_bf16 a[132:135], a[36:39], a[80:83], a[132:135]
  ds_read_b128 a[104:107], v7 offset:36864
  v_mfma_f32_16x16x32_bf16 a[136:139], a[8:11], a[64:67], a[136:139]
  s_add_u32 m0, s80, 0
  v_mfma_f32_16x16x32_bf16 a[136:139], a[40:43], a[80:83], a[136:139]
  buffer_load_dwordx4 v3, s[48:51], s70 offen lds
  v_mfma_f32_16x16x32_bf16 a[152:155], a[8:11], a[68:71], a[152:155]
  ds_read_b128 a[108:111], v7 offset:38912
  v_mfma_f32_16x16x32_bf16 a[152:155], a[40:43], a[84:87], a[152:155]
  s_add_u32 s85, s82, 12288
  buffer_store_dwordx4 v[56:59], v10, s[32:35], s85 offen sc1
  v_mfma_f32_16x16x32_bf16 a[168:171], a[8:11], a[72:75], a[168:171]
  v_mfma_f32_16x16x32_bf16 a[168:171], a[40:43], a[88:91], a[168:171]
  ds_read_b128 a[112:115], v8 offset:32768
  v_mfma_f32_16x16x32_bf16 a[184:187], a[8:11], a[76:79], a[184:187]
  s_add_u32 m0, s80, 4224
  v_mfma_f32_16x16x32_bf16 a[184:187], a[40:43], a[92:95], a[184:187]
  buffer_load_dwordx4 v3, s[52:55], s70 offen lds
  v_mfma_f32_16x16x32_bf16 a[188:191], a[12:15], a[76:79], a[188:191]
  s_add_u32 s70, s70, s74
  v_mfma_f32_16x16x32_bf16 a[188:191], a[44:47], a[92:95], a[188:191]
  ds_read_b128 a[116:119], v8 offset:34816
  v_mfma_f32_16x16x32_bf16 a[172:175], a[12:15], a[72:75], a[172:175]
  v_mfma_f32_16x16x32_bf16 a[172:175], a[44:47], a[88:91], a[172:175]
  ds_read_b128 a[120:123], v8 offset:36864
  v_mfma_f32_16x16x32_bf16 a[156:159], a[12:15], a[68:71], a[156:159]
  v_mfma_f32_16x16x32_bf16 a[156:159], a[44:47], a[84:87], a[156:159]
  ds_read_b128 a[124:127], v8 offset:38912
  v_mfma_f32_16x16x32_bf16 a[140:143], a[12:15], a[64:67], a[140:143]
  s_add_u32 m0, s79, 1024
  v_mfma_f32_16x16x32_bf16 a[140:143], a[44:47], a[80:83], a[140:143]
  buffer_load_dwordx4 v2, s[44:47], s69 offen lds
  v_mfma_f32_16x16x32_bf16 a[192:195], a[16:19], a[64:67], a[192:195]
  s_add_u32 s69, s69, s71
  v_mfma_f32_16x16x32_bf16 a[192:195], a[48:51], a[80:83], a[192:195]
  v_mfma_f32_16x16x32_bf16 a[208:211], a[16:19], a[68:71], a[208:211]
  v_mfma_f32_16x16x32_bf16 a[208:211], a[48:51], a[84:87], a[208:211]
  v_mfma_f32_16x16x32_bf16 a[224:227], a[16:19], a[72:75], a[224:227]
  v_mfma_f32_16x16x32_bf16 a[224:227], a[48:51], a[88:91], a[224:227]
  v_mfma_f32_16x16x32_bf16 a[240:243], a[16:19], a[76:79], a[240:243]
  s_add_u32 m0, s80, 1056
  v_mfma_f32_16x16x32_bf16 a[240:243], a[48:51], a[92:95], a[240:243]
  buffer_load_dwordx4 v3, s[48:51], s70 offen lds
  v_mfma_f32_16x16x32_bf16 a[244:247], a[20:23], a[76:79], a[244:247]
  v_mfma_f32_16x16x32_bf16 a[244:247], a[52:55], a[92:95], a[244:247]
  s_add_u32 s85, s82, 12288
  buffer_store_dwordx4 v[60:63], v11, s[32:35], s85 offen sc1
  v_mfma_f32_16x16x32_bf16 a[228:231], a[20:23], a[72:75], a[228:231]
  v_mfma_f32_16x16x32_bf16 a[228:231], a[52:55], a[88:91], a[228:231]
  v_mfma_f32_16x16x32_bf16 a[212:215], a[20:23], a[68:71], a[212:215]
  v_mfma_f32_16x16x32_bf16 a[212:215], a[52:55], a[84:87], a[212:215]
  v_mfma_f32_16x16x32_bf16 a[196:199], a[20:23], a[64:67], a[196:199]
  s_add_u32 m0, s80, 5280
  v_mfma_f32_16x16x32_bf16 a[196:199], a[52:55], a[80:83], a[196:199]
  buffer_load_dwordx4 v3, s[52:55], s70 offen lds
  v_mfma_f32_16x16x32_bf16 a[200:203], a[24:27], a[64:67], a[200:203]
  s_add_u32 s70, s70, s74
  v_mfma_f32_16x16x32_bf16 a[200:203], a[56:59], a[80:83], a[200:203]
  v_mfma_f32_16x16x32_bf16 a[216:219], a[24:27], a[68:71], a[216:219]
  v_mfma_f32_16x16x32_bf16 a[216:219], a[56:59], a[84:87], a[216:219]
  v_mfma_f32_16x16x32_bf16 a[232:235], a[24:27], a[72:75], a[232:235]
  s_add_u32 m0, s79, 2048
  v_mfma_f32_16x16x32_bf16 a[232:235], a[56:59], a[88:91], a[232:235]
  buffer_load_dwordx4 v1, s[44:47], s69 offen lds
  v_mfma_f32_16x16x32_bf16 a[248:251], a[24:27], a[76:79], a[248:251]
  s_add_u32 s69, s69, s71
  v_mfma_f32_16x16x32_bf16 a[248:251], a[56:59], a[92:95], a[248:251]
  v_mfma_f32_16x16x32_bf16 a[252:255], a[28:31], a[76:79], a[252:255]
  v_mfma_f32_16x16x32_bf16 a[252:255], a[60:63], a[92:95], a[252:255]
  v_mfma_f32_16x16x32_bf16 a[236:239], a[28:31], a[72:75], a[236:239]
  v_mfma_f32_16x16x32_bf16 a[236:239], a[60:63], a[88:91], a[236:239]
  v_mfma_f32_16x16x32_bf16 a[220:223], a[28:31], a[68:71], a[220:223]
  s_add_u32 m0, s80, 2112
  v_mfma_f32_16x16x32_bf16 a[220:223], a[60:63], a[84:87], a[220:223]
  buffer_load_dwordx4 v3, s[48:51], s70 offen lds
  v_mfma_f32_16x16x32_bf16 a[204:207], a[28:31], a[64:67], a[204:207]
  v_mfma_f32_16x16x32_bf16 a[204:207], a[60:63], a[80:83], a[204:207]
  s_add_u32 s85, s82, 532480
  buffer_store_dwordx4 v[64:67], v10, s[32:35], s85 offen sc1
  s_waitcnt vmcnt(17) lgkmcnt(0)
  s_barrier
  v_mfma_f32_16x16x32_bf16 v[192:195], a[0:3], a[96:99], v[192:195]
  v_mfma_f32_16x16x32_bf16 v[192:195], a[32:35], a[112:115], v[192:195]
  ds_read_b128 a[64:67], v7 offset:16384
  v_mfma_f32_16x16x32_bf16 v[208:211], a[0:3], a[100:103], v[208:211]
  v_mfma_f32_16x16x32_bf16 v[208:211], a[32:35], a[116:119], v[208:211]
  ds_read_b128 a[68:71], v7 offset:18432
  v_mfma_f32_16x16x32_bf16 v[224:227], a[0:3], a[104:107], v[224:227]
  s_add_u32 m0, s80, 6336
  v_mfma_f32_16x16x32_bf16 v[224:227], a[32:35], a[120:123], v[224:227]
  buffer_load_dwordx4 v3, s[52:55], s70 offen lds
  v_mfma_f32_16x16x32_bf16 v[240:243], a[0:3], a[108:111], v[240:243]
  s_add_u32 s70, s70, s74
  v_mfma_f32_16x16x32_bf16 v[240:243], a[32:35], a[124:127], v[240:243]
  ds_read_b128 a[72:75], v7 offset:20480
  v_mfma_f32_16x16x32_bf16 v[244:247], a[4:7], a[108:111], v[244:247]
  ds_read_b64_tr_b16 a[0:1], v9 offset:50688
  v_mfma_f32_16x16x32_bf16 v[244:247], a[36:39], a[124:127], v[244:247]
  ds_read_b64_tr_b16 a[2:3], v9 offset:50944
  v_mfma_f32_16x16x32_bf16 v[228:231], a[4:7], a[104:107], v[228:231]
  s_add_u32 m0, s79, 3072
  v_mfma_f32_16x16x32_bf16 v[228:231], a[36:39], a[120:123], v[228:231]
  buffer_load_dwordx4 v2, s[44:47], s69 offen lds
  v_mfma_f32_16x16x32_bf16 v[212:215], a[4:7], a[100:103], v[212:215]
  s_add_u32 s69, s69, s72
  v_mfma_f32_16x16x32_bf16 v[212:215], a[36:39], a[116:119], v[212:215]
  ds_read_b128 a[76:79], v7 offset:22528
  v_mfma_f32_16x16x32_bf16 v[196:199], a[4:7], a[96:99], v[196:199]
  ds_read_b64_tr_b16 a[32:33], v9 offset:59136
  v_mfma_f32_16x16x32_bf16 v[196:199], a[36:39], a[112:115], v[196:199]
  ds_read_b64_tr_b16 a[34:35], v9 offset:59392
  v_mfma_f32_16x16x32_bf16 v[200:203], a[8:11], a[96:99], v[200:203]
  ds_read_b64_tr_b16 a[4:5], v9 offset:50720
  v_mfma_f32_16x16x32_bf16 v[200:203], a[40:43], a[112:115], v[200:203]
  ds_read_b64_tr_b16 a[6:7], v9 offset:50976
  v_mfma_f32_16x16x32_bf16 v[216:219], a[8:11], a[100:103], v[216:219]
  s_add_u32 m0, s80, 3168
  v_mfma_f32_16x16x32_bf16 v[216:219], a[40:43], a[116:119], v[216:219]
  buffer_load_dwordx4 v3, s[48:51], s70 offen lds
  v_mfma_f32_16x16x32_bf16 v[232:235], a[8:11], a[104:107], v[232:235]
  ds_read_b128 a[80:83], v8 offset:16384
  v_mfma_f32_16x16x32_bf16 v[232:235], a[40:43], a[120:123], v[232:235]
  s_add_u32 s85, s82, 532480
  buffer_store_dwordx4 v[68:71], v11, s[32:35], s85 offen sc1
  v_mfma_f32_16x16x32_bf16 v[248:251], a[8:11], a[108:111], v[248:251]
  ds_read_b64_tr_b16 a[36:37], v9 offset:59168
  v_mfma_f32_16x16x32_bf16 v[248:251], a[40:43], a[124:127], v[248:251]
  ds_read_b64_tr_b16 a[38:39], v9 offset:59424
  v_mfma_f32_16x16x32_bf16 v[252:255], a[12:15], a[108:111], v[252:255]
  ds_read_b64_tr_b16 a[8:9], v9 offset:54912
  v_mfma_f32_16x16x32_bf16 v[252:255], a[44:47], a[124:127], v[252:255]
  ds_read_b64_tr_b16 a[10:11], v9 offset:55168
  v_mfma_f32_16x16x32_bf16 v[236:239], a[12:15], a[104:107], v[236:239]
  s_add_u32 m0, s80, 7392
  v_mfma_f32_16x16x32_bf16 v[236:239], a[44:47], a[120:123], v[236:239]
  buffer_load_dwordx4 v3, s[52:55], s70 offen lds
  v_mfma_f32_16x16x32_bf16 v[220:223], a[12:15], a[100:103], v[220:223]
  s_add_u32 s70, s70, s75
  v_mfma_f32_16x16x32_bf16 v[220:223], a[44:47], a[116:119], v[220:223]
  ds_read_b128 a[84:87], v8 offset:18432
  v_mfma_f32_16x16x32_bf16 v[204:207], a[12:15], a[96:99], v[204:207]
  ds_read_b64_tr_b16 a[40:41], v9 offset:63360
  v_mfma_f32_16x16x32_bf16 v[204:207], a[44:47], a[112:115], v[204:207]
  ds_read_b64_tr_b16 a[42:43], v9 offset:63616
  v_mfma_f32_16x16x32_bf16 v[128:131], a[16:19], a[96:99], v[128:131]
  s_add_u32 m0, s79, 32768
  v_mfma_f32_16x16x32_bf16 v[128:131], a[48:51], a[112:115], v[128:131]
  buffer_load_dwordx4 v1, s[44:47], s69 offen lds
  v_mfma_f32_16x16x32_bf16 v[144:147], a[16:19], a[100:103], v[144:147]
  s_add_u32 s69, s69, s71
  v_mfma_f32_16x16x32_bf16 v[144:147], a[48:51], a[116:119], v[144:147]
  ds_read_b64_tr_b16 a[12:13], v9 offset:54944
  v_mfma_f32_16x16x32_bf16 v[160:163], a[16:19], a[104:107], v[160:163]
  ds_read_b64_tr_b16 a[14:15], v9 offset:55200
  v_mfma_f32_16x16x32_bf16 v[160:163], a[48:51], a[120:123], v[160:163]
  ds_read_b128 a[88:91], v8 offset:20480
  v_mfma_f32_16x16x32_bf16 v[176:179], a[16:19], a[108:111], v[176:179]
  ds_read_b64_tr_b16 a[44:45], v9 offset:63392
  v_mfma_f32_16x16x32_bf16 v[176:179], a[48:51], a[124:127], v[176:179]
  ds_read_b64_tr_b16 a[46:47], v9 offset:63648
  v_mfma_f32_16x16x32_bf16 v[180:183], a[20:23], a[108:111], v[180:183]
  s_add_u32 m0, s79, 33792
  v_mfma_f32_16x16x32_bf16 v[180:183], a[52:55], a[124:127], v[180:183]
  buffer_load_dwordx4 v2, s[44:47], s69 offen lds
  v_mfma_f32_16x16x32_bf16 v[164:167], a[20:23], a[104:107], v[164:167]
  s_add_u32 s69, s69, s71
  v_mfma_f32_16x16x32_bf16 v[164:167], a[52:55], a[120:123], v[164:167]
  s_add_u32 s85, s82, 16384
  buffer_store_dwordx4 v[72:75], v10, s[32:35], s85 offen sc1
  v_mfma_f32_16x16x32_bf16 v[148:151], a[20:23], a[100:103], v[148:151]
  ds_read_b64_tr_b16 a[16:17], v9 offset:16896
  v_mfma_f32_16x16x32_bf16 v[148:151], a[52:55], a[116:119], v[148:151]
  ds_read_b64_tr_b16 a[18:19], v9 offset:17152
  v_mfma_f32_16x16x32_bf16 v[132:135], a[20:23], a[96:99], v[132:135]
  ds_read_b128 a[92:95], v8 offset:22528
  v_mfma_f32_16x16x32_bf16 v[132:135], a[52:55], a[112:115], v[132:135]
  ds_read_b64_tr_b16 a[48:49], v9 offset:25344
  v_mfma_f32_16x16x32_bf16 v[136:139], a[24:27], a[96:99], v[136:139]
  s_add_u32 m0, s79, 34816
  v_mfma_f32_16x16x32_bf16 v[136:139], a[56:59], a[112:115], v[136:139]
  buffer_load_dwordx4 v1, s[44:47], s69 offen lds
  v_mfma_f32_16x16x32_bf16 v[152:155], a[24:27], a[100:103], v[152:155]
  s_add_u32 s69, s69, s71
  v_mfma_f32_16x16x32_bf16 v[152:155], a[56:59], a[116:119], v[152:155]
  ds_read_b64_tr_b16 a[50:51], v9 offset:25600
  v_mfma_f32_16x16x32_bf16 v[168:171], a[24:27], a[104:107], v[168:171]
  ds_read_b64_tr_b16 a[20:21], v9 offset:16928
  v_mfma_f32_16x16x32_bf16 v[168:171], a[56:59], a[120:123], v[168:171]
  ds_read_b64_tr_b16 a[22:23], v9 offset:17184
  v_mfma_f32_16x16x32_bf16 v[184:187], a[24:27], a[108:111], v[184:187]
  ds_read_b64_tr_b16 a[52:53], v9 offset:25376
  v_mfma_f32_16x16x32_bf16 v[184:187], a[56:59], a[124:127], v[184:187]
  ds_read_b64_tr_b16 a[54:55], v9 offset:25632
  v_mfma_f32_16x16x32_bf16 v[188:191], a[28:31], a[108:111], v[188:191]
  s_add_u32 m0, s79, 35840
  v_mfma_f32_16x16x32_bf16 v[172:175], a[28:31], a[104:107], v[172:175]
  buffer_load_dwordx4 v2, s[44:47], s69 offen lds
  v_mfma_f32_16x16x32_bf16 v[156:159], a[28:31], a[100:103], v[156:159]
  s_add_u32 s69, s69, s73
  v_mfma_f32_16x16x32_bf16 v[140:143], a[28:31], a[96:99], v[140:143]
  ds_read_b64_tr_b16 a[24:25], v9 offset:21120
  v_mfma_f32_16x16x32_bf16 v[140:143], a[60:63], a[112:115], v[140:143]
  ds_read_b64_tr_b16 a[26:27], v9 offset:21376
  v_mfma_f32_16x16x32_bf16 v[156:159], a[60:63], a[116:119], v[156:159]
  ds_read_b64_tr_b16 a[56:57], v9 offset:29568
  v_mfma_f32_16x16x32_bf16 v[172:175], a[60:63], a[120:123], v[172:175]
  ds_read_b64_tr_b16 a[58:59], v9 offset:29824
  v_mfma_f32_16x16x32_bf16 v[188:191], a[60:63], a[124:127], v[188:191]
  ds_read_b64_tr_b16 a[28:29], v9 offset:21152
  ds_read_b64_tr_b16 a[30:31], v9 offset:21408
  ds_read_b64_tr_b16 a[60:61], v9 offset:29600
  ds_read_b64_tr_b16 a[62:63], v9 offset:29856
  s_waitcnt lgkmcnt(15)
  v_mfma_f32_16x16x32_bf16 a[128:131], a[0:3], a[64:67], a[128:131]
  v_mfma_f32_16x16x32_bf16 a[128:131], a[32:35], a[80:83], a[128:131]
  v_mfma_f32_16x16x32_bf16 a[144:147], a[0:3], a[68:71], a[144:147]
  v_mfma_f32_16x16x32_bf16 a[144:147], a[32:35], a[84:87], a[144:147]
  v_mfma_f32_16x16x32_bf16 a[160:163], a[0:3], a[72:75], a[160:163]
  v_mfma_f32_16x16x32_bf16 a[160:163], a[32:35], a[88:91], a[160:163]
  v_mfma_f32_16x16x32_bf16 a[176:179], a[0:3], a[76:79], a[176:179]
  s_waitcnt lgkmcnt(14)
  v_mfma_f32_16x16x32_bf16 a[176:179], a[32:35], a[92:95], a[176:179]
  s_waitcnt vmcnt(22) lgkmcnt(0)
  s_barrier
  v_mfma_f32_16x16x32_bf16 a[180:183], a[4:7], a[76:79], a[180:183]
  s_add_u32 m0, s79, 16384
  v_mfma_f32_16x16x32_bf16 a[180:183], a[36:39], a[92:95], a[180:183]
  buffer_load_dwordx4 v1, s[44:47], s69 offen lds
  v_mfma_f32_16x16x32_bf16 a[164:167], a[4:7], a[72:75], a[164:167]
  s_add_u32 s69, s69, s71
  v_mfma_f32_16x16x32_bf16 a[164:167], a[36:39], a[88:91], a[164:167]
  ds_read_b128 a[96:99], v7 offset:49152
  v_mfma_f32_16x16x32_bf16 a[148:151], a[4:7], a[68:71], a[148:151]
  v_mfma_f32_16x16x32_bf16 a[148:151], a[36:39], a[84:87], a[148:151]
  ds_read_b128 a[100:103], v7 offset:51200
  v_mfma_f32_16x16x32_bf16 a[132:135], a[4:7], a[64:67], a[132:135]
  v_mfma_f32_16x16x32_bf16 a[132:135], a[36:39], a[80:83], a[132:135]
  ds_read_b128 a[104:107], v7 offset:53248
  v_mfma_f32_16x16x32_bf16 a[136:139], a[8:11], a[64:67], a[136:139]
  s_add_u32 m0, s80, 16896
  v_mfma_f32_16x16x32_bf16 a[136:139], a[40:43], a[80:83], a[136:139]
  buffer_load_dwordx4 v3, s[48:51], s70 offen lds
  v_mfma_f32_16x16x32_bf16 a[152:155], a[8:11], a[68:71], a[152:155]
  ds_read_b128 a[108:111], v7 offset:55296
  v_mfma_f32_16x16x32_bf16 a[152:155], a[40:43], a[84:87], a[152:155]
  s_add_u32 s85, s82, 16384
  buffer_store_dwordx4 v[76:79], v11, s[32:35], s85 offen sc1
  v_mfma_f32_16x16x32_bf16 a[168:171], a[8:11], a[72:75], a[168:171]
  v_mfma_f32_16x16x32_bf16 a[168:171], a[40:43], a[88:91], a[168:171]
  ds_read_b128 a[112:115], v8 offset:49152
  v_mfma_f32_16x16x32_bf16 a[184:187], a[8:11], a[76:79], a[184:187]
  s_add_u32 m0, s80, 21120
  v_mfma_f32_16x16x32_bf16 a[184:187], a[40:43], a[92:95], a[184:187]
  buffer_load_dwordx4 v3, s[52:55], s70 offen lds
  v_mfma_f32_16x16x32_bf16 a[188:191], a[12:15], a[76:79], a[188:191]
  s_add_u32 s70, s70, s74
  v_mfma_f32_16x16x32_bf16 a[188:191], a[44:47], a[92:95], a[188:191]
  ds_read_b128 a[116:119], v8 offset:51200
  v_mfma_f32_16x16x32_bf16 a[172:175], a[12:15], a[72:75], a[172:175]
  v_mfma_f32_16x16x32_bf16 a[172:175], a[44:47], a[88:91], a[172:175]
  ds_read_b128 a[120:123], v8 offset:53248
  v_mfma_f32_16x16x32_bf16 a[156:159], a[12:15], a[68:71], a[156:159]
  v_mfma_f32_16x16x32_bf16 a[156:159], a[44:47], a[84:87], a[156:159]
  ds_read_b128 a[124:127], v8 offset:55296
  v_mfma_f32_16x16x32_bf16 a[140:143], a[12:15], a[64:67], a[140:143]
  s_add_u32 m0, s79, 17408
  v_mfma_f32_16x16x32_bf16 a[140:143], a[44:47], a[80:83], a[140:143]
  buffer_load_dwordx4 v2, s[44:47], s69 offen lds
  v_mfma_f32_16x16x32_bf16 a[192:195], a[16:19], a[64:67], a[192:195]
  s_add_u32 s69, s69, s71
  v_mfma_f32_16x16x32_bf16 a[192:195], a[48:51], a[80:83], a[192:195]
  v_mfma_f32_16x16x32_bf16 a[208:211], a[16:19], a[68:71], a[208:211]
  v_mfma_f32_16x16x32_bf16 a[208:211], a[48:51], a[84:87], a[208:211]
  v_mfma_f32_16x16x32_bf16 a[224:227], a[16:19], a[72:75], a[224:227]
  v_mfma_f32_16x16x32_bf16 a[224:227], a[48:51], a[88:91], a[224:227]
  v_mfma_f32_16x16x32_bf16 a[240:243], a[16:19], a[76:79], a[240:243]
  s_add_u32 m0, s80, 17952
  v_mfma_f32_16x16x32_bf16 a[240:243], a[48:51], a[92:95], a[240:243]
  buffer_load_dwordx4 v3, s[48:51], s70 offen lds
  v_mfma_f32_16x16x32_bf16 a[244:247], a[20:23], a[76:79], a[244:247]
  v_mfma_f32_16x16x32_bf16 a[244:247], a[52:55], a[92:95], a[244:247]
  s_add_u32 s85, s82, 20480
  buffer_store_dwordx4 v[80:83], v10, s[32:35], s85 offen sc1
  v_mfma_f32_16x16x32_bf16 a[228:231], a[20:23], a[72:75], a[228:231]
  v_mfma_f32_16x16x32_bf16 a[228:231], a[52:55], a[88:91], a[228:231]
  v_mfma_f32_16x16x32_bf16 a[212:215], a[20:23], a[68:71], a[212:215]
  v_mfma_f32_16x16x32_bf16 a[212:215], a[52:55], a[84:87], a[212:215]
  v_mfma_f32_16x16x32_bf16 a[196:199], a[20:23], a[64:67], a[196:199]
  s_add_u32 m0, s80, 22176
  v_mfma_f32_16x16x32_bf16 a[196:199], a[52:55], a[80:83], a[196:199]
  buffer_load_dwordx4 v3, s[52:55], s70 offen lds
  v_mfma_f32_16x16x32_bf16 a[200:203], a[24:27], a[64:67], a[200:203]
  s_add_u32 s70, s70, s74
  v_mfma_f32_16x16x32_bf16 a[200:203], a[56:59], a[80:83], a[200:203]
  v_mfma_f32_16x16x32_bf16 a[216:219], a[24:27], a[68:71], a[216:219]
  v_mfma_f32_16x16x32_bf16 a[216:219], a[56:59], a[84:87], a[216:219]
  v_mfma_f32_16x16x32_bf16 a[232:235], a[24:27], a[72:75], a[232:235]
  s_add_u32 m0, s79, 18432
  v_mfma_f32_16x16x32_bf16 a[232:235], a[56:59], a[88:91], a[232:235]
  buffer_load_dwordx4 v1, s[44:47], s69 offen lds
  v_mfma_f32_16x16x32_bf16 a[248:251], a[24:27], a[76:79], a[248:251]
  s_add_u32 s69, s69, s71
  v_mfma_f32_16x16x32_bf16 a[248:251], a[56:59], a[92:95], a[248:251]
  v_mfma_f32_16x16x32_bf16 a[252:255], a[28:31], a[76:79], a[252:255]
  v_mfma_f32_16x16x32_bf16 a[252:255], a[60:63], a[92:95], a[252:255]
  v_mfma_f32_16x16x32_bf16 a[236:239], a[28:31], a[72:75], a[236:239]
  v_mfma_f32_16x16x32_bf16 a[236:239], a[60:63], a[88:91], a[236:239]
  v_mfma_f32_16x16x32_bf16 a[220:223], a[28:31], a[68:71], a[220:223]
  s_add_u32 m0, s80, 19008
  v_mfma_f32_16x16x32_bf16 a[220:223], a[60:63], a[84:87], a[220:223]
  buffer_load_dwordx4 v3, s[48:51], s70 offen lds
  v_mfma_f32_16x16x32_bf16 a[204:207], a[28:31], a[64:67], a[204:207]
  v_mfma_f32_16x16x32_bf16 a[204:207], a[60:63], a[80:83], a[204:207]
  s_add_u32 s85, s82, 20480
  buffer_store_dwordx4 v[84:87], v11, s[32:35], s85 offen sc1
  s_waitcnt vmcnt(16) lgkmcnt(0)
  s_barrier
  v_mfma_f32_16x16x32_bf16 v[192:195], a[0:3], a[96:99], v[192:195]
  v_mfma_f32_16x16x32_bf16 v[192:195], a[32:35], a[112:115], v[192:195]
  ds_read_b128 a[64:67], v7 offset:0
  v_mfma_f32_16x16x32_bf16 v[208:211], a[0:3], a[100:103], v[208:211]
  v_mfma_f32_16x16x32_bf16 v[208:211], a[32:35], a[116:119], v[208:211]
  ds_read_b128 a[68:71], v7 offset:2048
  v_mfma_f32_16x16x32_bf16 v[224:227], a[0:3], a[104:107], v[224:227]
  s_add_u32 m0, s80, 23232
  v_mfma_f32_16x16x32_bf16 v[224:227], a[32:35], a[120:123], v[224:227]
  buffer_load_dwordx4 v3, s[52:55], s70 offen lds
  v_mfma_f32_16x16x32_bf16 v[240:243], a[0:3], a[108:111], v[240:243]
  s_add_u32 s70, s70, s74
  v_mfma_f32_16x16x32_bf16 v[240:243], a[32:35], a[124:127], v[240:243]
  ds_read_b128 a[72:75], v7 offset:4096
  v_mfma_f32_16x16x32_bf16 v[244:247], a[4:7], a[108:111], v[244:247]
  ds_read_b64_tr_b16 a[0:1], v9 offset:33792
  v_mfma_f32_16x16x32_bf16 v[244:247], a[36:39], a[124:127], v[244:247]
  ds_read_b64_tr_b16 a[2:3], v9 offset:34048
  v_mfma_f32_16x16x32_bf16 v[228:231], a[4:7], a[104:107], v[228:231]
  s_add_u32 m0, s79, 19456
  v_mfma_f32_16x16x32_bf16 v[228:231], a[36:39], a[120:123], v[228:231]
  buffer_load_dwordx4 v2, s[44:47], s69 offen lds
  v_mfma_f32_16x16x32_bf16 v[212:215], a[4:7], a[100:103], v[212:215]
  s_add_u32 s69, s69, s72
  v_mfma_f32_16x16x32_bf16 v[212:215], a[36:39], a[116:119], v[212:215]
  ds_read_b128 a[76:79], v7 offset:6144
  v_mfma_f32_16x16x32_bf16 v[196:199], a[4:7], a[96:99], v[196:199]
  ds_read_b64_tr_b16 a[32:33], v9 offset:42240
  v_mfma_f32_16x16x32_bf16 v[196:199], a[36:39], a[112:115], v[196:199]
  ds_read_b64_tr_b16 a[34:35], v9 offset:42496
  v_mfma_f32_16x16x32_bf16 v[200:203], a[8:11], a[96:99], v[200:203]
  ds_read_b64_tr_b16 a[4:5], v9 offset:33824
  v_mfma_f32_16x16x32_bf16 v[200:203], a[40:43], a[112:115], v[200:203]
  ds_read_b64_tr_b16 a[6:7], v9 offset:34080
  v_mfma_f32_16x16x32_bf16 v[216:219], a[8:11], a[100:103], v[216:219]
  s_add_u32 m0, s80, 20064
  v_mfma_f32_16x16x32_bf16 v[216:219], a[40:43], a[116:119], v[216:219]
  buffer_load_dwordx4 v3, s[48:51], s70 offen lds
  v_mfma_f32_16x16x32_bf16 v[232:235], a[8:11], a[104:107], v[232:235]
  ds_read_b128 a[80:83], v8 offset:0
  v_mfma_f32_16x16x32_bf16 v[232:235], a[40:43], a[120:123], v[232:235]
  s_add_u32 s85, s82, 540672
  buffer_store_dwordx4 v[88:91], v10, s[32:35], s85 offen sc1
  v_mfma_f32_16x16x32_bf16 v[248:251], a[8:11], a[108:111], v[248:251]
  ds_read_b64_tr_b16 a[36:37], v9 offset:42272
  v_mfma_f32_16x16x32_bf16 v[248:251], a[40:43], a[124:127], v[248:251]
  ds_read_b64_tr_b16 a[38:39], v9 offset:42528
  v_mfma_f32_16x16x32_bf16 v[252:255], a[12:15], a[108:111], v[252:255]
  ds_read_b64_tr_b16 a[8:9], v9 offset:38016
  v_mfma_f32_16x16x32_bf16 v[252:255], a[44:47], a[124:127], v[252:255]
  ds_read_b64_tr_b16 a[10:11], v9 offset:38272
  v_mfma_f32_16x16x32_bf16 v[236:239], a[12:15], a[104:107], v[236:239]
  s_add_u32 m0, s80, 24288
  v_mfma_f32_16x16x32_bf16 v[236:239], a[44:47], a[120:123], v[236:239]
  buffer_load_dwordx4 v3, s[52:55], s70 offen lds
  v_mfma_f32_16x16x32_bf16 v[220:223], a[12:15], a[100:103], v[220:223]
  s_add_u32 s70, s70, s75
  v_mfma_f32_16x16x32_bf16 v[220:223], a[44:47], a[116:119], v[220:223]
  ds_read_b128 a[84:87], v8 offset:2048
  v_mfma_f32_16x16x32_bf16 v[204:207], a[12:15], a[96:99], v[204:207]
  ds_read_b64_tr_b16 a[40:41], v9 offset:46464
  v_mfma_f32_16x16x32_bf16 v[204:207], a[44:47], a[112:115], v[204:207]
  ds_read_b64_tr_b16 a[42:43], v9 offset:46720
  v_mfma_f32_16x16x32_bf16 v[128:131], a[16:19], a[96:99], v[128:131]
  s_add_u32 m0, s79, 49152
  v_mfma_f32_16x16x32_bf16 v[128:131], a[48:51], a[112:115], v[128:131]
  buffer_load_dwordx4 v1, s[44:47], s69 offen lds
  v_mfma_f32_16x16x32_bf16 v[144:147], a[16:19], a[100:103], v[144:147]
  s_add_u32 s69, s69, s71
  v_mfma_f32_16x16x32_bf16 v[144:147], a[48:51], a[116:119], v[144:147]
  ds_read_b64_tr_b16 a[12:13], v9 offset:38048
  v_mfma_f32_16x16x32_bf16 v[160:163], a[16:19], a[104:107], v[160:163]
  ds_read_b64_tr_b16 a[14:15], v9 offset:38304
  v_mfma_f32_16x16x32_bf16 v[160:163], a[48:51], a[120:123], v[160:163]
  ds_read_b128 a[88:91], v8 offset:4096
  v_mfma_f32_16x16x32_bf16 v[176:179], a[16:19], a[108:111], v[176:179]
  ds_read_b64_tr_b16 a[44:45], v9 offset:46496
  v_mfma_f32_16x16x32_bf16 v[176:179], a[48:51], a[124:127], v[176:179]
  ds_read_b64_tr_b16 a[46:47], v9 offset:46752
  v_mfma_f32_16x16x32_bf16 v[180:183], a[20:23], a[108:111], v[180:183]
  s_add_u32 m0, s79, 50176
  v_mfma_f32_16x16x32_bf16 v[180:183], a[52:55], a[124:127], v[180:183]
  buffer_load_dwordx4 v2, s[44:47], s69 offen lds
  v_mfma_f32_16x16x32_bf16 v[164:167], a[20:23], a[104:107], v[164:167]
  s_add_u32 s69, s69, s71
  v_mfma_f32_16x16x32_bf16 v[164:167], a[52:55], a[120:123], v[164:167]
  s_add_u32 s85, s82, 540672
  buffer_store_dwordx4 v[92:95], v11, s[32:35], s85 offen sc1
  v_mfma_f32_16x16x32_bf16 v[148:151], a[20:23], a[100:103], v[148:151]
  ds_read_b64_tr_b16 a[16:17], v9 offset:0
  v_mfma_f32_16x16x32_bf16 v[148:151], a[52:55], a[116:119], v[148:151]
  ds_read_b64_tr_b16 a[18:19], v9 offset:256
  v_mfma_f32_16x16x32_bf16 v[132:135], a[20:23], a[96:99], v[132:135]
  ds_read_b128 a[92:95], v8 offset:6144
  v_mfma_f32_16x16x32_bf16 v[132:135], a[52:55], a[112:115], v[132:135]
  ds_read_b64_tr_b16 a[48:49], v9 offset:8448
  v_mfma_f32_16x16x32_bf16 v[136:139], a[24:27], a[96:99], v[136:139]
  s_add_u32 m0, s79, 51200
  v_mfma_f32_16x16x32_bf16 v[136:139], a[56:59], a[112:115], v[136:139]
  buffer_load_dwordx4 v1, s[44:47], s69 offen lds
  v_mfma_f32_16x16x32_bf16 v[152:155], a[24:27], a[100:103], v[152:155]
  s_add_u32 s69, s69, s71
  v_mfma_f32_16x16x32_bf16 v[152:155], a[56:59], a[116:119], v[152:155]
  ds_read_b64_tr_b16 a[50:51], v9 offset:8704
  v_mfma_f32_16x16x32_bf16 v[168:171], a[24:27], a[104:107], v[168:171]
  ds_read_b64_tr_b16 a[20:21], v9 offset:32
  v_mfma_f32_16x16x32_bf16 v[168:171], a[56:59], a[120:123], v[168:171]
  ds_read_b64_tr_b16 a[22:23], v9 offset:288
  v_mfma_f32_16x16x32_bf16 v[184:187], a[24:27], a[108:111], v[184:187]
  ds_read_b64_tr_b16 a[52:53], v9 offset:8480
  v_mfma_f32_16x16x32_bf16 v[184:187], a[56:59], a[124:127], v[184:187]
  ds_read_b64_tr_b16 a[54:55], v9 offset:8736
  v_mfma_f32_16x16x32_bf16 v[188:191], a[28:31], a[108:111], v[188:191]
  s_add_u32 m0, s79, 52224
  v_mfma_f32_16x16x32_bf16 v[172:175], a[28:31], a[104:107], v[172:175]
  buffer_load_dwordx4 v2, s[44:47], s69 offen lds
  v_mfma_f32_16x16x32_bf16 v[156:159], a[28:31], a[100:103], v[156:159]
  s_add_u32 s69, s69, s73
  v_mfma_f32_16x16x32_bf16 v[140:143], a[28:31], a[96:99], v[140:143]
  ds_read_b64_tr_b16 a[24:25], v9 offset:4224
  v_mfma_f32_16x16x32_bf16 v[140:143], a[60:63], a[112:115], v[140:143]
  ds_read_b64_tr_b16 a[26:27], v9 offset:4480
  v_mfma_f32_16x16x32_bf16 v[156:159], a[60:63], a[116:119], v[156:159]
  ds_read_b64_tr_b16 a[56:57], v9 offset:12672
  v_mfma_f32_16x16x32_bf16 v[172:175], a[60:63], a[120:123], v[172:175]
  ds_read_b64_tr_b16 a[58:59], v9 offset:12928
  v_mfma_f32_16x16x32_bf16 v[188:191], a[60:63], a[124:127], v[188:191]
  ds_read_b64_tr_b16 a[28:29], v9 offset:4256
  ds_read_b64_tr_b16 a[30:31], v9 offset:4512
  ds_read_b64_tr_b16 a[60:61], v9 offset:12704
  ds_read_b64_tr_b16 a[62:63], v9 offset:12960
  s_waitcnt lgkmcnt(15)
  v_mfma_f32_16x16x32_bf16 a[128:131], a[0:3], a[64:67], a[128:131]
  v_mfma_f32_16x16x32_bf16 a[128:131], a[32:35], a[80:83], a[128:131]
  v_mfma_f32_16x16x32_bf16 a[144:147], a[0:3], a[68:71], a[144:147]
  v_mfma_f32_16x16x32_bf16 a[144:147], a[32:35], a[84:87], a[144:147]
  v_mfma_f32_16x16x32_bf16 a[160:163], a[0:3], a[72:75], a[160:163]
  v_mfma_f32_16x16x32_bf16 a[160:163], a[32:35], a[88:91], a[160:163]
  v_mfma_f32_16x16x32_bf16 a[176:179], a[0:3], a[76:79], a[176:179]
  s_waitcnt lgkmcnt(14)
  v_mfma_f32_16x16x32_bf16 a[176:179], a[32:35], a[92:95], a[176:179]
  s_waitcnt vmcnt(21) lgkmcnt(0)
  s_barrier
  v_mfma_f32_16x16x32_bf16 a[180:183], a[4:7], a[76:79], a[180:183]
  s_add_u32 m0, s79, 0
  v_mfma_f32_16x16x32_bf16 a[180:183], a[36:39], a[92:95], a[180:183]
  buffer_load_dwordx4 v1, s[44:47], s69 offen lds
  v_mfma_f32_16x16x32_bf16 a[164:167], a[4:7], a[72:75], a[164:167]
  s_add_u32 s69, s69, s71
  v_mfma_f32_16x16x32_bf16 a[164:167], a[36:39], a[88:91], a[164:167]
  ds_read_b128 a[96:99], v7 offset:32768
  v_mfma_f32_16x16x32_bf16 a[148:151], a[4:7], a[68:71], a[148:151]
  v_mfma_f32_16x16x32_bf16 a[148:151], a[36:39], a[84:87], a[148:151]
  ds_read_b128 a[100:103], v7 offset:34816
  v_mfma_f32_16x16x32_bf16 a[132:135], a[4:7], a[64:67], a[132:135]
  v_mfma_f32_16x16x32_bf16 a[132:135], a[36:39], a[80:83], a[132:135]
  ds_read_b128 a[104:107], v7 offset:36864
  v_mfma_f32_16x16x32_bf16 a[136:139], a[8:11], a[64:67], a[136:139]
  s_add_u32 m0, s80, 0
  v_mfma_f32_16x16x32_bf16 a[136:139], a[40:43], a[80:83], a[136:139]
  buffer_load_dwordx4 v3, s[48:51], s70 offen lds
  v_mfma_f32_16x16x32_bf16 a[152:155], a[8:11], a[68:71], a[152:155]
  ds_read_b128 a[108:111], v7 offset:38912
  v_mfma_f32_16x16x32_bf16 a[152:155], a[40:43], a[84:87], a[152:155]
  s_add_u32 s85, s82, 544768
  buffer_store_dwordx4 v[96:99], v10, s[32:35], s85 offen sc1
  v_mfma_f32_16x16x32_bf16 a[168:171], a[8:11], a[72:75], a[168:171]
  v_mfma_f32_16x16x32_bf16 a[168:171], a[40:43], a[88:91], a[168:171]
  ds_read_b128 a[112:115], v8 offset:32768
  v_mfma_f32_16x16x32_bf16 a[184:187], a[8:11], a[76:79], a[184:187]
  s_add_u32 m0, s80, 4224
  v_mfma_f32_16x16x32_bf16 a[184:187], a[40:43], a[92:95], a[184:187]
  buffer_load_dwordx4 v3, s[52:55], s70 offen lds
  v_mfma_f32_16x16x32_bf16 a[188:191], a[12:15], a[76:79], a[188:191]
  s_add_u32 s70, s70, s74
  v_mfma_f32_16x16x32_bf16 a[188:191], a[44:47], a[92:95], a[188:191]
  ds_read_b128 a[116:119], v8 offset:34816
  v_mfma_f32_16x16x32_bf16 a[172:175], a[12:15], a[72:75], a[172:175]
  v_mfma_f32_16x16x32_bf16 a[172:175], a[44:47], a[88:91], a[172:175]
  ds_read_b128 a[120:123], v8 offset:36864
  v_mfma_f32_16x16x32_bf16 a[156:159], a[12:15], a[68:71], a[156:159]
  v_mfma_f32_16x16x32_bf16 a[156:159], a[44:47], a[84:87], a[156:159]
  ds_read_b128 a[124:127], v8 offset:38912
  v_mfma_f32_16x16x32_bf16 a[140:143], a[12:15], a[64:67], a[140:143]
  s_add_u32 m0, s79, 1024
  v_mfma_f32_16x16x32_bf16 a[140:143], a[44:47], a[80:83], a[140:143]
  buffer_load_dwordx4 v2, s[44:47], s69 offen lds
  v_mfma_f32_16x16x32_bf16 a[192:195], a[16:19], a[64:67], a[192:195]
  s_add_u32 s69, s69, s71
  v_mfma_f32_16x16x32_bf16 a[192:195], a[48:51], a[80:83], a[192:195]
  v_mfma_f32_16x16x32_bf16 a[208:211], a[16:19], a[68:71], a[208:211]
  v_mfma_f32_16x16x32_bf16 a[208:211], a[48:51], a[84:87], a[208:211]
  v_mfma_f32_16x16x32_bf16 a[224:227], a[16:19], a[72:75], a[224:227]
  v_mfma_f32_16x16x32_bf16 a[224:227], a[48:51], a[88:91], a[224:227]
  v_mfma_f32_16x16x32_bf16 a[240:243], a[16:19], a[76:79], a[240:243]
  s_add_u32 m0, s80, 1056
  v_mfma_f32_16x16x32_bf16 a[240:243], a[48:51], a[92:95], a[240:243]
  buffer_load_dwordx4 v3, s[48:51], s70 offen lds
  v_mfma_f32_16x16x32_bf16 a[244:247], a[20:23], a[76:79], a[244:247]
  v_mfma_f32_16x16x32_bf16 a[244:247], a[52:55], a[92:95], a[244:247]
  s_add_u32 s85, s82, 544768
  buffer_store_dwordx4 v[100:103], v11, s[32:35], s85 offen sc1
  v_mfma_f32_16x16x32_bf16 a[228:231], a[20:23], a[72:75], a[228:231]
  v_mfma_f32_16x16x32_bf16 a[228:231], a[52:55], a[88:91], a[228:231]
  v_mfma_f32_16x16x32_bf16 a[212:215], a[20:23], a[68:71], a[212:215]
  v_mfma_f32_16x16x32_bf16 a[212:215], a[52:55], a[84:87], a[212:215]
  v_mfma_f32_16x16x32_bf16 a[196:199], a[20:23], a[64:67], a[196:199]
  s_add_u32 m0, s80, 5280
  v_mfma_f32_16x16x32_bf16 a[196:199], a[52:55], a[80:83], a[196:199]
  buffer_load_dwordx4 v3, s[52:55], s70 offen lds
  v_mfma_f32_16x16x32_bf16 a[200:203], a[24:27], a[64:67], a[200:203]
  s_add_u32 s70, s70, s74
  v_mfma_f32_16x16x32_bf16 a[200:203], a[56:59], a[80:83], a[200:203]
  v_mfma_f32_16x16x32_bf16 a[216:219], a[24:27], a[68:71], a[216:219]
  v_mfma_f32_16x16x32_bf16 a[216:219], a[56:59], a[84:87], a[216:219]
  v_mfma_f32_16x16x32_bf16 a[232:235], a[24:27], a[72:75], a[232:235]
  s_add_u32 m0, s79, 2048
  v_mfma_f32_16x16x32_bf16 a[232:235], a[56:59], a[88:91], a[232:235]
  buffer_load_dwordx4 v1, s[44:47], s69 offen lds
  v_mfma_f32_16x16x32_bf16 a[248:251], a[24:27], a[76:79], a[248:251]
  s_add_u32 s69, s69, s71
  v_mfma_f32_16x16x32_bf16 a[248:251], a[56:59], a[92:95], a[248:251]
  v_mfma_f32_16x16x32_bf16 a[252:255], a[28:31], a[76:79], a[252:255]
  v_mfma_f32_16x16x32_bf16 a[252:255], a[60:63], a[92:95], a[252:255]
  v_mfma_f32_16x16x32_bf16 a[236:239], a[28:31], a[72:75], a[236:239]
  v_mfma_f32_16x16x32_bf16 a[236:239], a[60:63], a[88:91], a[236:239]
  v_mfma_f32_16x16x32_bf16 a[220:223], a[28:31], a[68:71], a[220:223]
  s_add_u32 m0, s80, 2112
  v_mfma_f32_16x16x32_bf16 a[220:223], a[60:63], a[84:87], a[220:223]
  buffer_load_dwordx4 v3, s[48:51], s70 offen lds
  v_mfma_f32_16x16x32_bf16 a[204:207], a[28:31], a[64:67], a[204:207]
  v_mfma_f32_16x16x32_bf16 a[204:207], a[60:63], a[80:83], a[204:207]
  s_add_u32 s85, s82, 24576
  buffer_store_dwordx4 v[104:107], v10, s[32:35], s85 offen sc1
  s_waitcnt vmcnt(16) lgkmcnt(0)
  s_barrier
  v_mfma_f32_16x16x32_bf16 v[192:195], a[0:3], a[96:99], v[192:195]
  v_mfma_f32_16x16x32_bf16 v[192:195], a[32:35], a[112:115], v[192:195]
  ds_read_b128 a[64:67], v7 offset:16384
  v_mfma_f32_16x16x32_bf16 v[208:211], a[0:3], a[100:103], v[208:211]
  v_mfma_f32_16x16x32_bf16 v[208:211], a[32:35], a[116:119], v[208:211]
  ds_read_b128 a[68:71], v7 offset:18432
  v_mfma_f32_16x16x32_bf16 v[224:227], a[0:3], a[104:107], v[224:227]
  s_add_u32 m0, s80, 6336
  v_mfma_f32_16x16x32_bf16 v[224:227], a[32:35], a[120:123], v[224:227]
  buffer_load_dwordx4 v3, s[52:55], s70 offen lds
  v_mfma_f32_16x16x32_bf16 v[240:243], a[0:3], a[108:111], v[240:243]
  s_add_u32 s70, s70, s74
  v_mfma_f32_16x16x32_bf16 v[240:243], a[32:35], a[124:127], v[240:243]
  ds_read_b128 a[72:75], v7 offset:20480
  v_mfma_f32_16x16x32_bf16 v[244:247], a[4:7], a[108:111], v[244:247]
  ds_read_b64_tr_b16 a[0:1], v9 offset:50688
  v_mfma_f32_16x16x32_bf16 v[244:247], a[36:39], a[124:127], v[244:247]
  ds_read_b64_tr_b16 a[2:3], v9 offset:50944
  v_mfma_f32_16x16x32_bf16 v[228:231], a[4:7], a[104:107], v[228:231]
  s_add_u32 m0, s79, 3072
  v_mfma_f32_16x16x32_bf16 v[228:231], a[36:39], a[120:123], v[228:231]
  buffer_load_dwordx4 v2, s[44:47], s69 offen lds
  v_mfma_f32_16x16x32_bf16 v[212:215], a[4:7], a[100:103], v[212:215]
  s_add_u32 s69, s69, s72
  v_mfma_f32_16x16x32_bf16 v[212:215], a[36:39], a[116:119], v[212:215]
  ds_read_b128 a[76:79], v7 offset:22528
  v_mfma_f32_16x16x32_bf16 v[196:199], a[4:7], a[96:99], v[196:199]
  ds_read_b64_tr_b16 a[32:33], v9 offset:59136
  v_mfma_f32_16x16x32_bf16 v[196:199], a[36:39], a[112:115], v[196:199]
  ds_read_b64_tr_b16 a[34:35], v9 offset:59392
  v_mfma_f32_16x16x32_bf16 v[200:203], a[8:11], a[96:99], v[200:203]
  ds_read_b64_tr_b16 a[4:5], v9 offset:50720
  v_mfma_f32_16x16x32_bf16 v[200:203], a[40:43], a[112:115], v[200:203]
  ds_read_b64_tr_b16 a[6:7], v9 offset:50976
  v_mfma_f32_16x16x32_bf16 v[216:219], a[8:11], a[100:103], v[216:219]
  s_add_u32 m0, s80, 3168
  v_mfma_f32_16x16x32_bf16 v[216:219], a[40:43], a[116:119], v[216:219]
  buffer_load_dwordx4 v3, s[48:51], s70 offen lds
  v_mfma_f32_16x16x32_bf16 v[232:235], a[8:11], a[104:107], v[232:235]
  ds_read_b128 a[80:83], v8 offset:16384
  v_mfma_f32_16x16x32_bf16 v[232:235], a[40:43], a[120:123], v[232:235]
  s_add_u32 s85, s82, 24576
  buffer_store_dwordx4 v[108:111], v11, s[32:35], s85 offen sc1
  v_mfma_f32_16x16x32_bf16 v[248:251], a[8:11], a[108:111], v[248:251]
  ds_read_b64_tr_b16 a[36:37], v9 offset:59168
  v_mfma_f32_16x16x32_bf16 v[248:251], a[40:43], a[124:127], v[248:251]
  ds_read_b64_tr_b16 a[38:39], v9 offset:59424
  v_mfma_f32_16x16x32_bf16 v[252:255], a[12:15], a[108:111], v[252:255]
  ds_read_b64_tr_b16 a[8:9], v9 offset:54912
  v_mfma_f32_16x16x32_bf16 v[252:255], a[44:47], a[124:127], v[252:255]
  ds_read_b64_tr_b16 a[10:11], v9 offset:55168
  v_mfma_f32_16x16x32_bf16 v[236:239], a[12:15], a[104:107], v[236:239]
  s_add_u32 m0, s80, 7392
  v_mfma_f32_16x16x32_bf16 v[236:239], a[44:47], a[120:123], v[236:239]
  buffer_load_dwordx4 v3, s[52:55], s70 offen lds
  v_mfma_f32_16x16x32_bf16 v[220:223], a[12:15], a[100:103], v[220:223]
  s_add_u32 s70, s70, s75
  v_mfma_f32_16x16x32_bf16 v[220:223], a[44:47], a[116:119], v[220:223]
  ds_read_b128 a[84:87], v8 offset:18432
  v_mfma_f32_16x16x32_bf16 v[204:207], a[12:15], a[96:99], v[204:207]
  ds_read_b64_tr_b16 a[40:41], v9 offset:63360
  v_mfma_f32_16x16x32_bf16 v[204:207], a[44:47], a[112:115], v[204:207]
  ds_read_b64_tr_b16 a[42:43], v9 offset:63616
  v_mfma_f32_16x16x32_bf16 v[128:131], a[16:19], a[96:99], v[128:131]
  s_add_u32 m0, s79, 32768
  v_mfma_f32_16x16x32_bf16 v[128:131], a[48:51], a[112:115], v[128:131]
  buffer_load_dwordx4 v1, s[44:47], s69 offen lds
  v_mfma_f32_16x16x32_bf16 v[144:147], a[16:19], a[100:103], v[144:147]
  s_add_u32 s69, s69, s71
  v_mfma_f32_16x16x32_bf16 v[144:147], a[48:51], a[116:119], v[144:147]
  ds_read_b64_tr_b16 a[12:13], v9 offset:54944
  v_mfma_f32_16x16x32_bf16 v[160:163], a[16:19], a[104:107], v[160:163]
  ds_read_b64_tr_b16 a[14:15], v9 offset:55200
  v_mfma_f32_16x16x32_bf16 v[160:163], a[48:51], a[120:123], v[160:163]
  ds_read_b128 a[88:91], v8 offset:20480
  v_mfma_f32_16x16x32_bf16 v[176:179], a[16:19], a[108:111], v[176:179]
  ds_read_b64_tr_b16 a[44:45], v9 offset:63392
  v_mfma_f32_16x16x32_bf16 v[176:179], a[48:51], a[124:127], v[176:179]
  ds_read_b64_tr_b16 a[46:47], v9 offset:63648
  v_mfma_f32_16x16x32_bf16 v[180:183], a[20:23], a[108:111], v[180:183]
  s_add_u32 m0, s79, 33792
  v_mfma_f32_16x16x32_bf16 v[180:183], a[52:55], a[124:127], v[180:183]
  buffer_load_dwordx4 v2, s[44:47], s69 offen lds
  v_mfma_f32_16x16x32_bf16 v[164:167], a[20:23], a[104:107], v[164:167]
  s_add_u32 s69, s69, s71
  v_mfma_f32_16x16x32_bf16 v[164:167], a[52:55], a[120:123], v[164:167]
  s_add_u32 s85, s82, 28672
  buffer_store_dwordx4 v[112:115], v10, s[32:35], s85 offen sc1
  v_mfma_f32_16x16x32_bf16 v[148:151], a[20:23], a[100:103], v[148:151]
  ds_read_b64_tr_b16 a[16:17], v9 offset:16896
  v_mfma_f32_16x16x32_bf16 v[148:151], a[52:55], a[116:119], v[148:151]
  ds_read_b64_tr_b16 a[18:19], v9 offset:17152
  v_mfma_f32_16x16x32_bf16 v[132:135], a[20:23], a[96:99], v[132:135]
  ds_read_b128 a[92:95], v8 offset:22528
  v_mfma_f32_16x16x32_bf16 v[132:135], a[52:55], a[112:115], v[132:135]
  ds_read_b64_tr_b16 a[48:49], v9 offset:25344
  v_mfma_f32_16x16x32_bf16 v[136:139], a[24:27], a[96:99], v[136:139]
  s_add_u32 m0, s79, 34816
  v_mfma_f32_16x16x32_bf16 v[136:139], a[56:59], a[112:115], v[136:139]
  buffer_load_dwordx4 v1, s[44:47], s69 offen lds
  v_mfma_f32_16x16x32_bf16 v[152:155], a[24:27], a[100:103], v[152:155]
  s_add_u32 s69, s69, s71
  v_mfma_f32_16x16x32_bf16 v[152:155], a[56:59], a[116:119], v[152:155]
  ds_read_b64_tr_b16 a[50:51], v9 offset:25600
  v_mfma_f32_16x16x32_bf16 v[168:171], a[24:27], a[104:107], v[168:171]
  ds_read_b64_tr_b16 a[20:21], v9 offset:16928
  v_mfma_f32_16x16x32_bf16 v[168:171], a[56:59], a[120:123], v[168:171]
  ds_read_b64_tr_b16 a[22:23], v9 offset:17184
  v_mfma_f32_16x16x32_bf16 v[184:187], a[24:27], a[108:111], v[184:187]
  ds_read_b64_tr_b16 a[52:53], v9 offset:25376
  v_mfma_f32_16x16x32_bf16 v[184:187], a[56:59], a[124:127], v[184:187]
  ds_read_b64_tr_b16 a[54:55], v9 offset:25632
  v_mfma_f32_16x16x32_bf16 v[188:191], a[28:31], a[108:111], v[188:191]
  s_add_u32 m0, s79, 35840
  v_mfma_f32_16x16x32_bf16 v[172:175], a[28:31], a[104:107], v[172:175]
  buffer_load_dwordx4 v2, s[44:47], s69 offen lds
  v_mfma_f32_16x16x32_bf16 v[156:159], a[28:31], a[100:103], v[156:159]
  s_add_u32 s69, s69, s73
  v_mfma_f32_16x16x32_bf16 v[140:143], a[28:31], a[96:99], v[140:143]
  ds_read_b64_tr_b16 a[24:25], v9 offset:21120
  v_mfma_f32_16x16x32_bf16 v[140:143], a[60:63], a[112:115], v[140:143]
  ds_read_b64_tr_b16 a[26:27], v9 offset:21376
  v_mfma_f32_16x16x32_bf16 v[156:159], a[60:63], a[116:119], v[156:159]
  ds_read_b64_tr_b16 a[56:57], v9 offset:29568
  v_mfma_f32_16x16x32_bf16 v[172:175], a[60:63], a[120:123], v[172:175]
  ds_read_b64_tr_b16 a[58:59], v9 offset:29824
  v_mfma_f32_16x16x32_bf16 v[188:191], a[60:63], a[124:127], v[188:191]
  ds_read_b64_tr_b16 a[28:29], v9 offset:21152
  ds_read_b64_tr_b16 a[30:31], v9 offset:21408
  ds_read_b64_tr_b16 a[60:61], v9 offset:29600
  ds_read_b64_tr_b16 a[62:63], v9 offset:29856
  s_waitcnt lgkmcnt(15)
  v_mfma_f32_16x16x32_bf16 a[128:131], a[0:3], a[64:67], a[128:131]
  v_mfma_f32_16x16x32_bf16 a[128:131], a[32:35], a[80:83], a[128:131]
  v_mfma_f32_16x16x32_bf16 a[144:147], a[0:3], a[68:71], a[144:147]
  v_mfma_f32_16x16x32_bf16 a[144:147], a[32:35], a[84:87], a[144:147]
  v_mfma_f32_16x16x32_bf16 a[160:163], a[0:3], a[72:75], a[160:163]
  v_mfma_f32_16x16x32_bf16 a[160:163], a[32:35], a[88:91], a[160:163]
  v_mfma_f32_16x16x32_bf16 a[176:179], a[0:3], a[76:79], a[176:179]
  s_waitcnt lgkmcnt(14)
  v_mfma_f32_16x16x32_bf16 a[176:179], a[32:35], a[92:95], a[176:179]
  s_waitcnt vmcnt(21) lgkmcnt(0)
  s_barrier
  v_mfma_f32_16x16x32_bf16 a[180:183], a[4:7], a[76:79], a[180:183]
  s_add_u32 m0, s79, 16384
  v_mfma_f32_16x16x32_bf16 a[180:183], a[36:39], a[92:95], a[180:183]
  buffer_load_dwordx4 v1, s[44:47], s69 offen lds
  v_mfma_f32_16x16x32_bf16 a[164:167], a[4:7], a[72:75], a[164:167]
  s_add_u32 s69, s69, s71
  v_mfma_f32_16x16x32_bf16 a[164:167], a[36:39], a[88:91], a[164:167]
  ds_read_b128 a[96:99], v7 offset:49152
  v_mfma_f32_16x16x32_bf16 a[148:151], a[4:7], a[68:71], a[148:151]
  v_mfma_f32_16x16x32_bf16 a[148:151], a[36:39], a[84:87], a[148:151]
  ds_read_b128 a[100:103], v7 offset:51200
  v_mfma_f32_16x16x32_bf16 a[132:135], a[4:7], a[64:67], a[132:135]
  v_mfma_f32_16x16x32_bf16 a[132:135], a[36:39], a[80:83], a[132:135]
  ds_read_b128 a[104:107], v7 offset:53248
  v_mfma_f32_16x16x32_bf16 a[136:139], a[8:11], a[64:67], a[136:139]
  s_add_u32 m0, s80, 16896
  v_mfma_f32_16x16x32_bf16 a[136:139], a[40:43], a[80:83], a[136:139]
  buffer_load_dwordx4 v3, s[48:51], s70 offen lds
  v_mfma_f32_16x16x32_bf16 a[152:155], a[8:11], a[68:71], a[152:155]
  ds_read_b128 a[108:111], v7 offset:55296
  v_mfma_f32_16x16x32_bf16 a[152:155], a[40:43], a[84:87], a[152:155]
  s_add_u32 s85, s82, 28672
  buffer_store_dwordx4 v[116:119], v11, s[32:35], s85 offen sc1
  v_mfma_f32_16x16x32_bf16 a[168:171], a[8:11], a[72:75], a[168:171]
  v_mfma_f32_16x16x32_bf16 a[168:171], a[40:43], a[88:91], a[168:171]
  ds_read_b128 a[112:115], v8 offset:49152
  v_mfma_f32_16x16x32_bf16 a[184:187], a[8:11], a[76:79], a[184:187]
  s_add_u32 m0, s80, 21120
  v_mfma_f32_16x16x32_bf16 a[184:187], a[40:43], a[92:95], a[184:187]
  buffer_load_dwordx4 v3, s[52:55], s70 offen lds
  v_mfma_f32_16x16x32_bf16 a[188:191], a[12:15], a[76:79], a[188:191]
  s_add_u32 s70, s70, s74
  v_mfma_f32_16x16x32_bf16 a[188:191], a[44:47], a[92:95], a[188:191]
  ds_read_b128 a[116:119], v8 offset:51200
  v_mfma_f32_16x16x32_bf16 a[172:175], a[12:15], a[72:75], a[172:175]
  v_mfma_f32_16x16x32_bf16 a[172:175], a[44:47], a[88:91], a[172:175]
  ds_read_b128 a[120:123], v8 offset:53248
  v_mfma_f32_16x16x32_bf16 a[156:159], a[12:15], a[68:71], a[156:159]
  v_mfma_f32_16x16x32_bf16 a[156:159], a[44:47], a[84:87], a[156:159]
  ds_read_b128 a[124:127], v8 offset:55296
  v_mfma_f32_16x16x32_bf16 a[140:143], a[12:15], a[64:67], a[140:143]
  s_add_u32 m0, s79, 17408
  v_mfma_f32_16x16x32_bf16 a[140:143], a[44:47], a[80:83], a[140:143]
  buffer_load_dwordx4 v2, s[44:47], s69 offen lds
  v_mfma_f32_16x16x32_bf16 a[192:195], a[16:19], a[64:67], a[192:195]
  s_add_u32 s69, s69, s71
  v_mfma_f32_16x16x32_bf16 a[192:195], a[48:51], a[80:83], a[192:195]
  v_mfma_f32_16x16x32_bf16 a[208:211], a[16:19], a[68:71], a[208:211]
  v_mfma_f32_16x16x32_bf16 a[208:211], a[48:51], a[84:87], a[208:211]
  v_mfma_f32_16x16x32_bf16 a[224:227], a[16:19], a[72:75], a[224:227]
  v_mfma_f32_16x16x32_bf16 a[224:227], a[48:51], a[88:91], a[224:227]
  v_mfma_f32_16x16x32_bf16 a[240:243], a[16:19], a[76:79], a[240:243]
  s_add_u32 m0, s80, 17952
  v_mfma_f32_16x16x32_bf16 a[240:243], a[48:51], a[92:95], a[240:243]
  buffer_load_dwordx4 v3, s[48:51], s70 offen lds
  v_mfma_f32_16x16x32_bf16 a[244:247], a[20:23], a[76:79], a[244:247]
  v_mfma_f32_16x16x32_bf16 a[244:247], a[52:55], a[92:95], a[244:247]
  s_add_u32 s85, s82, 548864
  buffer_store_dwordx4 v[120:123], v10, s[32:35], s85 offen sc1
  v_mfma_f32_16x16x32_bf16 a[228:231], a[20:23], a[72:75], a[228:231]
  v_mfma_f32_16x16x32_bf16 a[228:231], a[52:55], a[88:91], a[228:231]
  v_mfma_f32_16x16x32_bf16 a[212:215], a[20:23], a[68:71], a[212:215]
  v_mfma_f32_16x16x32_bf16 a[212:215], a[52:55], a[84:87], a[212:215]
  v_mfma_f32_16x16x32_bf16 a[196:199], a[20:23], a[64:67], a[196:199]
  s_add_u32 m0, s80, 22176
  v_mfma_f32_16x16x32_bf16 a[196:199], a[52:55], a[80:83], a[196:199]
  buffer_load_dwordx4 v3, s[52:55], s70 offen lds
  v_mfma_f32_16x16x32_bf16 a[200:203], a[24:27], a[64:67], a[200:203]
  s_add_u32 s70, s70, s74
  v_mfma_f32_16x16x32_bf16 a[200:203], a[56:59], a[80:83], a[200:203]
  v_mfma_f32_16x16x32_bf16 a[216:219], a[24:27], a[68:71], a[216:219]
  v_mfma_f32_16x16x32_bf16 a[216:219], a[56:59], a[84:87], a[216:219]
  v_mfma_f32_16x16x32_bf16 a[232:235], a[24:27], a[72:75], a[232:235]
  s_add_u32 m0, s79, 18432
  v_mfma_f32_16x16x32_bf16 a[232:235], a[56:59], a[88:91], a[232:235]
  buffer_load_dwordx4 v1, s[44:47], s69 offen lds
  v_mfma_f32_16x16x32_bf16 a[248:251], a[24:27], a[76:79], a[248:251]
  s_add_u32 s69, s69, s71
  v_mfma_f32_16x16x32_bf16 a[248:251], a[56:59], a[92:95], a[248:251]
  v_mfma_f32_16x16x32_bf16 a[252:255], a[28:31], a[76:79], a[252:255]
  v_mfma_f32_16x16x32_bf16 a[252:255], a[60:63], a[92:95], a[252:255]
  v_mfma_f32_16x16x32_bf16 a[236:239], a[28:31], a[72:75], a[236:239]
  v_mfma_f32_16x16x32_bf16 a[236:239], a[60:63], a[88:91], a[236:239]
  v_mfma_f32_16x16x32_bf16 a[220:223], a[28:31], a[68:71], a[220:223]
  s_add_u32 m0, s80, 19008
  v_mfma_f32_16x16x32_bf16 a[220:223], a[60:63], a[84:87], a[220:223]
  buffer_load_dwordx4 v3, s[48:51], s70 offen lds
  v_mfma_f32_16x16x32_bf16 a[204:207], a[28:31], a[64:67], a[204:207]
  v_mfma_f32_16x16x32_bf16 a[204:207], a[60:63], a[80:83], a[204:207]
  s_add_u32 s85, s82, 548864
  buffer_store_dwordx4 v[124:127], v11, s[32:35], s85 offen sc1
  s_waitcnt vmcnt(16) lgkmcnt(0)
  s_barrier
  v_mfma_f32_16x16x32_bf16 v[192:195], a[0:3], a[96:99], v[192:195]
  v_mfma_f32_16x16x32_bf16 v[192:195], a[32:35], a[112:115], v[192:195]
  ds_read_b128 a[64:67], v7 offset:0
  v_mfma_f32_16x16x32_bf16 v[208:211], a[0:3], a[100:103], v[208:211]
  v_mfma_f32_16x16x32_bf16 v[208:211], a[32:35], a[116:119], v[208:211]
  ds_read_b128 a[68:71], v7 offset:2048
  v_mfma_f32_16x16x32_bf16 v[224:227], a[0:3], a[104:107], v[224:227]
  s_add_u32 m0, s80, 23232
  v_mfma_f32_16x16x32_bf16 v[224:227], a[32:35], a[120:123], v[224:227]
  buffer_load_dwordx4 v3, s[52:55], s70 offen lds
  v_mfma_f32_16x16x32_bf16 v[240:243], a[0:3], a[108:111], v[240:243]
  s_add_u32 s70, s70, s74
  v_mfma_f32_16x16x32_bf16 v[240:243], a[32:35], a[124:127], v[240:243]
  ds_read_b128 a[72:75], v7 offset:4096
  v_mfma_f32_16x16x32_bf16 v[244:247], a[4:7], a[108:111], v[244:247]
  ds_read_b64_tr_b16 a[0:1], v9 offset:33792
  v_mfma_f32_16x16x32_bf16 v[244:247], a[36:39], a[124:127], v[244:247]
  ds_read_b64_tr_b16 a[2:3], v9 offset:34048
  v_mfma_f32_16x16x32_bf16 v[228:231], a[4:7], a[104:107], v[228:231]
  s_add_u32 m0, s79, 19456
  v_mfma_f32_16x16x32_bf16 v[228:231], a[36:39], a[120:123], v[228:231]
  buffer_load_dwordx4 v2, s[44:47], s69 offen lds
  v_mfma_f32_16x16x32_bf16 v[212:215], a[4:7], a[100:103], v[212:215]
  s_add_u32 s69, s69, s72
  v_mfma_f32_16x16x32_bf16 v[212:215], a[36:39], a[116:119], v[212:215]
  ds_read_b128 a[76:79], v7 offset:6144
  v_mfma_f32_16x16x32_bf16 v[196:199], a[4:7], a[96:99], v[196:199]
  ds_read_b64_tr_b16 a[32:33], v9 offset:42240
  v_mfma_f32_16x16x32_bf16 v[196:199], a[36:39], a[112:115], v[196:199]
  ds_read_b64_tr_b16 a[34:35], v9 offset:42496
  v_mfma_f32_16x16x32_bf16 v[200:203], a[8:11], a[96:99], v[200:203]
  ds_read_b64_tr_b16 a[4:5], v9 offset:33824
  v_mfma_f32_16x16x32_bf16 v[200:203], a[40:43], a[112:115], v[200:203]
  ds_read_b64_tr_b16 a[6:7], v9 offset:34080
  v_mfma_f32_16x16x32_bf16 v[216:219], a[8:11], a[100:103], v[216:219]
  s_add_u32 m0, s80, 20064
  v_mfma_f32_16x16x32_bf16 v[216:219], a[40:43], a[116:119], v[216:219]
  buffer_load_dwordx4 v3, s[48:51], s70 offen lds
  v_mfma_f32_16x16x32_bf16 v[232:235], a[8:11], a[104:107], v[232:235]
  ds_read_b128 a[80:83], v8 offset:0
  v_mfma_f32_16x16x32_bf16 v[232:235], a[40:43], a[120:123], v[232:235]
  ds_read_b64_tr_b16 a[36:37], v9 offset:42272
  v_mfma_f32_16x16x32_bf16 v[248:251], a[8:11], a[108:111], v[248:251]
  ds_read_b64_tr_b16 a[38:39], v9 offset:42528
  v_mfma_f32_16x16x32_bf16 v[248:251], a[40:43], a[124:127], v[248:251]
  ds_read_b64_tr_b16 a[8:9], v9 offset:38016
  v_mfma_f32_16x16x32_bf16 v[252:255], a[12:15], a[108:111], v[252:255]
  v_mfma_f32_16x16x32_bf16 v[252:255], a[44:47], a[124:127], v[252:255]
  ds_read_b64_tr_b16 a[10:11], v9 offset:38272
  v_mfma_f32_16x16x32_bf16 v[236:239], a[12:15], a[104:107], v[236:239]
  s_add_u32 m0, s80, 24288
  v_mfma_f32_16x16x32_bf16 v[236:239], a[44:47], a[120:123], v[236:239]
  buffer_load_dwordx4 v3, s[52:55], s70 offen lds
  v_mfma_f32_16x16x32_bf16 v[220:223], a[12:15], a[100:103], v[220:223]
  s_add_u32 s70, s70, s75
  v_mfma_f32_16x16x32_bf16 v[220:223], a[44:47], a[116:119], v[220:223]
  ds_read_b128 a[84:87], v8 offset:2048
  v_mfma_f32_16x16x32_bf16 v[204:207], a[12:15], a[96:99], v[204:207]
  ds_read_b64_tr_b16 a[40:41], v9 offset:46464
  v_mfma_f32_16x16x32_bf16 v[204:207], a[44:47], a[112:115], v[204:207]
  ds_read_b64_tr_b16 a[42:43], v9 offset:46720
  v_mfma_f32_16x16x32_bf16 v[128:131], a[16:19], a[96:99], v[128:131]
  s_add_u32 m0, s79, 49152
  v_mfma_f32_16x16x32_bf16 v[128:131], a[48:51], a[112:115], v[128:131]
  buffer_load_dwordx4 v1, s[44:47], s69 offen lds
  v_mfma_f32_16x16x32_bf16 v[144:147], a[16:19], a[100:103], v[144:147]
  s_add_u32 s69, s69, s71
  v_mfma_f32_16x16x32_bf16 v[144:147], a[48:51], a[116:119], v[144:147]
  ds_read_b64_tr_b16 a[12:13], v9 offset:38048
  v_mfma_f32_16x16x32_bf16 v[160:163], a[16:19], a[104:107], v[160:163]
  ds_read_b64_tr_b16 a[14:15], v9 offset:38304
  v_mfma_f32_16x16x32_bf16 v[160:163], a[48:51], a[120:123], v[160:163]
  ds_read_b128 a[88:91], v8 offset:4096
  v_mfma_f32_16x16x32_bf16 v[176:179], a[16:19], a[108:111], v[176:179]
  ds_read_b64_tr_b16 a[44:45], v9 offset:46496
  v_mfma_f32_16x16x32_bf16 v[176:179], a[48:51], a[124:127], v[176:179]
  ds_read_b64_tr_b16 a[46:47], v9 offset:46752
  v_mfma_f32_16x16x32_bf16 v[180:183], a[20:23], a[108:111], v[180:183]
  s_add_u32 m0, s79, 50176
  v_mfma_f32_16x16x32_bf16 v[180:183], a[52:55], a[124:127], v[180:183]
  buffer_load_dwordx4 v2, s[44:47], s69 offen lds
  v_mfma_f32_16x16x32_bf16 v[164:167], a[20:23], a[104:107], v[164:167]
  s_add_u32 s69, s69, s71
  v_mfma_f32_16x16x32_bf16 v[164:167], a[52:55], a[120:123], v[164:167]
  ds_read_b64_tr_b16 a[16:17], v9 offset:0
  v_mfma_f32_16x16x32_bf16 v[148:151], a[20:23], a[100:103], v[148:151]
  ds_read_b64_tr_b16 a[18:19], v9 offset:256
  v_mfma_f32_16x16x32_bf16 v[148:151], a[52:55], a[116:119], v[148:151]
  ds_read_b128 a[92:95], v8 offset:6144
  v_mfma_f32_16x16x32_bf16 v[132:135], a[20:23], a[96:99], v[132:135]
  ds_read_b64_tr_b16 a[48:49], v9 offset:8448
  v_mfma_f32_16x16x32_bf16 v[132:135], a[52:55], a[112:115], v[132:135]
  ds_read_b64_tr_b16 a[50:51], v9 offset:8704
  v_mfma_f32_16x16x32_bf16 v[136:139], a[24:27], a[96:99], v[136:139]
  s_add_u32 m0, s79, 51200
  v_mfma_f32_16x16x32_bf16 v[136:139], a[56:59], a[112:115], v[136:139]
  buffer_load_dwordx4 v1, s[44:47], s69 offen lds
  v_mfma_f32_16x16x32_bf16 v[152:155], a[24:27], a[100:103], v[152:155]
  s_add_u32 s69, s69, s71
  v_mfma_f32_16x16x32_bf16 v[152:155], a[56:59], a[116:119], v[152:155]
  ds_read_b64_tr_b16 a[20:21], v9 offset:32
  v_mfma_f32_16x16x32_bf16 v[168:171], a[24:27], a[104:107], v[168:171]
  ds_read_b64_tr_b16 a[22:23], v9 offset:288
  v_mfma_f32_16x16x32_bf16 v[168:171], a[56:59], a[120:123], v[168:171]
  ds_read_b64_tr_b16 a[52:53], v9 offset:8480
  v_mfma_f32_16x16x32_bf16 v[184:187], a[24:27], a[108:111], v[184:187]
  ds_read_b64_tr_b16 a[54:55], v9 offset:8736
  v_mfma_f32_16x16x32_bf16 v[184:187], a[56:59], a[124:127], v[184:187]
  ds_read_b64_tr_b16 a[24:25], v9 offset:4224
  v_mfma_f32_16x16x32_bf16 v[188:191], a[28:31], a[108:111], v[188:191]
  s_add_u32 m0, s79, 52224
  v_mfma_f32_16x16x32_bf16 v[172:175], a[28:31], a[104:107], v[172:175]
  buffer_load_dwordx4 v2, s[44:47], s69 offen lds
  v_mfma_f32_16x16x32_bf16 v[156:159], a[28:31], a[100:103], v[156:159]
  s_add_u32 s69, s69, s73
  v_mfma_f32_16x16x32_bf16 v[140:143], a[28:31], a[96:99], v[140:143]
  s_add_u32 s65, s64, 16384
  buffer_load_dword v5, v4, s[60:63], s65 offen
  v_mfma_f32_16x16x32_bf16 v[140:143], a[60:63], a[112:115], v[140:143]
  ds_read_b64_tr_b16 a[26:27], v9 offset:4480
  v_mfma_f32_16x16x32_bf16 v[156:159], a[60:63], a[116:119], v[156:159]
  ds_read_b64_tr_b16 a[56:57], v9 offset:12672
  v_mfma_f32_16x16x32_bf16 v[172:175], a[60:63], a[120:123], v[172:175]
  ds_read_b64_tr_b16 a[58:59], v9 offset:12928
  v_mfma_f32_16x16x32_bf16 v[188:191], a[60:63], a[124:127], v[188:191]
  ds_read_b64_tr_b16 a[28:29], v9 offset:4256
  ds_read_b64_tr_b16 a[30:31], v9 offset:4512
  ds_read_b64_tr_b16 a[60:61], v9 offset:12704
  ds_read_b64_tr_b16 a[62:63], v9 offset:12960
  s_waitcnt lgkmcnt(15)
  v_mfma_f32_16x16x32_bf16 a[128:131], a[0:3], a[64:67], a[128:131]
  v_mfma_f32_16x16x32_bf16 a[128:131], a[32:35], a[80:83], a[128:131]
  v_mfma_f32_16x16x32_bf16 a[144:147], a[0:3], a[68:71], a[144:147]
  v_mfma_f32_16x16x32_bf16 a[144:147], a[32:35], a[84:87], a[144:147]
  v_mfma_f32_16x16x32_bf16 a[160:163], a[0:3], a[72:75], a[160:163]
  v_mfma_f32_16x16x32_bf16 a[160:163], a[32:35], a[88:91], a[160:163]
  v_mfma_f32_16x16x32_bf16 a[176:179], a[0:3], a[76:79], a[176:179]
  s_waitcnt lgkmcnt(14)
  v_mfma_f32_16x16x32_bf16 a[176:179], a[32:35], a[92:95], a[176:179]
  s_waitcnt vmcnt(20) lgkmcnt(0)
  s_barrier
  v_mfma_f32_16x16x32_bf16 a[180:183], a[4:7], a[76:79], a[180:183]
  s_add_u32 m0, s79, 0
  v_mfma_f32_16x16x32_bf16 a[180:183], a[36:39], a[92:95], a[180:183]
  buffer_load_dwordx4 v1, s[44:47], s69 offen lds
  v_mfma_f32_16x16x32_bf16 a[164:167], a[4:7], a[72:75], a[164:167]
  s_add_u32 s69, s69, s71
  v_mfma_f32_16x16x32_bf16 a[164:167], a[36:39], a[88:91], a[164:167]
  ds_read_b128 a[96:99], v7 offset:32768
  v_mfma_f32_16x16x32_bf16 a[148:151], a[4:7], a[68:71], a[148:151]
  v_mfma_f32_16x16x32_bf16 a[148:151], a[36:39], a[84:87], a[148:151]
  ds_read_b128 a[100:103], v7 offset:34816
  v_mfma_f32_16x16x32_bf16 a[132:135], a[4:7], a[64:67], a[132:135]
  v_mfma_f32_16x16x32_bf16 a[132:135], a[36:39], a[80:83], a[132:135]
  ds_read_b128 a[104:107], v7 offset:36864
  v_mfma_f32_16x16x32_bf16 a[136:139], a[8:11], a[64:67], a[136:139]
  s_add_u32 m0, s80, 0
  v_mfma_f32_16x16x32_bf16 a[136:139], a[40:43], a[80:83], a[136:139]
  buffer_load_dwordx4 v3, s[48:51], s70 offen lds
  v_mfma_f32_16x16x32_bf16 a[152:155], a[8:11], a[68:71], a[152:155]
  ds_read_b128 a[108:111], v7 offset:38912
  v_mfma_f32_16x16x32_bf16 a[152:155], a[40:43], a[84:87], a[152:155]
  v_mfma_f32_16x16x32_bf16 a[168:171], a[8:11], a[72:75], a[168:171]
  v_mfma_f32_16x16x32_bf16 a[168:171], a[40:43], a[88:91], a[168:171]
  ds_read_b128 a[112:115], v8 offset:32768
  v_mfma_f32_16x16x32_bf16 a[184:187], a[8:11], a[76:79], a[184:187]
  s_add_u32 m0, s80, 4224
  v_mfma_f32_16x16x32_bf16 a[184:187], a[40:43], a[92:95], a[184:187]
  buffer_load_dwordx4 v3, s[52:55], s70 offen lds
  v_mfma_f32_16x16x32_bf16 a[188:191], a[12:15], a[76:79], a[188:191]
  s_add_u32 s70, s70, s74
  v_mfma_f32_16x16x32_bf16 a[188:191], a[44:47], a[92:95], a[188:191]
  ds_read_b128 a[116:119], v8 offset:34816
  v_mfma_f32_16x16x32_bf16 a[172:175], a[12:15], a[72:75], a[172:175]
  v_mfma_f32_16x16x32_bf16 a[172:175], a[44:47], a[88:91], a[172:175]
  ds_read_b128 a[120:123], v8 offset:36864
  v_mfma_f32_16x16x32_bf16 a[156:159], a[12:15], a[68:71], a[156:159]
  v_mfma_f32_16x16x32_bf16 a[156:159], a[44:47], a[84:87], a[156:159]
  ds_read_b128 a[124:127], v8 offset:38912
  v_mfma_f32_16x16x32_bf16 a[140:143], a[12:15], a[64:67], a[140:143]
  s_add_u32 m0, s79, 1024
  v_mfma_f32_16x16x32_bf16 a[140:143], a[44:47], a[80:83], a[140:143]
  buffer_load_dwordx4 v2, s[44:47], s69 offen lds
  v_mfma_f32_16x16x32_bf16 a[192:195], a[16:19], a[64:67], a[192:195]
  s_add_u32 s69, s69, s71
  v_mfma_f32_16x16x32_bf16 a[192:195], a[48:51], a[80:83], a[192:195]
  v_mfma_f32_16x16x32_bf16 a[208:211], a[16:19], a[68:71], a[208:211]
  v_mfma_f32_16x16x32_bf16 a[208:211], a[48:51], a[84:87], a[208:211]
  v_mfma_f32_16x16x32_bf16 a[224:227], a[16:19], a[72:75], a[224:227]
  v_mfma_f32_16x16x32_bf16 a[224:227], a[48:51], a[88:91], a[224:227]
  v_mfma_f32_16x16x32_bf16 a[240:243], a[16:19], a[76:79], a[240:243]
  s_add_u32 m0, s80, 1056
  v_mfma_f32_16x16x32_bf16 a[240:243], a[48:51], a[92:95], a[240:243]
  buffer_load_dwordx4 v3, s[48:51], s70 offen lds
  v_mfma_f32_16x16x32_bf16 a[244:247], a[20:23], a[76:79], a[244:247]
  v_mfma_f32_16x16x32_bf16 a[244:247], a[52:55], a[92:95], a[244:247]
  v_mfma_f32_16x16x32_bf16 a[228:231], a[20:23], a[72:75], a[228:231]
  v_mfma_f32_16x16x32_bf16 a[228:231], a[52:55], a[88:91], a[228:231]
  v_mfma_f32_16x16x32_bf16 a[212:215], a[20:23], a[68:71], a[212:215]
  v_mfma_f32_16x16x32_bf16 a[212:215], a[52:55], a[84:87], a[212:215]
  v_mfma_f32_16x16x32_bf16 a[196:199], a[20:23], a[64:67], a[196:199]
  s_add_u32 m0, s80, 5280
  v_mfma_f32_16x16x32_bf16 a[196:199], a[52:55], a[80:83], a[196:199]
  buffer_load_dwordx4 v3, s[52:55], s70 offen lds
  v_mfma_f32_16x16x32_bf16 a[200:203], a[24:27], a[64:67], a[200:203]
  s_add_u32 s70, s70, s74
  v_mfma_f32_16x16x32_bf16 a[200:203], a[56:59], a[80:83], a[200:203]
  v_mfma_f32_16x16x32_bf16 a[216:219], a[24:27], a[68:71], a[216:219]
  v_mfma_f32_16x16x32_bf16 a[216:219], a[56:59], a[84:87], a[216:219]
  v_mfma_f32_16x16x32_bf16 a[232:235], a[24:27], a[72:75], a[232:235]
  s_add_u32 m0, s79, 2048
  v_mfma_f32_16x16x32_bf16 a[232:235], a[56:59], a[88:91], a[232:235]
  buffer_load_dwordx4 v1, s[44:47], s69 offen lds
  v_mfma_f32_16x16x32_bf16 a[248:251], a[24:27], a[76:79], a[248:251]
  s_add_u32 s69, s69, s71
  v_mfma_f32_16x16x32_bf16 a[248:251], a[56:59], a[92:95], a[248:251]
  v_mfma_f32_16x16x32_bf16 a[252:255], a[28:31], a[76:79], a[252:255]
  v_mfma_f32_16x16x32_bf16 a[252:255], a[60:63], a[92:95], a[252:255]
  v_mfma_f32_16x16x32_bf16 a[236:239], a[28:31], a[72:75], a[236:239]
  v_mfma_f32_16x16x32_bf16 a[236:239], a[60:63], a[88:91], a[236:239]
  v_mfma_f32_16x16x32_bf16 a[220:223], a[28:31], a[68:71], a[220:223]
  s_add_u32 m0, s80, 2112
  v_mfma_f32_16x16x32_bf16 a[220:223], a[60:63], a[84:87], a[220:223]
  buffer_load_dwordx4 v3, s[48:51], s70 offen lds
  v_mfma_f32_16x16x32_bf16 a[204:207], a[28:31], a[64:67], a[204:207]
  v_mfma_f32_16x16x32_bf16 a[204:207], a[60:63], a[80:83], a[204:207]
  s_waitcnt vmcnt(13) lgkmcnt(0)
  s_barrier
  buffer_atomic_add v14, v15, s[16:19], 0 offen
  v_mfma_f32_16x16x32_bf16 v[192:195], a[0:3], a[96:99], v[192:195]
  v_mfma_f32_16x16x32_bf16 v[192:195], a[32:35], a[112:115], v[192:195]
  ds_read_b128 a[64:67], v7 offset:16384
  v_mfma_f32_16x16x32_bf16 v[208:211], a[0:3], a[100:103], v[208:211]
  v_mfma_f32_16x16x32_bf16 v[208:211], a[32:35], a[116:119], v[208:211]
  ds_read_b128 a[68:71], v7 offset:18432
  v_accvgpr_read_b32 v16, a128
  v_mfma_f32_16x16x32_bf16 v[224:227], a[0:3], a[104:107], v[224:227]
  s_add_u32 m0, s80, 6336
  v_accvgpr_read_b32 v17, a129
  v_mfma_f32_16x16x32_bf16 v[224:227], a[32:35], a[120:123], v[224:227]
  buffer_load_dwordx4 v3, s[52:55], s70 offen lds
  v_accvgpr_read_b32 v18, a130
  v_mfma_f32_16x16x32_bf16 v[240:243], a[0:3], a[108:111], v[240:243]
  s_add_u32 s70, s70, s74
  v_accvgpr_read_b32 v19, a131
  v_mfma_f32_16x16x32_bf16 v[240:243], a[32:35], a[124:127], v[240:243]
  ds_read_b128 a[72:75], v7 offset:20480
  v_accvgpr_read_b32 v20, a132
  v_mfma_f32_16x16x32_bf16 v[244:247], a[4:7], a[108:111], v[244:247]
  ds_read_b64_tr_b16 a[0:1], v9 offset:50688
  v_accvgpr_read_b32 v21, a133
  v_mfma_f32_16x16x32_bf16 v[244:247], a[36:39], a[124:127], v[244:247]
  ds_read_b64_tr_b16 a[2:3], v9 offset:50944
  v_accvgpr_read_b32 v22, a134
  v_mfma_f32_16x16x32_bf16 v[228:231], a[4:7], a[104:107], v[228:231]
  s_add_u32 m0, s79, 3072
  v_accvgpr_read_b32 v23, a135
  v_mfma_f32_16x16x32_bf16 v[228:231], a[36:39], a[120:123], v[228:231]
  buffer_load_dwordx4 v2, s[44:47], s69 offen lds
  v_accvgpr_read_b32 v24, a136
  v_mfma_f32_16x16x32_bf16 v[212:215], a[4:7], a[100:103], v[212:215]
  s_add_u32 s69, s69, s72
  v_accvgpr_read_b32 v25, a137
  v_mfma_f32_16x16x32_bf16 v[212:215], a[36:39], a[116:119], v[212:215]
  ds_read_b128 a[76:79], v7 offset:22528
  v_accvgpr_read_b32 v26, a138
  v_mfma_f32_16x16x32_bf16 v[196:199], a[4:7], a[96:99], v[196:199]
  ds_read_b64_tr_b16 a[32:33], v9 offset:59136
  v_accvgpr_read_b32 v27, a139
  v_mfma_f32_16x16x32_bf16 v[196:199], a[36:39], a[112:115], v[196:199]
  ds_read_b64_tr_b16 a[34:35], v9 offset:59392
  v_accvgpr_read_b32 v28, a140
  v_mfma_f32_16x16x32_bf16 v[200:203], a[8:11], a[96:99], v[200:203]
  ds_read_b64_tr_b16 a[4:5], v9 offset:50720
  v_accvgpr_read_b32 v29, a141
  v_mfma_f32_16x16x32_bf16 v[200:203], a[40:43], a[112:115], v[200:203]
  ds_read_b64_tr_b16 a[6:7], v9 offset:50976
  v_accvgpr_read_b32 v30, a142
  v_mfma_f32_16x16x32_bf16 v[216:219], a[8:11], a[100:103], v[216:219]
  s_add_u32 m0, s80, 3168
  v_accvgpr_read_b32 v31, a143
  v_mfma_f32_16x16x32_bf16 v[216:219], a[40:43], a[116:119], v[216:219]
  buffer_load_dwordx4 v3, s[48:51], s70 offen lds
  v_accvgpr_read_b32 v32, a144
  v_mfma_f32_16x16x32_bf16 v[232:235], a[8:11], a[104:107], v[232:235]
  ds_read_b128 a[80:83], v8 offset:16384
  v_accvgpr_read_b32 v33, a145
  v_mfma_f32_16x16x32_bf16 v[232:235], a[40:43], a[120:123], v[232:235]
  ds_read_b64_tr_b16 a[36:37], v9 offset:59168
  v_accvgpr_read_b32 v34, a146
  v_mfma_f32_16x16x32_bf16 v[248:251], a[8:11], a[108:111], v[248:251]
  ds_read_b64_tr_b16 a[38:39], v9 offset:59424
  v_accvgpr_read_b32 v35, a147
  v_mfma_f32_16x16x32_bf16 v[248:251], a[40:43], a[124:127], v[248:251]
  ds_read_b64_tr_b16 a[8:9], v9 offset:54912
  v_accvgpr_read_b32 v36, a148
  v_mfma_f32_16x16x32_bf16 v[252:255], a[12:15], a[108:111], v[252:255]
  v_accvgpr_read_b32 v37, a149
  v_accvgpr_read_b32 v38, a150
  v_mfma_f32_16x16x32_bf16 v[252:255], a[44:47], a[124:127], v[252:255]
  ds_read_b64_tr_b16 a[10:11], v9 offset:55168
  v_accvgpr_read_b32 v39, a151
  v_mfma_f32_16x16x32_bf16 v[236:239], a[12:15], a[104:107], v[236:239]
  s_add_u32 m0, s80, 7392
  v_accvgpr_read_b32 v40, a152
  v_mfma_f32_16x16x32_bf16 v[236:239], a[44:47], a[120:123], v[236:239]
  buffer_load_dwordx4 v3, s[52:55], s70 offen lds
  v_accvgpr_read_b32 v41, a153
  v_mfma_f32_16x16x32_bf16 v[220:223], a[12:15], a[100:103], v[220:223]
  s_add_u32 s70, s70, s75
  v_accvgpr_read_b32 v42, a154
  v_mfma_f32_16x16x32_bf16 v[220:223], a[44:47], a[116:119], v[220:223]
  ds_read_b128 a[84:87], v8 offset:18432
  v_accvgpr_read_b32 v43, a155
  v_mfma_f32_16x16x32_bf16 v[204:207], a[12:15], a[96:99], v[204:207]
  ds_read_b64_tr_b16 a[40:41], v9 offset:63360
  v_accvgpr_read_b32 v44, a156
  v_mfma_f32_16x16x32_bf16 v[204:207], a[44:47], a[112:115], v[204:207]
  ds_read_b64_tr_b16 a[42:43], v9 offset:63616
  v_accvgpr_read_b32 v45, a157
  v_mfma_f32_16x16x32_bf16 v[128:131], a[16:19], a[96:99], v[128:131]
  s_add_u32 m0, s79, 32768
  v_accvgpr_read_b32 v46, a158
  v_mfma_f32_16x16x32_bf16 v[128:131], a[48:51], a[112:115], v[128:131]
  buffer_load_dwordx4 v1, s[44:47], s69 offen lds
  v_accvgpr_read_b32 v47, a159
  v_mfma_f32_16x16x32_bf16 v[144:147], a[16:19], a[100:103], v[144:147]
  s_add_u32 s69, s69, s71
  v_accvgpr_read_b32 v48, a160
  v_mfma_f32_16x16x32_bf16 v[144:147], a[48:51], a[116:119], v[144:147]
  ds_read_b64_tr_b16 a[12:13], v9 offset:54944
  v_accvgpr_read_b32 v49, a161
  v_mfma_f32_16x16x32_bf16 v[160:163], a[16:19], a[104:107], v[160:163]
  ds_read_b64_tr_b16 a[14:15], v9 offset:55200
  v_accvgpr_read_b32 v50, a162
  v_mfma_f32_16x16x32_bf16 v[160:163], a[48:51], a[120:123], v[160:163]
  ds_read_b128 a[88:91], v8 offset:20480
  v_accvgpr_read_b32 v51, a163
  v_mfma_f32_16x16x32_bf16 v[176:179], a[16:19], a[108:111], v[176:179]
  ds_read_b64_tr_b16 a[44:45], v9 offset:63392
  v_accvgpr_read_b32 v52, a164
  v_mfma_f32_16x16x32_bf16 v[176:179], a[48:51], a[124:127], v[176:179]
  ds_read_b64_tr_b16 a[46:47], v9 offset:63648
  v_accvgpr_read_b32 v53, a165
  v_mfma_f32_16x16x32_bf16 v[180:183], a[20:23], a[108:111], v[180:183]
  s_add_u32 m0, s79, 33792
  v_accvgpr_read_b32 v54, a166
  v_mfma_f32_16x16x32_bf16 v[180:183], a[52:55], a[124:127], v[180:183]
  buffer_load_dwordx4 v2, s[44:47], s69 offen lds
  v_accvgpr_read_b32 v55, a167
  v_mfma_f32_16x16x32_bf16 v[164:167], a[20:23], a[104:107], v[164:167]
  s_add_u32 s69, s69, s71
  v_accvgpr_read_b32 v56, a168
  v_mfma_f32_16x16x32_bf16 v[164:167], a[52:55], a[120:123], v[164:167]
  ds_read_b64_tr_b16 a[16:17], v9 offset:16896
  v_accvgpr_read_b32 v57, a169
  v_mfma_f32_16x16x32_bf16 v[148:151], a[20:23], a[100:103], v[148:151]
  ds_read_b64_tr_b16 a[18:19], v9 offset:17152
  v_accvgpr_read_b32 v58, a170
  v_mfma_f32_16x16x32_bf16 v[148:151], a[52:55], a[116:119], v[148:151]
  ds_read_b128 a[92:95], v8 offset:22528
  v_accvgpr_read_b32 v59, a171
  v_mfma_f32_16x16x32_bf16 v[132:135], a[20:23], a[96:99], v[132:135]
  ds_read_b64_tr_b16 a[48:49], v9 offset:25344
  v_accvgpr_read_b32 v60, a172
  v_mfma_f32_16x16x32_bf16 v[132:135], a[52:55], a[112:115], v[132:135]
  ds_read_b64_tr_b16 a[50:51], v9 offset:25600
  v_accvgpr_read_b32 v61, a173
  v_mfma_f32_16x16x32_bf16 v[136:139], a[24:27], a[96:99], v[136:139]
  s_add_u32 m0, s79, 34816
  v_accvgpr_read_b32 v62, a174
  v_mfma_f32_16x16x32_bf16 v[136:139], a[56:59], a[112:115], v[136:139]
  buffer_load_dwordx4 v1, s[44:47], s69 offen lds
  v_accvgpr_read_b32 v63, a175
  v_mfma_f32_16x16x32_bf16 v[152:155], a[24:27], a[100:103], v[152:155]
  s_add_u32 s69, s69, s71
  v_accvgpr_read_b32 v112, a176
  v_mfma_f32_16x16x32_bf16 v[152:155], a[56:59], a[116:119], v[152:155]
  ds_read_b64_tr_b16 a[20:21], v9 offset:16928
  v_accvgpr_read_b32 v113, a177
  v_mfma_f32_16x16x32_bf16 v[168:171], a[24:27], a[104:107], v[168:171]
  ds_read_b64_tr_b16 a[22:23], v9 offset:17184
  v_accvgpr_read_b32 v114, a178
  v_mfma_f32_16x16x32_bf16 v[168:171], a[56:59], a[120:123], v[168:171]
  ds_read_b64_tr_b16 a[52:53], v9 offset:25376
  v_accvgpr_read_b32 v115, a179
  v_mfma_f32_16x16x32_bf16 v[184:187], a[24:27], a[108:111], v[184:187]
  ds_read_b64_tr_b16 a[54:55], v9 offset:25632
  v_accvgpr_read_b32 v116, a180
  v_mfma_f32_16x16x32_bf16 v[184:187], a[56:59], a[124:127], v[184:187]
  ds_read_b64_tr_b16 a[24:25], v9 offset:21120
  v_accvgpr_read_b32 v117, a181
  v_mfma_f32_16x16x32_bf16 v[188:191], a[28:31], a[108:111], v[188:191]
  s_add_u32 m0, s79, 35840
  v_accvgpr_read_b32 v118, a182
  v_mfma_f32_16x16x32_bf16 v[172:175], a[28:31], a[104:107], v[172:175]
  buffer_load_dwordx4 v2, s[44:47], s69 offen lds
  v_accvgpr_read_b32 v119, a183
  v_mfma_f32_16x16x32_bf16 v[156:159], a[28:31], a[100:103], v[156:159]
  s_add_u32 s69, s69, s73
  v_mfma_f32_16x16x32_bf16 v[140:143], a[28:31], a[96:99], v[140:143]
  ds_read_b64_tr_b16 a[26:27], v9 offset:21376
  v_mfma_f32_16x16x32_bf16 v[140:143], a[60:63], a[112:115], v[140:143]
  ds_read_b64_tr_b16 a[56:57], v9 offset:29568
  v_mfma_f32_16x16x32_bf16 v[156:159], a[60:63], a[116:119], v[156:159]
  ds_read_b64_tr_b16 a[58:59], v9 offset:29824
  v_mfma_f32_16x16x32_bf16 v[172:175], a[60:63], a[120:123], v[172:175]
  ds_read_b64_tr_b16 a[28:29], v9 offset:21152
  v_mfma_f32_16x16x32_bf16 v[188:191], a[60:63], a[124:127], v[188:191]
  ds_read_b64_tr_b16 a[30:31], v9 offset:21408
  ds_read_b64_tr_b16 a[60:61], v9 offset:29600
  ds_read_b64_tr_b16 a[62:63], v9 offset:29856
  s_waitcnt lgkmcnt(15)
  v_mfma_f32_16x16x32_bf16 v[16:19], a[0:3], a[64:67], v[16:19]
  v_mfma_f32_16x16x32_bf16 v[16:19], a[32:35], a[80:83], v[16:19]
  v_mfma_f32_16x16x32_bf16 v[32:35], a[0:3], a[68:71], v[32:35]
  v_mfma_f32_16x16x32_bf16 v[32:35], a[32:35], a[84:87], v[32:35]
  v_mfma_f32_16x16x32_bf16 v[48:51], a[0:3], a[72:75], v[48:51]
  v_mfma_f32_16x16x32_bf16 v[48:51], a[32:35], a[88:91], v[48:51]
  v_mfma_f32_16x16x32_bf16 v[112:115], a[0:3], a[76:79], v[112:115]
  s_waitcnt lgkmcnt(14)
  v_mfma_f32_16x16x32_bf16 v[112:115], a[32:35], a[92:95], v[112:115]
  s_waitcnt vmcnt(18) lgkmcnt(0)
  s_barrier
  v_mfma_f32_16x16x32_bf16 v[116:119], a[4:7], a[76:79], v[116:119]
  s_add_u32 m0, s79, 16384
  v_mfma_f32_16x16x32_bf16 v[116:119], a[36:39], a[92:95], v[116:119]
  buffer_load_dwordx4 v1, s[44:47], s69 offen lds
  v_mfma_f32_16x16x32_bf16 v[52:55], a[4:7], a[72:75], v[52:55]
  s_add_u32 s69, s69, s71
  v_mfma_f32_16x16x32_bf16 v[52:55], a[36:39], a[88:91], v[52:55]
  ds_read_b128 a[96:99], v7 offset:49152
  v_mfma_f32_16x16x32_bf16 v[36:39], a[4:7], a[68:71], v[36:39]
  v_mfma_f32_16x16x32_bf16 v[36:39], a[36:39], a[84:87], v[36:39]
  ds_read_b128 a[100:103], v7 offset:51200
  v_mfma_f32_16x16x32_bf16 v[20:23], a[4:7], a[64:67], v[20:23]
  s_add_u32 m0, s80, 16896
  v_mfma_f32_16x16x32_bf16 v[20:23], a[36:39], a[80:83], v[20:23]
  buffer_load_dwordx4 v3, s[48:51], s70 offen lds
  v_mfma_f32_16x16x32_bf16 v[24:27], a[8:11], a[64:67], v[24:27]
  ds_read_b128 a[104:107], v7 offset:53248
  v_mfma_f32_16x16x32_bf16 v[24:27], a[40:43], a[80:83], v[24:27]
  v_mfma_f32_16x16x32_bf16 v[40:43], a[8:11], a[68:71], v[40:43]
  v_mfma_f32_16x16x32_bf16 v[40:43], a[40:43], a[84:87], v[40:43]
  ds_read_b128 a[108:111], v7 offset:55296
  v_mfma_f32_16x16x32_bf16 v[56:59], a[8:11], a[72:75], v[56:59]
  s_add_u32 m0, s80, 21120
  v_mfma_f32_16x16x32_bf16 v[56:59], a[40:43], a[88:91], v[56:59]
  buffer_load_dwordx4 v3, s[52:55], s70 offen lds
  v_mfma_f32_16x16x32_bf16 a[184:187], a[8:11], a[76:79], a[184:187]
  s_add_u32 s70, s70, s74
  v_mfma_f32_16x16x32_bf16 a[184:187], a[40:43], a[92:95], a[184:187]
  ds_read_b128 a[112:115], v8 offset:49152
  v_mfma_f32_16x16x32_bf16 a[188:191], a[12:15], a[76:79], a[188:191]
  s_add_u32 m0, s79, 17408
  v_mfma_f32_16x16x32_bf16 a[188:191], a[44:47], a[92:95], a[188:191]
  buffer_load_dwordx4 v2, s[44:47], s69 offen lds
  v_mfma_f32_16x16x32_bf16 v[60:63], a[12:15], a[72:75], v[60:63]
  s_add_u32 s69, s69, s71
  v_mfma_f32_16x16x32_bf16 v[60:63], a[44:47], a[88:91], v[60:63]
  ds_read_b128 a[116:119], v8 offset:51200
  v_mfma_f32_16x16x32_bf16 v[44:47], a[12:15], a[68:71], v[44:47]
  v_mfma_f32_16x16x32_bf16 v[44:47], a[44:47], a[84:87], v[44:47]
  ds_read_b128 a[120:123], v8 offset:53248
  v_mfma_f32_16x16x32_bf16 v[28:31], a[12:15], a[64:67], v[28:31]
  s_add_u32 m0, s80, 17952
  v_mfma_f32_16x16x32_bf16 v[28:31], a[44:47], a[80:83], v[28:31]
  buffer_load_dwordx4 v3, s[48:51], s70 offen lds
  v_mfma_f32_16x16x32_bf16 a[192:195], a[16:19], a[64:67], a[192:195]
  ds_read_b128 a[124:127], v8 offset:55296
  v_mfma_f32_16x16x32_bf16 a[192:195], a[48:51], a[80:83], a[192:195]
  v_mfma_f32_16x16x32_bf16 a[208:211], a[16:19], a[68:71], a[208:211]
  v_mfma_f32_16x16x32_bf16 a[208:211], a[48:51], a[84:87], a[208:211]
  v_mfma_f32_16x16x32_bf16 a[224:227], a[16:19], a[72:75], a[224:227]
  s_add_u32 m0, s80, 22176
  v_mfma_f32_16x16x32_bf16 a[224:227], a[48:51], a[88:91], a[224:227]
  buffer_load_dwordx4 v3, s[52:55], s70 offen lds
  v_mfma_f32_16x16x32_bf16 a[240:243], a[16:19], a[76:79], a[240:243]
  s_add_u32 s70, s70, s74
  v_mfma_f32_16x16x32_bf16 a[240:243], a[48:51], a[92:95], a[240:243]
  v_mfma_f32_16x16x32_bf16 a[244:247], a[20:23], a[76:79], a[244:247]
  v_mfma_f32_16x16x32_bf16 a[244:247], a[52:55], a[92:95], a[244:247]
  v_mfma_f32_16x16x32_bf16 a[228:231], a[20:23], a[72:75], a[228:231]
  s_add_u32 m0, s79, 18432
  v_mfma_f32_16x16x32_bf16 a[228:231], a[52:55], a[88:91], a[228:231]
  buffer_load_dwordx4 v1, s[44:47], s69 offen lds
  v_mfma_f32_16x16x32_bf16 a[212:215], a[20:23], a[68:71], a[212:215]
  s_add_u32 s69, s69, s71
  v_mfma_f32_16x16x32_bf16 a[212:215], a[52:55], a[84:87], a[212:215]
  v_mfma_f32_16x16x32_bf16 a[196:199], a[20:23], a[64:67], a[196:199]
  s_add_u32 m0, s80, 19008
  v_mfma_f32_16x16x32_bf16 a[196:199], a[52:55], a[80:83], a[196:199]
  buffer_load_dwordx4 v3, s[48:51], s70 offen lds
  v_mfma_f32_16x16x32_bf16 a[200:203], a[24:27], a[64:67], a[200:203]
  v_mfma_f32_16x16x32_bf16 a[200:203], a[56:59], a[80:83], a[200:203]
  v_mfma_f32_16x16x32_bf16 a[216:219], a[24:27], a[68:71], a[216:219]
  v_mfma_f32_16x16x32_bf16 a[216:219], a[56:59], a[84:87], a[216:219]
  v_mfma_f32_16x16x32_bf16 a[232:235], a[24:27], a[72:75], a[232:235]
  s_add_u32 m0, s80, 23232
  v_mfma_f32_16x16x32_bf16 a[232:235], a[56:59], a[88:91], a[232:235]
  buffer_load_dwordx4 v3, s[52:55], s70 offen lds
  v_mfma_f32_16x16x32_bf16 a[248:251], a[24:27], a[76:79], a[248:251]
  s_add_u32 s70, s70, s74
  v_mfma_f32_16x16x32_bf16 a[248:251], a[56:59], a[92:95], a[248:251]
  v_mfma_f32_16x16x32_bf16 a[252:255], a[28:31], a[76:79], a[252:255]
  v_mfma_f32_16x16x32_bf16 a[252:255], a[60:63], a[92:95], a[252:255]
  v_mfma_f32_16x16x32_bf16 a[236:239], a[28:31], a[72:75], a[236:239]
  s_add_u32 m0, s79, 19456
  v_mfma_f32_16x16x32_bf16 a[236:239], a[60:63], a[88:91], a[236:239]
  buffer_load_dwordx4 v2, s[44:47], s69 offen lds
  v_mfma_f32_16x16x32_bf16 a[220:223], a[28:31], a[68:71], a[220:223]
  s_add_u32 s69, s69, s72
  v_mfma_f32_16x16x32_bf16 a[220:223], a[60:63], a[84:87], a[220:223]
  v_mfma_f32_16x16x32_bf16 a[204:207], a[28:31], a[64:67], a[204:207]
  v_mfma_f32_16x16x32_bf16 a[204:207], a[60:63], a[80:83], a[204:207]
  s_waitcnt vmcnt(14) lgkmcnt(0)
  s_barrier
  v_mfma_f32_16x16x32_bf16 v[192:195], a[0:3], a[96:99], v[192:195]
  s_add_u32 m0, s80, 20064
  v_mfma_f32_16x16x32_bf16 v[192:195], a[32:35], a[112:115], v[192:195]
  buffer_load_dwordx4 v3, s[48:51], s70 offen lds
  v_mfma_f32_16x16x32_bf16 v[208:211], a[0:3], a[100:103], v[208:211]
  ds_read_b128 a[64:67], v7 offset:0
  v_mfma_f32_16x16x32_bf16 v[208:211], a[32:35], a[116:119], v[208:211]
  ds_read_b128 a[68:71], v7 offset:2048
  v_accvgpr_read_b32 v120, a184
  v_mfma_f32_16x16x32_bf16 v[224:227], a[0:3], a[104:107], v[224:227]
  s_add_u32 m0, s80, 24288
  v_accvgpr_read_b32 v121, a185
  v_mfma_f32_16x16x32_bf16 v[224:227], a[32:35], a[120:123], v[224:227]
  buffer_load_dwordx4 v3, s[52:55], s70 offen lds
  v_accvgpr_read_b32 v122, a186
  v_mfma_f32_16x16x32_bf16 v[240:243], a[0:3], a[108:111], v[240:243]
  s_add_u32 s70, s70, s75
  v_accvgpr_read_b32 v123, a187
  v_mfma_f32_16x16x32_bf16 v[240:243], a[32:35], a[124:127], v[240:243]
  ds_read_b128 a[72:75], v7 offset:4096
  v_accvgpr_read_b32 v124, a188
  v_mfma_f32_16x16x32_bf16 v[244:247], a[4:7], a[108:111], v[244:247]
  v_accvgpr_read_b32 v125, a189
  v_accvgpr_read_b32 v126, a190
  v_mfma_f32_16x16x32_bf16 v[244:247], a[36:39], a[124:127], v[244:247]
  v_accvgpr_read_b32 v127, a191
  v_accvgpr_read_b32 v64, a192
  v_mfma_f32_16x16x32_bf16 v[228:231], a[4:7], a[104:107], v[228:231]
  s_add_u32 m0, s79, 49152
  v_accvgpr_read_b32 v65, a193
  v_mfma_f32_16x16x32_bf16 v[228:231], a[36:39], a[120:123], v[228:231]
  buffer_load_dwordx4 v1, s[44:47], s69 offen lds
  v_accvgpr_read_b32 v66, a194
  v_mfma_f32_16x16x32_bf16 v[212:215], a[4:7], a[100:103], v[212:215]
  s_add_u32 s69, s69, s71
  v_accvgpr_read_b32 v67, a195
  v_mfma_f32_16x16x32_bf16 v[212:215], a[36:39], a[116:119], v[212:215]
  ds_read_b128 a[76:79], v7 offset:6144
  v_accvgpr_read_b32 v68, a196
  v_mfma_f32_16x16x32_bf16 v[196:199], a[4:7], a[96:99], v[196:199]
  v_accvgpr_read_b32 v69, a197
  v_accvgpr_read_b32 v70, a198
  v_mfma_f32_16x16x32_bf16 v[196:199], a[36:39], a[112:115], v[196:199]
  v_accvgpr_read_b32 v71, a199
  v_accvgpr_read_b32 v72, a200
  v_mfma_f32_16x16x32_bf16 v[200:203], a[8:11], a[96:99], v[200:203]
  s_add_u32 m0, s79, 50176
  v_accvgpr_read_b32 v73, a201
  v_mfma_f32_16x16x32_bf16 v[200:203], a[40:43], a[112:115], v[200:203]
  buffer_load_dwordx4 v2, s[44:47], s69 offen lds
  v_accvgpr_read_b32 v74, a202
  v_mfma_f32_16x16x32_bf16 v[216:219], a[8:11], a[100:103], v[216:219]
  s_add_u32 s69, s69, s71
  v_accvgpr_read_b32 v75, a203
  v_mfma_f32_16x16x32_bf16 v[216:219], a[40:43], a[116:119], v[216:219]
  ds_read_b128 a[80:83], v8 offset:0
  v_accvgpr_read_b32 v76, a204
  v_mfma_f32_16x16x32_bf16 v[232:235], a[8:11], a[104:107], v[232:235]
  v_accvgpr_read_b32 v77, a205
  v_accvgpr_read_b32 v78, a206
  v_mfma_f32_16x16x32_bf16 v[232:235], a[40:43], a[120:123], v[232:235]
  v_accvgpr_read_b32 v79, a207
  v_accvgpr_read_b32 v80, a208
  v_mfma_f32_16x16x32_bf16 v[248:251], a[8:11], a[108:111], v[248:251]
  s_add_u32 m0, s79, 51200
  v_accvgpr_read_b32 v81, a209
  v_mfma_f32_16x16x32_bf16 v[248:251], a[40:43], a[124:127], v[248:251]
  buffer_load_dwordx4 v1, s[44:47], s69 offen lds
  v_accvgpr_read_b32 v82, a210
  v_mfma_f32_16x16x32_bf16 v[252:255], a[12:15], a[108:111], v[252:255]
  s_add_u32 s69, s69, s71
  v_accvgpr_read_b32 v83, a211
  v_mfma_f32_16x16x32_bf16 v[252:255], a[44:47], a[124:127], v[252:255]
  v_accvgpr_read_b32 v84, a212
  v_accvgpr_read_b32 v85, a213
  v_mfma_f32_16x16x32_bf16 v[236:239], a[12:15], a[104:107], v[236:239]
  s_add_u32 m0, s79, 52224
  v_accvgpr_read_b32 v86, a214
  v_mfma_f32_16x16x32_bf16 v[236:239], a[44:47], a[120:123], v[236:239]
  buffer_load_dwordx4 v2, s[44:47], s69 offen lds
  v_accvgpr_read_b32 v87, a215
  v_mfma_f32_16x16x32_bf16 v[220:223], a[12:15], a[100:103], v[220:223]
  s_add_u32 s69, s69, s73
  v_accvgpr_read_b32 v88, a216
  v_mfma_f32_16x16x32_bf16 v[220:223], a[44:47], a[116:119], v[220:223]
  s_add_u32 s65, s64, 24576
  buffer_load_dword v5, v4, s[60:63], s65 offen
  v_mfma_f32_16x16x32_bf16 v[204:207], a[12:15], a[96:99], v[204:207]
  ds_read_b128 a[84:87], v8 offset:2048
  v_accvgpr_read_b32 v89, a217
  v_mfma_f32_16x16x32_bf16 v[204:207], a[44:47], a[112:115], v[204:207]
  v_accvgpr_read_b32 v90, a218
  v_accvgpr_read_b32 v91, a219
  v_mfma_f32_16x16x32_bf16 v[128:131], a[16:19], a[96:99], v[128:131]
  v_accvgpr_read_b32 v92, a220
  v_accvgpr_read_b32 v93, a221
  v_mfma_f32_16x16x32_bf16 v[128:131], a[48:51], a[112:115], v[128:131]
  v_accvgpr_read_b32 v94, a222
  v_accvgpr_read_b32 v95, a223
  v_mfma_f32_16x16x32_bf16 v[144:147], a[16:19], a[100:103], v[144:147]
  ds_read_b128 a[88:91], v8 offset:4096
  v_accvgpr_read_b32 v96, a224
  v_mfma_f32_16x16x32_bf16 v[144:147], a[48:51], a[116:119], v[144:147]
  v_accvgpr_read_b32 v97, a225
  v_accvgpr_read_b32 v98, a226
  v_mfma_f32_16x16x32_bf16 v[160:163], a[16:19], a[104:107], v[160:163]
  v_accvgpr_read_b32 v99, a227
  v_accvgpr_read_b32 v100, a228
  v_mfma_f32_16x16x32_bf16 v[160:163], a[48:51], a[120:123], v[160:163]
  v_accvgpr_read_b32 v101, a229
  v_accvgpr_read_b32 v102, a230
  v_mfma_f32_16x16x32_bf16 v[176:179], a[16:19], a[108:111], v[176:179]
  v_accvgpr_read_b32 v103, a231
  v_accvgpr_read_b32 v104, a232
  v_mfma_f32_16x16x32_bf16 v[176:179], a[48:51], a[124:127], v[176:179]
  ds_read_b64_tr_b16 a[16:17], v9 offset:0
  v_accvgpr_read_b32 v105, a233
  v_mfma_f32_16x16x32_bf16 v[180:183], a[20:23], a[108:111], v[180:183]
  v_accvgpr_read_b32 v106, a234
  v_accvgpr_read_b32 v107, a235
  v_mfma_f32_16x16x32_bf16 v[180:183], a[52:55], a[124:127], v[180:183]
  ds_read_b64_tr_b16 a[18:19], v9 offset:256
  v_accvgpr_read_b32 v108, a236
  v_mfma_f32_16x16x32_bf16 v[164:167], a[20:23], a[104:107], v[164:167]
  ds_read_b128 a[92:95], v8 offset:6144
  v_accvgpr_read_b32 v109, a237
  v_mfma_f32_16x16x32_bf16 v[164:167], a[52:55], a[120:123], v[164:167]
  ds_read_b64_tr_b16 a[48:49], v9 offset:8448
  v_accvgpr_read_b32 v110, a238
  v_mfma_f32_16x16x32_bf16 v[148:151], a[20:23], a[100:103], v[148:151]
  v_accvgpr_read_b32 v111, a239
  v_mfma_f32_16x16x32_bf16 v[148:151], a[52:55], a[116:119], v[148:151]
  ds_read_b64_tr_b16 a[50:51], v9 offset:8704
  v_mfma_f32_16x16x32_bf16 v[132:135], a[20:23], a[96:99], v[132:135]
  v_mfma_f32_16x16x32_bf16 v[132:135], a[52:55], a[112:115], v[132:135]
  ds_read_b64_tr_b16 a[20:21], v9 offset:32
  v_mfma_f32_16x16x32_bf16 v[136:139], a[24:27], a[96:99], v[136:139]
  v_mfma_f32_16x16x32_bf16 v[136:139], a[56:59], a[112:115], v[136:139]
  ds_read_b64_tr_b16 a[22:23], v9 offset:288
  v_mfma_f32_16x16x32_bf16 v[152:155], a[24:27], a[100:103], v[152:155]
  v_mfma_f32_16x16x32_bf16 v[152:155], a[56:59], a[116:119], v[152:155]
  ds_read_b64_tr_b16 a[52:53], v9 offset:8480
  v_mfma_f32_16x16x32_bf16 v[168:171], a[24:27], a[104:107], v[168:171]
  v_mfma_f32_16x16x32_bf16 v[168:171], a[56:59], a[120:123], v[168:171]
  ds_read_b64_tr_b16 a[54:55], v9 offset:8736
  v_mfma_f32_16x16x32_bf16 v[184:187], a[24:27], a[108:111], v[184:187]
  v_mfma_f32_16x16x32_bf16 v[184:187], a[56:59], a[124:127], v[184:187]
  ds_read_b64_tr_b16 a[24:25], v9 offset:4224
  v_mfma_f32_16x16x32_bf16 v[188:191], a[28:31], a[108:111], v[188:191]
  ds_read_b64_tr_b16 a[26:27], v9 offset:4480
  v_mfma_f32_16x16x32_bf16 v[172:175], a[28:31], a[104:107], v[172:175]
  ds_read_b64_tr_b16 a[56:57], v9 offset:12672
  v_mfma_f32_16x16x32_bf16 v[156:159], a[28:31], a[100:103], v[156:159]
  ds_read_b64_tr_b16 a[58:59], v9 offset:12928
  v_mfma_f32_16x16x32_bf16 v[140:143], a[28:31], a[96:99], v[140:143]
  v_mfma_f32_16x16x32_bf16 v[140:143], a[60:63], a[112:115], v[140:143]
  ds_read_b64_tr_b16 a[28:29], v9 offset:4256
  v_mfma_f32_16x16x32_bf16 v[156:159], a[60:63], a[116:119], v[156:159]
  ds_read_b64_tr_b16 a[30:31], v9 offset:4512
  v_mfma_f32_16x16x32_bf16 v[172:175], a[60:63], a[120:123], v[172:175]
  v_mfma_f32_16x16x32_bf16 v[188:191], a[60:63], a[124:127], v[188:191]
  ds_read_b64_tr_b16 a[60:61], v9 offset:12704
  ds_read_b64_tr_b16 a[62:63], v9 offset:12960
  s_waitcnt lgkmcnt(15)
  v_mfma_f32_16x16x32_bf16 v[64:67], a[16:19], a[64:67], v[64:67]
  s_waitcnt lgkmcnt(10)
  v_mfma_f32_16x16x32_bf16 v[68:71], a[20:23], a[64:67], v[68:71]
  v_add_u32 v11, 4096, v10
  s_lshl_b32 s78, s42, 19
  v_mfma_f32_16x16x32_bf16 v[80:83], a[16:19], a[68:71], v[80:83]
  s_lshl_b32 s39, s43, 2
  s_add_u32 s79, s39, s36
  s_sub_u32 s39, 60, s39
  v_mfma_f32_16x16x32_bf16 v[84:87], a[20:23], a[68:71], v[84:87]
  s_add_u32 s80, s39, s36
  s_lshl_b32 s41, s38, 13
  v_mfma_f32_16x16x32_bf16 v[96:99], a[16:19], a[72:75], v[96:99]
  s_add_u32 s82, s78, s41
  s_add_u32 s40, s43, 1
  s_lshl_b32 s73, s40, 15
  v_mfma_f32_16x16x32_bf16 v[100:103], a[20:23], a[72:75], v[100:103]
  s_cmp_lt_u32 s36, 2
  s_cselect_b32 s39, 0, 16777216
  v_mfma_f32_16x16x32_bf16 a[240:243], a[16:19], a[76:79], a[240:243]
  s_cselect_b32 s40, 1, -1
  s_lshl_b32 s40, s40, 14
  s_add_u32 s74, s39, s82
  v_mfma_f32_16x16x32_bf16 a[244:247], a[20:23], a[76:79], a[244:247]
  s_add_u32 s72, s74, s40
  s_max_u32 s40, s73, 229376
  s_waitcnt lgkmcnt(6)
  v_mfma_f32_16x16x32_bf16 a[248:251], a[24:27], a[76:79], a[248:251]
  s_add_u32 s49, s74, s73
  s_add_u32 s72, s72, s40
  s_add_u32 s82, s82, s40
  s_waitcnt lgkmcnt(2)
  v_mfma_f32_16x16x32_bf16 a[252:255], a[28:31], a[76:79], a[252:255]
  s_sub_u32 s73, 557056, s73
  s_add_u32 s84, s74, 16384
  v_mfma_f32_16x16x32_bf16 v[104:107], a[24:27], a[72:75], v[104:107]
  s_add_u32 s73, s74, s73
  s_cmp_lt_u32 s36, 2
  s_cselect_b32 s82, s72, s82
  v_mfma_f32_16x16x32_bf16 v[108:111], a[28:31], a[72:75], v[108:111]
  s_cselect_b32 s84, s84, -1
  s_sub_u32 s48, s73, 32768
  v_mfma_f32_16x16x32_bf16 v[88:91], a[24:27], a[68:71], v[88:91]
  s_add_u32 s50, s74, 229376
  s_mov_b32 s51, s48
  s_mov_b32 s52, s73
  v_mfma_f32_16x16x32_bf16 v[92:95], a[28:31], a[68:71], v[92:95]
  s_mov_b32 s53, s74
  s_mov_b32 s54, s84
  v_mfma_f32_16x16x32_bf16 v[72:75], a[24:27], a[64:67], v[72:75]
  s_mov_b32 s55, s74
  s_cmp_ge_u32 s43, 6
  s_cselect_b64 s[48:49], s[52:53], s[48:49]
  v_mfma_f32_16x16x32_bf16 v[76:79], a[28:31], a[64:67], v[76:79]
  s_cselect_b64 s[50:51], s[54:55], s[50:51]
  s_cselect_b32 s52, -1, s52
  v_mfma_f32_16x16x32_bf16 v[64:67], a[48:51], a[80:83], v[64:67]
  s_cselect_b32 s54, -1, s54
  s_lshl_b32 s75, s36, 13
  v_add_u32 v1, s41, v10
  v_mfma_f32_16x16x32_bf16 v[68:71], a[52:55], a[80:83], v[68:71]
  v_subrev_u32 v2, s75, v1
  v_and_b32 v12, 15, v0
  v_mfma_f32_16x16x32_bf16 v[80:83], a[48:51], a[84:87], v[80:83]
  v_lshlrev_b32 v12, 2, v12
  v_lshlrev_b32 v13, 2, v0
  s_lshl_b32 s62, s79, 1
  s_waitcnt vmcnt(5)
  s_barrier
  v_mfma_f32_16x16x32_bf16 v[84:87], a[52:55], a[84:87], v[84:87]
  ds_read_b128 a[96:99], v7 offset:16384
  ds_read_b128 a[104:107], v7 offset:20480
  v_mfma_f32_16x16x32_bf16 v[96:99], a[48:51], a[88:91], v[96:99]
  ds_read_b64_tr_b16 a[0:1], v9 offset:16896
  ds_read_b64_tr_b16 a[2:3], v9 offset:17152
  s_sub_u32 s62, s62, s36
  v_mfma_f32_16x16x32_bf16 v[100:103], a[52:55], a[88:91], v[100:103]
  ds_read_b128 a[100:103], v7 offset:18432
  ds_read_b128 a[108:111], v7 offset:22528
  v_mfma_f32_16x16x32_bf16 a[240:243], a[48:51], a[92:95], a[240:243]
  ds_read_b64_tr_b16 a[4:5], v9 offset:16928
  ds_read_b64_tr_b16 a[6:7], v9 offset:17184
  s_mul_i32 s68, s62, 186368
  v_mfma_f32_16x16x32_bf16 a[244:247], a[52:55], a[92:95], a[244:247]
  ds_read_b64_tr_b16 a[8:9], v9 offset:21120
  ds_read_b64_tr_b16 a[10:11], v9 offset:21376
  v_mfma_f32_16x16x32_bf16 a[248:251], a[56:59], a[92:95], a[248:251]
  ds_read_b64_tr_b16 a[12:13], v9 offset:21152
  ds_read_b64_tr_b16 a[14:15], v9 offset:21408
  s_lshl_b32 s39, s42, 12
  s_waitcnt lgkmcnt(12)
  v_mfma_f32_16x16x32_bf16 a[252:255], a[60:63], a[92:95], a[252:255]
  ds_read_b128 a[112:115], v8 offset:16384
  ds_read_b128 a[120:123], v8 offset:20480
  v_mfma_f32_16x16x32_bf16 v[104:107], a[56:59], a[88:91], v[104:107]
  ds_read_b64_tr_b16 a[32:33], v9 offset:25344
  ds_read_b64_tr_b16 a[34:35], v9 offset:25600
  s_add_u32 s39, s39, 50331648
  v_mfma_f32_16x16x32_bf16 v[108:111], a[60:63], a[88:91], v[108:111]
  ds_read_b128 a[116:119], v8 offset:18432
  ds_read_b128 a[124:127], v8 offset:22528
  v_mfma_f32_16x16x32_bf16 v[88:91], a[56:59], a[84:87], v[88:91]
  ds_read_b64_tr_b16 a[36:37], v9 offset:25376
  ds_read_b64_tr_b16 a[38:39], v9 offset:25632
  s_add_u32 s68, s68, s39
  v_mfma_f32_16x16x32_bf16 v[92:95], a[60:63], a[84:87], v[92:95]
  ds_read_b64_tr_b16 a[40:41], v9 offset:29568
  ds_read_b64_tr_b16 a[42:43], v9 offset:29824
  v_mfma_f32_16x16x32_bf16 v[72:75], a[56:59], a[80:83], v[72:75]
  ds_read_b64_tr_b16 a[44:45], v9 offset:29600
  ds_read_b64_tr_b16 a[46:47], v9 offset:29856
  s_add_u32 s69, s68, 745472
  v_mfma_f32_16x16x32_bf16 v[76:79], a[60:63], a[80:83], v[76:79]
  ds_read_b128 a[64:67], v7 offset:32768
  s_lshl_b32 s63, s80, 1
  s_waitcnt lgkmcnt(15)
  v_mfma_f32_16x16x32_bf16 v[64:67], a[0:3], a[96:99], v[64:67]
  ds_read_b128 a[68:71], v7 offset:34816
  s_sub_u32 s63, s63, s36
  s_mul_i32 s70, s63, 186368
  v_mfma_f32_16x16x32_bf16 v[68:71], a[4:7], a[96:99], v[68:71]
  ds_read_b128 a[72:75], v7 offset:36864
  s_lshl_b32 s39, s42, 12
  v_mfma_f32_16x16x32_bf16 v[80:83], a[0:3], a[100:103], v[80:83]
  ds_read_b128 a[76:79], v7 offset:38912
  s_add_u32 s39, s39, 50331648
  s_add_u32 s70, s70, s39
  v_mfma_f32_16x16x32_bf16 v[84:87], a[4:7], a[100:103], v[84:87]
  ds_read_b128 a[80:83], v8 offset:32768
  s_add_u32 s71, s70, 745472
  v_mfma_f32_16x16x32_bf16 v[96:99], a[0:3], a[104:107], v[96:99]
  ds_read_b128 a[84:87], v8 offset:34816
  s_lshl_b32 s39, s37, 14
  s_lshl_b32 s40, s38, 10
  v_mfma_f32_16x16x32_bf16 v[100:103], a[4:7], a[104:107], v[100:103]
  ds_read_b128 a[88:91], v8 offset:36864
  s_add_u32 s39, s39, s40
  v_mfma_f32_16x16x32_bf16 a[240:243], a[0:3], a[108:111], a[240:243]
  ds_read_b128 a[92:95], v8 offset:38912
  s_add_u32 s39, s39, 98304
  v_add_u32 v14, s39, v10
  v_mfma_f32_16x16x32_bf16 a[244:247], a[4:7], a[108:111], a[244:247]
  s_lshl_b32 s39, s36, 12
  s_add_u32 s39, s39, 98304
  v_mfma_f32_16x16x32_bf16 a[248:251], a[8:11], a[108:111], a[248:251]
  v_add_u32 v15, s39, v10
  v_mov_b32 v3, 0x3f803f80
  v_accvgpr_write_b32 a192, v3
  s_waitcnt lgkmcnt(15)
  v_mfma_f32_16x16x32_bf16 a[252:255], a[12:15], a[108:111], a[252:255]
  v_accvgpr_write_b32 a193, v3
  v_accvgpr_write_b32 a194, v3
  v_mfma_f32_16x16x32_bf16 v[104:107], a[8:11], a[104:107], v[104:107]
  v_accvgpr_write_b32 a195, v3
  s_lshl_b32 s77, s36, 4
  s_lshl_b32 s39, s38, 5
  v_mfma_f32_16x16x32_bf16 v[108:111], a[12:15], a[104:107], v[108:111]
  s_sub_u32 s77, s77, s39
  s_cmp_eq_u32 s43, 7
  v_mfma_f32_16x16x32_bf16 v[88:91], a[8:11], a[100:103], v[88:91]
  s_cselect_b32 s61, -1, 0
  s_lshl_b32 s86, s79, 5
  s_add_u32 s86, s86, s42
  v_mfma_f32_16x16x32_bf16 v[92:95], a[12:15], a[100:103], v[92:95]
  s_lshl_b32 s86, s86, 2
  s_add_u32 s86, s86, 84938752
  v_mfma_f32_16x16x32_bf16 v[72:75], a[8:11], a[96:99], v[72:75]
  s_lshl_b32 s87, s80, 5
  s_add_u32 s87, s87, s42
  s_lshl_b32 s87, s87, 2
  v_mfma_f32_16x16x32_bf16 v[76:79], a[12:15], a[96:99], v[76:79]
  s_add_u32 s87, s87, 84938752
  s_cmp_eq_u32 s37, 0
  v_mfma_f32_16x16x32_bf16 v[64:67], a[32:35], a[112:115], v[64:67]
  s_cselect_b32 s1, s79, s80
  s_lshr_b32 s1, s1, 2
  s_lshl_b32 s1, s1, 5
  s_waitcnt vmcnt(1) lgkmcnt(0)
  s_barrier
  v_mfma_f32_16x16x32_bf16 v[68:71], a[36:39], a[112:115], v[68:71]
  ds_read_b128 a[96:99], v7 offset:49152
  s_add_u32 s1, s1, s42
  v_mfma_f32_16x16x32_bf16 v[80:83], a[32:35], a[116:119], v[80:83]
  ds_read_b128 a[100:103], v7 offset:51200
  s_lshl_b32 s1, s1, 1
  s_add_u32 s1, s1, s38
  v_mfma_f32_16x16x32_bf16 v[84:87], a[36:39], a[116:119], v[84:87]
  ds_read_b128 a[104:107], v7 offset:53248
  s_lshl_b32 s1, s1, 2
  v_mfma_f32_16x16x32_bf16 v[96:99], a[32:35], a[120:123], v[96:99]
  ds_read_b128 a[108:111], v7 offset:55296
  s_add_u32 s1, s1, 84934656
  s_lshl_b32 s41, s36, 12
  v_mfma_f32_16x16x32_bf16 v[100:103], a[36:39], a[120:123], v[100:103]
  s_mov_b32 s40, s28
  s_mov_b32 s28, 0x66666666
  v_mfma_f32_16x16x32_bf16 a[240:243], a[32:35], a[124:127], a[240:243]
  s_mov_b64 s[56:57], 0
  s_cmp_eq_u32 s40, 0
  s_cselect_b32 s28, 0x55433000, s28
  v_mfma_f32_16x16x32_bf16 a[244:247], a[36:39], a[124:127], a[244:247]
  s_cselect_b32 s56, 0xa9a0a0a0, s56
  s_cselect_b32 s57, 0xb1b1b1a9, s57
  v_mfma_f32_16x16x32_bf16 a[248:251], a[40:43], a[124:127], a[248:251]
  s_cmp_eq_u32 s40, 1
  s_cselect_b32 s28, 0x22544111, s28
  s_cselect_b32 s56, 0xa8a0a0a0, s56
  v_mfma_f32_16x16x32_bf16 a[252:255], a[44:47], a[124:127], a[252:255]
  s_cselect_b32 s57, 0xb1b1b1a8, s57
  s_cmp_eq_u32 s40, 2
  v_mfma_f32_16x16x32_bf16 v[104:107], a[40:43], a[120:123], v[104:107]
  s_cselect_b32 s28, 0x44155222, s28
  s_cselect_b32 s56, 0x88808080, s56
  s_cselect_b32 s57, 0x92928a88, s57
  v_mfma_f32_16x16x32_bf16 v[108:111], a[44:47], a[120:123], v[108:111]
  s_cmp_eq_u32 s40, 3
  s_cselect_b32 s28, 0x11000333, s28
  v_mfma_f32_16x16x32_bf16 v[88:91], a[40:43], a[116:119], v[88:91]
  s_cselect_b32 s56, 0x8a808080, s56
  s_cselect_b32 s57, 0x92928a8a, s57
  s_cmp_eq_u32 s40, 4
  v_mfma_f32_16x16x32_bf16 v[92:95], a[44:47], a[116:119], v[92:95]
  s_cselect_b32 s28, 0x33311544, s28
  s_cselect_b32 s56, 0x6a696060, s56
  v_mfma_f32_16x16x32_bf16 v[72:75], a[40:43], a[112:115], v[72:75]
  s_cselect_b32 s57, 0x7373736a, s57
  s_cmp_eq_u32 s40, 5
  s_cselect_b32 s28, 0x222455, s28
  v_mfma_f32_16x16x32_bf16 v[76:79], a[44:47], a[112:115], v[76:79]
  s_cselect_b32 s56, 0x69696060, s56
  s_cselect_b32 s57, 0x73737369, s57
  v_mfma_f32_16x16x32_bf16 v[128:131], a[16:19], a[64:67], v[128:131]
  ds_read_b128 a[112:115], v8 offset:49152
  v_mfma_f32_16x16x32_bf16 v[132:135], a[20:23], a[64:67], v[132:135]
  ds_read_b128 a[116:119], v8 offset:51200
  v_mfma_f32_16x16x32_bf16 v[144:147], a[16:19], a[68:71], v[144:147]
  ds_read_b128 a[120:123], v8 offset:53248
  v_mfma_f32_16x16x32_bf16 v[148:151], a[20:23], a[68:71], v[148:151]
  ds_read_b128 a[124:127], v8 offset:55296
  v_mul_f32 v72, v64, v72
  v_mul_f32 v73, v65, v73
  v_mul_f32 v74, v66, v74
  v_mfma_f32_16x16x32_bf16 v[160:163], a[16:19], a[72:75], v[160:163]
  v_mul_f32 v75, v67, v75
  v_mul_f32 v76, v68, v76
  v_mul_f32 v77, v69, v77
  v_mul_f32 v78, v70, v78
  v_mfma_f32_16x16x32_bf16 v[164:167], a[20:23], a[72:75], v[164:167]
  v_mul_f32 v79, v71, v79
  v_mul_f32 v64, s5, v64
  v_mul_f32 v65, s5, v65
  v_mul_f32 v66, s5, v66
  v_mfma_f32_16x16x32_bf16 v[176:179], a[16:19], a[76:79], v[176:179]
  ds_read_b64_tr_b16 a[16:17], v9 offset:33792
  v_mul_f32 v67, s5, v67
  v_mul_f32 v68, s5, v68
  v_mul_f32 v69, s5, v69
  v_mfma_f32_16x16x32_bf16 v[180:183], a[20:23], a[76:79], v[180:183]
  ds_read_b64_tr_b16 a[18:19], v9 offset:34048
  v_mul_f32 v70, s5, v70
  v_mul_f32 v71, s5, v71
  v_exp_f32 v64, v64
  v_mfma_f32_16x16x32_bf16 v[184:187], a[24:27], a[76:79], v[184:187]
  ds_read_b64_tr_b16 a[20:21], v9 offset:33824
  v_exp_f32 v65, v65
  v_exp_f32 v66, v66
  v_mfma_f32_16x16x32_bf16 v[188:191], a[28:31], a[76:79], v[188:191]
  ds_read_b64_tr_b16 a[22:23], v9 offset:34080
  v_exp_f32 v67, v67
  v_exp_f32 v68, v68
  v_mfma_f32_16x16x32_bf16 v[168:171], a[24:27], a[72:75], v[168:171]
  v_exp_f32 v69, v69
  v_exp_f32 v70, v70
  v_mfma_f32_16x16x32_bf16 v[172:175], a[28:31], a[72:75], v[172:175]
  v_exp_f32 v71, v71
  v_add_f32 v64, 1.0, v64
  v_add_f32 v65, 1.0, v65
  v_mfma_f32_16x16x32_bf16 v[152:155], a[24:27], a[68:71], v[152:155]
  v_add_f32 v66, 1.0, v66
  v_add_f32 v67, 1.0, v67
  v_add_f32 v68, 1.0, v68
  v_add_f32 v69, 1.0, v69
  v_mfma_f32_16x16x32_bf16 v[156:159], a[28:31], a[68:71], v[156:159]
  v_add_f32 v70, 1.0, v70
  v_add_f32 v71, 1.0, v71
  v_rcp_f32 v64, v64
  v_mfma_f32_16x16x32_bf16 v[136:139], a[24:27], a[64:67], v[136:139]
  ds_read_b64_tr_b16 a[24:25], v9 offset:38016
  v_rcp_f32 v65, v65
  v_rcp_f32 v66, v66
  v_mfma_f32_16x16x32_bf16 v[140:143], a[28:31], a[64:67], v[140:143]
  ds_read_b64_tr_b16 a[26:27], v9 offset:38272
  v_rcp_f32 v67, v67
  v_rcp_f32 v68, v68
  v_mfma_f32_16x16x32_bf16 v[128:131], a[48:51], a[80:83], v[128:131]
  ds_read_b64_tr_b16 a[28:29], v9 offset:38048
  v_rcp_f32 v69, v69
  v_rcp_f32 v70, v70
  v_mfma_f32_16x16x32_bf16 v[132:135], a[52:55], a[80:83], v[132:135]
  ds_read_b64_tr_b16 a[30:31], v9 offset:38304
  v_rcp_f32 v71, v71
  v_mul_f32 v72, v64, v72
  v_mfma_f32_16x16x32_bf16 v[144:147], a[48:51], a[84:87], v[144:147]
  v_mul_f32 v73, v65, v73
  v_mul_f32 v74, v66, v74
  v_mul_f32 v75, v67, v75
  v_mul_f32 v76, v68, v76
  v_mfma_f32_16x16x32_bf16 v[148:151], a[52:55], a[84:87], v[148:151]
  v_mul_f32 v77, v69, v77
  v_mul_f32 v78, v70, v78
  v_mul_f32 v79, v71, v79
  v_cvt_pk_bf16_f32 v72, v72, v73
  v_mfma_f32_16x16x32_bf16 v[160:163], a[48:51], a[88:91], v[160:163]
  v_cvt_pk_bf16_f32 v73, v74, v75
  v_cvt_pk_bf16_f32 v74, v76, v77
  v_cvt_pk_bf16_f32 v75, v78, v79
  s_add_u32 s85, s4, 0
  v_mfma_f32_16x16x32_bf16 v[164:167], a[52:55], a[88:91], v[164:167]
  buffer_store_dwordx4 v[72:75], v10, s[32:35], s85 offen sc1
  v_mul_f32 v88, v80, v88
  v_mul_f32 v89, v81, v89
  v_mfma_f32_16x16x32_bf16 v[176:179], a[48:51], a[92:95], v[176:179]
  ds_read_b64_tr_b16 a[48:49], v9 offset:42240
  v_mul_f32 v90, v82, v90
  v_mul_f32 v91, v83, v91
  v_mul_f32 v92, v84, v92
  v_mfma_f32_16x16x32_bf16 v[180:183], a[52:55], a[92:95], v[180:183]
  ds_read_b64_tr_b16 a[50:51], v9 offset:42496
  v_mul_f32 v93, v85, v93
  v_mul_f32 v94, v86, v94
  v_mul_f32 v95, v87, v95
  v_mfma_f32_16x16x32_bf16 v[184:187], a[56:59], a[92:95], v[184:187]
  ds_read_b64_tr_b16 a[52:53], v9 offset:42272
  v_mul_f32 v80, s5, v80
  v_mul_f32 v81, s5, v81
  v_mul_f32 v82, s5, v82
  v_mfma_f32_16x16x32_bf16 v[188:191], a[60:63], a[92:95], v[188:191]
  ds_read_b64_tr_b16 a[54:55], v9 offset:42528
  v_mul_f32 v83, s5, v83
  v_mul_f32 v84, s5, v84
  v_mul_f32 v85, s5, v85
  v_mfma_f32_16x16x32_bf16 v[168:171], a[56:59], a[88:91], v[168:171]
  v_mul_f32 v86, s5, v86
  v_mul_f32 v87, s5, v87
  v_exp_f32 v80, v80
  v_mfma_f32_16x16x32_bf16 v[172:175], a[60:63], a[88:91], v[172:175]
  v_exp_f32 v81, v81
  v_exp_f32 v82, v82
  v_mfma_f32_16x16x32_bf16 v[152:155], a[56:59], a[84:87], v[152:155]
  v_exp_f32 v83, v83
  v_exp_f32 v84, v84
  v_mfma_f32_16x16x32_bf16 v[156:159], a[60:63], a[84:87], v[156:159]
  v_exp_f32 v85, v85
  v_exp_f32 v86, v86
  v_mfma_f32_16x16x32_bf16 v[136:139], a[56:59], a[80:83], v[136:139]
  ds_read_b64_tr_b16 a[56:57], v9 offset:46464
  v_exp_f32 v87, v87
  v_add_f32 v80, 1.0, v80
  v_mfma_f32_16x16x32_bf16 v[140:143], a[60:63], a[80:83], v[140:143]
  ds_read_b64_tr_b16 a[58:59], v9 offset:46720
  v_add_f32 v81, 1.0, v81
  v_add_f32 v82, 1.0, v82
  v_add_f32 v83, 1.0, v83
  s_waitcnt lgkmcnt(15)
  v_mfma_f32_16x16x32_bf16 v[128:131], a[0:3], a[96:99], v[128:131]
  ds_read_b64_tr_b16 a[60:61], v9 offset:46496
  v_add_f32 v84, 1.0, v84
  v_add_f32 v85, 1.0, v85
  v_add_f32 v86, 1.0, v86
  v_mfma_f32_16x16x32_bf16 v[132:135], a[4:7], a[96:99], v[132:135]
  ds_read_b64_tr_b16 a[62:63], v9 offset:46752
  v_add_f32 v87, 1.0, v87
  v_rcp_f32 v80, v80
  v_mfma_f32_16x16x32_bf16 v[144:147], a[0:3], a[100:103], v[144:147]
  v_rcp_f32 v81, v81
  v_rcp_f32 v82, v82
  v_mfma_f32_16x16x32_bf16 v[148:151], a[4:7], a[100:103], v[148:151]
  v_rcp_f32 v83, v83
  v_rcp_f32 v84, v84
  v_mfma_f32_16x16x32_bf16 v[160:163], a[0:3], a[104:107], v[160:163]
  buffer_load_dword v4, v13, s[16:19], 0 offen sc1
  v_rcp_f32 v85, v85
  v_mfma_f32_16x16x32_bf16 v[164:167], a[4:7], a[104:107], v[164:167]
  v_rcp_f32 v86, v86
  v_rcp_f32 v87, v87
  v_mfma_f32_16x16x32_bf16 v[176:179], a[0:3], a[108:111], v[176:179]
  ds_read_b64_tr_b16 a[0:1], v9 offset:50688
  v_mul_f32 v88, v80, v88
  v_mul_f32 v89, v81, v89
  v_mul_f32 v90, v82, v90
  v_mfma_f32_16x16x32_bf16 v[180:183], a[4:7], a[108:111], v[180:183]
  ds_read_b64_tr_b16 a[2:3], v9 offset:50944
  v_mul_f32 v91, v83, v91
  v_mul_f32 v92, v84, v92
  v_mul_f32 v93, v85, v93
  v_mfma_f32_16x16x32_bf16 v[184:187], a[8:11], a[108:111], v[184:187]
  ds_read_b64_tr_b16 a[4:5], v9 offset:50720
  v_mul_f32 v94, v86, v94
  v_mul_f32 v95, v87, v95
  v_cvt_pk_bf16_f32 v88, v88, v89
  v_mfma_f32_16x16x32_bf16 v[188:191], a[12:15], a[108:111], v[188:191]
  ds_read_b64_tr_b16 a[6:7], v9 offset:50976
  v_cvt_pk_bf16_f32 v89, v90, v91
  v_cvt_pk_bf16_f32 v90, v92, v93
  v_cvt_pk_bf16_f32 v91, v94, v95
  v_mfma_f32_16x16x32_bf16 v[168:171], a[8:11], a[104:107], v[168:171]
  s_add_u32 s85, s4, 186368
  buffer_store_dwordx4 v[88:91], v10, s[32:35], s85 offen sc1
  v_mul_f32 v104, v96, v104
  v_mfma_f32_16x16x32_bf16 v[172:175], a[12:15], a[104:107], v[172:175]
  v_mul_f32 v105, v97, v105
  v_mul_f32 v106, v98, v106
  v_mul_f32 v107, v99, v107
  v_mul_f32 v108, v100, v108
  v_mul_f32 v109, v101, v109
  v_mfma_f32_16x16x32_bf16 v[152:155], a[8:11], a[100:103], v[152:155]
  v_mul_f32 v110, v102, v110
  v_mul_f32 v111, v103, v111
  v_mul_f32 v96, s5, v96
  v_mul_f32 v97, s5, v97
  v_mul_f32 v98, s5, v98
  v_mfma_f32_16x16x32_bf16 v[156:159], a[12:15], a[100:103], v[156:159]
  v_mul_f32 v99, s5, v99
  v_mul_f32 v100, s5, v100
  v_mul_f32 v101, s5, v101
  v_mul_f32 v102, s5, v102
  v_mul_f32 v103, s5, v103
  v_mfma_f32_16x16x32_bf16 v[136:139], a[8:11], a[96:99], v[136:139]
  ds_read_b64_tr_b16 a[8:9], v9 offset:54912
  v_exp_f32 v96, v96
  v_exp_f32 v97, v97
  v_mfma_f32_16x16x32_bf16 v[140:143], a[12:15], a[96:99], v[140:143]
  ds_read_b64_tr_b16 a[10:11], v9 offset:55168
  v_exp_f32 v98, v98
  v_exp_f32 v99, v99
  v_mfma_f32_16x16x32_bf16 v[128:131], a[32:35], a[112:115], v[128:131]
  ds_read_b64_tr_b16 a[12:13], v9 offset:54944
  v_exp_f32 v100, v100
  v_exp_f32 v101, v101
  v_mfma_f32_16x16x32_bf16 v[132:135], a[36:39], a[112:115], v[132:135]
  ds_read_b64_tr_b16 a[14:15], v9 offset:55200
  v_exp_f32 v102, v102
  v_exp_f32 v103, v103
  v_mfma_f32_16x16x32_bf16 v[144:147], a[32:35], a[116:119], v[144:147]
  v_add_f32 v96, 1.0, v96
  v_add_f32 v97, 1.0, v97
  v_add_f32 v98, 1.0, v98
  v_add_f32 v99, 1.0, v99
  v_add_f32 v100, 1.0, v100
  v_mfma_f32_16x16x32_bf16 v[148:151], a[36:39], a[116:119], v[148:151]
  v_add_f32 v101, 1.0, v101
  v_add_f32 v102, 1.0, v102
  v_add_f32 v103, 1.0, v103
  v_rcp_f32 v96, v96
  v_mfma_f32_16x16x32_bf16 v[160:163], a[32:35], a[120:123], v[160:163]
  v_rcp_f32 v97, v97
  v_rcp_f32 v98, v98
  v_mfma_f32_16x16x32_bf16 v[164:167], a[36:39], a[120:123], v[164:167]
  v_rcp_f32 v99, v99
  v_rcp_f32 v100, v100
  s_waitcnt lgkmcnt(15)
  v_mfma_f32_16x16x32_bf16 v[176:179], a[32:35], a[124:127], v[176:179]
  ds_read_b64_tr_b16 a[32:33], v9 offset:59136
  v_rcp_f32 v101, v101
  v_rcp_f32 v102, v102
  v_mfma_f32_16x16x32_bf16 v[180:183], a[36:39], a[124:127], v[180:183]
  ds_read_b64_tr_b16 a[34:35], v9 offset:59392
  v_rcp_f32 v103, v103
  v_mul_f32 v104, v96, v104
  v_mul_f32 v105, v97, v105
  v_mfma_f32_16x16x32_bf16 v[184:187], a[40:43], a[124:127], v[184:187]
  ds_read_b64_tr_b16 a[36:37], v9 offset:59168
  v_mul_f32 v106, v98, v106
  v_mul_f32 v107, v99, v107
  v_mul_f32 v108, v100, v108
  v_mul_f32 v109, v101, v109
  v_mfma_f32_16x16x32_bf16 v[188:191], a[44:47], a[124:127], v[188:191]
  ds_read_b64_tr_b16 a[38:39], v9 offset:59424
  v_mul_f32 v110, v102, v110
  v_mul_f32 v111, v103, v111
  v_cvt_pk_bf16_f32 v104, v104, v105
  v_cvt_pk_bf16_f32 v105, v106, v107
  v_mfma_f32_16x16x32_bf16 v[168:171], a[40:43], a[120:123], v[168:171]
  v_cvt_pk_bf16_f32 v106, v108, v109
  v_cvt_pk_bf16_f32 v107, v110, v111
  s_add_u32 s85, s4, 372736
  buffer_store_dwordx4 v[104:107], v10, s[32:35], s85 offen sc1
  v_mfma_f32_16x16x32_bf16 v[172:175], a[44:47], a[120:123], v[172:175]
  v_accvgpr_read_b32 v64, a240
  v_accvgpr_read_b32 v65, a241
  v_accvgpr_read_b32 v66, a242
  v_accvgpr_read_b32 v67, a243
  v_mfma_f32_16x16x32_bf16 v[152:155], a[40:43], a[116:119], v[152:155]
  v_accvgpr_read_b32 v68, a244
  v_accvgpr_read_b32 v69, a245
  v_accvgpr_read_b32 v70, a246
  v_accvgpr_read_b32 v71, a247
  v_accvgpr_read_b32 v72, a248
  s_waitcnt vmcnt(2)
L_f_chk:
  v_cmp_ne_u32 vcc, 4, v4
  s_cbranch_vccnz L_f_spin
L_f_go:
  v_mfma_f32_16x16x32_bf16 v[156:159], a[44:47], a[116:119], v[156:159]
  v_accvgpr_read_b32 v73, a249
  v_accvgpr_read_b32 v74, a250
  v_accvgpr_read_b32 v75, a251
  v_accvgpr_read_b32 v76, a252
  v_accvgpr_read_b32 v77, a253
  v_mfma_f32_16x16x32_bf16 v[136:139], a[40:43], a[112:115], v[136:139]
  ds_read_b64_tr_b16 a[40:41], v9 offset:63360
  s_add_u32 m0, s75, 0
  v_accvgpr_read_b32 v78, a254
  v_accvgpr_read_b32 v79, a255
  v_mul_f32 v72, v64, v72
  v_mfma_f32_16x16x32_bf16 v[140:143], a[44:47], a[112:115], v[140:143]
  ds_read_b64_tr_b16 a[42:43], v9 offset:63616
  buffer_load_dwordx4 v10, s[32:35], s82 offen offset:0 sc1 lds
  v_mul_f32 v73, v65, v73
  v_mul_f32 v74, v66, v74
  v_mfma_f32_16x16x32_bf16 v[192:195], a[16:19], a[64:67], v[192:195]
  ds_read_b64_tr_b16 a[44:45], v9 offset:63392
  s_lshl_b32 s39, s62, 6
  s_add_u32 s39, s39, 83886080
  v_mul_f32 v75, v67, v75
  v_mul_f32 v76, v68, v76
  v_mfma_f32_16x16x32_bf16 v[196:199], a[20:23], a[64:67], v[196:199]
  ds_read_b64_tr_b16 a[46:47], v9 offset:63648
  buffer_load_dword v3, v12, s[32:35], s39 offen offset:0 sc1
  v_mul_f32 v77, v69, v77
  v_mul_f32 v78, v70, v78
  v_mfma_f32_16x16x32_bf16 v[208:211], a[16:19], a[68:71], v[208:211]
  v_mul_f32 v79, v71, v79
  v_mul_f32 v64, s5, v64
  v_mul_f32 v65, s5, v65
  v_mul_f32 v66, s5, v66
  v_mul_f32 v67, s5, v67
  v_mfma_f32_16x16x32_bf16 v[212:215], a[20:23], a[68:71], v[212:215]
  buffer_load_dwordx4 v10, s[32:35], s82 offen offset:1024 sc1 lds
  v_mul_f32 v68, s5, v68
  v_mul_f32 v69, s5, v69
  v_mul_f32 v70, s5, v70
  v_mfma_f32_16x16x32_bf16 v[224:227], a[16:19], a[72:75], v[224:227]
  v_mul_f32 v71, s5, v71
  v_exp_f32 v64, v64
  v_exp_f32 v65, v65
  v_mfma_f32_16x16x32_bf16 v[228:231], a[20:23], a[72:75], v[228:231]
  buffer_load_dword v4, v12, s[32:35], s39 offen offset:256 sc1
  v_exp_f32 v66, v66
  v_mfma_f32_16x16x32_bf16 v[240:243], a[16:19], a[76:79], v[240:243]
  v_exp_f32 v67, v67
  v_exp_f32 v68, v68
  s_waitcnt lgkmcnt(0)
  s_barrier
  v_mfma_f32_16x16x32_bf16 v[244:247], a[20:23], a[76:79], v[244:247]
  buffer_load_dwordx4 v10, s[32:35], s82 offen offset:2048 sc1 lds
  v_exp_f32 v69, v69
  v_mfma_f32_16x16x32_bf16 v[248:251], a[24:27], a[76:79], v[248:251]
  s_lshl_b32 s39, s63, 6
  s_add_u32 s39, s39, 83886080
  v_exp_f32 v70, v70
  v_mfma_f32_16x16x32_bf16 v[252:255], a[28:31], a[76:79], v[252:255]
  buffer_load_dword v5, v12, s[32:35], s39 offen offset:0 sc1
  v_exp_f32 v71, v71
  v_mfma_f32_16x16x32_bf16 v[232:235], a[24:27], a[72:75], v[232:235]
  v_add_f32 v64, 1.0, v64
  v_add_f32 v65, 1.0, v65
  v_add_f32 v66, 1.0, v66
  v_add_f32 v67, 1.0, v67
  v_mfma_f32_16x16x32_bf16 v[236:239], a[28:31], a[72:75], v[236:239]
  buffer_load_dwordx4 v10, s[32:35], s82 offen offset:3072 sc1 lds
  v_add_f32 v68, 1.0, v68
  v_add_f32 v69, 1.0, v69
  v_add_f32 v70, 1.0, v70
  v_mfma_f32_16x16x32_bf16 v[216:219], a[24:27], a[68:71], v[216:219]
  v_add_f32 v71, 1.0, v71
  v_rcp_f32 v64, v64
  v_rcp_f32 v65, v65
  v_mfma_f32_16x16x32_bf16 v[220:223], a[28:31], a[68:71], v[220:223]
  buffer_load_dword v6, v12, s[32:35], s39 offen offset:256 sc1
  v_rcp_f32 v66, v66
  v_mfma_f32_16x16x32_bf16 v[200:203], a[24:27], a[64:67], v[200:203]
  s_add_u32 m0, s75, 4096
  v_rcp_f32 v67, v67
  v_rcp_f32 v68, v68
  v_mfma_f32_16x16x32_bf16 v[204:207], a[28:31], a[64:67], v[204:207]
  buffer_load_dwordx4 v11, s[32:35], s82 offen offset:0 sc1 lds
  v_rcp_f32 v69, v69
  v_mfma_f32_16x16x32_bf16 v[192:195], a[48:51], a[80:83], v[192:195]
  ds_read_b128 a[64:67], v7 offset:0
  v_rcp_f32 v70, v70
  v_rcp_f32 v71, v71
  v_mfma_f32_16x16x32_bf16 v[196:199], a[52:55], a[80:83], v[196:199]
  ds_read_b128 a[68:71], v7 offset:2048
  v_mul_f32 v72, v64, v72
  v_mul_f32 v73, v65, v73
  v_mul_f32 v74, v66, v74
  v_mfma_f32_16x16x32_bf16 v[208:211], a[48:51], a[84:87], v[208:211]
  ds_read_b128 a[72:75], v7 offset:4096
  v_mul_f32 v75, v67, v75
  v_mul_f32 v76, v68, v76
  v_mul_f32 v77, v69, v77
  v_mfma_f32_16x16x32_bf16 v[212:215], a[52:55], a[84:87], v[212:215]
  ds_read_b128 a[76:79], v7 offset:6144
  buffer_load_dwordx4 v11, s[32:35], s82 offen offset:1024 sc1 lds
  v_mul_f32 v78, v70, v78
  v_mfma_f32_16x16x32_bf16 v[224:227], a[48:51], a[88:91], v[224:227]
  v_mul_f32 v79, v71, v79
  v_cvt_pk_bf16_f32 v72, v72, v73
  v_cvt_pk_bf16_f32 v73, v74, v75
  v_cvt_pk_bf16_f32 v74, v76, v77
  v_mfma_f32_16x16x32_bf16 v[228:231], a[52:55], a[88:91], v[228:231]
  v_cvt_pk_bf16_f32 v75, v78, v79
  s_add_u32 s85, s4, 559104
  buffer_store_dwordx4 v[72:75], v10, s[32:35], s85 offen sc1
  v_mfma_f32_16x16x32_bf16 v[240:243], a[48:51], a[92:95], v[240:243]
  v_mul_f32 v136, v128, v136
  v_mul_f32 v137, v129, v137
  v_mul_f32 v138, v130, v138
  v_mul_f32 v139, v131, v139
  v_mfma_f32_16x16x32_bf16 v[244:247], a[52:55], a[92:95], v[244:247]
  buffer_load_dwordx4 v11, s[32:35], s82 offen offset:2048 sc1 lds
  v_mul_f32 v140, v132, v140
  v_mul_f32 v141, v133, v141
  v_mfma_f32_16x16x32_bf16 v[248:251], a[56:59], a[92:95], v[248:251]
  v_mul_f32 v142, v134, v142
  v_mul_f32 v143, v135, v143
  v_mul_f32 v128, s5, v128
  v_mul_f32 v129, s5, v129
  v_mfma_f32_16x16x32_bf16 v[252:255], a[60:63], a[92:95], v[252:255]
  v_mul_f32 v130, s5, v130
  v_mul_f32 v131, s5, v131
  v_mul_f32 v132, s5, v132
  v_mul_f32 v133, s5, v133
  v_mfma_f32_16x16x32_bf16 v[232:235], a[56:59], a[88:91], v[232:235]
  v_mul_f32 v134, s5, v134
  v_mul_f32 v135, s5, v135
  v_exp_f32 v128, v128
  v_mfma_f32_16x16x32_bf16 v[236:239], a[60:63], a[88:91], v[236:239]
  buffer_load_dwordx4 v11, s[32:35], s82 offen offset:3072 sc1 lds
  v_exp_f32 v129, v129
  v_mfma_f32_16x16x32_bf16 v[216:219], a[56:59], a[84:87], v[216:219]
  s_add_u32 s72, s72, 16384
  s_cmp_eq_u32 s72, s48
  s_cselect_b32 s72, s49, s72
  s_cselect_b64 s[48:49], s[50:51], s[48:49]
  s_cselect_b64 s[50:51], s[52:53], s[50:51]
  s_cselect_b64 s[52:53], s[54:55], s[52:53]
  s_cselect_b32 s54, -1, s54
  v_mfma_f32_16x16x32_bf16 v[220:223], a[60:63], a[84:87], v[220:223]
  v_exp_f32 v130, v130
  v_exp_f32 v131, v131
  v_mfma_f32_16x16x32_bf16 v[200:203], a[56:59], a[80:83], v[200:203]
  v_exp_f32 v132, v132
  v_exp_f32 v133, v133
  v_mfma_f32_16x16x32_bf16 v[204:207], a[60:63], a[80:83], v[204:207]
  v_exp_f32 v134, v134
  v_exp_f32 v135, v135
  v_mfma_f32_16x16x32_bf16 v[192:195], a[0:3], a[96:99], v[192:195]
  ds_read_b128 a[80:83], v8 offset:0
  v_add_f32 v128, 1.0, v128
  v_add_f32 v129, 1.0, v129
  v_add_f32 v130, 1.0, v130
  v_mfma_f32_16x16x32_bf16 v[196:199], a[4:7], a[96:99], v[196:199]
  ds_read_b128 a[84:87], v8 offset:2048
  s_add_u32 m0, s75, 32768
  v_add_f32 v131, 1.0, v131
  v_add_f32 v132, 1.0, v132
  v_mfma_f32_16x16x32_bf16 v[208:211], a[0:3], a[100:103], v[208:211]
  ds_read_b128 a[88:91], v8 offset:4096
  buffer_load_dwordx4 v10, s[32:35], s72 offen offset:0 sc1 lds
  v_add_f32 v133, 1.0, v133
  v_mfma_f32_16x16x32_bf16 v[212:215], a[4:7], a[100:103], v[212:215]
  ds_read_b128 a[92:95], v8 offset:6144
  v_add_f32 v134, 1.0, v134
  v_add_f32 v135, 1.0, v135
  v_rcp_f32 v128, v128
  v_mfma_f32_16x16x32_bf16 v[224:227], a[0:3], a[104:107], v[224:227]
  v_rcp_f32 v129, v129
  v_rcp_f32 v130, v130
  v_mfma_f32_16x16x32_bf16 v[228:231], a[4:7], a[104:107], v[228:231]
  v_rcp_f32 v131, v131
  v_rcp_f32 v132, v132
  v_mfma_f32_16x16x32_bf16 v[240:243], a[0:3], a[108:111], v[240:243]
  buffer_load_dwordx4 v10, s[32:35], s72 offen offset:1024 sc1 lds
  v_rcp_f32 v133, v133
  v_mfma_f32_16x16x32_bf16 v[244:247], a[4:7], a[108:111], v[244:247]
  v_rcp_f32 v134, v134
  v_rcp_f32 v135, v135
  v_mfma_f32_16x16x32_bf16 v[248:251], a[8:11], a[108:111], v[248:251]
  v_mul_f32 v136, v128, v136
  v_mul_f32 v137, v129, v137
  v_mul_f32 v138, v130, v138
  v_mul_f32 v139, v131, v139
  v_mfma_f32_16x16x32_bf16 v[252:255], a[12:15], a[108:111], v[252:255]
  v_mul_f32 v140, v132, v140
  v_mul_f32 v141, v133, v141
  v_mul_f32 v142, v134, v142
  v_mul_f32 v143, v135, v143
  v_mfma_f32_16x16x32_bf16 v[232:235], a[8:11], a[104:107], v[232:235]
  buffer_load_dwordx4 v10, s[32:35], s72 offen offset:2048 sc1 lds
  v_cvt_pk_bf16_f32 v136, v136, v137
  v_cvt_pk_bf16_f32 v137, v138, v139
  v_mfma_f32_16x16x32_bf16 v[236:239], a[12:15], a[104:107], v[236:239]
  v_cvt_pk_bf16_f32 v138, v140, v141
  v_cvt_pk_bf16_f32 v139, v142, v143
  s_add_u32 s85, s4, 745472
  buffer_store_dwordx4 v[136:139], v10, s[32:35], s85 offen sc1
  v_mfma_f32_16x16x32_bf16 v[216:219], a[8:11], a[100:103], v[216:219]
  v_mul_f32 v152, v144, v152
  v_mul_f32 v153, v145, v153
  v_mul_f32 v154, v146, v154
  v_mul_f32 v155, v147, v155
  v_mfma_f32_16x16x32_bf16 v[220:223], a[12:15], a[100:103], v[220:223]
  v_mul_f32 v156, v148, v156
  v_mul_f32 v157, v149, v157
  v_mul_f32 v158, v150, v158
  v_mul_f32 v159, v151, v159
  v_mfma_f32_16x16x32_bf16 v[200:203], a[8:11], a[96:99], v[200:203]
  buffer_load_dwordx4 v10, s[32:35], s72 offen offset:3072 sc1 lds
  v_mul_f32 v144, s5, v144
  v_mul_f32 v145, s5, v145
  v_mfma_f32_16x16x32_bf16 v[204:207], a[12:15], a[96:99], v[204:207]
  v_mul_f32 v146, s5, v146
  v_mul_f32 v147, s5, v147
  v_mul_f32 v148, s5, v148
  v_mul_f32 v149, s5, v149
  v_mfma_f32_16x16x32_bf16 v[192:195], a[32:35], a[112:115], v[192:195]
  ds_read_b128 a[96:99], v7 offset:16384
  v_mul_f32 v150, s5, v150
  v_mul_f32 v151, s5, v151
  v_exp_f32 v144, v144
  v_mfma_f32_16x16x32_bf16 v[196:199], a[36:39], a[112:115], v[196:199]
  ds_read_b128 a[100:103], v7 offset:18432
  s_add_u32 m0, s75, 36864
  v_exp_f32 v145, v145
  v_mfma_f32_16x16x32_bf16 v[208:211], a[32:35], a[116:119], v[208:211]
  ds_read_b128 a[104:107], v7 offset:20480
  buffer_load_dwordx4 v11, s[32:35], s72 offen offset:0 sc1 lds
  v_exp_f32 v146, v146
  v_mfma_f32_16x16x32_bf16 v[212:215], a[36:39], a[116:119], v[212:215]
  ds_read_b128 a[108:111], v7 offset:22528
  v_exp_f32 v147, v147
  v_exp_f32 v148, v148
  v_mfma_f32_16x16x32_bf16 v[224:227], a[32:35], a[120:123], v[224:227]
  v_exp_f32 v149, v149
  v_exp_f32 v150, v150
  v_mfma_f32_16x16x32_bf16 v[228:231], a[36:39], a[120:123], v[228:231]
  v_exp_f32 v151, v151
  v_add_f32 v144, 1.0, v144
  v_add_f32 v145, 1.0, v145
  v_mfma_f32_16x16x32_bf16 v[240:243], a[32:35], a[124:127], v[240:243]
  buffer_load_dwordx4 v11, s[32:35], s72 offen offset:1024 sc1 lds
  v_add_f32 v146, 1.0, v146
  v_add_f32 v147, 1.0, v147
  v_mfma_f32_16x16x32_bf16 v[244:247], a[36:39], a[124:127], v[244:247]
  v_add_f32 v148, 1.0, v148
  v_add_f32 v149, 1.0, v149
  v_add_f32 v150, 1.0, v150
  v_add_f32 v151, 1.0, v151
  v_mfma_f32_16x16x32_bf16 v[248:251], a[40:43], a[124:127], v[248:251]
  v_rcp_f32 v144, v144
  v_rcp_f32 v145, v145
  v_mfma_f32_16x16x32_bf16 v[252:255], a[44:47], a[124:127], v[252:255]
  v_rcp_f32 v146, v146
  v_rcp_f32 v147, v147
  v_mfma_f32_16x16x32_bf16 v[232:235], a[40:43], a[120:123], v[232:235]
  buffer_load_dwordx4 v11, s[32:35], s72 offen offset:2048 sc1 lds
  v_rcp_f32 v148, v148
  v_mfma_f32_16x16x32_bf16 v[236:239], a[44:47], a[120:123], v[236:239]
  v_rcp_f32 v149, v149
  v_rcp_f32 v150, v150
  v_mfma_f32_16x16x32_bf16 v[216:219], a[40:43], a[116:119], v[216:219]
  v_rcp_f32 v151, v151
  v_mul_f32 v152, v144, v152
  v_mul_f32 v153, v145, v153
  v_mfma_f32_16x16x32_bf16 v[220:223], a[44:47], a[116:119], v[220:223]
  v_mul_f32 v154, v146, v154
  v_mul_f32 v155, v147, v155
  v_mul_f32 v156, v148, v156
  v_mul_f32 v157, v149, v157
  v_mfma_f32_16x16x32_bf16 v[200:203], a[40:43], a[112:115], v[200:203]
  buffer_load_dwordx4 v11, s[32:35], s72 offen offset:3072 sc1 lds
  v_mul_f32 v158, v150, v158
  v_mul_f32 v159, v151, v159
  v_mfma_f32_16x16x32_bf16 v[204:207], a[44:47], a[112:115], v[204:207]
  s_add_u32 s72, s72, 16384
  s_cmp_eq_u32 s72, s48
  s_cselect_b32 s72, s49, s72
  s_cselect_b64 s[48:49], s[50:51], s[48:49]
  s_cselect_b64 s[50:51], s[52:53], s[50:51]
  s_cselect_b64 s[52:53], s[54:55], s[52:53]
  s_cselect_b32 s54, -1, s54
  s_waitcnt lgkmcnt(11)
  v_mfma_f32_16x16x32_bf16 v[16:19], a[16:19], a[64:67], v[16:19]
  ds_read_b128 a[112:115], v8 offset:16384
  v_cvt_pk_bf16_f32 v152, v152, v153
  v_cvt_pk_bf16_f32 v153, v154, v155
  v_cvt_pk_bf16_f32 v154, v156, v157
  v_mfma_f32_16x16x32_bf16 v[20:23], a[20:23], a[64:67], v[20:23]
  ds_read_b128 a[116:119], v8 offset:18432
  v_cvt_pk_bf16_f32 v155, v158, v159
  s_add_u32 s85, s4, 931840
  buffer_store_dwordx4 v[152:155], v10, s[32:35], s85 offen sc1
  s_waitcnt lgkmcnt(12)
  v_mfma_f32_16x16x32_bf16 v[32:35], a[16:19], a[68:71], v[32:35]
  ds_read_b128 a[120:123], v8 offset:20480
  v_mul_f32 v168, v160, v168
  v_mul_f32 v169, v161, v169
  v_mul_f32 v170, v162, v170
  v_mfma_f32_16x16x32_bf16 v[36:39], a[20:23], a[68:71], v[36:39]
  ds_read_b128 a[124:127], v8 offset:22528
  v_mul_f32 v171, v163, v171
  v_mul_f32 v172, v164, v172
  v_mul_f32 v173, v165, v173
  s_waitcnt lgkmcnt(13)
  v_mfma_f32_16x16x32_bf16 v[48:51], a[16:19], a[72:75], v[48:51]
  v_mul_f32 v174, v166, v174
  v_mul_f32 v175, v167, v175
  v_mul_f32 v160, s5, v160
  v_mul_f32 v161, s5, v161
  v_mfma_f32_16x16x32_bf16 v[52:55], a[20:23], a[72:75], v[52:55]
  v_mul_f32 v162, s5, v162
  v_mul_f32 v163, s5, v163
  v_mul_f32 v164, s5, v164
  v_mul_f32 v165, s5, v165
  s_waitcnt lgkmcnt(12)
  v_mfma_f32_16x16x32_bf16 v[112:115], a[16:19], a[76:79], v[112:115]
  v_mul_f32 v166, s5, v166
  v_mul_f32 v167, s5, v167
  v_exp_f32 v160, v160
  v_mfma_f32_16x16x32_bf16 v[116:119], a[20:23], a[76:79], v[116:119]
  v_exp_f32 v161, v161
  v_exp_f32 v162, v162
  v_mfma_f32_16x16x32_bf16 v[120:123], a[24:27], a[76:79], v[120:123]
  v_exp_f32 v163, v163
  v_exp_f32 v164, v164
  s_waitcnt vmcnt(10) lgkmcnt(0)
  s_barrier
  v_mfma_f32_16x16x32_bf16 v[124:127], a[28:31], a[76:79], v[124:127]
  v_exp_f32 v165, v165
  v_exp_f32 v166, v166
  v_mfma_f32_16x16x32_bf16 v[56:59], a[24:27], a[72:75], v[56:59]
  s_add_u32 m0, s75, 65536
  v_exp_f32 v167, v167
  v_add_f32 v160, 1.0, v160
  v_mfma_f32_16x16x32_bf16 v[60:63], a[28:31], a[72:75], v[60:63]
  buffer_load_dwordx4 v10, s[32:35], s72 offen offset:0 sc1 lds
  v_add_f32 v161, 1.0, v161
  v_add_f32 v162, 1.0, v162
  v_mfma_f32_16x16x32_bf16 v[40:43], a[24:27], a[68:71], v[40:43]
  v_add_f32 v163, 1.0, v163
  v_add_f32 v164, 1.0, v164
  v_add_f32 v165, 1.0, v165
  v_add_f32 v166, 1.0, v166
  v_mfma_f32_16x16x32_bf16 v[44:47], a[28:31], a[68:71], v[44:47]
  v_add_f32 v167, 1.0, v167
  v_rcp_f32 v160, v160
  v_rcp_f32 v161, v161
  v_mfma_f32_16x16x32_bf16 v[24:27], a[24:27], a[64:67], v[24:27]
  v_rcp_f32 v162, v162
  v_rcp_f32 v163, v163
  v_mfma_f32_16x16x32_bf16 v[28:31], a[28:31], a[64:67], v[28:31]
  buffer_load_dwordx4 v10, s[32:35], s72 offen offset:1024 sc1 lds
  v_rcp_f32 v164, v164
  v_mfma_f32_16x16x32_bf16 v[16:19], a[48:51], a[80:83], v[16:19]
  v_rcp_f32 v165, v165
  v_rcp_f32 v166, v166
  v_mfma_f32_16x16x32_bf16 v[20:23], a[52:55], a[80:83], v[20:23]
  v_rcp_f32 v167, v167
  v_mul_f32 v168, v160, v168
  v_mul_f32 v169, v161, v169
  v_mfma_f32_16x16x32_bf16 v[32:35], a[48:51], a[84:87], v[32:35]
  v_mul_f32 v170, v162, v170
  v_mul_f32 v171, v163, v171
  v_mul_f32 v172, v164, v172
  v_mul_f32 v173, v165, v173
  v_mfma_f32_16x16x32_bf16 v[36:39], a[52:55], a[84:87], v[36:39]
  buffer_load_dwordx4 v10, s[32:35], s72 offen offset:2048 sc1 lds
  v_mul_f32 v174, v166, v174
  v_mul_f32 v175, v167, v175
  v_mfma_f32_16x16x32_bf16 v[48:51], a[48:51], a[88:91], v[48:51]
  v_cvt_pk_bf16_f32 v168, v168, v169
  v_cvt_pk_bf16_f32 v169, v170, v171
  v_cvt_pk_bf16_f32 v170, v172, v173
  v_cvt_pk_bf16_f32 v171, v174, v175
  v_mfma_f32_16x16x32_bf16 v[52:55], a[52:55], a[88:91], v[52:55]
  s_add_u32 s85, s4, 1118208
  buffer_store_dwordx4 v[168:171], v10, s[32:35], s85 offen sc1
  v_mul_f32 v184, v176, v184
  v_mfma_f32_16x16x32_bf16 v[112:115], a[48:51], a[92:95], v[112:115]
  v_mul_f32 v185, v177, v185
  v_mul_f32 v186, v178, v186
  v_mul_f32 v187, v179, v187
  v_mul_f32 v188, v180, v188
  v_mfma_f32_16x16x32_bf16 v[116:119], a[52:55], a[92:95], v[116:119]
  buffer_load_dwordx4 v10, s[32:35], s72 offen offset:3072 sc1 lds
  v_mul_f32 v189, v181, v189
  v_mul_f32 v190, v182, v190
  v_mul_f32 v191, v183, v191
  v_mfma_f32_16x16x32_bf16 v[120:123], a[56:59], a[92:95], v[120:123]
  v_mul_f32 v176, s5, v176
  v_mul_f32 v177, s5, v177
  v_mul_f32 v178, s5, v178
  v_mul_f32 v179, s5, v179
  v_mul_f32 v180, s5, v180
  v_mfma_f32_16x16x32_bf16 v[124:127], a[60:63], a[92:95], v[124:127]
  v_mul_f32 v181, s5, v181
  v_mul_f32 v182, s5, v182
  v_mul_f32 v183, s5, v183
  v_exp_f32 v176, v176
  v_mfma_f32_16x16x32_bf16 v[56:59], a[56:59], a[88:91], v[56:59]
  s_add_u32 m0, s75, 69632
  v_exp_f32 v177, v177
  v_exp_f32 v178, v178
  v_mfma_f32_16x16x32_bf16 v[60:63], a[60:63], a[88:91], v[60:63]
  buffer_load_dwordx4 v11, s[32:35], s72 offen offset:0 sc1 lds
  v_exp_f32 v179, v179
  v_mfma_f32_16x16x32_bf16 v[40:43], a[56:59], a[84:87], v[40:43]
  v_exp_f32 v180, v180
  v_exp_f32 v181, v181
  v_mfma_f32_16x16x32_bf16 v[44:47], a[60:63], a[84:87], v[44:47]
  v_exp_f32 v182, v182
  v_exp_f32 v183, v183
  v_mfma_f32_16x16x32_bf16 v[24:27], a[56:59], a[80:83], v[24:27]
  v_add_f32 v176, 1.0, v176
  v_add_f32 v177, 1.0, v177
  v_add_f32 v178, 1.0, v178
  v_add_f32 v179, 1.0, v179
  v_mfma_f32_16x16x32_bf16 v[28:31], a[60:63], a[80:83], v[28:31]
  buffer_load_dwordx4 v11, s[32:35], s72 offen offset:1024 sc1 lds
  v_add_f32 v180, 1.0, v180
  v_add_f32 v181, 1.0, v181
  v_add_f32 v182, 1.0, v182
  v_mfma_f32_16x16x32_bf16 v[16:19], a[0:3], a[96:99], v[16:19]
  v_add_f32 v183, 1.0, v183
  v_rcp_f32 v176, v176
  v_rcp_f32 v177, v177
  v_mfma_f32_16x16x32_bf16 v[20:23], a[4:7], a[96:99], v[20:23]
  v_rcp_f32 v178, v178
  v_rcp_f32 v179, v179
  v_mfma_f32_16x16x32_bf16 v[32:35], a[0:3], a[100:103], v[32:35]
  v_rcp_f32 v180, v180
  v_rcp_f32 v181, v181
  v_mfma_f32_16x16x32_bf16 v[36:39], a[4:7], a[100:103], v[36:39]
  buffer_load_dwordx4 v11, s[32:35], s72 offen offset:2048 sc1 lds
  v_rcp_f32 v182, v182
  v_mfma_f32_16x16x32_bf16 v[48:51], a[0:3], a[104:107], v[48:51]
  v_rcp_f32 v183, v183
  v_mul_f32 v184, v176, v184
  v_mul_f32 v185, v177, v185
  v_mfma_f32_16x16x32_bf16 v[52:55], a[4:7], a[104:107], v[52:55]
  v_mul_f32 v186, v178, v186
  v_mul_f32 v187, v179, v187
  v_mul_f32 v188, v180, v188
  v_mul_f32 v189, v181, v189
  v_mul_f32 v190, v182, v190
  v_mfma_f32_16x16x32_bf16 v[112:115], a[0:3], a[108:111], v[112:115]
  v_mul_f32 v191, v183, v191
  v_cvt_pk_bf16_f32 v184, v184, v185
  v_cvt_pk_bf16_f32 v185, v186, v187
  v_cvt_pk_bf16_f32 v186, v188, v189
  v_cvt_pk_bf16_f32 v187, v190, v191
  v_mfma_f32_16x16x32_bf16 v[116:119], a[4:7], a[108:111], v[116:119]
  buffer_load_dwordx4 v11, s[32:35], s72 offen offset:3072 sc1 lds
  s_add_u32 s85, s4, 1304576
  buffer_store_dwordx4 v[184:187], v10, s[32:35], s85 offen sc1
  v_mfma_f32_16x16x32_bf16 v[120:123], a[8:11], a[108:111], v[120:123]
  s_add_u32 s72, s72, 16384
  s_cmp_eq_u32 s72, s48
  s_cselect_b32 s72, s49, s72
  s_cselect_b64 s[48:49], s[50:51], s[48:49]
  s_cselect_b64 s[50:51], s[52:53], s[50:51]
  s_cselect_b64 s[52:53], s[54:55], s[52:53]
  s_cselect_b32 s54, -1, s54
  v_mfma_f32_16x16x32_bf16 v[124:127], a[12:15], a[108:111], v[124:127]
  v_mul_f32 v192, s6, v192
  v_mul_f32 v193, s6, v193
  v_mul_f32 v194, s6, v194
  v_mul_f32 v195, s6, v195
  v_mfma_f32_16x16x32_bf16 v[56:59], a[8:11], a[104:107], v[56:59]
  v_mul_f32 v196, s6, v196
  v_mul_f32 v197, s6, v197
  v_mul_f32 v198, s6, v198
  v_mul_f32 v199, s6, v199
  v_cvt_pk_bf16_f32 v192, v192, v193
  v_mfma_f32_16x16x32_bf16 v[60:63], a[12:15], a[104:107], v[60:63]
  v_cvt_pk_bf16_f32 v193, v194, v195
  v_cvt_pk_bf16_f32 v194, v196, v197
  v_cvt_pk_bf16_f32 v195, v198, v199
  ds_write_b128 v14, v[192:195] offset:32768
  v_mul_f32 v200, s6, v200
  v_mfma_f32_16x16x32_bf16 v[40:43], a[8:11], a[100:103], v[40:43]
  v_mul_f32 v201, s6, v201
  v_mul_f32 v202, s6, v202
  v_mul_f32 v203, s6, v203
  v_mul_f32 v204, s6, v204
  v_mul_f32 v205, s6, v205
  v_mfma_f32_16x16x32_bf16 v[44:47], a[12:15], a[100:103], v[44:47]
  v_mul_f32 v206, s6, v206
  v_mul_f32 v207, s6, v207
  v_cvt_pk_bf16_f32 v200, v200, v201
  v_cvt_pk_bf16_f32 v201, v202, v203
  v_cvt_pk_bf16_f32 v202, v204, v205
  v_mfma_f32_16x16x32_bf16 v[24:27], a[8:11], a[96:99], v[24:27]
  v_cvt_pk_bf16_f32 v203, v206, v207
  ds_write_b128 v14, v[200:203] offset:34816
  v_mul_f32 v208, s6, v208
  v_mul_f32 v209, s6, v209
  v_mul_f32 v210, s6, v210
  v_mfma_f32_16x16x32_bf16 v[28:31], a[12:15], a[96:99], v[28:31]
  v_mul_f32 v211, s6, v211
  v_mul_f32 v212, s6, v212
  v_mul_f32 v213, s6, v213
  v_mul_f32 v214, s6, v214
  v_mul_f32 v215, s6, v215
  v_mfma_f32_16x16x32_bf16 v[16:19], a[32:35], a[112:115], v[16:19]
  v_cvt_pk_bf16_f32 v208, v208, v209
  v_cvt_pk_bf16_f32 v209, v210, v211
  v_cvt_pk_bf16_f32 v210, v212, v213
  v_cvt_pk_bf16_f32 v211, v214, v215
  ds_write_b128 v14, v[208:211] offset:36864
  v_mfma_f32_16x16x32_bf16 v[20:23], a[36:39], a[112:115], v[20:23]
  ds_read_b128 a[0:3], v1 offset:16384
  v_mul_f32 v216, s6, v216
  v_mul_f32 v217, s6, v217
  v_mul_f32 v218, s6, v218
  v_mul_f32 v219, s6, v219
  v_mfma_f32_16x16x32_bf16 v[32:35], a[32:35], a[116:119], v[32:35]
  ds_read_b128 a[4:7], v1 offset:17408
  v_mul_f32 v220, s6, v220
  v_mul_f32 v221, s6, v221
  v_mul_f32 v222, s6, v222
  v_mul_f32 v223, s6, v223
  v_mfma_f32_16x16x32_bf16 v[36:39], a[36:39], a[116:119], v[36:39]
  ds_read_b128 a[16:19], v1 offset:20480
  v_cvt_pk_bf16_f32 v216, v216, v217
  v_cvt_pk_bf16_f32 v217, v218, v219
  v_cvt_pk_bf16_f32 v218, v220, v221
  v_cvt_pk_bf16_f32 v219, v222, v223
  v_mfma_f32_16x16x32_bf16 v[48:51], a[32:35], a[120:123], v[48:51]
  ds_read_b128 a[20:23], v1 offset:21504
  ds_write_b128 v14, v[216:219] offset:38912
  v_mul_f32 v224, s6, v224
  v_mul_f32 v225, s6, v225
  v_mul_f32 v226, s6, v226
  v_mfma_f32_16x16x32_bf16 v[52:55], a[36:39], a[120:123], v[52:55]
  ds_read_b128 a[24:27], v1 offset:22528
  v_mul_f32 v227, s6, v227
  v_mul_f32 v228, s6, v228
  v_mul_f32 v229, s6, v229
  v_mul_f32 v230, s6, v230
  v_mfma_f32_16x16x32_bf16 v[112:115], a[32:35], a[124:127], v[112:115]
  ds_read_b128 a[28:31], v1 offset:23552
  v_mul_f32 v231, s6, v231
  v_cvt_pk_bf16_f32 v224, v224, v225
  v_cvt_pk_bf16_f32 v225, v226, v227
  v_cvt_pk_bf16_f32 v226, v228, v229
  v_mfma_f32_16x16x32_bf16 v[116:119], a[36:39], a[124:127], v[116:119]
  ds_read_b128 a[8:11], v1 offset:18432
  v_cvt_pk_bf16_f32 v227, v230, v231
  ds_write_b128 v14, v[224:227] offset:40960
  v_mul_f32 v232, s6, v232
  v_mul_f32 v233, s6, v233
  v_mfma_f32_16x16x32_bf16 v[120:123], a[40:43], a[124:127], v[120:123]
  ds_read_b128 a[12:15], v1 offset:19456
  v_mul_f32 v234, s6, v234
  v_mul_f32 v235, s6, v235
  v_mul_f32 v236, s6, v236
  v_mul_f32 v237, s6, v237
  v_mfma_f32_16x16x32_bf16 v[124:127], a[44:47], a[124:127], v[124:127]
  v_mul_f32 v238, s6, v238
  v_mul_f32 v239, s6, v239
  v_cvt_pk_bf16_f32 v232, v232, v233
  v_cvt_pk_bf16_f32 v233, v234, v235
  v_cvt_pk_bf16_f32 v234, v236, v237
  v_mfma_f32_16x16x32_bf16 v[56:59], a[40:43], a[120:123], v[56:59]
  v_cvt_pk_bf16_f32 v235, v238, v239
  ds_write_b128 v14, v[232:235] offset:43008
  v_mul_f32 v240, s6, v240
  v_mul_f32 v241, s6, v241
  v_mul_f32 v242, s6, v242
  v_mfma_f32_16x16x32_bf16 v[60:63], a[44:47], a[120:123], v[60:63]
  v_mul_f32 v243, s6, v243
  v_mul_f32 v244, s6, v244
  v_mul_f32 v245, s6, v245
  v_mul_f32 v246, s6, v246
  v_mul_f32 v247, s6, v247
  v_mfma_f32_16x16x32_bf16 v[40:43], a[40:43], a[116:119], v[40:43]
  v_cvt_pk_bf16_f32 v240, v240, v241
  v_cvt_pk_bf16_f32 v241, v242, v243
  v_cvt_pk_bf16_f32 v242, v244, v245
  v_cvt_pk_bf16_f32 v243, v246, v247
  ds_write_b128 v14, v[240:243] offset:45056
  v_mfma_f32_16x16x32_bf16 v[44:47], a[44:47], a[116:119], v[44:47]
  v_mul_f32 v248, s6, v248
  v_mul_f32 v249, s6, v249
  v_mul_f32 v250, s6, v250
  v_mul_f32 v251, s6, v251
  v_mul_f32 v252, s6, v252
  v_mfma_f32_16x16x32_bf16 v[24:27], a[40:43], a[112:115], v[24:27]
  v_mul_f32 v253, s6, v253
  v_mul_f32 v254, s6, v254
  v_mul_f32 v255, s6, v255
  v_cvt_pk_bf16_f32 v248, v248, v249
  v_cvt_pk_bf16_f32 v249, v250, v251
  v_mfma_f32_16x16x32_bf16 v[28:31], a[44:47], a[112:115], v[28:31]
  v_cvt_pk_bf16_f32 v250, v252, v253
  v_cvt_pk_bf16_f32 v251, v254, v255
  ds_write_b128 v14, v[248:251] offset:47104
  v_mov_b64 v[64:65], 0
  v_mov_b64 v[66:67], 0
  v_mov_b32 v232, 0xf149f2ca
  v_pk_mul_f32 v[16:17], v[16:17], s[6:7]
  v_pk_mul_f32 v[18:19], v[18:19], s[6:7]
  v_pk_mul_f32 v[20:21], v[20:21], s[6:7]
  v_pk_mul_f32 v[22:23], v[22:23], s[6:7]
  v_cvt_pk_bf16_f32 v16, v16, v17
  v_cvt_pk_bf16_f32 v17, v18, v19
  v_cvt_pk_bf16_f32 v18, v20, v21
  v_cvt_pk_bf16_f32 v19, v22, v23
  ds_write_b128 v14, v[16:19] offset:0
  v_mfma_f32_32x32x16_bf16 v[128:143], v[64:67], v[64:67], 0
  v_pk_mul_f32 v[24:25], v[24:25], s[6:7]
  v_pk_mul_f32 v[26:27], v[26:27], s[6:7]
  v_pk_mul_f32 v[28:29], v[28:29], s[6:7]
  v_pk_mul_f32 v[30:31], v[30:31], s[6:7]
  v_cvt_pk_bf16_f32 v24, v24, v25
  v_cvt_pk_bf16_f32 v25, v26, v27
  v_cvt_pk_bf16_f32 v26, v28, v29
  v_cvt_pk_bf16_f32 v27, v30, v31
  ds_write_b128 v14, v[24:27] offset:2048
  v_mfma_f32_32x32x16_bf16 v[144:159], v[64:67], v[64:67], 0
  v_pk_mul_f32 v[32:33], v[32:33], s[6:7]
  v_pk_mul_f32 v[34:35], v[34:35], s[6:7]
  v_pk_mul_f32 v[36:37], v[36:37], s[6:7]
  v_pk_mul_f32 v[38:39], v[38:39], s[6:7]
  v_cvt_pk_bf16_f32 v32, v32, v33
  v_cvt_pk_bf16_f32 v33, v34, v35
  v_cvt_pk_bf16_f32 v34, v36, v37
  v_cvt_pk_bf16_f32 v35, v38, v39
  ds_write_b128 v14, v[32:35] offset:4096
  v_mfma_f32_32x32x16_bf16 v[160:175], v[64:67], v[64:67], 0
  v_pk_mul_f32 v[40:41], v[40:41], s[6:7]
  v_pk_mul_f32 v[42:43], v[42:43], s[6:7]
  v_pk_mul_f32 v[44:45], v[44:45], s[6:7]
  v_pk_mul_f32 v[46:47], v[46:47], s[6:7]
  v_cvt_pk_bf16_f32 v40, v40, v41
  v_cvt_pk_bf16_f32 v41, v42, v43
  v_cvt_pk_bf16_f32 v42, v44, v45
  v_cvt_pk_bf16_f32 v43, v46, v47
  ds_write_b128 v14, v[40:43] offset:6144
  v_mfma_f32_32x32x16_bf16 v[176:191], v[64:67], v[64:67], 0
  v_pk_mul_f32 v[48:49], v[48:49], s[6:7]
  v_pk_mul_f32 v[50:51], v[50:51], s[6:7]
  v_pk_mul_f32 v[52:53], v[52:53], s[6:7]
  v_pk_mul_f32 v[54:55], v[54:55], s[6:7]
  v_cvt_pk_bf16_f32 v48, v48, v49
  v_cvt_pk_bf16_f32 v49, v50, v51
  v_cvt_pk_bf16_f32 v50, v52, v53
  v_cvt_pk_bf16_f32 v51, v54, v55
  ds_write_b128 v14, v[48:51] offset:8192
  v_mfma_f32_32x32x16_bf16 v[192:207], v[64:67], v[64:67], 0
  v_pk_mul_f32 v[56:57], v[56:57], s[6:7]
  v_pk_mul_f32 v[58:59], v[58:59], s[6:7]
  v_pk_mul_f32 v[60:61], v[60:61], s[6:7]
  v_pk_mul_f32 v[62:63], v[62:63], s[6:7]
  v_cvt_pk_bf16_f32 v56, v56, v57
  v_cvt_pk_bf16_f32 v57, v58, v59
  v_cvt_pk_bf16_f32 v58, v60, v61
  v_cvt_pk_bf16_f32 v59, v62, v63
  ds_write_b128 v14, v[56:59] offset:10240
  v_mfma_f32_32x32x16_bf16 v[208:223], v[64:67], v[64:67], 0
  v_pk_mul_f32 v[112:113], v[112:113], s[6:7]
  v_pk_mul_f32 v[114:115], v[114:115], s[6:7]
  v_pk_mul_f32 v[116:117], v[116:117], s[6:7]
  v_pk_mul_f32 v[118:119], v[118:119], s[6:7]
  v_cvt_pk_bf16_f32 v112, v112, v113
  v_cvt_pk_bf16_f32 v113, v114, v115
  v_cvt_pk_bf16_f32 v114, v116, v117
  v_cvt_pk_bf16_f32 v115, v118, v119
  ds_write_b128 v14, v[112:115] offset:12288
  v_pk_mul_f32 v[120:121], v[120:121], s[6:7]
  v_pk_mul_f32 v[122:123], v[122:123], s[6:7]
  v_pk_mul_f32 v[124:125], v[124:125], s[6:7]
  v_pk_mul_f32 v[126:127], v[126:127], s[6:7]
  v_cvt_pk_bf16_f32 v120, v120, v121
  v_cvt_pk_bf16_f32 v121, v122, v123
  v_cvt_pk_bf16_f32 v122, v124, v125
  v_cvt_pk_bf16_f32 v123, v126, v127
  ds_write_b128 v14, v[120:123] offset:14336
  v_xor_b32 v14, 4096, v15
  s_waitcnt lgkmcnt(0)
  s_barrier
  s_memrealtime s[4:5]
  ds_read_b128 a[128:131], v14 offset:16384
  ds_read_b128 a[144:147], v14 offset:49152
  ds_read_b128 a[132:135], v14 offset:17408
  ds_read_b128 a[148:151], v14 offset:50176
  ds_read_b128 a[136:139], v14 offset:18432
  ds_read_b128 a[152:155], v14 offset:51200
  ds_read_b128 a[140:143], v14 offset:19456
  ds_read_b128 a[156:159], v14 offset:52224
  ds_read_b128 a[160:163], v15 offset:16384
  ds_read_b128 a[176:179], v15 offset:49152
  ds_read_b128 a[164:167], v15 offset:17408
  ds_read_b128 a[180:183], v15 offset:50176
  ds_read_b128 a[168:171], v15 offset:18432
  ds_read_b128 a[184:187], v15 offset:51200
  ds_read_b128 a[172:175], v15 offset:19456
  ds_read_b128 a[188:191], v15 offset:52224
  v_mfma_f32_32x32x16_bf16 v[88:103], v[64:67], v[64:67], 0
  v_mfma_f32_32x32x16_bf16 v[104:119], v[64:67], v[64:67], 0
  v_and_b32 v12, 15, v0
  v_lshrrev_b32 v13, 4, v0
  v_lshlrev_b32 v13, 2, v13
  v_sub_u32 v12, v12, v13
  v_add_u32 v12, s77, v12
  v_cvt_f32_i32 v12, v12
  v_mul_f32 v12, 0x6f800000, v12
  s_mov_b32 s39, 0x71800000
  s_cmp_eq_u32 s38, 0
  s_cselect_b32 s39, s39, 0xf1800000
  v_add_f32 v13, s39, v12
  v_fma_f32 v239, s39, -2.0, v12
  v_add_f32 v72, 0x0, v13
  v_add_f32 v73, 0xef800000, v13
  v_add_f32 v74, 0xf0000000, v13
  v_add_f32 v75, 0xf0400000, v13
  v_add_f32 v76, 0xf1800000, v13
  v_add_f32 v77, 0xf1880000, v13
  v_add_f32 v78, 0xf1900000, v13
  v_add_f32 v79, 0xf1980000, v13
  v_min_f32 v72, 0, v72
  v_min_f32 v73, 0, v73
  v_min_f32 v74, 0, v74
  v_min_f32 v75, 0, v75
  v_min_f32 v76, 0, v76
  v_min_f32 v77, 0, v77
  v_min_f32 v78, 0, v78
  v_min_f32 v79, 0, v79
  v_and_b32 v16, s61, v72
  v_and_b32 v17, s61, v73
  v_and_b32 v18, s61, v74
  v_and_b32 v19, s61, v75
  v_and_b32 v20, s61, v76
  v_and_b32 v21, s61, v77
  v_and_b32 v22, s61, v78
  v_and_b32 v23, s61, v79
  s_waitcnt lgkmcnt(15)
  v_mfma_f32_16x16x32_bf16 v[16:19], a[0:3], a[128:131], v[16:19]
  v_add_f32 v80, 0x0, v12
  v_add_f32 v81, 0xef800000, v12
  v_mov_b64 v[120:121], 0
  ds_read_b128 a[96:99], v15 offset:0
  s_waitcnt lgkmcnt(14)
  v_mfma_f32_16x16x32_bf16 v[16:19], a[4:7], a[132:135], v[16:19]
  v_add_f32 v82, 0xf0000000, v12
  v_add_f32 v83, 0xf0400000, v12
  v_mov_b64 v[122:123], 0
  v_mfma_f32_16x16x32_bf16 v[24:27], a[0:3], a[144:147], 0
  v_add_f32 v84, 0xf1800000, v12
  v_add_f32 v85, 0xf1880000, v12
  v_mov_b64 v[124:125], 0
  ds_read_b128 a[100:103], v15 offset:1024
  s_waitcnt lgkmcnt(14)
  v_mfma_f32_16x16x32_bf16 v[24:27], a[4:7], a[148:151], v[24:27]
  v_add_f32 v86, 0xf1900000, v12
  v_add_f32 v87, 0xf1980000, v12
  v_mov_b64 v[126:127], 0
  v_mfma_f32_16x16x32_bf16 v[28:31], a[16:19], a[144:147], 0
  v_min_f32 v80, 0, v80
  v_min_f32 v81, 0, v81
  v_mov_b64 v[224:225], 0
  ds_read_b128 a[104:107], v15 offset:2048
  v_mfma_f32_16x16x32_bf16 v[28:31], a[20:23], a[148:151], v[28:31]
  v_min_f32 v82, 0, v82
  v_min_f32 v83, 0, v83
  v_mov_b64 v[226:227], 0
  v_mfma_f32_16x16x32_bf16 v[20:23], a[16:19], a[128:131], v[20:23]
  v_min_f32 v84, 0, v84
  v_min_f32 v85, 0, v85
  v_mov_b64 v[228:229], 0
  v_mfma_f32_16x16x32_bf16 v[20:23], a[20:23], a[132:135], v[20:23]
  v_min_f32 v86, 0, v86
  v_min_f32 v87, 0, v87
  v_mov_b64 v[230:231], 0
  ds_read_b128 a[108:111], v15 offset:3072
  s_waitcnt lgkmcnt(15)
  v_mfma_f32_16x16x32_bf16 v[20:23], a[24:27], a[136:139], v[20:23]
  v_and_b32 v32, s61, v80
  v_and_b32 v33, s61, v81
  v_lshlrev_b32 v9, 2, v0
  ds_read_b128 a[112:115], v15 offset:32768
  s_waitcnt lgkmcnt(14)
  v_mfma_f32_16x16x32_bf16 v[20:23], a[28:31], a[140:143], v[20:23]
  v_and_b32 v34, s61, v82
  v_and_b32 v35, s61, v83
  v_and_b32 v247, 60, v9
  v_mfma_f32_16x16x32_bf16 v[28:31], a[24:27], a[152:155], v[28:31]
  v_and_b32 v36, s61, v84
  v_and_b32 v37, s61, v85
  v_mov_b32 v245, 1073741824
  ds_read_b128 a[116:119], v15 offset:33792
  s_waitcnt lgkmcnt(14)
  v_mfma_f32_16x16x32_bf16 v[28:31], a[28:31], a[156:159], v[28:31]
  v_and_b32 v38, s61, v86
  v_lshlrev_b32 v7, 7, v0
  v_mfma_f32_16x16x32_bf16 v[24:27], a[8:11], a[152:155], v[24:27]
  v_and_b32 v39, s61, v87
  s_mov_b32 s16, s26
  ds_read_b128 a[120:123], v15 offset:34816
  v_mfma_f32_16x16x32_bf16 v[24:27], a[12:15], a[156:159], v[24:27]
  s_mov_b32 s17, s27
  v_mfma_f32_16x16x32_bf16 v[16:19], a[8:11], a[136:139], v[16:19]
  s_mov_b32 s18, 2621440
  ds_read_b128 a[124:127], v15 offset:35840
  v_mfma_f32_16x16x32_bf16 v[16:19], a[12:15], a[140:143], v[16:19]
  s_waitcnt lgkmcnt(4)
  s_barrier
  v_writelane_b32 v245, s1, 0
  s_add_u32 m0, s75, 98304
  v_mfma_f32_16x16x32_bf16 v[32:35], a[0:3], a[160:163], v[32:35]
  buffer_load_dwordx4 v10, s[32:35], s72 offen offset:0 sc1 lds
  v_mfma_f32_16x16x32_bf16 v[32:35], a[4:7], a[164:167], v[32:35]
  buffer_load_dwordx4 v10, s[32:35], s72 offen offset:1024 sc1 lds
  v_mfma_f32_16x16x32_bf16 v[40:43], a[0:3], a[176:179], 0
  v_exp_f32 v16, v16
  v_exp_f32 v17, v17
  v_mfma_f32_16x16x32_bf16 v[40:43], a[4:7], a[180:183], v[40:43]
  v_exp_f32 v18, v18
  v_exp_f32 v19, v19
  ds_read_b128 a[0:3], v1 offset:0
  v_mfma_f32_16x16x32_bf16 v[44:47], a[16:19], a[176:179], 0
  buffer_load_dwordx4 v10, s[32:35], s72 offen offset:2048 sc1 lds
  v_cvt_pk_bf16_f32 v48, v16, v17
  v_exp_f32 v24, v24
  ds_read_b128 a[4:7], v1 offset:1024
  v_mfma_f32_16x16x32_bf16 v[44:47], a[20:23], a[180:183], v[44:47]
  buffer_load_dwordx4 v10, s[32:35], s72 offen offset:3072 sc1 lds
  v_exp_f32 v25, v25
  v_cvt_pk_bf16_f32 v49, v18, v19
  s_add_u32 m0, m0, 4096
  v_mfma_f32_16x16x32_bf16 v[36:39], a[16:19], a[160:163], v[36:39]
  v_exp_f32 v26, v26
  v_mfma_f32_16x16x32_bf16 v[36:39], a[20:23], a[164:167], v[36:39]
  v_exp_f32 v27, v27
  v_cvt_pk_bf16_f32 v52, v24, v25
  ds_read_b128 a[16:19], v1 offset:4096
  buffer_load_dwordx4 v11, s[32:35], s72 offen offset:0 sc1 lds
  v_mfma_f32_16x16x32_bf16 v[36:39], a[24:27], a[168:171], v[36:39]
  v_exp_f32 v20, v20
  v_exp_f32 v21, v21
  ds_read_b128 a[20:23], v1 offset:5120
  v_mfma_f32_16x16x32_bf16 v[36:39], a[28:31], a[172:175], v[36:39]
  buffer_load_dwordx4 v11, s[32:35], s72 offen offset:1024 sc1 lds
  v_cvt_pk_bf16_f32 v53, v26, v27
  v_exp_f32 v22, v22
  v_mfma_f32_16x16x32_bf16 v[44:47], a[24:27], a[184:187], v[44:47]
  buffer_load_dwordx4 v11, s[32:35], s72 offen offset:2048 sc1 lds
  v_exp_f32 v23, v23
  v_mfma_f32_16x16x32_bf16 v[44:47], a[28:31], a[188:191], v[44:47]
  v_cvt_pk_bf16_f32 v50, v20, v21
  v_exp_f32 v28, v28
  ds_read_b128 a[24:27], v1 offset:6144
  buffer_load_dwordx4 v11, s[32:35], s72 offen offset:3072 sc1 lds
  v_mfma_f32_16x16x32_bf16 v[40:43], a[8:11], a[184:187], v[40:43]
  v_exp_f32 v29, v29
  v_cvt_pk_bf16_f32 v51, v22, v23
  ds_read_b128 a[28:31], v1 offset:7168
  s_add_u32 s72, s72, 16384
  s_cmp_eq_u32 s72, s48
  v_mfma_f32_16x16x32_bf16 v[40:43], a[12:15], a[188:191], v[40:43]
  s_cselect_b32 s72, s49, s72
  s_cselect_b64 s[48:49], s[50:51], s[48:49]
  s_cselect_b64 s[50:51], s[52:53], s[50:51]
  s_cselect_b64 s[52:53], s[54:55], s[52:53]
  s_cselect_b32 s54, -1, s54
  s_mov_b32 m0, s75
  v_mfma_f32_16x16x32_bf16 v[32:35], a[8:11], a[168:171], v[32:35]
  s_add_u32 s75, s75, 32768
  s_and_b32 s75, s75, 0x1ffff
  v_exp_f32 v30, v30
  v_exp_f32 v31, v31
  v_mfma_f32_16x16x32_bf16 v[32:35], a[12:15], a[172:175], v[32:35]
  v_cvt_pk_bf16_f32 v54, v28, v29
  s_nop 0
  v_cvt_pk_bf16_f32 v55, v30, v31
  ds_read_b128 a[8:11], v1 offset:2048
  ds_read_b128 a[12:15], v1 offset:3072
  v_add_u32 v1, s75, v2
  s_cmp_eq_u32 s43, 0
  s_cselect_b32 s61, -1, 0
  v_mov_b32 v236, 1073741824
  s_mul_i32 s39, s79, 81920
  s_lshl_b32 s76, s43, 2
  s_sub_u32 s76, 26, s76
  s_waitcnt vmcnt(8)
  buffer_store_dword v232, v245, s[32:35], 0 offen sc1
  buffer_load_dword v8, v247, s[16:19], s39 offen
  buffer_load_dword v8, v7, s[8:11], s0 offen
  s_cbranch_scc1 L_at_p0
.p2align 6
L_at_pl1:
  s_waitcnt vmcnt(16) lgkmcnt(0)
  s_barrier
  v_mfma_f32_16x16x32_bf16 v[16:19], a[0:3], a[128:131], 0
  ds_read_b128 a[32:35], v1 offset:16384
  ds_read_b128 a[36:39], v1 offset:17408
  v_mfma_f32_16x16x32_bf16 v[16:19], a[4:7], a[132:135], v[16:19]
  v_exp_f32 v32, v32
  v_mfma_f32_16x16x32_bf16 v[24:27], a[0:3], a[144:147], 0
  ds_read_b128 a[40:43], v1 offset:18432
  ds_read_b128 a[44:47], v1 offset:19456
  v_mfma_f32_16x16x32_bf16 v[24:27], a[4:7], a[148:151], v[24:27]
  v_exp_f32 v33, v33
  v_mfma_f32_16x16x32_bf16 v[28:31], a[16:19], a[144:147], 0
  ds_read_b128 a[48:51], v1 offset:20480
  v_cvt_pk_bf16_f32 v56, v32, v33
  v_mfma_f32_16x16x32_bf16 v[28:31], a[20:23], a[148:151], v[28:31]
  v_exp_f32 v34, v34
  v_mfma_f32_16x16x32_bf16 v[20:23], a[16:19], a[128:131], 0
  ds_read_b128 a[52:55], v1 offset:21504
  ds_read_b128 a[56:59], v1 offset:22528
  v_mfma_f32_16x16x32_bf16 v[20:23], a[20:23], a[132:135], v[20:23]
  v_exp_f32 v35, v35
  v_mfma_f32_16x16x32_bf16 v[20:23], a[24:27], a[136:139], v[20:23]
  ds_read_b128 a[60:63], v1 offset:23552
  v_cvt_pk_bf16_f32 v57, v34, v35
  v_mfma_f32_16x16x32_bf16 v[20:23], a[28:31], a[140:143], v[20:23]
  v_exp_f32 v40, v40
  v_mfma_f32_16x16x32_bf16 v[28:31], a[24:27], a[152:155], v[28:31]
  buffer_load_dwordx4 v10, s[32:35], s72 offen offset:0 sc1 lds
  v_mfma_f32_16x16x32_bf16 v[28:31], a[28:31], a[156:159], v[28:31]
  v_exp_f32 v41, v41
  v_mfma_f32_16x16x32_bf16 v[24:27], a[8:11], a[152:155], v[24:27]
  s_add_u32 s84, s72, 16384
  v_cvt_pk_bf16_f32 v60, v40, v41
  v_mfma_f32_16x16x32_bf16 v[24:27], a[12:15], a[156:159], v[24:27]
  v_exp_f32 v42, v42
  v_mfma_f32_16x16x32_bf16 v[16:19], a[8:11], a[136:139], v[16:19]
  s_cmp_eq_u32 s84, s48
  s_cselect_b32 s84, s49, s84
  v_mfma_f32_16x16x32_bf16 v[16:19], a[12:15], a[140:143], v[16:19]
  v_exp_f32 v43, v43
  s_waitcnt lgkmcnt(0)
  v_mfma_f32_16x16x32_bf16 v[88:91], a[32:35], v[48:51], v[88:91]
  s_cselect_b64 s[48:49], s[50:51], s[48:49]
  v_cvt_pk_bf16_f32 v61, v42, v43
  v_mfma_f32_16x16x32_bf16 v[120:123], a[32:35], v[52:55], v[120:123]
  v_exp_f32 v36, v36
  v_mfma_f32_16x16x32_bf16 v[92:95], a[36:39], v[48:51], v[92:95]
  buffer_load_dwordx4 v10, s[32:35], s72 offen offset:1024 sc1 lds
  v_mfma_f32_16x16x32_bf16 v[124:127], a[36:39], v[52:55], v[124:127]
  v_exp_f32 v37, v37
  v_mfma_f32_16x16x32_bf16 v[96:99], a[40:43], v[48:51], v[96:99]
  s_cselect_b64 s[50:51], s[52:53], s[50:51]
  v_cvt_pk_bf16_f32 v58, v36, v37
  v_mfma_f32_16x16x32_bf16 v[128:131], a[40:43], v[52:55], v[128:131]
  v_exp_f32 v38, v38
  v_mfma_f32_16x16x32_bf16 v[100:103], a[44:47], v[48:51], v[100:103]
  buffer_load_dwordx4 v10, s[32:35], s72 offen offset:2048 sc1 lds
  v_mfma_f32_16x16x32_bf16 v[132:135], a[44:47], v[52:55], v[132:135]
  v_exp_f32 v39, v39
  v_mfma_f32_16x16x32_bf16 v[104:107], a[48:51], v[48:51], v[104:107]
  s_cselect_b64 s[52:53], s[54:55], s[52:53]
  v_cvt_pk_bf16_f32 v59, v38, v39
  v_mfma_f32_16x16x32_bf16 v[136:139], a[48:51], v[52:55], v[136:139]
  v_exp_f32 v44, v44
  v_mfma_f32_16x16x32_bf16 v[108:111], a[52:55], v[48:51], v[108:111]
  buffer_load_dwordx4 v10, s[32:35], s72 offen offset:3072 sc1 lds
  v_mfma_f32_16x16x32_bf16 v[140:143], a[52:55], v[52:55], v[140:143]
  v_exp_f32 v45, v45
  v_mfma_f32_16x16x32_bf16 v[112:115], a[56:59], v[48:51], v[112:115]
  s_cselect_b32 s54, -1, s54
  v_cvt_pk_bf16_f32 v62, v44, v45
  v_mfma_f32_16x16x32_bf16 v[144:147], a[56:59], v[52:55], v[144:147]
  v_exp_f32 v46, v46
  v_mfma_f32_16x16x32_bf16 v[116:119], a[60:63], v[48:51], v[116:119]
  s_add_u32 m0, m0, 4096
  v_mfma_f32_16x16x32_bf16 v[148:151], a[60:63], v[52:55], v[148:151]
  v_exp_f32 v47, v47
  v_mfma_f32_16x16x32_bf16 v[216:219], a[192:195], v[48:51], v[216:219]
  v_cvt_pk_bf16_f32 v63, v46, v47
  v_mfma_f32_16x16x32_bf16 v[220:223], a[192:195], v[52:55], v[220:223]
  v_mfma_f32_16x16x32_bf16 v[32:35], a[0:3], a[160:163], 0
  v_mfma_f32_16x16x32_bf16 v[32:35], a[4:7], a[164:167], v[32:35]
  v_exp_f32 v16, v16
  v_mfma_f32_16x16x32_bf16 v[40:43], a[0:3], a[176:179], 0
  buffer_load_dwordx4 v11, s[32:35], s72 offen offset:0 sc1 lds
  v_mfma_f32_16x16x32_bf16 v[40:43], a[4:7], a[180:183], v[40:43]
  v_exp_f32 v17, v17
  v_mfma_f32_16x16x32_bf16 v[44:47], a[16:19], a[176:179], 0
  ds_read_b128 a[0:3], v1 offset:0
  v_cvt_pk_bf16_f32 v48, v16, v17
  v_mfma_f32_16x16x32_bf16 v[44:47], a[20:23], a[180:183], v[44:47]
  v_exp_f32 v18, v18
  v_mfma_f32_16x16x32_bf16 v[36:39], a[16:19], a[160:163], 0
  ds_read_b128 a[4:7], v1 offset:1024
  v_mfma_f32_16x16x32_bf16 v[36:39], a[20:23], a[164:167], v[36:39]
  v_exp_f32 v19, v19
  v_mfma_f32_16x16x32_bf16 v[36:39], a[24:27], a[168:171], v[36:39]
  ds_read_b128 a[16:19], v1 offset:4096
  v_cvt_pk_bf16_f32 v49, v18, v19
  v_mfma_f32_16x16x32_bf16 v[36:39], a[28:31], a[172:175], v[36:39]
  v_exp_f32 v24, v24
  v_mfma_f32_16x16x32_bf16 v[44:47], a[24:27], a[184:187], v[44:47]
  buffer_load_dwordx4 v11, s[32:35], s72 offen offset:1024 sc1 lds
  v_mfma_f32_16x16x32_bf16 v[44:47], a[28:31], a[188:191], v[44:47]
  v_exp_f32 v25, v25
  v_mfma_f32_16x16x32_bf16 v[40:43], a[8:11], a[184:187], v[40:43]
  ds_read_b128 a[20:23], v1 offset:5120
  v_cvt_pk_bf16_f32 v52, v24, v25
  v_mfma_f32_16x16x32_bf16 v[40:43], a[12:15], a[188:191], v[40:43]
  v_exp_f32 v26, v26
  v_mfma_f32_16x16x32_bf16 v[32:35], a[8:11], a[168:171], v[32:35]
  ds_read_b128 a[24:27], v1 offset:6144
  ds_read_b128 a[28:31], v1 offset:7168
  v_mfma_f32_16x16x32_bf16 v[32:35], a[12:15], a[172:175], v[32:35]
  v_exp_f32 v27, v27
  v_mfma_f32_16x16x32_bf16 v[152:155], a[32:35], v[56:59], v[152:155]
  ds_read_b128 a[8:11], v1 offset:2048
  v_cvt_pk_bf16_f32 v53, v26, v27
  v_mfma_f32_16x16x32_bf16 v[184:187], a[32:35], v[60:63], v[184:187]
  v_exp_f32 v20, v20
  v_mfma_f32_16x16x32_bf16 v[156:159], a[36:39], v[56:59], v[156:159]
  buffer_load_dwordx4 v11, s[32:35], s72 offen offset:2048 sc1 lds
  v_mfma_f32_16x16x32_bf16 v[188:191], a[36:39], v[60:63], v[188:191]
  v_exp_f32 v21, v21
  v_mfma_f32_16x16x32_bf16 v[160:163], a[40:43], v[56:59], v[160:163]
  ds_read_b128 a[12:15], v1 offset:3072
  v_cvt_pk_bf16_f32 v50, v20, v21
  v_mfma_f32_16x16x32_bf16 v[192:195], a[40:43], v[60:63], v[192:195]
  v_exp_f32 v22, v22
  v_mfma_f32_16x16x32_bf16 v[164:167], a[44:47], v[56:59], v[164:167]
  buffer_load_dwordx4 v11, s[32:35], s72 offen offset:3072 sc1 lds
  v_mfma_f32_16x16x32_bf16 v[196:199], a[44:47], v[60:63], v[196:199]
  v_exp_f32 v23, v23
  v_mfma_f32_16x16x32_bf16 v[168:171], a[48:51], v[56:59], v[168:171]
  s_mov_b32 s72, s84
  v_cvt_pk_bf16_f32 v51, v22, v23
  v_mfma_f32_16x16x32_bf16 v[200:203], a[48:51], v[60:63], v[200:203]
  v_exp_f32 v28, v28
  v_mfma_f32_16x16x32_bf16 v[172:175], a[52:55], v[56:59], v[172:175]
  s_mov_b32 m0, s75
  s_add_u32 s75, s75, 32768
  v_mfma_f32_16x16x32_bf16 v[204:207], a[52:55], v[60:63], v[204:207]
  v_exp_f32 v29, v29
  v_mfma_f32_16x16x32_bf16 v[176:179], a[56:59], v[56:59], v[176:179]
  s_and_b32 s75, s75, 0x1ffff
  v_cvt_pk_bf16_f32 v54, v28, v29
  v_mfma_f32_16x16x32_bf16 v[208:211], a[56:59], v[60:63], v[208:211]
  v_exp_f32 v30, v30
  v_mfma_f32_16x16x32_bf16 v[180:183], a[60:63], v[56:59], v[180:183]
  v_mfma_f32_16x16x32_bf16 v[212:215], a[60:63], v[60:63], v[212:215]
  v_exp_f32 v31, v31
  v_mfma_f32_16x16x32_bf16 v[224:227], a[192:195], v[56:59], v[224:227]
  v_add_u32 v1, s75, v2
  v_cvt_pk_bf16_f32 v55, v30, v31
  v_mfma_f32_16x16x32_bf16 v[228:231], a[192:195], v[60:63], v[228:231]
  s_sub_u32 s76, s76, 1
  s_cbranch_scc0 L_at_pl1
  s_waitcnt vmcnt(16) lgkmcnt(0)
  s_barrier
  v_mfma_f32_16x16x32_bf16 v[16:19], a[0:3], a[128:131], v[72:75]
  ds_read_b128 a[32:35], v1 offset:16384
  ds_read_b128 a[36:39], v1 offset:17408
  v_mfma_f32_16x16x32_bf16 v[16:19], a[4:7], a[132:135], v[16:19]
  v_exp_f32 v32, v32
  v_mfma_f32_16x16x32_bf16 v[24:27], a[0:3], a[144:147], 0
  ds_read_b128 a[40:43], v1 offset:18432
  ds_read_b128 a[44:47], v1 offset:19456
  v_mfma_f32_16x16x32_bf16 v[24:27], a[4:7], a[148:151], v[24:27]
  v_exp_f32 v33, v33
  v_mfma_f32_16x16x32_bf16 v[28:31], a[16:19], a[144:147], 0
  ds_read_b128 a[48:51], v1 offset:20480
  v_cvt_pk_bf16_f32 v56, v32, v33
  v_mfma_f32_16x16x32_bf16 v[28:31], a[20:23], a[148:151], v[28:31]
  v_exp_f32 v34, v34
  v_mfma_f32_16x16x32_bf16 v[20:23], a[16:19], a[128:131], v[76:79]
  ds_read_b128 a[52:55], v1 offset:21504
  ds_read_b128 a[56:59], v1 offset:22528
  v_mfma_f32_16x16x32_bf16 v[20:23], a[20:23], a[132:135], v[20:23]
  v_exp_f32 v35, v35
  v_mfma_f32_16x16x32_bf16 v[20:23], a[24:27], a[136:139], v[20:23]
  ds_read_b128 a[60:63], v1 offset:23552
  v_cvt_pk_bf16_f32 v57, v34, v35
  v_mfma_f32_16x16x32_bf16 v[20:23], a[28:31], a[140:143], v[20:23]
  v_exp_f32 v40, v40
  v_mfma_f32_16x16x32_bf16 v[28:31], a[24:27], a[152:155], v[28:31]
  buffer_load_dwordx4 v10, s[32:35], s72 offen offset:0 sc1 lds
  v_mfma_f32_16x16x32_bf16 v[28:31], a[28:31], a[156:159], v[28:31]
  v_exp_f32 v41, v41
  v_mfma_f32_16x16x32_bf16 v[24:27], a[8:11], a[152:155], v[24:27]
  s_and_b32 s81, s2, 7
  v_cvt_pk_bf16_f32 v60, v40, v41
  v_mfma_f32_16x16x32_bf16 v[24:27], a[12:15], a[156:159], v[24:27]
  v_exp_f32 v42, v42
  v_mfma_f32_16x16x32_bf16 v[16:19], a[8:11], a[136:139], v[16:19]
  s_lshl_b32 s81, s81, 3
  v_mfma_f32_16x16x32_bf16 v[16:19], a[12:15], a[140:143], v[16:19]
  v_exp_f32 v43, v43
  s_waitcnt lgkmcnt(0)
  v_mfma_f32_16x16x32_bf16 v[88:91], a[32:35], v[48:51], v[88:91]
  s_add_u32 s81, s81, 84946944
  v_cvt_pk_bf16_f32 v61, v42, v43
  v_mfma_f32_16x16x32_bf16 v[120:123], a[32:35], v[52:55], v[120:123]
  v_exp_f32 v36, v36
  v_mfma_f32_16x16x32_bf16 v[92:95], a[36:39], v[48:51], v[92:95]
  buffer_load_dwordx4 v10, s[32:35], s72 offen offset:1024 sc1 lds
  v_mfma_f32_16x16x32_bf16 v[124:127], a[36:39], v[52:55], v[124:127]
  v_exp_f32 v37, v37
  v_mfma_f32_16x16x32_bf16 v[96:99], a[40:43], v[48:51], v[96:99]
  s_lshl_b32 s83, s36, 3
  v_cvt_pk_bf16_f32 v58, v36, v37
  v_mfma_f32_16x16x32_bf16 v[128:131], a[40:43], v[52:55], v[128:131]
  v_exp_f32 v38, v38
  v_mfma_f32_16x16x32_bf16 v[100:103], a[44:47], v[48:51], v[100:103]
  buffer_load_dwordx4 v10, s[32:35], s72 offen offset:2048 sc1 lds
  v_mfma_f32_16x16x32_bf16 v[132:135], a[44:47], v[52:55], v[132:135]
  v_exp_f32 v39, v39
  v_mfma_f32_16x16x32_bf16 v[104:107], a[48:51], v[48:51], v[104:107]
  s_add_u32 s83, s83, s43
  v_cvt_pk_bf16_f32 v59, v38, v39
  v_mfma_f32_16x16x32_bf16 v[136:139], a[48:51], v[52:55], v[136:139]
  v_exp_f32 v44, v44
  v_mfma_f32_16x16x32_bf16 v[108:111], a[52:55], v[48:51], v[108:111]
  buffer_load_dwordx4 v10, s[32:35], s72 offen offset:3072 sc1 lds
  v_mfma_f32_16x16x32_bf16 v[140:143], a[52:55], v[52:55], v[140:143]
  v_exp_f32 v45, v45
  v_mfma_f32_16x16x32_bf16 v[112:115], a[56:59], v[48:51], v[112:115]
  s_add_u32 m0, m0, 4096
  v_cvt_pk_bf16_f32 v62, v44, v45
  v_mfma_f32_16x16x32_bf16 v[144:147], a[56:59], v[52:55], v[144:147]
  v_exp_f32 v46, v46
  v_mfma_f32_16x16x32_bf16 v[116:119], a[60:63], v[48:51], v[116:119]
  s_sub_u32 s83, s83, 2
  v_mfma_f32_16x16x32_bf16 v[148:151], a[60:63], v[52:55], v[148:151]
  v_exp_f32 v47, v47
  v_mfma_f32_16x16x32_bf16 v[216:219], a[192:195], v[48:51], v[216:219]
  v_cvt_pk_bf16_f32 v63, v46, v47
  v_mfma_f32_16x16x32_bf16 v[220:223], a[192:195], v[52:55], v[220:223]
  s_cmp_lt_u32 s83, 4
  s_cselect_b32 s81, s81, 1073741824
  v_mfma_f32_16x16x32_bf16 v[32:35], a[0:3], a[160:163], v[80:83]
  v_mov_b32 v235, 0x10000
  v_mfma_f32_16x16x32_bf16 v[32:35], a[4:7], a[164:167], v[32:35]
  v_exp_f32 v16, v16
  v_mfma_f32_16x16x32_bf16 v[40:43], a[0:3], a[176:179], 0
  buffer_load_dwordx4 v11, s[32:35], s72 offen offset:0 sc1 lds
  v_mfma_f32_16x16x32_bf16 v[40:43], a[4:7], a[180:183], v[40:43]
  v_exp_f32 v17, v17
  v_mfma_f32_16x16x32_bf16 v[44:47], a[16:19], a[176:179], 0
  ds_read_b128 a[0:3], v1 offset:0
  v_cvt_pk_bf16_f32 v48, v16, v17
  v_mfma_f32_16x16x32_bf16 v[44:47], a[20:23], a[180:183], v[44:47]
  v_exp_f32 v18, v18
  v_mfma_f32_16x16x32_bf16 v[36:39], a[16:19], a[160:163], v[84:87]
  ds_read_b128 a[4:7], v1 offset:1024
  v_mfma_f32_16x16x32_bf16 v[36:39], a[20:23], a[164:167], v[36:39]
  v_exp_f32 v19, v19
  v_mfma_f32_16x16x32_bf16 v[36:39], a[24:27], a[168:171], v[36:39]
  ds_read_b128 a[16:19], v1 offset:4096
  v_cvt_pk_bf16_f32 v49, v18, v19
  v_mfma_f32_16x16x32_bf16 v[36:39], a[28:31], a[172:175], v[36:39]
  v_exp_f32 v24, v24
  v_mfma_f32_16x16x32_bf16 v[44:47], a[24:27], a[184:187], v[44:47]
  buffer_load_dwordx4 v11, s[32:35], s72 offen offset:1024 sc1 lds
  v_mfma_f32_16x16x32_bf16 v[44:47], a[28:31], a[188:191], v[44:47]
  v_exp_f32 v25, v25
  v_mfma_f32_16x16x32_bf16 v[40:43], a[8:11], a[184:187], v[40:43]
  ds_read_b128 a[20:23], v1 offset:5120
  v_cvt_pk_bf16_f32 v52, v24, v25
  v_mfma_f32_16x16x32_bf16 v[40:43], a[12:15], a[188:191], v[40:43]
  v_exp_f32 v26, v26
  v_mfma_f32_16x16x32_bf16 v[32:35], a[8:11], a[168:171], v[32:35]
  v_writelane_b32 v236, s81, 0
  ds_read_b128 a[24:27], v1 offset:6144
  v_mfma_f32_16x16x32_bf16 v[32:35], a[12:15], a[172:175], v[32:35]
  v_exp_f32 v27, v27
  v_mfma_f32_16x16x32_bf16 v[152:155], a[32:35], v[56:59], v[152:155]
  ds_read_b128 a[28:31], v1 offset:7168
  v_cvt_pk_bf16_f32 v53, v26, v27
  v_mfma_f32_16x16x32_bf16 v[184:187], a[32:35], v[60:63], v[184:187]
  v_exp_f32 v20, v20
  v_mfma_f32_16x16x32_bf16 v[156:159], a[36:39], v[56:59], v[156:159]
  buffer_load_dwordx4 v11, s[32:35], s72 offen offset:2048 sc1 lds
  v_mfma_f32_16x16x32_bf16 v[188:191], a[36:39], v[60:63], v[188:191]
  v_exp_f32 v21, v21
  v_mfma_f32_16x16x32_bf16 v[160:163], a[40:43], v[56:59], v[160:163]
  ds_read_b128 a[8:11], v1 offset:2048
  v_cvt_pk_bf16_f32 v50, v20, v21
  v_mfma_f32_16x16x32_bf16 v[192:195], a[40:43], v[60:63], v[192:195]
  v_exp_f32 v22, v22
  v_mfma_f32_16x16x32_bf16 v[164:167], a[44:47], v[56:59], v[164:167]
  buffer_load_dwordx4 v11, s[32:35], s72 offen offset:3072 sc1 lds
  v_mfma_f32_16x16x32_bf16 v[196:199], a[44:47], v[60:63], v[196:199]
  v_exp_f32 v23, v23
  v_mfma_f32_16x16x32_bf16 v[168:171], a[48:51], v[56:59], v[168:171]
  ds_read_b128 a[12:15], v1 offset:3072
  v_cvt_pk_bf16_f32 v51, v22, v23
  v_mfma_f32_16x16x32_bf16 v[200:203], a[48:51], v[60:63], v[200:203]
  v_exp_f32 v28, v28
  v_mfma_f32_16x16x32_bf16 v[172:175], a[52:55], v[56:59], v[172:175]
  s_mul_i32 s4, s4, 4
  s_add_u32 s72, s72, 16384
  v_mfma_f32_16x16x32_bf16 v[204:207], a[52:55], v[60:63], v[204:207]
  v_exp_f32 v29, v29
  v_mfma_f32_16x16x32_bf16 v[176:179], a[56:59], v[56:59], v[176:179]
  s_mov_b32 m0, s75
  v_cvt_pk_bf16_f32 v54, v28, v29
  v_mfma_f32_16x16x32_bf16 v[208:211], a[56:59], v[60:63], v[208:211]
  v_exp_f32 v30, v30
  v_mfma_f32_16x16x32_bf16 v[180:183], a[60:63], v[56:59], v[180:183]
  s_add_u32 s75, s75, 32768
  s_and_b32 s75, s75, 0x1ffff
  v_mfma_f32_16x16x32_bf16 v[212:215], a[60:63], v[60:63], v[212:215]
  v_exp_f32 v31, v31
  v_mfma_f32_16x16x32_bf16 v[224:227], a[192:195], v[56:59], v[224:227]
  v_add_u32 v1, s75, v2
  v_cvt_pk_bf16_f32 v55, v30, v31
  v_mfma_f32_16x16x32_bf16 v[228:231], a[192:195], v[60:63], v[228:231]
L_at_p0:
  s_waitcnt vmcnt(16) lgkmcnt(0)
  s_barrier
  v_mfma_f32_16x16x32_bf16 v[24:27], a[0:3], a[144:147], v[72:75]
  ds_read_b128 a[32:35], v1 offset:16384
  ds_read_b128 a[36:39], v1 offset:17408
  v_mfma_f32_16x16x32_bf16 v[24:27], a[4:7], a[148:151], v[24:27]
  v_exp_f32 v32, v32
  ds_read_b128 a[40:43], v1 offset:18432
  v_mfma_f32_16x16x32_bf16 v[28:31], a[16:19], a[144:147], v[76:79]
  v_exp_f32 v33, v33
  ds_read_b128 a[44:47], v1 offset:19456
  v_mfma_f32_16x16x32_bf16 v[28:31], a[20:23], a[148:151], v[28:31]
  ds_read_b128 a[48:51], v1 offset:20480
  v_cvt_pk_bf16_f32 v56, v32, v33
  v_mfma_f32_16x16x32_bf16 v[28:31], a[24:27], a[152:155], v[28:31]
  v_exp_f32 v34, v34
  ds_read_b128 a[52:55], v1 offset:21504
  v_mfma_f32_16x16x32_bf16 v[28:31], a[28:31], a[156:159], v[28:31]
  v_exp_f32 v35, v35
  ds_read_b128 a[56:59], v1 offset:22528
  v_mfma_f32_16x16x32_bf16 v[24:27], a[8:11], a[152:155], v[24:27]
  ds_read_b128 a[60:63], v1 offset:23552
  v_cvt_pk_bf16_f32 v57, v34, v35
  v_mfma_f32_16x16x32_bf16 v[24:27], a[12:15], a[156:159], v[24:27]
  v_exp_f32 v40, v40
  s_waitcnt lgkmcnt(7)
  v_mfma_f32_16x16x32_bf16 v[88:91], a[32:35], v[48:51], v[88:91]
  v_exp_f32 v41, v41
  v_mfma_f32_16x16x32_bf16 v[120:123], a[32:35], v[52:55], v[120:123]
  buffer_load_dwordx4 v10, s[32:35], s72 offen offset:0 sc1 lds
  v_cvt_pk_bf16_f32 v60, v40, v41
  s_waitcnt lgkmcnt(6)
  v_mfma_f32_16x16x32_bf16 v[92:95], a[36:39], v[48:51], v[92:95]
  v_exp_f32 v42, v42
  v_mfma_f32_16x16x32_bf16 v[124:127], a[36:39], v[52:55], v[124:127]
  v_exp_f32 v43, v43
  s_waitcnt lgkmcnt(5)
  v_mfma_f32_16x16x32_bf16 v[96:99], a[40:43], v[48:51], v[96:99]
  v_cvt_pk_bf16_f32 v61, v42, v43
  v_mfma_f32_16x16x32_bf16 v[128:131], a[40:43], v[52:55], v[128:131]
  v_exp_f32 v36, v36
  s_waitcnt lgkmcnt(4)
  v_mfma_f32_16x16x32_bf16 v[100:103], a[44:47], v[48:51], v[100:103]
  v_exp_f32 v37, v37
  v_mfma_f32_16x16x32_bf16 v[132:135], a[44:47], v[52:55], v[132:135]
  buffer_load_dwordx4 v10, s[32:35], s72 offen offset:1024 sc1 lds
  v_cvt_pk_bf16_f32 v58, v36, v37
  s_waitcnt lgkmcnt(3)
  v_mfma_f32_16x16x32_bf16 v[104:107], a[48:51], v[48:51], v[104:107]
  v_exp_f32 v38, v38
  v_mfma_f32_16x16x32_bf16 v[136:139], a[48:51], v[52:55], v[136:139]
  v_exp_f32 v39, v39
  s_waitcnt lgkmcnt(2)
  v_mfma_f32_16x16x32_bf16 v[108:111], a[52:55], v[48:51], v[108:111]
  buffer_load_dwordx4 v10, s[32:35], s72 offen offset:2048 sc1 lds
  v_cvt_pk_bf16_f32 v59, v38, v39
  v_mfma_f32_16x16x32_bf16 v[140:143], a[52:55], v[52:55], v[140:143]
  v_exp_f32 v44, v44
  s_waitcnt lgkmcnt(1)
  v_mfma_f32_16x16x32_bf16 v[112:115], a[56:59], v[48:51], v[112:115]
  v_exp_f32 v45, v45
  v_mfma_f32_16x16x32_bf16 v[144:147], a[56:59], v[52:55], v[144:147]
  buffer_load_dwordx4 v10, s[32:35], s72 offen offset:3072 sc1 lds
  v_cvt_pk_bf16_f32 v62, v44, v45
  s_waitcnt lgkmcnt(0)
  v_mfma_f32_16x16x32_bf16 v[116:119], a[60:63], v[48:51], v[116:119]
  v_exp_f32 v46, v46
  s_add_u32 m0, m0, 4096
  v_mfma_f32_16x16x32_bf16 v[148:151], a[60:63], v[52:55], v[148:151]
  v_exp_f32 v47, v47
  v_mfma_f32_16x16x32_bf16 v[216:219], a[192:195], v[48:51], v[216:219]
  v_cvt_pk_bf16_f32 v63, v46, v47
  v_mfma_f32_16x16x32_bf16 v[220:223], a[192:195], v[52:55], v[220:223]
  v_mfma_f32_16x16x32_bf16 v[40:43], a[0:3], a[176:179], v[80:83]
  v_mfma_f32_16x16x32_bf16 v[40:43], a[4:7], a[180:183], v[40:43]
  v_exp_f32 v24, v24
  v_mfma_f32_16x16x32_bf16 v[44:47], a[16:19], a[176:179], v[84:87]
  buffer_load_dwordx4 v11, s[32:35], s72 offen offset:0 sc1 lds
  ds_write_b128 v15, v[88:91] offset:32768
  v_mfma_f32_16x16x32_bf16 v[44:47], a[20:23], a[180:183], v[44:47]
  ds_write_b128 v15, v[92:95] offset:33792
  v_mfma_f32_16x16x32_bf16 v[44:47], a[24:27], a[184:187], v[44:47]
  v_exp_f32 v25, v25
  ds_read_b128 a[0:3], v1 offset:0
  v_mfma_f32_16x16x32_bf16 v[44:47], a[28:31], a[188:191], v[44:47]
  ds_read_b128 a[4:7], v1 offset:1024
  ds_read_b128 a[16:19], v1 offset:4096
  v_cvt_pk_bf16_f32 v52, v24, v25
  v_mfma_f32_16x16x32_bf16 v[40:43], a[8:11], a[184:187], v[40:43]
  ds_read_b128 a[20:23], v1 offset:5120
  ds_write_b128 v15, v[96:99] offset:34816
  ds_read_b128 a[24:27], v1 offset:6144
  v_mfma_f32_16x16x32_bf16 v[40:43], a[12:15], a[188:191], v[40:43]
  v_exp_f32 v26, v26
  ds_read_b128 a[28:31], v1 offset:7168
  v_mfma_f32_16x16x32_bf16 v[152:155], a[32:35], v[56:59], v[152:155]
  buffer_load_dwordx4 v11, s[32:35], s72 offen offset:1024 sc1 lds
  ds_write_b128 v15, v[100:103] offset:35840
  v_mfma_f32_16x16x32_bf16 v[184:187], a[32:35], v[60:63], v[184:187]
  ds_read_b128 a[8:11], v1 offset:2048
  ds_write_b128 v15, v[104:107] offset:49152
  ds_read_b128 a[12:15], v1 offset:3072
  v_mfma_f32_16x16x32_bf16 v[156:159], a[36:39], v[56:59], v[156:159]
  v_exp_f32 v27, v27
  v_and_b32 v16, s61, v80
  v_mfma_f32_16x16x32_bf16 v[188:191], a[36:39], v[60:63], v[188:191]
  ds_write_b128 v15, v[108:111] offset:50176
  v_and_b32 v17, s61, v81
  v_cvt_pk_bf16_f32 v53, v26, v27
  v_mfma_f32_16x16x32_bf16 v[160:163], a[40:43], v[56:59], v[160:163]
  v_mov_b32_sdwa v116, v216 dst_sel:BYTE_0 dst_unused:UNUSED_PRESERVE src0_sel:BYTE_0
  v_and_b32 v18, s61, v82
  v_mov_b32_sdwa v117, v216 dst_sel:BYTE_0 dst_unused:UNUSED_PRESERVE src0_sel:BYTE_1
  v_mfma_f32_16x16x32_bf16 v[192:195], a[40:43], v[60:63], v[192:195]
  v_exp_f32 v28, v28
  v_mov_b32_sdwa v118, v216 dst_sel:BYTE_0 dst_unused:UNUSED_PRESERVE src0_sel:BYTE_2
  v_mfma_f32_16x16x32_bf16 v[164:167], a[44:47], v[56:59], v[164:167]
  buffer_load_dwordx4 v11, s[32:35], s72 offen offset:2048 sc1 lds
  v_and_b32 v19, s61, v83
  v_mfma_f32_16x16x32_bf16 v[196:199], a[44:47], v[60:63], v[196:199]
  v_and_b32 v20, s61, v84
  v_mov_b32_sdwa v119, v216 dst_sel:BYTE_0 dst_unused:UNUSED_PRESERVE src0_sel:BYTE_3
  v_mfma_f32_16x16x32_bf16 v[168:171], a[48:51], v[56:59], v[168:171]
  v_exp_f32 v29, v29
  ds_write_b128 v15, v[112:115] offset:51200
  v_mfma_f32_16x16x32_bf16 v[200:203], a[48:51], v[60:63], v[200:203]
  v_and_b32 v21, s61, v85
  v_cvt_pk_bf16_f32 v54, v28, v29
  v_mfma_f32_16x16x32_bf16 v[172:175], a[52:55], v[56:59], v[172:175]
  buffer_load_dwordx4 v11, s[32:35], s72 offen offset:3072 sc1 lds
  ds_write_b128 v15, v[116:119] offset:52224
  v_mfma_f32_16x16x32_bf16 v[204:207], a[52:55], v[60:63], v[204:207]
  v_exp_f32 v30, v30
  v_and_b32 v22, s61, v86
  v_mfma_f32_16x16x32_bf16 v[176:179], a[56:59], v[56:59], v[176:179]
  s_add_u32 s72, s72, 16384
  s_mov_b32 m0, s75
  s_add_u32 s75, s75, 32768
  v_mfma_f32_16x16x32_bf16 v[208:211], a[56:59], v[60:63], v[208:211]
  s_and_b32 s75, s75, 0x1ffff
  v_and_b32 v23, s61, v87
  s_memrealtime s[6:7]
  v_mfma_f32_16x16x32_bf16 v[180:183], a[60:63], v[56:59], v[180:183]
  v_exp_f32 v31, v31
  v_mfma_f32_16x16x32_bf16 v[212:215], a[60:63], v[60:63], v[212:215]
  v_add_u32 v1, s75, v2
  v_cvt_pk_bf16_f32 v55, v30, v31
  v_mfma_f32_16x16x32_bf16 v[224:227], a[192:195], v[56:59], v[224:227]
  v_mfma_f32_16x16x32_bf16 v[228:231], a[192:195], v[60:63], v[228:231]
  s_cmp_eq_u32 s43, 0
  s_cselect_b32 s72, 1073741824, s72
  s_getpc_b64 s[44:45]
L_pc10:
  s_mov_b32 s46, L_code_end-L_pc10
  s_mov_b32 s47, 0x20000
  s_lshl_b32 s81, s36, 13
  s_cmp_lg_u32 s43, 0
  s_cselect_b32 s81, s81, 1073741824
  s_waitcnt vmcnt(16) lgkmcnt(0)
  s_cbranch_scc1 L_j_n2
  v_lshlrev_b32 v70, 3, v0
  v_and_b32 v70, 56, v70
  v_add_u32 v70, 84946944, v70
  s_lshl_b32 s58, s36, 10
  s_add_u32 s58, s58, 84934656
  buffer_load_dwordx4 v[248:251], v10, s[32:35], s58 offen sc1
  buffer_load_dwordx2 v[68:69], v70, s[32:35], 0 offen sc1
L_j_n2:
  s_barrier
  v_mfma_f32_16x16x32_bf16 v[16:19], a[0:3], a[96:99], v[16:19]
  ds_read_b128 a[32:35], v1 offset:16384
  ds_read_b128 a[36:39], v1 offset:17408
  v_mfma_f32_16x16x32_bf16 v[16:19], a[4:7], a[100:103], v[16:19]
  v_exp_f32 v40, v40
  ds_read_b128 a[40:43], v1 offset:18432
  v_mfma_f32_16x16x32_bf16 v[24:27], a[0:3], a[112:115], 0
  s_mul_i32 s6, s6, 8
  ds_read_b128 a[44:47], v1 offset:19456
  v_mfma_f32_16x16x32_bf16 v[24:27], a[4:7], a[116:119], v[24:27]
  v_exp_f32 v41, v41
  ds_read_b128 a[48:51], v1 offset:20480
  v_mfma_f32_16x16x32_bf16 v[28:31], a[16:19], a[112:115], 0
  ds_read_b128 a[52:55], v1 offset:21504
  v_cvt_pk_bf16_f32 v60, v40, v41
  v_mfma_f32_16x16x32_bf16 v[28:31], a[20:23], a[116:119], v[28:31]
  ds_read_b128 a[56:59], v1 offset:22528
  v_mfma_f32_16x16x32_bf16 v[20:23], a[16:19], a[96:99], v[20:23]
  v_exp_f32 v42, v42
  ds_read_b128 a[60:63], v1 offset:23552
  v_mfma_f32_16x16x32_bf16 v[20:23], a[20:23], a[100:103], v[20:23]
  buffer_load_dwordx4 v10, s[32:35], s72 offen offset:0 sc1 lds
  s_sub_u32 s6, s6, s4
  v_mfma_f32_16x16x32_bf16 v[20:23], a[24:27], a[104:107], v[20:23]
  ds_read_b128 v[116:119], v14 offset:52224
  ds_read_b128 v[88:91], v14 offset:32768
  v_mfma_f32_16x16x32_bf16 v[20:23], a[28:31], a[108:111], v[20:23]
  v_exp_f32 v43, v43
  v_mfma_f32_16x16x32_bf16 v[28:31], a[24:27], a[120:123], v[28:31]
  ds_read_b128 v[92:95], v14 offset:33792
  v_cvt_pk_bf16_f32 v61, v42, v43
  v_mfma_f32_16x16x32_bf16 v[28:31], a[28:31], a[124:127], v[28:31]
  v_mov_b32 v234, s6
  v_mfma_f32_16x16x32_bf16 v[24:27], a[8:11], a[120:123], v[24:27]
  v_exp_f32 v44, v44
  ds_read_b128 v[96:99], v14 offset:34816
  v_mfma_f32_16x16x32_bf16 v[24:27], a[12:15], a[124:127], v[24:27]
  buffer_load_dwordx4 v10, s[32:35], s72 offen offset:1024 sc1 lds
  v_mfma_f32_16x16x32_bf16 v[16:19], a[8:11], a[104:107], v[16:19]
  ds_read_b128 v[100:103], v14 offset:35840
  v_mfma_f32_16x16x32_bf16 v[16:19], a[12:15], a[108:111], v[16:19]
  v_exp_f32 v45, v45
  s_waitcnt lgkmcnt(5)
  v_mfma_f32_16x16x32_bf16 v[120:123], a[32:35], v[52:55], v[120:123]
  ds_read_b128 v[104:107], v14 offset:49152
  v_cvt_pk_bf16_f32 v62, v44, v45
  v_mfma_f32_16x16x32_bf16 v[124:127], a[36:39], v[52:55], v[124:127]
  buffer_load_dwordx4 v10, s[32:35], s72 offen offset:2048 sc1 lds
  v_mfma_f32_16x16x32_bf16 v[128:131], a[40:43], v[52:55], v[128:131]
  v_exp_f32 v46, v46
  ds_read_b128 v[108:111], v14 offset:50176
  v_mfma_f32_16x16x32_bf16 v[132:135], a[44:47], v[52:55], v[132:135]
  buffer_load_dwordx4 v10, s[32:35], s72 offen offset:3072 sc1 lds
  v_mfma_f32_16x16x32_bf16 v[136:139], a[48:51], v[52:55], v[136:139]
  buffer_atomic_add_x2 v[234:235], v236, s[32:35], 0 offen sc1
  s_add_u32 m0, m0, 4096
  v_mfma_f32_16x16x32_bf16 v[140:143], a[52:55], v[52:55], v[140:143]
  v_exp_f32 v47, v47
  ds_read_b128 v[112:115], v14 offset:51200
  v_mfma_f32_16x16x32_bf16 v[144:147], a[56:59], v[52:55], v[144:147]
  v_xor_b32 v1, 8192, v1
  v_cvt_pk_bf16_f32 v63, v46, v47
  v_mfma_f32_16x16x32_bf16 v[148:151], a[60:63], v[52:55], v[148:151]
  buffer_load_dword v8, v7, s[44:47], s81 offen
  v_mfma_f32_16x16x32_bf16 v[220:223], a[192:195], v[52:55], v[220:223]
  v_mfma_f32_16x16x32_bf16 v[32:35], a[0:3], a[160:163], 0
  v_mfma_f32_16x16x32_bf16 v[32:35], a[4:7], a[164:167], v[32:35]
  v_exp_f32 v16, v16
  v_mfma_f32_16x16x32_bf16 v[40:43], a[0:3], a[176:179], 0
  v_exp_f32 v17, v17
  s_waitcnt lgkmcnt(7)
  v_pk_add_f32 v[180:181], v[180:181], v[116:117]
  v_pk_add_f32 v[182:183], v[182:183], v[118:119]
  ds_write_b128 v14, v[120:123] offset:32768
  v_mov_b32_sdwa v148, v220 dst_sel:BYTE_0 dst_unused:UNUSED_PRESERVE src0_sel:BYTE_0
  v_mfma_f32_16x16x32_bf16 v[40:43], a[4:7], a[180:183], v[40:43]
  v_exp_f32 v18, v18
  v_mfma_f32_16x16x32_bf16 v[44:47], a[16:19], a[176:179], 0
  ds_read_b128 a[0:3], v1 offset:0
  ds_read_b128 a[4:7], v1 offset:1024
  buffer_load_dwordx4 v11, s[32:35], s72 offen offset:0 sc1 lds
  v_cvt_pk_bf16_f32 v48, v16, v17
  v_mfma_f32_16x16x32_bf16 v[44:47], a[20:23], a[180:183], v[44:47]
  v_exp_f32 v19, v19
  s_waitcnt lgkmcnt(9)
  v_pk_add_f32 v[152:153], v[152:153], v[88:89]
  v_pk_add_f32 v[154:155], v[154:155], v[90:91]
  ds_write_b128 v14, v[124:127] offset:33792
  v_mov_b32_sdwa v149, v220 dst_sel:BYTE_0 dst_unused:UNUSED_PRESERVE src0_sel:BYTE_1
  v_mfma_f32_16x16x32_bf16 v[36:39], a[16:19], a[160:163], 0
  v_exp_f32 v24, v24
  v_mfma_f32_16x16x32_bf16 v[36:39], a[20:23], a[164:167], v[36:39]
  ds_read_b128 a[16:19], v1 offset:4096
  buffer_load_dwordx4 v11, s[32:35], s72 offen offset:1024 sc1 lds
  v_cvt_pk_bf16_f32 v49, v18, v19
  v_mfma_f32_16x16x32_bf16 v[36:39], a[24:27], a[168:171], v[36:39]
  v_exp_f32 v25, v25
  s_waitcnt lgkmcnt(10)
  v_pk_add_f32 v[156:157], v[156:157], v[92:93]
  v_pk_add_f32 v[158:159], v[158:159], v[94:95]
  ds_write_b128 v14, v[128:131] offset:34816
  v_mov_b32_sdwa v150, v220 dst_sel:BYTE_0 dst_unused:UNUSED_PRESERVE src0_sel:BYTE_2
  v_mfma_f32_16x16x32_bf16 v[36:39], a[28:31], a[172:175], v[36:39]
  v_exp_f32 v26, v26
  ds_read_b128 a[20:23], v1 offset:5120
  v_mfma_f32_16x16x32_bf16 v[44:47], a[24:27], a[184:187], v[44:47]
  s_waitcnt lgkmcnt(11)
  v_pk_add_f32 v[160:161], v[160:161], v[96:97]
  v_pk_add_f32 v[162:163], v[162:163], v[98:99]
  ds_write_b128 v14, v[132:135] offset:35840
  v_mov_b32_sdwa v151, v220 dst_sel:BYTE_0 dst_unused:UNUSED_PRESERVE src0_sel:BYTE_3
  v_cvt_pk_bf16_f32 v52, v24, v25
  v_mfma_f32_16x16x32_bf16 v[44:47], a[28:31], a[188:191], v[44:47]
  v_exp_f32 v27, v27
  ds_read_b128 a[24:27], v1 offset:6144
  v_mfma_f32_16x16x32_bf16 v[40:43], a[8:11], a[184:187], v[40:43]
  v_exp_f32 v20, v20
  ds_read_b128 a[28:31], v1 offset:7168
  v_mfma_f32_16x16x32_bf16 v[40:43], a[12:15], a[188:191], v[40:43]
  v_exp_f32 v21, v21
  s_waitcnt lgkmcnt(13)
  v_pk_add_f32 v[164:165], v[164:165], v[100:101]
  v_pk_add_f32 v[166:167], v[166:167], v[102:103]
  ds_write_b128 v14, v[136:139] offset:49152
  v_mov_b32_sdwa v71, v116 dst_sel:BYTE_0 dst_unused:UNUSED_PAD src0_sel:BYTE_0
  v_mfma_f32_16x16x32_bf16 v[32:35], a[8:11], a[168:171], v[32:35]
  s_waitcnt lgkmcnt(13)
  v_pk_add_f32 v[168:169], v[168:169], v[104:105]
  v_pk_add_f32 v[170:171], v[170:171], v[106:107]
  ds_write_b128 v14, v[140:143] offset:50176
  v_mov_b32_sdwa v71, v117 dst_sel:BYTE_1 dst_unused:UNUSED_PRESERVE src0_sel:BYTE_0
  v_cvt_pk_bf16_f32 v53, v26, v27
  v_cvt_pk_bf16_f32 v50, v20, v21
  v_mfma_f32_16x16x32_bf16 v[32:35], a[12:15], a[172:175], v[32:35]
  v_exp_f32 v22, v22
  ds_read_b128 a[8:11], v1 offset:2048
  v_mfma_f32_16x16x32_bf16 v[184:187], a[32:35], v[60:63], v[184:187]
  v_exp_f32 v23, v23
  ds_read_b128 a[12:15], v1 offset:3072
  v_mfma_f32_16x16x32_bf16 v[188:191], a[36:39], v[60:63], v[188:191]
  buffer_load_dwordx4 v11, s[32:35], s72 offen offset:2048 sc1 lds
  v_cvt_pk_bf16_f32 v51, v22, v23
  v_mfma_f32_16x16x32_bf16 v[192:195], a[40:43], v[60:63], v[192:195]
  v_exp_f32 v28, v28
  s_waitcnt lgkmcnt(15)
  v_pk_add_f32 v[172:173], v[172:173], v[108:109]
  v_pk_add_f32 v[174:175], v[174:175], v[110:111]
  ds_write_b128 v14, v[144:147] offset:51200
  v_mov_b32_sdwa v71, v118 dst_sel:BYTE_2 dst_unused:UNUSED_PRESERVE src0_sel:BYTE_0
  v_mfma_f32_16x16x32_bf16 v[196:199], a[44:47], v[60:63], v[196:199]
  v_exp_f32 v29, v29
  s_waitcnt lgkmcnt(15)
  v_pk_add_f32 v[176:177], v[176:177], v[112:113]
  v_pk_add_f32 v[178:179], v[178:179], v[114:115]
  ds_write_b128 v14, v[148:151] offset:52224
  v_mov_b32_sdwa v71, v119 dst_sel:BYTE_3 dst_unused:UNUSED_PRESERVE src0_sel:BYTE_0
  v_mfma_f32_16x16x32_bf16 v[200:203], a[48:51], v[60:63], v[200:203]
  buffer_load_dwordx4 v11, s[32:35], s72 offen offset:3072 sc1 lds
  v_cvt_pk_bf16_f32 v54, v28, v29
  v_mfma_f32_16x16x32_bf16 v[204:207], a[52:55], v[60:63], v[204:207]
  v_exp_f32 v30, v30
  s_add_u32 s72, s72, 16384
  s_mov_b32 m0, s75
  s_add_u32 s75, s75, 32768
  s_and_b32 s75, s75, 0x1ffff
  v_mfma_f32_16x16x32_bf16 v[208:211], a[56:59], v[60:63], v[208:211]
  v_exp_f32 v31, v31
  v_add_u32 v1, s75, v2
  v_add_f32 v224, v224, v71
  v_mfma_f32_16x16x32_bf16 v[212:215], a[60:63], v[60:63], v[212:215]
  v_cvt_pk_bf16_f32 v55, v30, v31
  v_mfma_f32_16x16x32_bf16 v[228:231], a[192:195], v[60:63], v[228:231]
  s_cmp_lg_u32 s43, 0
  s_cbranch_scc1 L_j_h
  s_and_b32 s39, s43, 1
  s_mul_i32 s74, s39, 65536
  s_lshl_b32 s39, s39, 16
  s_add_u32 s73, s41, s39
  s_sub_u32 s74, s41, s74
  s_add_u32 s39, s39, 32768
  s_lshl_b32 s40, s37, 13
  s_add_u32 s40, s40, s39
  s_lshl_b32 s82, s38, 7
  s_add_u32 s82, s82, s39
  v_add_u32 v240, 743424, v10
  v_lshrrev_b32 v12, 4, v0
  v_bfe_u32 v13, v0, 1, 3
  v_xor_b32 v13, v13, v12
  v_and_b32 v246, 16, v10
  v_lshl_or_b32 v13, v13, 5, v246
  v_mul_u32_u24 v12, 1280, v12
  v_add_u32 v241, v12, v13
  v_xor_b32 v13, 128, v13
  v_add_u32 v12, 4096, v12
  v_add_u32 v242, v12, v13
  v_add_u32 v243, 8192, v241
  v_add_u32 v244, 8192, v242
  v_add_u32 v233, s40, v10
  v_lshrrev_b32 v12, 2, v0
  v_and_b32 v13, 7, v12
  v_lshlrev_b32 v13, 5, v13
  v_lshl_or_b32 v12, v12, 8, v13
  v_and_b32 v13, 3, v0
  v_lshl_or_b32 v12, v13, 3, v12
  v_xor_b32 v252, s82, v12
  v_xor_b32 v253, 32, v252
  v_xor_b32 v254, 64, v252
  v_xor_b32 v255, 96, v252
  v_mul_u32_u24 v66, 320, v247
  v_and_b32 v13, 16, v0
  v_lshl_add_u32 v66, v13, 1, v66
  v_lshrrev_b32 v13, 5, v0
  v_lshl_add_u32 v66, v13, 4, v66
  s_mov_b32 s8, s22
  s_mov_b32 s9, s23
  s_mov_b32 s10, 2211840
  v_add_f32 v72, 0x0, v239
  v_add_f32 v73, 0xef800000, v239
  v_add_f32 v74, 0xf0000000, v239
  v_add_f32 v75, 0xf0400000, v239
  v_add_f32 v76, 0xf1800000, v239
  v_add_f32 v77, 0xf1880000, v239
  v_add_f32 v78, 0xf1900000, v239
  v_add_f32 v79, 0xf1980000, v239
  v_min_f32 v72, 0, v72
  v_min_f32 v73, 0, v73
  v_min_f32 v74, 0, v74
  v_min_f32 v75, 0, v75
  v_min_f32 v76, 0, v76
  v_min_f32 v77, 0, v77
  v_min_f32 v78, 0, v78
  v_min_f32 v79, 0, v79
  s_waitcnt vmcnt(0) lgkmcnt(0)
L_chk_r0:
  v_min_u32 v246, v248, v249
  v_min3_u32 v246, v246, v250, v251
  v_cmp_eq_u32 vcc, 0, v246
  s_cbranch_vccnz L_spin_r0
  v_cmp_gt_u32 vcc, 0x100000, v69
  s_cbranch_vccnz L_spin_r0
L_go_r0:
  s_barrier
  v_mfma_f32_16x16x32_bf16 v[16:19], a[0:3], a[96:99], v[72:75]
  ds_read_b128 a[32:35], v1 offset:16384
  ds_read_b128 a[36:39], v1 offset:17408
  v_readfirstlane_b32 s82, v68
  v_and_b32 v237, 7, v0
  v_mfma_f32_16x16x32_bf16 v[16:19], a[4:7], a[100:103], v[16:19]
  ds_read_b128 v[116:119], v15 offset:52224
  v_exp_f32 v32, v32
  ds_read_b128 a[40:43], v1 offset:18432
  v_mfma_f32_16x16x32_bf16 v[24:27], a[0:3], a[112:115], 0
  s_mov_b32 s83, 0x76352410
  v_subrev_u32 v234, s82, v68
  ds_read_b128 a[44:47], v1 offset:19456
  v_lshl_or_b32 v234, v234, 3, v237
  v_mfma_f32_16x16x32_bf16 v[24:27], a[4:7], a[116:119], v[24:27]
  ds_read_b128 v[88:91], v15 offset:32768
  v_exp_f32 v33, v33
  v_mov_b32 v235, 0
  v_mfma_f32_16x16x32_bf16 v[28:31], a[16:19], a[112:115], 0
  ds_read_b128 a[48:51], v1 offset:20480
  s_and_b32 s84, s2, 7
  v_sub_u32_dpp v238, v234, v234 row_ror:1 row_mask:0xf bank_mask:0xf
  v_cvt_pk_bf16_f32 v56, v32, v33
  v_mfma_f32_16x16x32_bf16 v[28:31], a[20:23], a[116:119], v[28:31]
  ds_read_b128 v[92:95], v15 offset:33792
  v_exp_f32 v34, v34
  ds_read_b128 a[52:55], v1 offset:21504
  v_mfma_f32_16x16x32_bf16 v[20:23], a[16:19], a[96:99], v[76:79]
  v_alignbit_b32 v235, v235, v238, 31
  ds_read_b128 a[56:59], v1 offset:22528
  v_sub_u32_dpp v238, v234, v234 row_ror:2 row_mask:0xf bank_mask:0xf
  v_alignbit_b32 v235, v235, v238, 31
  v_mfma_f32_16x16x32_bf16 v[20:23], a[20:23], a[100:103], v[20:23]
  ds_read_b128 v[96:99], v15 offset:34816
  v_exp_f32 v35, v35
  ds_read_b128 a[60:63], v1 offset:23552
  v_mfma_f32_16x16x32_bf16 v[20:23], a[24:27], a[104:107], v[20:23]
  v_sub_u32_dpp v238, v234, v234 row_ror:3 row_mask:0xf bank_mask:0xf
  v_alignbit_b32 v235, v235, v238, 31
  ds_read_b128 v[100:103], v15 offset:35840
  v_cvt_pk_bf16_f32 v57, v34, v35
  v_mfma_f32_16x16x32_bf16 v[20:23], a[28:31], a[108:111], v[20:23]
  ds_read_b128 v[104:107], v15 offset:49152
  v_exp_f32 v40, v40
  v_sub_u32_dpp v238, v234, v234 row_ror:4 row_mask:0xf bank_mask:0xf
  v_mfma_f32_16x16x32_bf16 v[28:31], a[24:27], a[120:123], v[28:31]
  v_alignbit_b32 v235, v235, v238, 31
  v_sub_u32_dpp v238, v234, v234 row_ror:5 row_mask:0xf bank_mask:0xf
  v_alignbit_b32 v235, v235, v238, 31
  v_sub_u32_dpp v238, v234, v234 row_ror:6 row_mask:0xf bank_mask:0xf
  v_mfma_f32_16x16x32_bf16 v[28:31], a[28:31], a[124:127], v[28:31]
  ds_read_b128 v[108:111], v15 offset:50176
  v_exp_f32 v41, v41
  v_alignbit_b32 v235, v235, v238, 31
  v_mfma_f32_16x16x32_bf16 v[24:27], a[8:11], a[120:123], v[24:27]
  v_sub_u32_dpp v238, v234, v234 row_ror:7 row_mask:0xf bank_mask:0xf
  v_alignbit_b32 v235, v235, v238, 31
  ds_read_b128 v[112:115], v15 offset:51200
  v_cvt_pk_bf16_f32 v60, v40, v41
  v_mfma_f32_16x16x32_bf16 v[24:27], a[12:15], a[124:127], v[24:27]
  v_exp_f32 v42, v42
  v_bcnt_u32_b32 v235, v235, 0
  v_lshlrev_b32 v235, 2, v235
  v_mfma_f32_16x16x32_bf16 v[16:19], a[8:11], a[104:107], v[16:19]
  v_lshlrev_b32 v237, v235, v237
  v_bfe_u32 v236, s83, v235, 3
  s_nop 0
  v_or_b32_dpp v237, v237, v237 row_ror:1 row_mask:0xf bank_mask:0xf
  v_mfma_f32_16x16x32_bf16 v[16:19], a[12:15], a[108:111], v[16:19]
  v_exp_f32 v43, v43
  v_readlane_b32 s82, v236, s84
  s_lshl_b32 s39, s82, 2
  s_waitcnt lgkmcnt(4)
  v_mov_b32_sdwa v71, v116 dst_sel:BYTE_0 dst_unused:UNUSED_PAD src0_sel:BYTE_0
  v_pk_add_f32 v[212:213], v[212:213], v[116:117]
  v_mov_b32_sdwa v71, v117 dst_sel:BYTE_1 dst_unused:UNUSED_PRESERVE src0_sel:BYTE_0
  v_pk_add_f32 v[214:215], v[214:215], v[118:119]
  v_mov_b32_sdwa v71, v118 dst_sel:BYTE_2 dst_unused:UNUSED_PRESERVE src0_sel:BYTE_0
  v_pk_add_f32 v[184:185], v[184:185], v[88:89]
  v_mov_b32_sdwa v71, v119 dst_sel:BYTE_3 dst_unused:UNUSED_PRESERVE src0_sel:BYTE_0
  v_pk_add_f32 v[186:187], v[186:187], v[90:91]
  v_pk_add_f32 v[188:189], v[188:189], v[92:93]
  v_pk_add_f32 v[190:191], v[190:191], v[94:95]
  v_pk_add_f32 v[192:193], v[192:193], v[96:97]
  v_pk_add_f32 v[194:195], v[194:195], v[98:99]
  s_waitcnt lgkmcnt(3)
  v_pk_add_f32 v[196:197], v[196:197], v[100:101]
  v_pk_add_f32 v[198:199], v[198:199], v[102:103]
  s_waitcnt lgkmcnt(2)
  v_pk_add_f32 v[200:201], v[200:201], v[104:105]
  v_pk_add_f32 v[202:203], v[202:203], v[106:107]
  s_waitcnt lgkmcnt(1)
  v_pk_add_f32 v[204:205], v[204:205], v[108:109]
  v_pk_add_f32 v[206:207], v[206:207], v[110:111]
  s_waitcnt lgkmcnt(0)
  v_pk_add_f32 v[208:209], v[208:209], v[112:113]
  v_pk_add_f32 v[210:211], v[210:211], v[114:115]
  v_add_f32 v228, v228, v71
  s_nop 1
  v_mfma_f32_16x16x32_bf16 v[88:91], a[32:35], v[48:51], 0
  v_or_b32_dpp v237, v237, v237 row_ror:2 row_mask:0xf bank_mask:0xf
  s_lshr_b32 s28, s28, s39
  v_cvt_pk_bf16_f32 v61, v42, v43
  v_mfma_f32_16x16x32_bf16 v[120:123], a[32:35], v[52:55], 0
  v_exp_f32 v36, v36
  s_and_b32 s28, s28, 7
  v_or_b32_dpp v237, v237, v237 row_ror:4 row_mask:0xf bank_mask:0xf
  v_mfma_f32_16x16x32_bf16 v[92:95], a[36:39], v[48:51], 0
  s_mul_i32 s39, s82, 6
  v_mfma_f32_16x16x32_bf16 v[124:127], a[36:39], v[52:55], 0
  v_exp_f32 v37, v37
  s_add_u32 s39, s39, s28
  s_lshr_b32 s40, s39, 4
  v_mfma_f32_16x16x32_bf16 v[96:99], a[40:43], v[48:51], 0
  s_sub_u32 s39, s39, s40
  s_sub_u32 s39, s39, s40
  v_cvt_pk_bf16_f32 v58, v36, v37
  v_mfma_f32_16x16x32_bf16 v[128:131], a[40:43], v[52:55], 0
  v_exp_f32 v38, v38
  s_and_b32 s29, s39, 15
  s_mul_i32 s39, s29, 20
  v_mfma_f32_16x16x32_bf16 v[100:103], a[44:47], v[48:51], 0
  s_add_u32 s30, s30, s39
  s_mul_i32 s39, s29, 163840
  v_mfma_f32_16x16x32_bf16 v[132:135], a[44:47], v[52:55], 0
  v_exp_f32 v39, v39
  s_add_u32 s31, s31, s39
  v_mfma_f32_16x16x32_bf16 v[104:107], a[48:51], v[48:51], 0
  s_mul_i32 s39, s29, 1490944
  s_add_u32 s20, s20, s39
  v_cvt_pk_bf16_f32 v59, v38, v39
  v_mfma_f32_16x16x32_bf16 v[136:139], a[48:51], v[52:55], 0
  v_exp_f32 v44, v44
  s_lshl_b32 s39, s82, 3
  s_lshr_b64 s[56:57], s[56:57], s39
  v_mfma_f32_16x16x32_bf16 v[108:111], a[52:55], v[48:51], 0
  s_and_b32 s5, s56, 31
  s_bfe_u32 s4, s56, 0x30005
  v_mfma_f32_16x16x32_bf16 v[140:143], a[52:55], v[52:55], 0
  v_exp_f32 v45, v45
  s_mul_i32 s13, s5, 81920
  s_add_u32 s13, s13, s25
  v_mfma_f32_16x16x32_bf16 v[112:115], a[56:59], v[48:51], 0
  s_lshl_b32 s12, s5, 11
  v_cvt_pk_bf16_f32 v62, v44, v45
  v_mfma_f32_16x16x32_bf16 v[144:147], a[56:59], v[52:55], 0
  v_exp_f32 v46, v46
  s_add_u32 s12, s12, s20
  s_add_u32 s12, s12, 131072
  v_mfma_f32_16x16x32_bf16 v[116:119], a[60:63], v[48:51], 0
  s_cmp_lt_u32 s28, 6
  s_cselect_b32 s28, s40, 3
  s_cselect_b32 s12, s12, 1073741824
  s_cselect_b32 s13, s13, 1073741824
  v_mfma_f32_16x16x32_bf16 v[148:151], a[60:63], v[52:55], 0
  v_exp_f32 v47, v47
  v_readfirstlane_b32 s81, v237
  s_lshl_b32 s59, s29, 2
  v_mfma_f32_16x16x32_bf16 v[216:219], a[192:195], v[48:51], 0
  s_add_u32 s55, s59, s36
  s_add_u32 s59, s59, s37
  v_cvt_pk_bf16_f32 v63, v46, v47
  v_mfma_f32_16x16x32_bf16 v[220:223], a[192:195], v[52:55], 0
  s_lshl_b32 s59, s59, 7
  v_mfma_f32_16x16x32_bf16 v[32:35], a[0:3], a[160:163], 0
  s_add_u32 s59, s59, 83886080
  s_lshl_b32 s55, s55, 7
  v_mfma_f32_16x16x32_bf16 v[32:35], a[4:7], a[164:167], v[32:35]
  v_exp_f32 v16, v16
  s_add_u32 s55, s55, 84938752
  s_add_u32 m0, s73, 32768
  v_mfma_f32_16x16x32_bf16 v[40:43], a[0:3], a[176:179], 0
  s_mov_b32 s51, 0
  v_mfma_f32_16x16x32_bf16 v[40:43], a[4:7], a[180:183], v[40:43]
  v_exp_f32 v17, v17
  s_cmp_ge_u32 s29, 6
  s_cselect_b32 s82, 1, 0
  v_mfma_f32_16x16x32_bf16 v[44:47], a[16:19], a[176:179], 0
  ds_read_b128 a[0:3], v1 offset:0
  ds_read_b128 a[4:7], v1 offset:1024
  s_add_u32 s84, s82, 6
  v_cvt_pk_bf16_f32 v48, v16, v17
  v_mfma_f32_16x16x32_bf16 v[44:47], a[20:23], a[180:183], v[44:47]
  v_exp_f32 v18, v18
  buffer_load_dwordx4 v10, s[32:35], s12 offen offset:0 sc1 lds
  v_mfma_f32_16x16x32_bf16 v[36:39], a[16:19], a[160:163], 0
  s_cmp_ge_u32 s29, 12
  s_cselect_b32 s82, 2, s82
  s_cselect_b32 s84, 5, s84
  s_add_u32 s83, s82, 3
  v_mfma_f32_16x16x32_bf16 v[36:39], a[20:23], a[164:167], v[36:39]
  v_exp_f32 v19, v19
  s_cmp_ge_u32 s29, 14
  s_cselect_b32 s83, 2, s83
  v_mfma_f32_16x16x32_bf16 v[36:39], a[24:27], a[168:171], v[36:39]
  ds_read_b128 a[16:19], v1 offset:4096
  v_cmp_eq_u32 vcc, s82, v236
  ds_read_b128 a[20:23], v1 offset:5120
  v_cvt_pk_bf16_f32 v49, v18, v19
  v_mfma_f32_16x16x32_bf16 v[36:39], a[28:31], a[172:175], v[36:39]
  v_exp_f32 v24, v24
  buffer_load_dwordx4 v10, s[32:35], s12 offen offset:1024 sc1 lds
  v_mfma_f32_16x16x32_bf16 v[44:47], a[24:27], a[184:187], v[44:47]
  s_ff1_i32_b32 s82, vcc_lo
  v_readlane_b32 s82, v234, s82
  v_cmp_eq_u32 vcc, s83, v236
  v_mfma_f32_16x16x32_bf16 v[44:47], a[28:31], a[188:191], v[44:47]
  v_exp_f32 v25, v25
  buffer_load_dwordx4 v240, s[32:35], s12 offen offset:2048 sc1 lds
  v_mfma_f32_16x16x32_bf16 v[40:43], a[8:11], a[184:187], v[40:43]
  ds_read_b128 a[24:27], v1 offset:6144
  s_ff1_i32_b32 s83, vcc_lo
  v_readlane_b32 s83, v234, s83
  v_cvt_pk_bf16_f32 v52, v24, v25
  v_mfma_f32_16x16x32_bf16 v[40:43], a[12:15], a[188:191], v[40:43]
  v_exp_f32 v26, v26
  ds_read_b128 a[28:31], v1 offset:7168
  v_cmp_eq_u32 vcc, s84, v236
  v_mfma_f32_16x16x32_bf16 v[32:35], a[8:11], a[168:171], v[32:35]
  s_ff1_i32_b32 s84, vcc_lo
  buffer_load_dwordx4 v240, s[32:35], s12 offen offset:3072 sc1 lds
  v_readlane_b32 s84, v234, s84
  v_mfma_f32_16x16x32_bf16 v[32:35], a[12:15], a[172:175], v[32:35]
  v_exp_f32 v27, v27
  ds_read_b128 a[8:11], v1 offset:2048
  s_add_u32 s83, s83, s82
  v_mfma_f32_16x16x32_bf16 v[152:155], a[32:35], v[56:59], v[152:155]
  ds_read_b128 a[12:15], v1 offset:3072
  s_add_u32 s83, s83, s84
  s_mul_i32 s82, s82, 3
  v_cvt_pk_bf16_f32 v53, v26, v27
  v_mfma_f32_16x16x32_bf16 v[184:187], a[32:35], v[60:63], v[184:187]
  v_exp_f32 v20, v20
  s_add_u32 m0, s73, 49152
  s_add_u32 s12, s12, 2048
  v_mfma_f32_16x16x32_bf16 v[156:159], a[36:39], v[56:59], v[156:159]
  s_sub_u32 s82, s83, s82
  s_mul_hi_i32 s82, s82, 19884107
  v_mfma_f32_16x16x32_bf16 v[188:191], a[36:39], v[60:63], v[188:191]
  v_exp_f32 v21, v21
  s_mov_b32 s6, 0x78897978
  v_mfma_f32_16x16x32_bf16 v[160:163], a[40:43], v[56:59], v[160:163]
  buffer_load_dwordx4 v241, s[8:11], s13 offen offset:0  lds
  s_mov_b32 s7, 0x78788979
  v_cvt_pk_bf16_f32 v50, v20, v21
  v_mfma_f32_16x16x32_bf16 v[192:195], a[40:43], v[60:63], v[192:195]
  v_exp_f32 v22, v22
  s_lshl_b32 s39, s29, 2
  v_mfma_f32_16x16x32_bf16 v[164:167], a[44:47], v[56:59], v[164:167]
  s_lshr_b64 s[6:7], s[6:7], s39
  s_and_b32 s6, s6, 15
  buffer_load_dwordx4 v242, s[8:11], s13 offen offset:1024  lds
  v_mfma_f32_16x16x32_bf16 v[196:199], a[44:47], v[60:63], v[196:199]
  v_exp_f32 v23, v23
  s_mul_i32 s6, s6, 76
  v_mfma_f32_16x16x32_bf16 v[168:171], a[48:51], v[56:59], v[168:171]
  s_add_u32 s82, s82, s6
  v_cvt_pk_bf16_f32 v51, v22, v23
  v_mfma_f32_16x16x32_bf16 v[200:203], a[48:51], v[60:63], v[200:203]
  v_exp_f32 v28, v28
  s_add_u32 s82, s82, 4981
  v_mfma_f32_16x16x32_bf16 v[172:175], a[52:55], v[56:59], v[172:175]
  buffer_load_dwordx4 v243, s[8:11], s13 offen offset:2048  lds
  s_ashr_i32 s82, s82, 8
  v_mfma_f32_16x16x32_bf16 v[204:207], a[52:55], v[60:63], v[204:207]
  v_exp_f32 v29, v29
  s_max_i32 s82, s82, 12
  s_min_i32 s82, s82, 26
  v_mfma_f32_16x16x32_bf16 v[176:179], a[56:59], v[56:59], v[176:179]
  s_mul_i32 s84, s84, 3
  buffer_load_dwordx4 v244, s[8:11], s13 offen offset:3072  lds
  v_cvt_pk_bf16_f32 v54, v28, v29
  v_mfma_f32_16x16x32_bf16 v[208:211], a[56:59], v[60:63], v[208:211]
  v_exp_f32 v30, v30
  s_sub_u32 s84, s83, s84
  v_mfma_f32_16x16x32_bf16 v[180:183], a[60:63], v[56:59], v[180:183]
  s_mul_hi_i32 s84, s84, 19884107
  v_mfma_f32_16x16x32_bf16 v[212:215], a[60:63], v[60:63], v[212:215]
  v_exp_f32 v31, v31
  v_xor_b32 v1, 8192, v1
  s_mov_b32 s6, 0x79789779
  v_mfma_f32_16x16x32_bf16 v[224:227], a[192:195], v[56:59], v[224:227]
  s_mov_b32 s7, 0x77997897
  s_add_u32 s13, s13, 81920
  v_cvt_pk_bf16_f32 v55, v30, v31
  v_mfma_f32_16x16x32_bf16 v[228:231], a[192:195], v[60:63], v[228:231]
  s_lshl_b32 s39, s29, 2
  s_waitcnt lgkmcnt(7)
  v_mfma_f32_16x16x32_bf16 v[24:27], a[0:3], a[112:115], v[80:83]
  ds_read_b128 a[32:35], v1 offset:16384
  ds_read_b128 a[36:39], v1 offset:17408
  s_lshr_b64 s[6:7], s[6:7], s39
  s_and_b32 s6, s6, 15
  s_mul_i32 s6, s6, 76
  s_waitcnt lgkmcnt(8)
  v_mfma_f32_16x16x32_bf16 v[24:27], a[4:7], a[116:119], v[24:27]
  v_exp_f32 v32, v32
  ds_read_b128 a[40:43], v1 offset:18432
  s_add_u32 s84, s84, s6
  s_add_u32 s84, s84, 4981
  s_waitcnt lgkmcnt(8)
  v_mfma_f32_16x16x32_bf16 v[28:31], a[16:19], a[112:115], v[84:87]
  v_exp_f32 v33, v33
  ds_read_b128 a[44:47], v1 offset:19456
  s_add_u32 m0, s41, 131072
  s_ashr_i32 s84, s84, 8
  s_waitcnt lgkmcnt(8)
  v_mfma_f32_16x16x32_bf16 v[28:31], a[20:23], a[116:119], v[28:31]
  s_max_i32 s84, s84, 12
  s_min_i32 s84, s84, 26
  ds_read_b128 a[48:51], v1 offset:20480
  s_sub_u32 s84, 64, s84
  v_cvt_pk_bf16_f32 v56, v32, v33
  s_waitcnt lgkmcnt(8)
  v_mfma_f32_16x16x32_bf16 v[28:31], a[24:27], a[120:123], v[28:31]
  v_exp_f32 v34, v34
  s_add_u32 s83, s82, 26
  ds_read_b128 a[52:55], v1 offset:21504
  s_min_i32 s84, s84, s83
  s_waitcnt lgkmcnt(8)
  v_mfma_f32_16x16x32_bf16 v[28:31], a[28:31], a[124:127], v[28:31]
  v_exp_f32 v35, v35
  s_add_u32 s83, s82, 12
  ds_read_b128 a[56:59], v1 offset:22528
  s_max_i32 s84, s84, s83
  s_waitcnt lgkmcnt(8)
  v_mfma_f32_16x16x32_bf16 v[24:27], a[8:11], a[120:123], v[24:27]
  buffer_load_dwordx4 v10, s[32:35], s12 offen offset:0 sc1 lds
  s_lshl_b32 s84, s84, 8
  s_or_b32 s82, s82, s84
  v_cvt_pk_bf16_f32 v57, v34, v35
  s_waitcnt lgkmcnt(7)
  v_mfma_f32_16x16x32_bf16 v[24:27], a[12:15], a[124:127], v[24:27]
  v_exp_f32 v40, v40
  ds_read_b128 a[60:63], v1 offset:23552
  s_lshr_b32 s83, s82, 1
  s_and_b32 s83, s83, 0x7f7f
  s_waitcnt lgkmcnt(7)
  v_mfma_f32_16x16x32_bf16 v[88:91], a[32:35], v[48:51], v[88:91]
  v_exp_f32 v41, v41
  s_sub_u32 s82, s82, s83
  s_lshl_b32 s82, s82, 8
  s_lshl_b32 s83, s83, 8
  v_mfma_f32_16x16x32_bf16 v[120:123], a[32:35], v[52:55], v[120:123]
  buffer_load_dwordx4 v10, s[32:35], s12 offen offset:1024 sc1 lds
  s_add_u32 s82, s82, 0x20000000
  s_add_u32 s83, s83, 0x40202020
  v_cvt_pk_bf16_f32 v60, v40, v41
  s_waitcnt lgkmcnt(6)
  v_mfma_f32_16x16x32_bf16 v[92:95], a[36:39], v[48:51], v[92:95]
  v_exp_f32 v42, v42
  s_lshl_b32 s39, s28, 3
  s_lshr_b32 s82, s82, s39
  s_lshr_b32 s83, s83, s39
  v_mfma_f32_16x16x32_bf16 v[124:127], a[36:39], v[52:55], v[124:127]
  v_exp_f32 v43, v43
  s_bfe_u32 s84, s82, 0x80008
  s_and_b32 s82, s82, 255
  s_sub_u32 s84, s84, s82
  s_waitcnt lgkmcnt(5)
  v_mfma_f32_16x16x32_bf16 v[96:99], a[40:43], v[48:51], v[96:99]
  s_bfe_u32 s29, s83, 0x80008
  buffer_load_dwordx4 v240, s[32:35], s12 offen offset:2048 sc1 lds
  s_and_b32 s83, s83, 255
  v_cvt_pk_bf16_f32 v61, v42, v43
  v_mfma_f32_16x16x32_bf16 v[128:131], a[40:43], v[52:55], v[128:131]
  v_exp_f32 v36, v36
  s_sub_u32 s29, s29, s83
  s_bfm_b32 s50, s84, s4
  s_sub_u32 s82, s82, s4
  s_waitcnt lgkmcnt(4)
  v_mfma_f32_16x16x32_bf16 v[100:103], a[44:47], v[48:51], v[100:103]
  v_exp_f32 v37, v37
  s_add_u32 s84, s84, s4
  s_sub_u32 s83, s83, s84
  v_cmp_gt_u32 vcc, s84, v0
  v_mfma_f32_16x16x32_bf16 v[132:135], a[44:47], v[52:55], v[132:135]
  buffer_load_dwordx4 v240, s[32:35], s12 offen offset:3072 sc1 lds
  v_add_u32 v12, s82, v0
  v_add_u32 v13, s83, v0
  v_cvt_pk_bf16_f32 v58, v36, v37
  s_waitcnt lgkmcnt(3)
  v_mfma_f32_16x16x32_bf16 v[104:107], a[48:51], v[48:51], v[104:107]
  v_exp_f32 v38, v38
  v_cndmask_b32 v12, v13, v12, vcc
  v_cmp_gt_u32 vcc, s4, v0
  v_lshrrev_b32 v13, 1, v12
  v_mfma_f32_16x16x32_bf16 v[136:139], a[48:51], v[52:55], v[136:139]
  v_exp_f32 v39, v39
  v_and_b32 v13, 28, v13
  v_bfe_u32 v13, s81, v13, 3
  v_and_b32 v12, 7, v12
  s_waitcnt lgkmcnt(2)
  v_mfma_f32_16x16x32_bf16 v[108:111], a[52:55], v[48:51], v[108:111]
  s_add_u32 m0, s41, 147456
  s_add_u32 s12, s12, 2048
  v_lshl_or_b32 v12, v13, 3, v12
  s_add_u32 s82, s5, 69
  v_cvt_pk_bf16_f32 v59, v38, v39
  v_mfma_f32_16x16x32_bf16 v[140:143], a[52:55], v[52:55], v[140:143]
  v_exp_f32 v44, v44
  v_add_u32 v13, s82, v0
  v_cndmask_b32 v12, v12, v13, vcc
  s_waitcnt lgkmcnt(1)
  v_mfma_f32_16x16x32_bf16 v[112:115], a[56:59], v[48:51], v[112:115]
  v_exp_f32 v45, v45
  s_add_u32 s82, s84, s29
  v_lshl_add_u32 v68, v12, 11, s20
  v_cmp_gt_u32 vcc, s82, v0
  v_mfma_f32_16x16x32_bf16 v[144:147], a[56:59], v[52:55], v[144:147]
  v_and_b32 v13, 63, v12
  v_mul_u32_u24 v13, 81920, v13
  v_cvt_pk_bf16_f32 v62, v44, v45
  s_waitcnt lgkmcnt(0)
  v_mfma_f32_16x16x32_bf16 v[116:119], a[60:63], v[48:51], v[116:119]
  v_exp_f32 v46, v46
  buffer_load_dwordx4 v241, s[8:11], s13 offen offset:0  lds
  v_add_u32 v69, s25, v13
  v_mfma_f32_16x16x32_bf16 v[148:151], a[60:63], v[52:55], v[148:151]
  v_exp_f32 v47, v47
  v_lshlrev_b32 v12, 1, v12
  v_and_b32 v70, 0x7c, v12
  v_cndmask_b32 v68, v245, v68, vcc
  v_mfma_f32_16x16x32_bf16 v[216:219], a[192:195], v[48:51], v[216:219]
  v_cndmask_b32 v69, v245, v69, vcc
  s_bfm_b32 s20, s29, s84
  s_sub_u32 s25, s84, 6
  v_cvt_pk_bf16_f32 v63, v46, v47
  v_mfma_f32_16x16x32_bf16 v[220:223], a[192:195], v[52:55], v[220:223]
  s_sub_u32 s25, s25, s4
  v_mfma_f32_16x16x32_bf16 v[32:35], a[0:3], a[160:163], 0
  v_mfma_f32_16x16x32_bf16 v[32:35], a[4:7], a[164:167], v[32:35]
  v_exp_f32 v24, v24
  buffer_load_dwordx4 v242, s[8:11], s13 offen offset:1024  lds
  v_mfma_f32_16x16x32_bf16 v[40:43], a[0:3], a[176:179], 0
  v_rcp_f32 v234, v216
  v_subrev_u32 v235, 0x1f800000, v216
  v_cmp_lt_u32 vcc, 0x40000000, v235
  v_mfma_f32_16x16x32_bf16 v[40:43], a[4:7], a[180:183], v[40:43]
  v_mul_f32 v234, v234, v3
  s_mov_b64 s[64:65], vcc
  buffer_load_dwordx4 v243, s[8:11], s13 offen offset:2048  lds
  v_mfma_f32_16x16x32_bf16 v[44:47], a[16:19], a[176:179], 0
  v_exp_f32 v25, v25
  v_mul_f32 v88, v88, v234
  v_mul_f32 v89, v89, v234
  v_mfma_f32_16x16x32_bf16 v[44:47], a[20:23], a[180:183], v[44:47]
  ds_read_b128 a[0:3], v1 offset:0
  ds_read_b128 a[4:7], v1 offset:1024
  v_mul_f32 v90, v90, v234
  v_cvt_pk_bf16_f32 v52, v24, v25
  v_mfma_f32_16x16x32_bf16 v[36:39], a[16:19], a[160:163], 0
  v_mul_f32 v91, v91, v234
  buffer_load_dwordx4 v244, s[8:11], s13 offen offset:3072  lds
  v_mul_f32 v92, v92, v234
  v_mfma_f32_16x16x32_bf16 v[36:39], a[20:23], a[164:167], v[36:39]
  v_exp_f32 v26, v26
  v_mul_f32 v93, v93, v234
  v_mul_f32 v94, v94, v234
  v_mfma_f32_16x16x32_bf16 v[36:39], a[24:27], a[168:171], v[36:39]
  ds_read_b128 a[16:19], v1 offset:4096
  s_add_u32 s13, s13, 81920
  v_mul_f32 v95, v95, v234
  v_cvt_pk_bf16_f32 v88, v88, v89
  v_mfma_f32_16x16x32_bf16 v[36:39], a[28:31], a[172:175], v[36:39]
  ds_read_b128 a[20:23], v1 offset:5120
  v_cvt_pk_bf16_f32 v89, v90, v91
  v_cvt_pk_bf16_f32 v90, v92, v93
  s_add_u32 m0, s74, 65536
  v_mfma_f32_16x16x32_bf16 v[44:47], a[24:27], a[184:187], v[44:47]
  v_exp_f32 v27, v27
  v_cvt_pk_bf16_f32 v91, v94, v95
  v_mfma_f32_16x16x32_bf16 v[44:47], a[28:31], a[188:191], v[44:47]
  buffer_store_dwordx4 v[88:91], v10, s[32:35], s68 offen offset:0 sc1
  v_mul_f32 v96, v96, v234
  v_cvt_pk_bf16_f32 v53, v26, v27
  v_mfma_f32_16x16x32_bf16 v[40:43], a[8:11], a[184:187], v[40:43]
  ds_read_b128 a[24:27], v1 offset:6144
  buffer_load_dwordx4 v10, s[32:35], s12 offen offset:0 sc1 lds
  v_mul_f32 v97, v97, v234
  v_mfma_f32_16x16x32_bf16 v[40:43], a[12:15], a[188:191], v[40:43]
  v_exp_f32 v28, v28
  v_mul_f32 v98, v98, v234
  ds_read_b128 a[28:31], v1 offset:7168
  v_mfma_f32_16x16x32_bf16 v[32:35], a[8:11], a[168:171], v[32:35]
  v_mul_f32 v99, v99, v234
  v_mul_f32 v100, v100, v234
  buffer_load_dwordx4 v10, s[32:35], s12 offen offset:1024 sc1 lds
  v_mfma_f32_16x16x32_bf16 v[32:35], a[12:15], a[172:175], v[32:35]
  v_mul_f32 v101, v101, v234
  v_mul_f32 v102, v102, v234
  v_mul_f32 v103, v103, v234
  ds_read_b128 a[8:11], v1 offset:2048
  v_mfma_f32_16x16x32_bf16 v[152:155], a[32:35], v[56:59], v[152:155]
  v_exp_f32 v29, v29
  v_cvt_pk_bf16_f32 v96, v96, v97
  v_cvt_pk_bf16_f32 v97, v98, v99
  v_mfma_f32_16x16x32_bf16 v[184:187], a[32:35], v[60:63], v[184:187]
  ds_read_b128 a[12:15], v1 offset:3072
  buffer_load_dwordx4 v240, s[32:35], s12 offen offset:2048 sc1 lds
  v_cvt_pk_bf16_f32 v54, v28, v29
  v_mfma_f32_16x16x32_bf16 v[156:159], a[36:39], v[56:59], v[156:159]
  v_cvt_pk_bf16_f32 v98, v100, v101
  v_cvt_pk_bf16_f32 v99, v102, v103
  buffer_store_dwordx4 v[96:99], v10, s[32:35], s68 offen offset:1024 sc1
  v_mfma_f32_16x16x32_bf16 v[188:191], a[36:39], v[60:63], v[188:191]
  v_exp_f32 v30, v30
  v_mul_f32 v104, v104, v234
  v_mul_f32 v105, v105, v234
  v_mfma_f32_16x16x32_bf16 v[160:163], a[40:43], v[56:59], v[160:163]
  buffer_load_dwordx4 v240, s[32:35], s12 offen offset:3072 sc1 lds
  v_mul_f32 v106, v106, v234
  v_mul_f32 v107, v107, v234
  v_mfma_f32_16x16x32_bf16 v[192:195], a[40:43], v[60:63], v[192:195]
  s_add_u32 m0, s74, 81920
  s_add_u32 s12, s12, 2048
  v_mul_f32 v108, v108, v234
  v_mul_f32 v109, v109, v234
  v_mfma_f32_16x16x32_bf16 v[164:167], a[44:47], v[56:59], v[164:167]
  v_exp_f32 v31, v31
  v_mul_f32 v110, v110, v234
  v_mul_f32 v111, v111, v234
  v_mfma_f32_16x16x32_bf16 v[196:199], a[44:47], v[60:63], v[196:199]
  buffer_load_dwordx4 v241, s[8:11], s13 offen offset:0  lds
  v_cvt_pk_bf16_f32 v104, v104, v105
  v_cvt_pk_bf16_f32 v55, v30, v31
  v_mfma_f32_16x16x32_bf16 v[168:171], a[48:51], v[56:59], v[168:171]
  v_cvt_pk_bf16_f32 v105, v106, v107
  v_cvt_pk_bf16_f32 v106, v108, v109
  buffer_load_dwordx4 v242, s[8:11], s13 offen offset:1024  lds
  v_mfma_f32_16x16x32_bf16 v[200:203], a[48:51], v[60:63], v[200:203]
  v_cvt_pk_bf16_f32 v107, v110, v111
  buffer_store_dwordx4 v[104:107], v10, s[32:35], s68 offen offset:2048 sc1
  v_mul_f32 v112, v112, v234
  v_mfma_f32_16x16x32_bf16 v[172:175], a[52:55], v[56:59], v[172:175]
  v_mul_f32 v113, v113, v234
  s_add_u32 s75, s75, 32768
  s_and_b32 s75, s75, 0x1ffff
  v_mul_f32 v114, v114, v234
  v_mfma_f32_16x16x32_bf16 v[204:207], a[52:55], v[60:63], v[204:207]
  buffer_load_dwordx4 v243, s[8:11], s13 offen offset:2048  lds
  v_mul_f32 v115, v115, v234
  v_mul_f32 v116, v116, v234
  v_mfma_f32_16x16x32_bf16 v[176:179], a[56:59], v[56:59], v[176:179]
  buffer_load_dwordx4 v244, s[8:11], s13 offen offset:3072  lds
  v_mul_f32 v117, v117, v234
  v_mul_f32 v118, v118, v234
  v_mfma_f32_16x16x32_bf16 v[208:211], a[56:59], v[60:63], v[208:211]
  v_mul_f32 v119, v119, v234
  v_cvt_pk_bf16_f32 v112, v112, v113
  v_mfma_f32_16x16x32_bf16 v[180:183], a[60:63], v[56:59], v[180:183]
  v_cvt_pk_bf16_f32 v113, v114, v115
  v_cvt_pk_bf16_f32 v114, v116, v117
  v_mfma_f32_16x16x32_bf16 v[212:215], a[60:63], v[60:63], v[212:215]
  v_add_u32 v1, s75, v2
  s_add_u32 s13, s13, 81920
  v_cvt_pk_bf16_f32 v115, v118, v119
  v_mfma_f32_16x16x32_bf16 v[224:227], a[192:195], v[56:59], v[224:227]
  buffer_store_dwordx4 v[112:115], v10, s[32:35], s68 offen offset:3072 sc1
  v_mfma_f32_16x16x32_bf16 v[228:231], a[192:195], v[60:63], v[228:231]
  s_branch L_j_t2
L_spin_r0:
  s_add_u32 s3, s3, 1
  s_cmp_gt_u32 s3, 0x10000
  s_cbranch_scc1 L_go_r0
  buffer_load_dwordx4 v[248:251], v10, s[32:35], s58 offen sc1
  buffer_load_dwordx2 v[68:69], v70, s[32:35], 0 offen sc1
  s_waitcnt vmcnt(0)
  s_branch L_chk_r0
L_spin_r:
  s_add_u32 s3, s3, 1
  s_cmp_gt_u32 s3, 0x10000
  s_cbranch_scc1 L_go_r
  buffer_load_dwordx4 v[248:251], v10, s[32:35], s58 offen sc1
  buffer_load_dwordx2 v[68:69], v70, s[32:35], 0 offen sc1
  s_waitcnt vmcnt(0)
  s_branch L_chk_r
L_j_h:
  s_waitcnt vmcnt(18) lgkmcnt(0)
  s_barrier
  v_mfma_f32_16x16x32_bf16 v[16:19], a[0:3], a[96:99], 0
  ds_read_b128 a[32:35], v1 offset:16384
  ds_read_b128 a[36:39], v1 offset:17408
  v_mfma_f32_16x16x32_bf16 v[16:19], a[4:7], a[100:103], v[16:19]
  ds_read_b128 v[116:119], v15 offset:52224
  v_exp_f32 v32, v32
  v_mfma_f32_16x16x32_bf16 v[24:27], a[0:3], a[112:115], 0
  ds_read_b128 a[40:43], v1 offset:18432
  ds_read_b128 a[44:47], v1 offset:19456
  v_mfma_f32_16x16x32_bf16 v[24:27], a[4:7], a[116:119], v[24:27]
  ds_read_b128 v[88:91], v15 offset:32768
  v_exp_f32 v33, v33
  v_mfma_f32_16x16x32_bf16 v[28:31], a[16:19], a[112:115], 0
  ds_read_b128 a[48:51], v1 offset:20480
  v_cvt_pk_bf16_f32 v56, v32, v33
  v_mfma_f32_16x16x32_bf16 v[28:31], a[20:23], a[116:119], v[28:31]
  ds_read_b128 v[92:95], v15 offset:33792
  v_exp_f32 v34, v34
  v_mfma_f32_16x16x32_bf16 v[20:23], a[16:19], a[96:99], 0
  ds_read_b128 a[52:55], v1 offset:21504
  ds_read_b128 a[56:59], v1 offset:22528
  v_mfma_f32_16x16x32_bf16 v[20:23], a[20:23], a[100:103], v[20:23]
  ds_read_b128 v[96:99], v15 offset:34816
  v_exp_f32 v35, v35
  v_mfma_f32_16x16x32_bf16 v[20:23], a[24:27], a[104:107], v[20:23]
  ds_read_b128 v[100:103], v15 offset:35840
  v_cvt_pk_bf16_f32 v57, v34, v35
  v_mfma_f32_16x16x32_bf16 v[20:23], a[28:31], a[108:111], v[20:23]
  ds_read_b128 v[104:107], v15 offset:49152
  v_exp_f32 v40, v40
  v_mfma_f32_16x16x32_bf16 v[28:31], a[24:27], a[120:123], v[28:31]
  buffer_load_dwordx4 v10, s[32:35], s72 offen offset:0 sc1 lds
  v_mfma_f32_16x16x32_bf16 v[28:31], a[28:31], a[124:127], v[28:31]
  ds_read_b128 v[108:111], v15 offset:50176
  v_exp_f32 v41, v41
  v_mfma_f32_16x16x32_bf16 v[24:27], a[8:11], a[120:123], v[24:27]
  ds_read_b128 v[112:115], v15 offset:51200
  v_cvt_pk_bf16_f32 v60, v40, v41
  v_mfma_f32_16x16x32_bf16 v[24:27], a[12:15], a[124:127], v[24:27]
  v_exp_f32 v42, v42
  v_mfma_f32_16x16x32_bf16 v[16:19], a[8:11], a[104:107], v[16:19]
  ds_read_b128 a[60:63], v1 offset:23552
  v_mfma_f32_16x16x32_bf16 v[16:19], a[12:15], a[108:111], v[16:19]
  v_exp_f32 v43, v43
  s_waitcnt lgkmcnt(0)
  v_mov_b32_sdwa v71, v116 dst_sel:BYTE_0 dst_unused:UNUSED_PAD src0_sel:BYTE_0
  v_pk_add_f32 v[212:213], v[212:213], v[116:117]
  v_mov_b32_sdwa v71, v117 dst_sel:BYTE_1 dst_unused:UNUSED_PRESERVE src0_sel:BYTE_0
  v_pk_add_f32 v[214:215], v[214:215], v[118:119]
  v_mov_b32_sdwa v71, v118 dst_sel:BYTE_2 dst_unused:UNUSED_PRESERVE src0_sel:BYTE_0
  v_pk_add_f32 v[184:185], v[184:185], v[88:89]
  v_mov_b32_sdwa v71, v119 dst_sel:BYTE_3 dst_unused:UNUSED_PRESERVE src0_sel:BYTE_0
  v_pk_add_f32 v[186:187], v[186:187], v[90:91]
  v_pk_add_f32 v[188:189], v[188:189], v[92:93]
  v_pk_add_f32 v[190:191], v[190:191], v[94:95]
  v_pk_add_f32 v[192:193], v[192:193], v[96:97]
  v_pk_add_f32 v[194:195], v[194:195], v[98:99]
  v_pk_add_f32 v[196:197], v[196:197], v[100:101]
  v_pk_add_f32 v[198:199], v[198:199], v[102:103]
  v_pk_add_f32 v[200:201], v[200:201], v[104:105]
  v_pk_add_f32 v[202:203], v[202:203], v[106:107]
  v_pk_add_f32 v[204:205], v[204:205], v[108:109]
  v_pk_add_f32 v[206:207], v[206:207], v[110:111]
  v_pk_add_f32 v[208:209], v[208:209], v[112:113]
  v_pk_add_f32 v[210:211], v[210:211], v[114:115]
  v_add_f32 v228, v228, v71
  s_nop 1
  v_mfma_f32_16x16x32_bf16 v[88:91], a[32:35], v[48:51], 0
  v_cvt_pk_bf16_f32 v61, v42, v43
  v_mfma_f32_16x16x32_bf16 v[120:123], a[32:35], v[52:55], 0
  v_exp_f32 v36, v36
  v_mfma_f32_16x16x32_bf16 v[92:95], a[36:39], v[48:51], 0
  v_mfma_f32_16x16x32_bf16 v[124:127], a[36:39], v[52:55], 0
  v_exp_f32 v37, v37
  v_mfma_f32_16x16x32_bf16 v[96:99], a[40:43], v[48:51], 0
  v_cvt_pk_bf16_f32 v58, v36, v37
  v_mfma_f32_16x16x32_bf16 v[128:131], a[40:43], v[52:55], 0
  v_exp_f32 v38, v38
  v_mfma_f32_16x16x32_bf16 v[100:103], a[44:47], v[48:51], 0
  buffer_load_dwordx4 v10, s[32:35], s72 offen offset:1024 sc1 lds
  v_mfma_f32_16x16x32_bf16 v[132:135], a[44:47], v[52:55], 0
  v_exp_f32 v39, v39
  v_mfma_f32_16x16x32_bf16 v[104:107], a[48:51], v[48:51], 0
  v_cvt_pk_bf16_f32 v59, v38, v39
  v_mfma_f32_16x16x32_bf16 v[136:139], a[48:51], v[52:55], 0
  v_exp_f32 v44, v44
  v_mfma_f32_16x16x32_bf16 v[108:111], a[52:55], v[48:51], 0
  v_mfma_f32_16x16x32_bf16 v[140:143], a[52:55], v[52:55], 0
  v_exp_f32 v45, v45
  v_mfma_f32_16x16x32_bf16 v[112:115], a[56:59], v[48:51], 0
  v_cvt_pk_bf16_f32 v62, v44, v45
  v_mfma_f32_16x16x32_bf16 v[144:147], a[56:59], v[52:55], 0
  v_exp_f32 v46, v46
  v_mfma_f32_16x16x32_bf16 v[116:119], a[60:63], v[48:51], 0
  v_mfma_f32_16x16x32_bf16 v[148:151], a[60:63], v[52:55], 0
  v_exp_f32 v47, v47
  v_mfma_f32_16x16x32_bf16 v[216:219], a[192:195], v[48:51], 0
  v_cvt_pk_bf16_f32 v63, v46, v47
  v_mfma_f32_16x16x32_bf16 v[220:223], a[192:195], v[52:55], 0
  v_mfma_f32_16x16x32_bf16 v[32:35], a[0:3], a[160:163], 0
  v_lshlrev_b32 v70, 3, v0
  v_mfma_f32_16x16x32_bf16 v[32:35], a[4:7], a[164:167], v[32:35]
  v_exp_f32 v16, v16
  v_mfma_f32_16x16x32_bf16 v[40:43], a[0:3], a[176:179], 0
  v_mfma_f32_16x16x32_bf16 v[40:43], a[4:7], a[180:183], v[40:43]
  v_exp_f32 v17, v17
  v_mfma_f32_16x16x32_bf16 v[44:47], a[16:19], a[176:179], 0
  v_and_b32 v70, 56, v70
  v_cvt_pk_bf16_f32 v48, v16, v17
  v_mfma_f32_16x16x32_bf16 v[44:47], a[20:23], a[180:183], v[44:47]
  v_exp_f32 v18, v18
  v_mfma_f32_16x16x32_bf16 v[36:39], a[16:19], a[160:163], 0
  ds_read_b128 a[0:3], v1 offset:0
  ds_read_b128 a[4:7], v1 offset:1024
  v_mfma_f32_16x16x32_bf16 v[36:39], a[20:23], a[164:167], v[36:39]
  v_exp_f32 v19, v19
  v_mfma_f32_16x16x32_bf16 v[36:39], a[24:27], a[168:171], v[36:39]
  v_add_u32 v70, 84946944, v70
  v_cvt_pk_bf16_f32 v49, v18, v19
  v_mfma_f32_16x16x32_bf16 v[36:39], a[28:31], a[172:175], v[36:39]
  v_exp_f32 v24, v24
  v_mfma_f32_16x16x32_bf16 v[44:47], a[24:27], a[184:187], v[44:47]
  buffer_load_dwordx4 v10, s[32:35], s72 offen offset:2048 sc1 lds
  v_mfma_f32_16x16x32_bf16 v[44:47], a[28:31], a[188:191], v[44:47]
  v_exp_f32 v25, v25
  v_mfma_f32_16x16x32_bf16 v[40:43], a[8:11], a[184:187], v[40:43]
  ds_read_b128 a[16:19], v1 offset:4096
  v_cvt_pk_bf16_f32 v52, v24, v25
  v_mfma_f32_16x16x32_bf16 v[40:43], a[12:15], a[188:191], v[40:43]
  v_exp_f32 v26, v26
  v_mfma_f32_16x16x32_bf16 v[32:35], a[8:11], a[168:171], v[32:35]
  ds_read_b128 a[20:23], v1 offset:5120
  s_lshl_b32 s58, s36, 10
  v_mfma_f32_16x16x32_bf16 v[32:35], a[12:15], a[172:175], v[32:35]
  v_exp_f32 v27, v27
  v_mfma_f32_16x16x32_bf16 v[152:155], a[32:35], v[56:59], v[152:155]
  ds_read_b128 a[24:27], v1 offset:6144
  v_cvt_pk_bf16_f32 v53, v26, v27
  v_mfma_f32_16x16x32_bf16 v[184:187], a[32:35], v[60:63], v[184:187]
  v_exp_f32 v20, v20
  v_mfma_f32_16x16x32_bf16 v[156:159], a[36:39], v[56:59], v[156:159]
  ds_read_b128 a[28:31], v1 offset:7168
  s_add_u32 s58, s58, 84934656
  v_mfma_f32_16x16x32_bf16 v[188:191], a[36:39], v[60:63], v[188:191]
  v_exp_f32 v21, v21
  v_mfma_f32_16x16x32_bf16 v[160:163], a[40:43], v[56:59], v[160:163]
  ds_read_b128 a[8:11], v1 offset:2048
  v_cvt_pk_bf16_f32 v50, v20, v21
  v_mfma_f32_16x16x32_bf16 v[192:195], a[40:43], v[60:63], v[192:195]
  v_exp_f32 v22, v22
  v_mfma_f32_16x16x32_bf16 v[164:167], a[44:47], v[56:59], v[164:167]
  buffer_load_dwordx4 v10, s[32:35], s72 offen offset:3072 sc1 lds
  v_mfma_f32_16x16x32_bf16 v[196:199], a[44:47], v[60:63], v[196:199]
  v_exp_f32 v23, v23
  v_mfma_f32_16x16x32_bf16 v[168:171], a[48:51], v[56:59], v[168:171]
  ds_read_b128 a[12:15], v1 offset:3072
  v_cvt_pk_bf16_f32 v51, v22, v23
  v_mfma_f32_16x16x32_bf16 v[200:203], a[48:51], v[60:63], v[200:203]
  v_exp_f32 v28, v28
  v_mfma_f32_16x16x32_bf16 v[172:175], a[52:55], v[56:59], v[172:175]
  s_and_b32 s39, s43, 1
  s_mul_i32 s74, s39, 65536
  v_mfma_f32_16x16x32_bf16 v[204:207], a[52:55], v[60:63], v[204:207]
  v_exp_f32 v29, v29
  v_mfma_f32_16x16x32_bf16 v[176:179], a[56:59], v[56:59], v[176:179]
  s_add_u32 m0, m0, 4096
  v_cvt_pk_bf16_f32 v54, v28, v29
  v_mfma_f32_16x16x32_bf16 v[208:211], a[56:59], v[60:63], v[208:211]
  v_exp_f32 v30, v30
  v_mfma_f32_16x16x32_bf16 v[180:183], a[60:63], v[56:59], v[180:183]
  s_lshl_b32 s39, s39, 16
  s_add_u32 s73, s41, s39
  v_mfma_f32_16x16x32_bf16 v[212:215], a[60:63], v[60:63], v[212:215]
  v_exp_f32 v31, v31
  v_mfma_f32_16x16x32_bf16 v[224:227], a[192:195], v[56:59], v[224:227]
  s_sub_u32 s74, s41, s74
  v_cvt_pk_bf16_f32 v55, v30, v31
  v_mfma_f32_16x16x32_bf16 v[228:231], a[192:195], v[60:63], v[228:231]
  v_xor_b32 v1, 8192, v1
  s_waitcnt lgkmcnt(7)
  v_mfma_f32_16x16x32_bf16 v[16:19], a[0:3], a[96:99], 0
  ds_read_b128 a[32:35], v1 offset:16384
  ds_read_b128 a[36:39], v1 offset:17408
  s_waitcnt lgkmcnt(8)
  v_mfma_f32_16x16x32_bf16 v[16:19], a[4:7], a[100:103], v[16:19]
  v_exp_f32 v32, v32
  v_mfma_f32_16x16x32_bf16 v[24:27], a[0:3], a[112:115], 0
  ds_read_b128 a[40:43], v1 offset:18432
  ds_read_b128 a[44:47], v1 offset:19456
  v_mfma_f32_16x16x32_bf16 v[24:27], a[4:7], a[116:119], v[24:27]
  v_exp_f32 v33, v33
  s_waitcnt lgkmcnt(9)
  v_mfma_f32_16x16x32_bf16 v[28:31], a[16:19], a[112:115], 0
  ds_read_b128 a[48:51], v1 offset:20480
  v_cvt_pk_bf16_f32 v56, v32, v33
  s_waitcnt lgkmcnt(9)
  v_mfma_f32_16x16x32_bf16 v[28:31], a[20:23], a[116:119], v[28:31]
  v_exp_f32 v34, v34
  v_mfma_f32_16x16x32_bf16 v[20:23], a[16:19], a[96:99], 0
  ds_read_b128 a[52:55], v1 offset:21504
  ds_read_b128 a[56:59], v1 offset:22528
  v_mfma_f32_16x16x32_bf16 v[20:23], a[20:23], a[100:103], v[20:23]
  v_exp_f32 v35, v35
  s_waitcnt lgkmcnt(10)
  v_mfma_f32_16x16x32_bf16 v[20:23], a[24:27], a[104:107], v[20:23]
  ds_read_b128 a[60:63], v1 offset:23552
  v_cvt_pk_bf16_f32 v57, v34, v35
  s_waitcnt lgkmcnt(10)
  v_mfma_f32_16x16x32_bf16 v[20:23], a[28:31], a[108:111], v[20:23]
  v_exp_f32 v40, v40
  v_mfma_f32_16x16x32_bf16 v[28:31], a[24:27], a[120:123], v[28:31]
  buffer_load_dwordx4 v11, s[32:35], s72 offen offset:0 sc1 lds
  v_mfma_f32_16x16x32_bf16 v[28:31], a[28:31], a[124:127], v[28:31]
  v_exp_f32 v41, v41
  s_waitcnt lgkmcnt(9)
  v_mfma_f32_16x16x32_bf16 v[24:27], a[8:11], a[120:123], v[24:27]
  s_add_u32 s39, s39, 32768
  v_cvt_pk_bf16_f32 v60, v40, v41
  s_waitcnt lgkmcnt(8)
  v_mfma_f32_16x16x32_bf16 v[24:27], a[12:15], a[124:127], v[24:27]
  v_exp_f32 v42, v42
  v_mfma_f32_16x16x32_bf16 v[16:19], a[8:11], a[104:107], v[16:19]
  s_lshl_b32 s40, s37, 13
  s_add_u32 s40, s40, s39
  v_mfma_f32_16x16x32_bf16 v[16:19], a[12:15], a[108:111], v[16:19]
  v_exp_f32 v43, v43
  s_waitcnt lgkmcnt(0)
  v_mfma_f32_16x16x32_bf16 v[88:91], a[32:35], v[48:51], v[88:91]
  s_lshl_b32 s82, s38, 7
  v_cvt_pk_bf16_f32 v61, v42, v43
  v_mfma_f32_16x16x32_bf16 v[120:123], a[32:35], v[52:55], v[120:123]
  v_exp_f32 v36, v36
  v_mfma_f32_16x16x32_bf16 v[92:95], a[36:39], v[48:51], v[92:95]
  s_add_u32 s82, s82, s39
  v_mfma_f32_16x16x32_bf16 v[124:127], a[36:39], v[52:55], v[124:127]
  v_exp_f32 v37, v37
  v_mfma_f32_16x16x32_bf16 v[96:99], a[40:43], v[48:51], v[96:99]
  v_add_u32 v240, 743424, v10
  v_cvt_pk_bf16_f32 v58, v36, v37
  v_mfma_f32_16x16x32_bf16 v[128:131], a[40:43], v[52:55], v[128:131]
  v_exp_f32 v38, v38
  v_mfma_f32_16x16x32_bf16 v[100:103], a[44:47], v[48:51], v[100:103]
  buffer_load_dwordx4 v11, s[32:35], s72 offen offset:1024 sc1 lds
  v_mfma_f32_16x16x32_bf16 v[132:135], a[44:47], v[52:55], v[132:135]
  v_exp_f32 v39, v39
  v_mfma_f32_16x16x32_bf16 v[104:107], a[48:51], v[48:51], v[104:107]
  v_lshrrev_b32 v12, 4, v0
  v_cvt_pk_bf16_f32 v59, v38, v39
  v_mfma_f32_16x16x32_bf16 v[136:139], a[48:51], v[52:55], v[136:139]
  v_exp_f32 v44, v44
  v_mfma_f32_16x16x32_bf16 v[108:111], a[52:55], v[48:51], v[108:111]
  v_bfe_u32 v13, v0, 1, 3
  v_mfma_f32_16x16x32_bf16 v[140:143], a[52:55], v[52:55], v[140:143]
  v_exp_f32 v45, v45
  v_mfma_f32_16x16x32_bf16 v[112:115], a[56:59], v[48:51], v[112:115]
  v_xor_b32 v13, v13, v12
  v_cvt_pk_bf16_f32 v62, v44, v45
  v_mfma_f32_16x16x32_bf16 v[144:147], a[56:59], v[52:55], v[144:147]
  v_exp_f32 v46, v46
  v_mfma_f32_16x16x32_bf16 v[116:119], a[60:63], v[48:51], v[116:119]
  v_and_b32 v246, 16, v10
  v_mfma_f32_16x16x32_bf16 v[148:151], a[60:63], v[52:55], v[148:151]
  v_exp_f32 v47, v47
  v_mfma_f32_16x16x32_bf16 v[216:219], a[192:195], v[48:51], v[216:219]
  v_cvt_pk_bf16_f32 v63, v46, v47
  v_mfma_f32_16x16x32_bf16 v[220:223], a[192:195], v[52:55], v[220:223]
  v_lshl_or_b32 v13, v13, 5, v246
  v_mfma_f32_16x16x32_bf16 v[32:35], a[0:3], a[160:163], 0
  v_mul_u32_u24 v12, 1280, v12
  v_mfma_f32_16x16x32_bf16 v[32:35], a[4:7], a[164:167], v[32:35]
  v_exp_f32 v16, v16
  v_mfma_f32_16x16x32_bf16 v[40:43], a[0:3], a[176:179], 0
  v_mfma_f32_16x16x32_bf16 v[40:43], a[4:7], a[180:183], v[40:43]
  v_exp_f32 v17, v17
  v_mfma_f32_16x16x32_bf16 v[44:47], a[16:19], a[176:179], 0
  ds_read_b128 a[0:3], v1 offset:0
  v_cvt_pk_bf16_f32 v48, v16, v17
  v_mfma_f32_16x16x32_bf16 v[44:47], a[20:23], a[180:183], v[44:47]
  v_exp_f32 v18, v18
  v_mfma_f32_16x16x32_bf16 v[36:39], a[16:19], a[160:163], 0
  ds_read_b128 a[4:7], v1 offset:1024
  v_add_u32 v241, v12, v13
  v_mfma_f32_16x16x32_bf16 v[36:39], a[20:23], a[164:167], v[36:39]
  v_exp_f32 v19, v19
  v_mfma_f32_16x16x32_bf16 v[36:39], a[24:27], a[168:171], v[36:39]
  ds_read_b128 a[16:19], v1 offset:4096
  v_cvt_pk_bf16_f32 v49, v18, v19
  v_mfma_f32_16x16x32_bf16 v[36:39], a[28:31], a[172:175], v[36:39]
  v_exp_f32 v24, v24
  v_mfma_f32_16x16x32_bf16 v[44:47], a[24:27], a[184:187], v[44:47]
  buffer_load_dwordx4 v11, s[32:35], s72 offen offset:2048 sc1 lds
  v_mfma_f32_16x16x32_bf16 v[44:47], a[28:31], a[188:191], v[44:47]
  v_exp_f32 v25, v25
  v_mfma_f32_16x16x32_bf16 v[40:43], a[8:11], a[184:187], v[40:43]
  ds_read_b128 a[20:23], v1 offset:5120
  v_cvt_pk_bf16_f32 v52, v24, v25
  v_mfma_f32_16x16x32_bf16 v[40:43], a[12:15], a[188:191], v[40:43]
  v_exp_f32 v26, v26
  v_mfma_f32_16x16x32_bf16 v[32:35], a[8:11], a[168:171], v[32:35]
  v_xor_b32 v13, 128, v13
  ds_read_b128 a[24:27], v1 offset:6144
  v_mfma_f32_16x16x32_bf16 v[32:35], a[12:15], a[172:175], v[32:35]
  v_exp_f32 v27, v27
  v_mfma_f32_16x16x32_bf16 v[152:155], a[32:35], v[56:59], v[152:155]
  ds_read_b128 a[28:31], v1 offset:7168
  v_cvt_pk_bf16_f32 v53, v26, v27
  v_mfma_f32_16x16x32_bf16 v[184:187], a[32:35], v[60:63], v[184:187]
  v_exp_f32 v20, v20
  v_mfma_f32_16x16x32_bf16 v[156:159], a[36:39], v[56:59], v[156:159]
  v_add_u32 v12, 4096, v12
  ds_read_b128 a[8:11], v1 offset:2048
  v_mfma_f32_16x16x32_bf16 v[188:191], a[36:39], v[60:63], v[188:191]
  v_exp_f32 v21, v21
  v_mfma_f32_16x16x32_bf16 v[160:163], a[40:43], v[56:59], v[160:163]
  ds_read_b128 a[12:15], v1 offset:3072
  v_cvt_pk_bf16_f32 v50, v20, v21
  v_mfma_f32_16x16x32_bf16 v[192:195], a[40:43], v[60:63], v[192:195]
  v_exp_f32 v22, v22
  v_mfma_f32_16x16x32_bf16 v[164:167], a[44:47], v[56:59], v[164:167]
  buffer_load_dwordx4 v11, s[32:35], s72 offen offset:3072 sc1 lds
  v_mfma_f32_16x16x32_bf16 v[196:199], a[44:47], v[60:63], v[196:199]
  v_exp_f32 v23, v23
  v_mfma_f32_16x16x32_bf16 v[168:171], a[48:51], v[56:59], v[168:171]
  v_add_u32 v242, v12, v13
  v_cvt_pk_bf16_f32 v51, v22, v23
  v_mfma_f32_16x16x32_bf16 v[200:203], a[48:51], v[60:63], v[200:203]
  v_exp_f32 v28, v28
  v_mfma_f32_16x16x32_bf16 v[172:175], a[52:55], v[56:59], v[172:175]
  v_add_u32 v243, 8192, v241
  s_add_u32 s72, s72, 16384
  v_mfma_f32_16x16x32_bf16 v[204:207], a[52:55], v[60:63], v[204:207]
  v_exp_f32 v29, v29
  v_mfma_f32_16x16x32_bf16 v[176:179], a[56:59], v[56:59], v[176:179]
  s_mov_b32 m0, s75
  v_cvt_pk_bf16_f32 v54, v28, v29
  v_mfma_f32_16x16x32_bf16 v[208:211], a[56:59], v[60:63], v[208:211]
  v_exp_f32 v30, v30
  v_mfma_f32_16x16x32_bf16 v[180:183], a[60:63], v[56:59], v[180:183]
  s_add_u32 s75, s75, 32768
  s_and_b32 s75, s75, 0x1ffff
  v_mfma_f32_16x16x32_bf16 v[212:215], a[60:63], v[60:63], v[212:215]
  v_exp_f32 v31, v31
  v_mfma_f32_16x16x32_bf16 v[224:227], a[192:195], v[56:59], v[224:227]
  v_add_u32 v244, 8192, v242
  v_cvt_pk_bf16_f32 v55, v30, v31
  v_mfma_f32_16x16x32_bf16 v[228:231], a[192:195], v[60:63], v[228:231]
  v_add_u32 v233, s40, v10
  v_add_u32 v1, s75, v2
  s_lshl_b32 s76, s43, 1
  s_sub_u32 s76, s76, 3
  s_cbranch_scc1 L_j_u
.p2align 6
L_at_pl2:
  s_waitcnt vmcnt(16) lgkmcnt(0)
  s_barrier
  v_mfma_f32_16x16x32_bf16 v[16:19], a[0:3], a[96:99], 0
  ds_read_b128 a[32:35], v1 offset:16384
  ds_read_b128 a[36:39], v1 offset:17408
  v_mfma_f32_16x16x32_bf16 v[16:19], a[4:7], a[100:103], v[16:19]
  v_exp_f32 v32, v32
  v_mfma_f32_16x16x32_bf16 v[24:27], a[0:3], a[112:115], 0
  ds_read_b128 a[40:43], v1 offset:18432
  ds_read_b128 a[44:47], v1 offset:19456
  v_mfma_f32_16x16x32_bf16 v[24:27], a[4:7], a[116:119], v[24:27]
  v_exp_f32 v33, v33
  v_mfma_f32_16x16x32_bf16 v[28:31], a[16:19], a[112:115], 0
  ds_read_b128 a[48:51], v1 offset:20480
  v_cvt_pk_bf16_f32 v56, v32, v33
  v_mfma_f32_16x16x32_bf16 v[28:31], a[20:23], a[116:119], v[28:31]
  v_exp_f32 v34, v34
  v_mfma_f32_16x16x32_bf16 v[20:23], a[16:19], a[96:99], 0
  ds_read_b128 a[52:55], v1 offset:21504
  ds_read_b128 a[56:59], v1 offset:22528
  v_mfma_f32_16x16x32_bf16 v[20:23], a[20:23], a[100:103], v[20:23]
  v_exp_f32 v35, v35
  v_mfma_f32_16x16x32_bf16 v[20:23], a[24:27], a[104:107], v[20:23]
  ds_read_b128 a[60:63], v1 offset:23552
  v_cvt_pk_bf16_f32 v57, v34, v35
  v_mfma_f32_16x16x32_bf16 v[20:23], a[28:31], a[108:111], v[20:23]
  v_exp_f32 v40, v40
  v_mfma_f32_16x16x32_bf16 v[28:31], a[24:27], a[120:123], v[28:31]
  buffer_load_dwordx4 v10, s[32:35], s72 offen offset:0 sc1 lds
  v_mfma_f32_16x16x32_bf16 v[28:31], a[28:31], a[124:127], v[28:31]
  v_exp_f32 v41, v41
  v_mfma_f32_16x16x32_bf16 v[24:27], a[8:11], a[120:123], v[24:27]
  v_cvt_pk_bf16_f32 v60, v40, v41
  v_mfma_f32_16x16x32_bf16 v[24:27], a[12:15], a[124:127], v[24:27]
  v_exp_f32 v42, v42
  v_mfma_f32_16x16x32_bf16 v[16:19], a[8:11], a[104:107], v[16:19]
  v_mfma_f32_16x16x32_bf16 v[16:19], a[12:15], a[108:111], v[16:19]
  v_exp_f32 v43, v43
  s_waitcnt lgkmcnt(0)
  v_mfma_f32_16x16x32_bf16 v[88:91], a[32:35], v[48:51], v[88:91]
  v_cvt_pk_bf16_f32 v61, v42, v43
  v_mfma_f32_16x16x32_bf16 v[120:123], a[32:35], v[52:55], v[120:123]
  v_exp_f32 v36, v36
  v_mfma_f32_16x16x32_bf16 v[92:95], a[36:39], v[48:51], v[92:95]
  v_mfma_f32_16x16x32_bf16 v[124:127], a[36:39], v[52:55], v[124:127]
  v_exp_f32 v37, v37
  v_mfma_f32_16x16x32_bf16 v[96:99], a[40:43], v[48:51], v[96:99]
  v_cvt_pk_bf16_f32 v58, v36, v37
  v_mfma_f32_16x16x32_bf16 v[128:131], a[40:43], v[52:55], v[128:131]
  v_exp_f32 v38, v38
  v_mfma_f32_16x16x32_bf16 v[100:103], a[44:47], v[48:51], v[100:103]
  buffer_load_dwordx4 v10, s[32:35], s72 offen offset:1024 sc1 lds
  v_mfma_f32_16x16x32_bf16 v[132:135], a[44:47], v[52:55], v[132:135]
  v_exp_f32 v39, v39
  v_mfma_f32_16x16x32_bf16 v[104:107], a[48:51], v[48:51], v[104:107]
  v_cvt_pk_bf16_f32 v59, v38, v39
  v_mfma_f32_16x16x32_bf16 v[136:139], a[48:51], v[52:55], v[136:139]
  v_exp_f32 v44, v44
  v_mfma_f32_16x16x32_bf16 v[108:111], a[52:55], v[48:51], v[108:111]
  v_mfma_f32_16x16x32_bf16 v[140:143], a[52:55], v[52:55], v[140:143]
  v_exp_f32 v45, v45
  v_mfma_f32_16x16x32_bf16 v[112:115], a[56:59], v[48:51], v[112:115]
  v_cvt_pk_bf16_f32 v62, v44, v45
  v_mfma_f32_16x16x32_bf16 v[144:147], a[56:59], v[52:55], v[144:147]
  v_exp_f32 v46, v46
  v_mfma_f32_16x16x32_bf16 v[116:119], a[60:63], v[48:51], v[116:119]
  v_mfma_f32_16x16x32_bf16 v[148:151], a[60:63], v[52:55], v[148:151]
  v_exp_f32 v47, v47
  v_mfma_f32_16x16x32_bf16 v[216:219], a[192:195], v[48:51], v[216:219]
  v_cvt_pk_bf16_f32 v63, v46, v47
  v_mfma_f32_16x16x32_bf16 v[220:223], a[192:195], v[52:55], v[220:223]
  v_mfma_f32_16x16x32_bf16 v[32:35], a[0:3], a[160:163], 0
  v_mfma_f32_16x16x32_bf16 v[32:35], a[4:7], a[164:167], v[32:35]
  v_exp_f32 v16, v16
  v_mfma_f32_16x16x32_bf16 v[40:43], a[0:3], a[176:179], 0
  v_mfma_f32_16x16x32_bf16 v[40:43], a[4:7], a[180:183], v[40:43]
  v_exp_f32 v17, v17
  v_mfma_f32_16x16x32_bf16 v[44:47], a[16:19], a[176:179], 0
  ds_read_b128 a[0:3], v1 offset:0
  v_cvt_pk_bf16_f32 v48, v16, v17
  v_mfma_f32_16x16x32_bf16 v[44:47], a[20:23], a[180:183], v[44:47]
  v_exp_f32 v18, v18
  v_mfma_f32_16x16x32_bf16 v[36:39], a[16:19], a[160:163], 0
  ds_read_b128 a[4:7], v1 offset:1024
  v_mfma_f32_16x16x32_bf16 v[36:39], a[20:23], a[164:167], v[36:39]
  v_exp_f32 v19, v19
  v_mfma_f32_16x16x32_bf16 v[36:39], a[24:27], a[168:171], v[36:39]
  ds_read_b128 a[16:19], v1 offset:4096
  v_cvt_pk_bf16_f32 v49, v18, v19
  v_mfma_f32_16x16x32_bf16 v[36:39], a[28:31], a[172:175], v[36:39]
  v_exp_f32 v24, v24
  v_mfma_f32_16x16x32_bf16 v[44:47], a[24:27], a[184:187], v[44:47]
  buffer_load_dwordx4 v10, s[32:35], s72 offen offset:2048 sc1 lds
  v_mfma_f32_16x16x32_bf16 v[44:47], a[28:31], a[188:191], v[44:47]
  v_exp_f32 v25, v25
  v_mfma_f32_16x16x32_bf16 v[40:43], a[8:11], a[184:187], v[40:43]
  ds_read_b128 a[20:23], v1 offset:5120
  v_cvt_pk_bf16_f32 v52, v24, v25
  v_mfma_f32_16x16x32_bf16 v[40:43], a[12:15], a[188:191], v[40:43]
  v_exp_f32 v26, v26
  v_mfma_f32_16x16x32_bf16 v[32:35], a[8:11], a[168:171], v[32:35]
  ds_read_b128 a[24:27], v1 offset:6144
  ds_read_b128 a[28:31], v1 offset:7168
  v_mfma_f32_16x16x32_bf16 v[32:35], a[12:15], a[172:175], v[32:35]
  v_exp_f32 v27, v27
  v_mfma_f32_16x16x32_bf16 v[152:155], a[32:35], v[56:59], v[152:155]
  ds_read_b128 a[8:11], v1 offset:2048
  v_cvt_pk_bf16_f32 v53, v26, v27
  v_mfma_f32_16x16x32_bf16 v[184:187], a[32:35], v[60:63], v[184:187]
  v_exp_f32 v20, v20
  v_mfma_f32_16x16x32_bf16 v[156:159], a[36:39], v[56:59], v[156:159]
  ds_read_b128 a[12:15], v1 offset:3072
  v_mfma_f32_16x16x32_bf16 v[188:191], a[36:39], v[60:63], v[188:191]
  v_exp_f32 v21, v21
  v_mfma_f32_16x16x32_bf16 v[160:163], a[40:43], v[56:59], v[160:163]
  v_cvt_pk_bf16_f32 v50, v20, v21
  v_mfma_f32_16x16x32_bf16 v[192:195], a[40:43], v[60:63], v[192:195]
  v_exp_f32 v22, v22
  v_mfma_f32_16x16x32_bf16 v[164:167], a[44:47], v[56:59], v[164:167]
  buffer_load_dwordx4 v10, s[32:35], s72 offen offset:3072 sc1 lds
  v_mfma_f32_16x16x32_bf16 v[196:199], a[44:47], v[60:63], v[196:199]
  v_exp_f32 v23, v23
  v_mfma_f32_16x16x32_bf16 v[168:171], a[48:51], v[56:59], v[168:171]
  s_add_u32 m0, m0, 4096
  v_cvt_pk_bf16_f32 v51, v22, v23
  v_mfma_f32_16x16x32_bf16 v[200:203], a[48:51], v[60:63], v[200:203]
  v_exp_f32 v28, v28
  v_mfma_f32_16x16x32_bf16 v[172:175], a[52:55], v[56:59], v[172:175]
  v_mfma_f32_16x16x32_bf16 v[204:207], a[52:55], v[60:63], v[204:207]
  v_exp_f32 v29, v29
  v_mfma_f32_16x16x32_bf16 v[176:179], a[56:59], v[56:59], v[176:179]
  v_cvt_pk_bf16_f32 v54, v28, v29
  v_mfma_f32_16x16x32_bf16 v[208:211], a[56:59], v[60:63], v[208:211]
  v_exp_f32 v30, v30
  v_mfma_f32_16x16x32_bf16 v[180:183], a[60:63], v[56:59], v[180:183]
  v_mfma_f32_16x16x32_bf16 v[212:215], a[60:63], v[60:63], v[212:215]
  v_exp_f32 v31, v31
  v_mfma_f32_16x16x32_bf16 v[224:227], a[192:195], v[56:59], v[224:227]
  v_xor_b32 v1, 8192, v1
  v_cvt_pk_bf16_f32 v55, v30, v31
  v_mfma_f32_16x16x32_bf16 v[228:231], a[192:195], v[60:63], v[228:231]
  s_waitcnt lgkmcnt(7)
  v_mfma_f32_16x16x32_bf16 v[16:19], a[0:3], a[96:99], 0
  ds_read_b128 a[32:35], v1 offset:16384
  ds_read_b128 a[36:39], v1 offset:17408
  s_waitcnt lgkmcnt(8)
  v_mfma_f32_16x16x32_bf16 v[16:19], a[4:7], a[100:103], v[16:19]
  v_exp_f32 v32, v32
  v_mfma_f32_16x16x32_bf16 v[24:27], a[0:3], a[112:115], 0
  ds_read_b128 a[40:43], v1 offset:18432
  ds_read_b128 a[44:47], v1 offset:19456
  v_mfma_f32_16x16x32_bf16 v[24:27], a[4:7], a[116:119], v[24:27]
  v_exp_f32 v33, v33
  s_waitcnt lgkmcnt(9)
  v_mfma_f32_16x16x32_bf16 v[28:31], a[16:19], a[112:115], 0
  ds_read_b128 a[48:51], v1 offset:20480
  v_cvt_pk_bf16_f32 v56, v32, v33
  s_waitcnt lgkmcnt(9)
  v_mfma_f32_16x16x32_bf16 v[28:31], a[20:23], a[116:119], v[28:31]
  v_exp_f32 v34, v34
  v_mfma_f32_16x16x32_bf16 v[20:23], a[16:19], a[96:99], 0
  ds_read_b128 a[52:55], v1 offset:21504
  ds_read_b128 a[56:59], v1 offset:22528
  v_mfma_f32_16x16x32_bf16 v[20:23], a[20:23], a[100:103], v[20:23]
  v_exp_f32 v35, v35
  s_waitcnt lgkmcnt(10)
  v_mfma_f32_16x16x32_bf16 v[20:23], a[24:27], a[104:107], v[20:23]
  ds_read_b128 a[60:63], v1 offset:23552
  v_cvt_pk_bf16_f32 v57, v34, v35
  s_waitcnt lgkmcnt(10)
  v_mfma_f32_16x16x32_bf16 v[20:23], a[28:31], a[108:111], v[20:23]
  v_exp_f32 v40, v40
  v_mfma_f32_16x16x32_bf16 v[28:31], a[24:27], a[120:123], v[28:31]
  buffer_load_dwordx4 v11, s[32:35], s72 offen offset:0 sc1 lds
  v_mfma_f32_16x16x32_bf16 v[28:31], a[28:31], a[124:127], v[28:31]
  v_exp_f32 v41, v41
  s_waitcnt lgkmcnt(9)
  v_mfma_f32_16x16x32_bf16 v[24:27], a[8:11], a[120:123], v[24:27]
  v_cvt_pk_bf16_f32 v60, v40, v41
  s_waitcnt lgkmcnt(8)
  v_mfma_f32_16x16x32_bf16 v[24:27], a[12:15], a[124:127], v[24:27]
  v_exp_f32 v42, v42
  v_mfma_f32_16x16x32_bf16 v[16:19], a[8:11], a[104:107], v[16:19]
  v_mfma_f32_16x16x32_bf16 v[16:19], a[12:15], a[108:111], v[16:19]
  v_exp_f32 v43, v43
  s_waitcnt lgkmcnt(0)
  v_mfma_f32_16x16x32_bf16 v[88:91], a[32:35], v[48:51], v[88:91]
  v_cvt_pk_bf16_f32 v61, v42, v43
  v_mfma_f32_16x16x32_bf16 v[120:123], a[32:35], v[52:55], v[120:123]
  v_exp_f32 v36, v36
  v_mfma_f32_16x16x32_bf16 v[92:95], a[36:39], v[48:51], v[92:95]
  v_mfma_f32_16x16x32_bf16 v[124:127], a[36:39], v[52:55], v[124:127]
  v_exp_f32 v37, v37
  v_mfma_f32_16x16x32_bf16 v[96:99], a[40:43], v[48:51], v[96:99]
  v_cvt_pk_bf16_f32 v58, v36, v37
  v_mfma_f32_16x16x32_bf16 v[128:131], a[40:43], v[52:55], v[128:131]
  v_exp_f32 v38, v38
  v_mfma_f32_16x16x32_bf16 v[100:103], a[44:47], v[48:51], v[100:103]
  buffer_load_dwordx4 v11, s[32:35], s72 offen offset:1024 sc1 lds
  v_mfma_f32_16x16x32_bf16 v[132:135], a[44:47], v[52:55], v[132:135]
  v_exp_f32 v39, v39
  v_mfma_f32_16x16x32_bf16 v[104:107], a[48:51], v[48:51], v[104:107]
  v_cvt_pk_bf16_f32 v59, v38, v39
  v_mfma_f32_16x16x32_bf16 v[136:139], a[48:51], v[52:55], v[136:139]
  v_exp_f32 v44, v44
  v_mfma_f32_16x16x32_bf16 v[108:111], a[52:55], v[48:51], v[108:111]
  v_mfma_f32_16x16x32_bf16 v[140:143], a[52:55], v[52:55], v[140:143]
  v_exp_f32 v45, v45
  v_mfma_f32_16x16x32_bf16 v[112:115], a[56:59], v[48:51], v[112:115]
  v_cvt_pk_bf16_f32 v62, v44, v45
  v_mfma_f32_16x16x32_bf16 v[144:147], a[56:59], v[52:55], v[144:147]
  v_exp_f32 v46, v46
  v_mfma_f32_16x16x32_bf16 v[116:119], a[60:63], v[48:51], v[116:119]
  v_mfma_f32_16x16x32_bf16 v[148:151], a[60:63], v[52:55], v[148:151]
  v_exp_f32 v47, v47
  v_mfma_f32_16x16x32_bf16 v[216:219], a[192:195], v[48:51], v[216:219]
  v_cvt_pk_bf16_f32 v63, v46, v47
  v_mfma_f32_16x16x32_bf16 v[220:223], a[192:195], v[52:55], v[220:223]
  v_mfma_f32_16x16x32_bf16 v[32:35], a[0:3], a[160:163], 0
  v_mfma_f32_16x16x32_bf16 v[32:35], a[4:7], a[164:167], v[32:35]
  v_exp_f32 v16, v16
  v_mfma_f32_16x16x32_bf16 v[40:43], a[0:3], a[176:179], 0
  v_mfma_f32_16x16x32_bf16 v[40:43], a[4:7], a[180:183], v[40:43]
  v_exp_f32 v17, v17
  v_mfma_f32_16x16x32_bf16 v[44:47], a[16:19], a[176:179], 0
  ds_read_b128 a[0:3], v1 offset:0
  v_cvt_pk_bf16_f32 v48, v16, v17
  v_mfma_f32_16x16x32_bf16 v[44:47], a[20:23], a[180:183], v[44:47]
  v_exp_f32 v18, v18
  v_mfma_f32_16x16x32_bf16 v[36:39], a[16:19], a[160:163], 0
  ds_read_b128 a[4:7], v1 offset:1024
  v_mfma_f32_16x16x32_bf16 v[36:39], a[20:23], a[164:167], v[36:39]
  v_exp_f32 v19, v19
  v_mfma_f32_16x16x32_bf16 v[36:39], a[24:27], a[168:171], v[36:39]
  ds_read_b128 a[16:19], v1 offset:4096
  v_cvt_pk_bf16_f32 v49, v18, v19
  v_mfma_f32_16x16x32_bf16 v[36:39], a[28:31], a[172:175], v[36:39]
  v_exp_f32 v24, v24
  v_mfma_f32_16x16x32_bf16 v[44:47], a[24:27], a[184:187], v[44:47]
  buffer_load_dwordx4 v11, s[32:35], s72 offen offset:2048 sc1 lds
  v_mfma_f32_16x16x32_bf16 v[44:47], a[28:31], a[188:191], v[44:47]
  v_exp_f32 v25, v25
  v_mfma_f32_16x16x32_bf16 v[40:43], a[8:11], a[184:187], v[40:43]
  ds_read_b128 a[20:23], v1 offset:5120
  v_cvt_pk_bf16_f32 v52, v24, v25
  v_mfma_f32_16x16x32_bf16 v[40:43], a[12:15], a[188:191], v[40:43]
  v_exp_f32 v26, v26
  v_mfma_f32_16x16x32_bf16 v[32:35], a[8:11], a[168:171], v[32:35]
  ds_read_b128 a[24:27], v1 offset:6144
  ds_read_b128 a[28:31], v1 offset:7168
  v_mfma_f32_16x16x32_bf16 v[32:35], a[12:15], a[172:175], v[32:35]
  v_exp_f32 v27, v27
  v_mfma_f32_16x16x32_bf16 v[152:155], a[32:35], v[56:59], v[152:155]
  ds_read_b128 a[8:11], v1 offset:2048
  v_cvt_pk_bf16_f32 v53, v26, v27
  v_mfma_f32_16x16x32_bf16 v[184:187], a[32:35], v[60:63], v[184:187]
  v_exp_f32 v20, v20
  v_mfma_f32_16x16x32_bf16 v[156:159], a[36:39], v[56:59], v[156:159]
  ds_read_b128 a[12:15], v1 offset:3072
  v_mfma_f32_16x16x32_bf16 v[188:191], a[36:39], v[60:63], v[188:191]
  v_exp_f32 v21, v21
  v_mfma_f32_16x16x32_bf16 v[160:163], a[40:43], v[56:59], v[160:163]
  v_cvt_pk_bf16_f32 v50, v20, v21
  v_mfma_f32_16x16x32_bf16 v[192:195], a[40:43], v[60:63], v[192:195]
  v_exp_f32 v22, v22
  v_mfma_f32_16x16x32_bf16 v[164:167], a[44:47], v[56:59], v[164:167]
  buffer_load_dwordx4 v11, s[32:35], s72 offen offset:3072 sc1 lds
  v_mfma_f32_16x16x32_bf16 v[196:199], a[44:47], v[60:63], v[196:199]
  v_exp_f32 v23, v23
  v_mfma_f32_16x16x32_bf16 v[168:171], a[48:51], v[56:59], v[168:171]
  s_add_u32 s72, s72, 16384
  v_cvt_pk_bf16_f32 v51, v22, v23
  v_mfma_f32_16x16x32_bf16 v[200:203], a[48:51], v[60:63], v[200:203]
  v_exp_f32 v28, v28
  v_mfma_f32_16x16x32_bf16 v[172:175], a[52:55], v[56:59], v[172:175]
  s_mov_b32 m0, s75
  s_add_u32 s75, s75, 32768
  v_mfma_f32_16x16x32_bf16 v[204:207], a[52:55], v[60:63], v[204:207]
  v_exp_f32 v29, v29
  v_mfma_f32_16x16x32_bf16 v[176:179], a[56:59], v[56:59], v[176:179]
  s_and_b32 s75, s75, 0x1ffff
  v_cvt_pk_bf16_f32 v54, v28, v29
  v_mfma_f32_16x16x32_bf16 v[208:211], a[56:59], v[60:63], v[208:211]
  v_exp_f32 v30, v30
  v_mfma_f32_16x16x32_bf16 v[180:183], a[60:63], v[56:59], v[180:183]
  v_mfma_f32_16x16x32_bf16 v[212:215], a[60:63], v[60:63], v[212:215]
  v_exp_f32 v31, v31
  v_mfma_f32_16x16x32_bf16 v[224:227], a[192:195], v[56:59], v[224:227]
  v_add_u32 v1, s75, v2
  v_cvt_pk_bf16_f32 v55, v30, v31
  v_mfma_f32_16x16x32_bf16 v[228:231], a[192:195], v[60:63], v[228:231]
  s_sub_u32 s76, s76, 1
  s_cbranch_scc0 L_at_pl2
L_j_u:
  s_waitcnt vmcnt(16) lgkmcnt(0)
  s_barrier
  buffer_load_dwordx4 v[248:251], v10, s[32:35], s58 offen sc1
  buffer_load_dwordx2 v[68:69], v70, s[32:35], 0 offen sc1
  v_mfma_f32_16x16x32_bf16 v[16:19], a[0:3], a[96:99], 0
  ds_read_b128 a[32:35], v1 offset:16384
  ds_read_b128 a[36:39], v1 offset:17408
  v_mfma_f32_16x16x32_bf16 v[16:19], a[4:7], a[100:103], v[16:19]
  v_exp_f32 v32, v32
  v_mfma_f32_16x16x32_bf16 v[24:27], a[0:3], a[112:115], 0
  ds_read_b128 a[40:43], v1 offset:18432
  ds_read_b128 a[44:47], v1 offset:19456
  v_mfma_f32_16x16x32_bf16 v[24:27], a[4:7], a[116:119], v[24:27]
  v_exp_f32 v33, v33
  v_mfma_f32_16x16x32_bf16 v[28:31], a[16:19], a[112:115], 0
  ds_read_b128 a[48:51], v1 offset:20480
  v_cvt_pk_bf16_f32 v56, v32, v33
  v_mfma_f32_16x16x32_bf16 v[28:31], a[20:23], a[116:119], v[28:31]
  v_exp_f32 v34, v34
  v_mfma_f32_16x16x32_bf16 v[20:23], a[16:19], a[96:99], 0
  ds_read_b128 a[52:55], v1 offset:21504
  ds_read_b128 a[56:59], v1 offset:22528
  v_mfma_f32_16x16x32_bf16 v[20:23], a[20:23], a[100:103], v[20:23]
  v_exp_f32 v35, v35
  v_mfma_f32_16x16x32_bf16 v[20:23], a[24:27], a[104:107], v[20:23]
  ds_read_b128 a[60:63], v1 offset:23552
  v_cvt_pk_bf16_f32 v57, v34, v35
  v_mfma_f32_16x16x32_bf16 v[20:23], a[28:31], a[108:111], v[20:23]
  v_exp_f32 v40, v40
  v_mfma_f32_16x16x32_bf16 v[28:31], a[24:27], a[120:123], v[28:31]
  v_lshrrev_b32 v12, 2, v0
  v_and_b32 v13, 7, v12
  v_mfma_f32_16x16x32_bf16 v[28:31], a[28:31], a[124:127], v[28:31]
  v_exp_f32 v41, v41
  v_mfma_f32_16x16x32_bf16 v[24:27], a[8:11], a[120:123], v[24:27]
  v_lshlrev_b32 v13, 5, v13
  v_cvt_pk_bf16_f32 v60, v40, v41
  v_mfma_f32_16x16x32_bf16 v[24:27], a[12:15], a[124:127], v[24:27]
  v_exp_f32 v42, v42
  v_mfma_f32_16x16x32_bf16 v[16:19], a[8:11], a[104:107], v[16:19]
  v_lshl_or_b32 v12, v12, 8, v13
  v_and_b32 v13, 3, v0
  v_mfma_f32_16x16x32_bf16 v[16:19], a[12:15], a[108:111], v[16:19]
  v_exp_f32 v43, v43
  s_waitcnt lgkmcnt(0)
  v_mfma_f32_16x16x32_bf16 v[88:91], a[32:35], v[48:51], v[88:91]
  v_lshl_or_b32 v12, v13, 3, v12
  v_cvt_pk_bf16_f32 v61, v42, v43
  v_mfma_f32_16x16x32_bf16 v[120:123], a[32:35], v[52:55], v[120:123]
  v_exp_f32 v36, v36
  v_mfma_f32_16x16x32_bf16 v[92:95], a[36:39], v[48:51], v[92:95]
  v_xor_b32 v252, s82, v12
  v_xor_b32 v253, 32, v252
  v_mfma_f32_16x16x32_bf16 v[124:127], a[36:39], v[52:55], v[124:127]
  v_exp_f32 v37, v37
  v_mfma_f32_16x16x32_bf16 v[96:99], a[40:43], v[48:51], v[96:99]
  v_xor_b32 v254, 64, v252
  v_cvt_pk_bf16_f32 v58, v36, v37
  v_mfma_f32_16x16x32_bf16 v[128:131], a[40:43], v[52:55], v[128:131]
  v_exp_f32 v38, v38
  v_mfma_f32_16x16x32_bf16 v[100:103], a[44:47], v[48:51], v[100:103]
  v_xor_b32 v255, 96, v252
  v_mfma_f32_16x16x32_bf16 v[132:135], a[44:47], v[52:55], v[132:135]
  v_exp_f32 v39, v39
  v_mfma_f32_16x16x32_bf16 v[104:107], a[48:51], v[48:51], v[104:107]
  v_mul_u32_u24 v66, 320, v247
  v_cvt_pk_bf16_f32 v59, v38, v39
  v_mfma_f32_16x16x32_bf16 v[136:139], a[48:51], v[52:55], v[136:139]
  v_exp_f32 v44, v44
  v_mfma_f32_16x16x32_bf16 v[108:111], a[52:55], v[48:51], v[108:111]
  v_and_b32 v13, 16, v0
  v_lshl_add_u32 v66, v13, 1, v66
  v_mfma_f32_16x16x32_bf16 v[140:143], a[52:55], v[52:55], v[140:143]
  v_exp_f32 v45, v45
  v_mfma_f32_16x16x32_bf16 v[112:115], a[56:59], v[48:51], v[112:115]
  v_lshrrev_b32 v13, 5, v0
  v_cvt_pk_bf16_f32 v62, v44, v45
  v_mfma_f32_16x16x32_bf16 v[144:147], a[56:59], v[52:55], v[144:147]
  v_exp_f32 v46, v46
  v_mfma_f32_16x16x32_bf16 v[116:119], a[60:63], v[48:51], v[116:119]
  v_lshl_add_u32 v66, v13, 4, v66
  v_mfma_f32_16x16x32_bf16 v[148:151], a[60:63], v[52:55], v[148:151]
  v_exp_f32 v47, v47
  v_mfma_f32_16x16x32_bf16 v[216:219], a[192:195], v[48:51], v[216:219]
  s_mov_b32 s8, s22
  v_cvt_pk_bf16_f32 v63, v46, v47
  v_mfma_f32_16x16x32_bf16 v[220:223], a[192:195], v[52:55], v[220:223]
  s_mov_b32 s9, s23
  v_mfma_f32_16x16x32_bf16 v[32:35], a[0:3], a[160:163], 0
  s_mov_b32 s10, 2211840
  v_mfma_f32_16x16x32_bf16 v[32:35], a[4:7], a[164:167], v[32:35]
  v_exp_f32 v16, v16
  v_mfma_f32_16x16x32_bf16 v[40:43], a[0:3], a[176:179], 0
  v_add_f32 v72, 0x0, v239
  v_mfma_f32_16x16x32_bf16 v[40:43], a[4:7], a[180:183], v[40:43]
  v_exp_f32 v17, v17
  v_mfma_f32_16x16x32_bf16 v[44:47], a[16:19], a[176:179], 0
  v_add_f32 v73, 0xef800000, v239
  v_cvt_pk_bf16_f32 v48, v16, v17
  v_mfma_f32_16x16x32_bf16 v[44:47], a[20:23], a[180:183], v[44:47]
  v_exp_f32 v18, v18
  v_mfma_f32_16x16x32_bf16 v[36:39], a[16:19], a[160:163], 0
  ds_read_b128 a[0:3], v1 offset:0
  ds_read_b128 a[4:7], v1 offset:1024
  v_mfma_f32_16x16x32_bf16 v[36:39], a[20:23], a[164:167], v[36:39]
  v_exp_f32 v19, v19
  v_mfma_f32_16x16x32_bf16 v[36:39], a[24:27], a[168:171], v[36:39]
  v_add_f32 v74, 0xf0000000, v239
  v_cvt_pk_bf16_f32 v49, v18, v19
  v_mfma_f32_16x16x32_bf16 v[36:39], a[28:31], a[172:175], v[36:39]
  v_exp_f32 v24, v24
  v_mfma_f32_16x16x32_bf16 v[44:47], a[24:27], a[184:187], v[44:47]
  ds_read_b128 a[16:19], v1 offset:4096
  v_add_f32 v75, 0xf0400000, v239
  v_mfma_f32_16x16x32_bf16 v[44:47], a[28:31], a[188:191], v[44:47]
  v_exp_f32 v25, v25
  v_mfma_f32_16x16x32_bf16 v[40:43], a[8:11], a[184:187], v[40:43]
  ds_read_b128 a[20:23], v1 offset:5120
  v_cvt_pk_bf16_f32 v52, v24, v25
  v_mfma_f32_16x16x32_bf16 v[40:43], a[12:15], a[188:191], v[40:43]
  v_exp_f32 v26, v26
  v_mfma_f32_16x16x32_bf16 v[32:35], a[8:11], a[168:171], v[32:35]
  v_add_f32 v76, 0xf1800000, v239
  ds_read_b128 a[24:27], v1 offset:6144
  v_mfma_f32_16x16x32_bf16 v[32:35], a[12:15], a[172:175], v[32:35]
  v_exp_f32 v27, v27
  v_mfma_f32_16x16x32_bf16 v[152:155], a[32:35], v[56:59], v[152:155]
  v_add_f32 v77, 0xf1880000, v239
  v_cvt_pk_bf16_f32 v53, v26, v27
  v_mfma_f32_16x16x32_bf16 v[184:187], a[32:35], v[60:63], v[184:187]
  v_exp_f32 v20, v20
  v_mfma_f32_16x16x32_bf16 v[156:159], a[36:39], v[56:59], v[156:159]
  ds_read_b128 a[28:31], v1 offset:7168
  v_add_f32 v78, 0xf1900000, v239
  v_mfma_f32_16x16x32_bf16 v[188:191], a[36:39], v[60:63], v[188:191]
  v_exp_f32 v21, v21
  v_mfma_f32_16x16x32_bf16 v[160:163], a[40:43], v[56:59], v[160:163]
  ds_read_b128 a[8:11], v1 offset:2048
  v_cvt_pk_bf16_f32 v50, v20, v21
  v_mfma_f32_16x16x32_bf16 v[192:195], a[40:43], v[60:63], v[192:195]
  v_exp_f32 v22, v22
  v_mfma_f32_16x16x32_bf16 v[164:167], a[44:47], v[56:59], v[164:167]
  v_add_f32 v79, 0xf1980000, v239
  ds_read_b128 a[12:15], v1 offset:3072
  v_mfma_f32_16x16x32_bf16 v[196:199], a[44:47], v[60:63], v[196:199]
  v_exp_f32 v23, v23
  v_mfma_f32_16x16x32_bf16 v[168:171], a[48:51], v[56:59], v[168:171]
  v_min_f32 v72, 0, v72
  v_cvt_pk_bf16_f32 v51, v22, v23
  v_mfma_f32_16x16x32_bf16 v[200:203], a[48:51], v[60:63], v[200:203]
  v_exp_f32 v28, v28
  v_mfma_f32_16x16x32_bf16 v[172:175], a[52:55], v[56:59], v[172:175]
  v_min_f32 v73, 0, v73
  v_min_f32 v74, 0, v74
  v_mfma_f32_16x16x32_bf16 v[204:207], a[52:55], v[60:63], v[204:207]
  v_exp_f32 v29, v29
  v_mfma_f32_16x16x32_bf16 v[176:179], a[56:59], v[56:59], v[176:179]
  v_min_f32 v75, 0, v75
  v_cvt_pk_bf16_f32 v54, v28, v29
  v_mfma_f32_16x16x32_bf16 v[208:211], a[56:59], v[60:63], v[208:211]
  v_exp_f32 v30, v30
  v_mfma_f32_16x16x32_bf16 v[180:183], a[60:63], v[56:59], v[180:183]
  v_min_f32 v76, 0, v76
  v_min_f32 v77, 0, v77
  v_mfma_f32_16x16x32_bf16 v[212:215], a[60:63], v[60:63], v[212:215]
  v_exp_f32 v31, v31
  v_mfma_f32_16x16x32_bf16 v[224:227], a[192:195], v[56:59], v[224:227]
  v_min_f32 v78, 0, v78
  v_cvt_pk_bf16_f32 v55, v30, v31
  v_mfma_f32_16x16x32_bf16 v[228:231], a[192:195], v[60:63], v[228:231]
  v_min_f32 v79, 0, v79
  v_xor_b32 v1, 8192, v1
  s_waitcnt vmcnt(0)
L_chk_r:
  v_min_u32 v246, v248, v249
  v_min3_u32 v246, v246, v250, v251
  v_cmp_eq_u32 vcc, 0, v246
  s_cbranch_vccnz L_spin_r
  v_cmp_gt_u32 vcc, 0x100000, v69
  s_cbranch_vccnz L_spin_r
L_go_r:
  s_waitcnt lgkmcnt(7)
  v_mfma_f32_16x16x32_bf16 v[16:19], a[0:3], a[96:99], v[80:83]
  ds_read_b128 a[32:35], v1 offset:16384
  ds_read_b128 a[36:39], v1 offset:17408
  v_readfirstlane_b32 s82, v68
  s_waitcnt lgkmcnt(8)
  v_mfma_f32_16x16x32_bf16 v[16:19], a[4:7], a[100:103], v[16:19]
  v_exp_f32 v32, v32
  v_and_b32 v237, 7, v0
  v_mfma_f32_16x16x32_bf16 v[24:27], a[0:3], a[112:115], 0
  ds_read_b128 a[40:43], v1 offset:18432
  s_mov_b32 s83, 0x76352410
  ds_read_b128 a[44:47], v1 offset:19456
  v_mfma_f32_16x16x32_bf16 v[24:27], a[4:7], a[116:119], v[24:27]
  v_exp_f32 v33, v33
  v_subrev_u32 v234, s82, v68
  s_waitcnt lgkmcnt(9)
  v_mfma_f32_16x16x32_bf16 v[28:31], a[16:19], a[112:115], 0
  v_lshl_or_b32 v234, v234, 3, v237
  ds_read_b128 a[48:51], v1 offset:20480
  v_cvt_pk_bf16_f32 v56, v32, v33
  s_waitcnt lgkmcnt(9)
  v_mfma_f32_16x16x32_bf16 v[28:31], a[20:23], a[116:119], v[28:31]
  v_exp_f32 v34, v34
  v_mov_b32 v235, 0
  v_mfma_f32_16x16x32_bf16 v[20:23], a[16:19], a[96:99], v[84:87]
  ds_read_b128 a[52:55], v1 offset:21504
  s_and_b32 s84, s2, 7
  v_sub_u32_dpp v238, v234, v234 row_ror:1 row_mask:0xf bank_mask:0xf
  v_mfma_f32_16x16x32_bf16 v[20:23], a[20:23], a[100:103], v[20:23]
  v_exp_f32 v35, v35
  ds_read_b128 a[56:59], v1 offset:22528
  s_waitcnt lgkmcnt(10)
  v_mfma_f32_16x16x32_bf16 v[20:23], a[24:27], a[104:107], v[20:23]
  v_alignbit_b32 v235, v235, v238, 31
  ds_read_b128 a[60:63], v1 offset:23552
  v_cvt_pk_bf16_f32 v57, v34, v35
  s_waitcnt lgkmcnt(10)
  v_mfma_f32_16x16x32_bf16 v[20:23], a[28:31], a[108:111], v[20:23]
  v_exp_f32 v40, v40
  v_sub_u32_dpp v238, v234, v234 row_ror:2 row_mask:0xf bank_mask:0xf
  v_mfma_f32_16x16x32_bf16 v[28:31], a[24:27], a[120:123], v[28:31]
  v_alignbit_b32 v235, v235, v238, 31
  v_sub_u32_dpp v238, v234, v234 row_ror:3 row_mask:0xf bank_mask:0xf
  v_alignbit_b32 v235, v235, v238, 31
  v_mfma_f32_16x16x32_bf16 v[28:31], a[28:31], a[124:127], v[28:31]
  v_exp_f32 v41, v41
  v_sub_u32_dpp v238, v234, v234 row_ror:4 row_mask:0xf bank_mask:0xf
  s_waitcnt lgkmcnt(9)
  v_mfma_f32_16x16x32_bf16 v[24:27], a[8:11], a[120:123], v[24:27]
  v_alignbit_b32 v235, v235, v238, 31
  v_sub_u32_dpp v238, v234, v234 row_ror:5 row_mask:0xf bank_mask:0xf
  v_cvt_pk_bf16_f32 v60, v40, v41
  s_waitcnt lgkmcnt(8)
  v_mfma_f32_16x16x32_bf16 v[24:27], a[12:15], a[124:127], v[24:27]
  v_exp_f32 v42, v42
  v_alignbit_b32 v235, v235, v238, 31
  v_mfma_f32_16x16x32_bf16 v[16:19], a[8:11], a[104:107], v[16:19]
  v_sub_u32_dpp v238, v234, v234 row_ror:6 row_mask:0xf bank_mask:0xf
  v_alignbit_b32 v235, v235, v238, 31
  v_sub_u32_dpp v238, v234, v234 row_ror:7 row_mask:0xf bank_mask:0xf
  v_mfma_f32_16x16x32_bf16 v[16:19], a[12:15], a[108:111], v[16:19]
  v_exp_f32 v43, v43
  v_alignbit_b32 v235, v235, v238, 31
  s_waitcnt lgkmcnt(0)
  v_mfma_f32_16x16x32_bf16 v[88:91], a[32:35], v[48:51], v[88:91]
  v_bcnt_u32_b32 v235, v235, 0
  v_lshlrev_b32 v235, 2, v235
  v_cvt_pk_bf16_f32 v61, v42, v43
  v_mfma_f32_16x16x32_bf16 v[120:123], a[32:35], v[52:55], v[120:123]
  v_exp_f32 v36, v36
  v_lshlrev_b32 v237, v235, v237
  v_mfma_f32_16x16x32_bf16 v[92:95], a[36:39], v[48:51], v[92:95]
  v_bfe_u32 v236, s83, v235, 3
  s_nop 0
  v_or_b32_dpp v237, v237, v237 row_ror:1 row_mask:0xf bank_mask:0xf
  v_mfma_f32_16x16x32_bf16 v[124:127], a[36:39], v[52:55], v[124:127]
  v_exp_f32 v37, v37
  v_readlane_b32 s82, v236, s84
  v_mfma_f32_16x16x32_bf16 v[96:99], a[40:43], v[48:51], v[96:99]
  s_lshl_b32 s39, s82, 2
  v_or_b32_dpp v237, v237, v237 row_ror:2 row_mask:0xf bank_mask:0xf
  v_cvt_pk_bf16_f32 v58, v36, v37
  v_mfma_f32_16x16x32_bf16 v[128:131], a[40:43], v[52:55], v[128:131]
  v_exp_f32 v38, v38
  s_lshr_b32 s28, s28, s39
  v_mfma_f32_16x16x32_bf16 v[100:103], a[44:47], v[48:51], v[100:103]
  s_and_b32 s28, s28, 7
  v_or_b32_dpp v237, v237, v237 row_ror:4 row_mask:0xf bank_mask:0xf
  s_mul_i32 s39, s82, 6
  v_mfma_f32_16x16x32_bf16 v[132:135], a[44:47], v[52:55], v[132:135]
  v_exp_f32 v39, v39
  s_add_u32 s39, s39, s28
  v_mfma_f32_16x16x32_bf16 v[104:107], a[48:51], v[48:51], v[104:107]
  s_lshr_b32 s40, s39, 4
  s_sub_u32 s39, s39, s40
  v_cvt_pk_bf16_f32 v59, v38, v39
  v_mfma_f32_16x16x32_bf16 v[136:139], a[48:51], v[52:55], v[136:139]
  v_exp_f32 v44, v44
  s_sub_u32 s39, s39, s40
  v_mfma_f32_16x16x32_bf16 v[108:111], a[52:55], v[48:51], v[108:111]
  s_and_b32 s29, s39, 15
  s_mul_i32 s39, s29, 20
  s_add_u32 s30, s30, s39
  v_mfma_f32_16x16x32_bf16 v[140:143], a[52:55], v[52:55], v[140:143]
  v_exp_f32 v45, v45
  s_mul_i32 s39, s29, 163840
  v_mfma_f32_16x16x32_bf16 v[112:115], a[56:59], v[48:51], v[112:115]
  s_add_u32 s31, s31, s39
  s_mul_i32 s39, s29, 1490944
  v_cvt_pk_bf16_f32 v62, v44, v45
  v_mfma_f32_16x16x32_bf16 v[144:147], a[56:59], v[52:55], v[144:147]
  v_exp_f32 v46, v46
  s_add_u32 s20, s20, s39
  v_mfma_f32_16x16x32_bf16 v[116:119], a[60:63], v[48:51], v[116:119]
  s_lshl_b32 s39, s82, 3
  s_lshr_b64 s[56:57], s[56:57], s39
  v_mfma_f32_16x16x32_bf16 v[148:151], a[60:63], v[52:55], v[148:151]
  v_exp_f32 v47, v47
  s_and_b32 s5, s56, 31
  v_mfma_f32_16x16x32_bf16 v[216:219], a[192:195], v[48:51], v[216:219]
  s_bfe_u32 s4, s56, 0x30005
  v_cvt_pk_bf16_f32 v63, v46, v47
  v_mfma_f32_16x16x32_bf16 v[220:223], a[192:195], v[52:55], v[220:223]
  s_mul_i32 s13, s5, 81920
  v_mfma_f32_16x16x32_bf16 v[32:35], a[0:3], a[160:163], 0
  s_add_u32 s13, s13, s25
  s_lshl_b32 s12, s5, 11
  v_mfma_f32_16x16x32_bf16 v[32:35], a[4:7], a[164:167], v[32:35]
  v_exp_f32 v16, v16
  s_add_u32 s12, s12, s20
  v_mfma_f32_16x16x32_bf16 v[40:43], a[0:3], a[176:179], 0
  s_add_u32 s12, s12, 131072
  v_mfma_f32_16x16x32_bf16 v[40:43], a[4:7], a[180:183], v[40:43]
  v_exp_f32 v17, v17
  v_mfma_f32_16x16x32_bf16 v[44:47], a[16:19], a[176:179], 0
  ds_read_b128 a[0:3], v1 offset:0
  ds_read_b128 a[4:7], v1 offset:1024
  v_cvt_pk_bf16_f32 v48, v16, v17
  v_mfma_f32_16x16x32_bf16 v[44:47], a[20:23], a[180:183], v[44:47]
  v_exp_f32 v18, v18
  v_mfma_f32_16x16x32_bf16 v[36:39], a[16:19], a[160:163], 0
  s_cmp_lt_u32 s28, 6
  s_cselect_b32 s28, s40, 3
  s_cselect_b32 s12, s12, 1073741824
  s_cselect_b32 s13, s13, 1073741824
  v_mfma_f32_16x16x32_bf16 v[36:39], a[20:23], a[164:167], v[36:39]
  v_exp_f32 v19, v19
  v_readfirstlane_b32 s81, v237
  s_lshl_b32 s59, s29, 2
  v_mfma_f32_16x16x32_bf16 v[36:39], a[24:27], a[168:171], v[36:39]
  s_add_u32 s55, s59, s36
  s_add_u32 s59, s59, s37
  s_lshl_b32 s59, s59, 7
  v_cvt_pk_bf16_f32 v49, v18, v19
  v_mfma_f32_16x16x32_bf16 v[36:39], a[28:31], a[172:175], v[36:39]
  v_exp_f32 v24, v24
  ds_read_b128 a[16:19], v1 offset:4096
  s_add_u32 s59, s59, 83886080
  v_mfma_f32_16x16x32_bf16 v[44:47], a[24:27], a[184:187], v[44:47]
  ds_read_b128 a[20:23], v1 offset:5120
  s_lshl_b32 s55, s55, 7
  s_add_u32 s55, s55, 84938752
  s_mov_b32 s51, 0
  v_mfma_f32_16x16x32_bf16 v[44:47], a[28:31], a[188:191], v[44:47]
  v_exp_f32 v25, v25
  s_cmp_ge_u32 s29, 6
  s_cselect_b32 s82, 1, 0
  v_mfma_f32_16x16x32_bf16 v[40:43], a[8:11], a[184:187], v[40:43]
  ds_read_b128 a[24:27], v1 offset:6144
  s_add_u32 s84, s82, 6
  ds_read_b128 a[28:31], v1 offset:7168
  v_cvt_pk_bf16_f32 v52, v24, v25
  v_mfma_f32_16x16x32_bf16 v[40:43], a[12:15], a[188:191], v[40:43]
  v_exp_f32 v26, v26
  v_mfma_f32_16x16x32_bf16 v[32:35], a[8:11], a[168:171], v[32:35]
  s_cmp_ge_u32 s29, 12
  s_cselect_b32 s82, 2, s82
  s_cselect_b32 s84, 5, s84
  s_add_u32 s83, s82, 3
  v_mfma_f32_16x16x32_bf16 v[32:35], a[12:15], a[172:175], v[32:35]
  v_exp_f32 v27, v27
  s_cmp_ge_u32 s29, 14
  s_cselect_b32 s83, 2, s83
  v_mfma_f32_16x16x32_bf16 v[152:155], a[32:35], v[56:59], v[152:155]
  v_cmp_eq_u32 vcc, s82, v236
  ds_read_b128 a[8:11], v1 offset:2048
  s_ff1_i32_b32 s82, vcc_lo
  v_cvt_pk_bf16_f32 v53, v26, v27
  v_mfma_f32_16x16x32_bf16 v[184:187], a[32:35], v[60:63], v[184:187]
  v_exp_f32 v20, v20
  v_readlane_b32 s82, v234, s82
  ds_read_b128 a[12:15], v1 offset:3072
  v_mfma_f32_16x16x32_bf16 v[156:159], a[36:39], v[56:59], v[156:159]
  v_cmp_eq_u32 vcc, s83, v236
  s_ff1_i32_b32 s83, vcc_lo
  v_readlane_b32 s83, v234, s83
  v_cmp_eq_u32 vcc, s84, v236
  v_mfma_f32_16x16x32_bf16 v[188:191], a[36:39], v[60:63], v[188:191]
  v_exp_f32 v21, v21
  s_ff1_i32_b32 s84, vcc_lo
  v_mfma_f32_16x16x32_bf16 v[160:163], a[40:43], v[56:59], v[160:163]
  v_readlane_b32 s84, v234, s84
  v_cvt_pk_bf16_f32 v50, v20, v21
  v_mfma_f32_16x16x32_bf16 v[192:195], a[40:43], v[60:63], v[192:195]
  v_exp_f32 v22, v22
  s_add_u32 s83, s83, s82
  s_add_u32 s83, s83, s84
  v_mfma_f32_16x16x32_bf16 v[164:167], a[44:47], v[56:59], v[164:167]
  s_mul_i32 s82, s82, 3
  v_mfma_f32_16x16x32_bf16 v[196:199], a[44:47], v[60:63], v[196:199]
  v_exp_f32 v23, v23
  s_sub_u32 s82, s83, s82
  v_mfma_f32_16x16x32_bf16 v[168:171], a[48:51], v[56:59], v[168:171]
  s_mul_hi_i32 s82, s82, 19884107
  s_mov_b32 s6, 0x78897978
  v_cvt_pk_bf16_f32 v51, v22, v23
  v_mfma_f32_16x16x32_bf16 v[200:203], a[48:51], v[60:63], v[200:203]
  v_exp_f32 v28, v28
  s_mov_b32 s7, 0x78788979
  v_mfma_f32_16x16x32_bf16 v[172:175], a[52:55], v[56:59], v[172:175]
  s_add_u32 s75, s75, 32768
  s_and_b32 s75, s75, 0x1ffff
  s_lshl_b32 s39, s29, 2
  v_mfma_f32_16x16x32_bf16 v[204:207], a[52:55], v[60:63], v[204:207]
  v_exp_f32 v29, v29
  s_lshr_b64 s[6:7], s[6:7], s39
  s_and_b32 s6, s6, 15
  v_mfma_f32_16x16x32_bf16 v[176:179], a[56:59], v[56:59], v[176:179]
  s_mul_i32 s6, s6, 76
  v_cvt_pk_bf16_f32 v54, v28, v29
  v_mfma_f32_16x16x32_bf16 v[208:211], a[56:59], v[60:63], v[208:211]
  v_exp_f32 v30, v30
  s_add_u32 s82, s82, s6
  v_mfma_f32_16x16x32_bf16 v[180:183], a[60:63], v[56:59], v[180:183]
  s_add_u32 s82, s82, 4981
  s_ashr_i32 s82, s82, 8
  v_mfma_f32_16x16x32_bf16 v[212:215], a[60:63], v[60:63], v[212:215]
  v_exp_f32 v31, v31
  v_add_u32 v1, s75, v2
  s_max_i32 s82, s82, 12
  v_mfma_f32_16x16x32_bf16 v[224:227], a[192:195], v[56:59], v[224:227]
  s_min_i32 s82, s82, 26
  v_cvt_pk_bf16_f32 v55, v30, v31
  v_mfma_f32_16x16x32_bf16 v[228:231], a[192:195], v[60:63], v[228:231]
  s_mul_i32 s84, s84, 3
  s_waitcnt lgkmcnt(0)
  s_barrier
  v_mfma_f32_16x16x32_bf16 v[16:19], a[0:3], a[96:99], v[72:75]
  ds_read_b128 a[32:35], v1 offset:16384
  ds_read_b128 a[36:39], v1 offset:17408
  s_sub_u32 s84, s83, s84
  v_mfma_f32_16x16x32_bf16 v[16:19], a[4:7], a[100:103], v[16:19]
  v_exp_f32 v32, v32
  ds_read_b128 a[40:43], v1 offset:18432
  v_mfma_f32_16x16x32_bf16 v[24:27], a[0:3], a[112:115], 0
  s_mul_hi_i32 s84, s84, 19884107
  ds_read_b128 a[44:47], v1 offset:19456
  v_mfma_f32_16x16x32_bf16 v[24:27], a[4:7], a[116:119], v[24:27]
  v_exp_f32 v33, v33
  ds_read_b128 a[48:51], v1 offset:20480
  v_mfma_f32_16x16x32_bf16 v[28:31], a[16:19], a[112:115], 0
  s_mov_b32 s6, 0x79789779
  ds_read_b128 a[52:55], v1 offset:21504
  v_cvt_pk_bf16_f32 v56, v32, v33
  v_mfma_f32_16x16x32_bf16 v[28:31], a[20:23], a[116:119], v[28:31]
  v_exp_f32 v34, v34
  ds_read_b128 a[56:59], v1 offset:22528
  v_mfma_f32_16x16x32_bf16 v[20:23], a[16:19], a[96:99], v[76:79]
  s_mov_b32 s7, 0x77997897
  ds_read_b128 a[60:63], v1 offset:23552
  s_lshl_b32 s39, s29, 2
  v_mfma_f32_16x16x32_bf16 v[20:23], a[20:23], a[100:103], v[20:23]
  v_exp_f32 v35, v35
  s_add_u32 m0, s73, 32768
  v_mfma_f32_16x16x32_bf16 v[20:23], a[24:27], a[104:107], v[20:23]
  s_lshr_b64 s[6:7], s[6:7], s39
  v_cvt_pk_bf16_f32 v57, v34, v35
  v_mfma_f32_16x16x32_bf16 v[20:23], a[28:31], a[108:111], v[20:23]
  v_exp_f32 v40, v40
  v_mfma_f32_16x16x32_bf16 v[28:31], a[24:27], a[120:123], v[28:31]
  buffer_load_dwordx4 v10, s[32:35], s12 offen offset:0 sc1 lds
  s_and_b32 s6, s6, 15
  v_mfma_f32_16x16x32_bf16 v[28:31], a[28:31], a[124:127], v[28:31]
  v_exp_f32 v41, v41
  v_mfma_f32_16x16x32_bf16 v[24:27], a[8:11], a[120:123], v[24:27]
  s_mul_i32 s6, s6, 76
  v_cvt_pk_bf16_f32 v60, v40, v41
  v_mfma_f32_16x16x32_bf16 v[24:27], a[12:15], a[124:127], v[24:27]
  v_exp_f32 v42, v42
  s_add_u32 s84, s84, s6
  v_mfma_f32_16x16x32_bf16 v[16:19], a[8:11], a[104:107], v[16:19]
  buffer_load_dwordx4 v10, s[32:35], s12 offen offset:1024 sc1 lds
  v_mfma_f32_16x16x32_bf16 v[16:19], a[12:15], a[108:111], v[16:19]
  v_exp_f32 v43, v43
  s_add_u32 s84, s84, 4981
  s_waitcnt lgkmcnt(0)
  v_mfma_f32_16x16x32_bf16 v[88:91], a[32:35], v[48:51], v[88:91]
  buffer_load_dwordx4 v240, s[32:35], s12 offen offset:2048 sc1 lds
  v_cvt_pk_bf16_f32 v61, v42, v43
  v_mfma_f32_16x16x32_bf16 v[120:123], a[32:35], v[52:55], v[120:123]
  v_exp_f32 v36, v36
  s_ashr_i32 s84, s84, 8
  v_mfma_f32_16x16x32_bf16 v[92:95], a[36:39], v[48:51], v[92:95]
  buffer_load_dwordx4 v240, s[32:35], s12 offen offset:3072 sc1 lds
  v_mfma_f32_16x16x32_bf16 v[124:127], a[36:39], v[52:55], v[124:127]
  v_exp_f32 v37, v37
  s_max_i32 s84, s84, 12
  v_mfma_f32_16x16x32_bf16 v[96:99], a[40:43], v[48:51], v[96:99]
  s_add_u32 m0, s73, 49152
  s_add_u32 s12, s12, 2048
  v_cvt_pk_bf16_f32 v58, v36, v37
  v_mfma_f32_16x16x32_bf16 v[128:131], a[40:43], v[52:55], v[128:131]
  v_exp_f32 v38, v38
  s_min_i32 s84, s84, 26
  v_mfma_f32_16x16x32_bf16 v[100:103], a[44:47], v[48:51], v[100:103]
  s_sub_u32 s84, 64, s84
  buffer_load_dwordx4 v241, s[8:11], s13 offen offset:0  lds
  v_mfma_f32_16x16x32_bf16 v[132:135], a[44:47], v[52:55], v[132:135]
  v_exp_f32 v39, v39
  v_mfma_f32_16x16x32_bf16 v[104:107], a[48:51], v[48:51], v[104:107]
  s_add_u32 s83, s82, 26
  v_cvt_pk_bf16_f32 v59, v38, v39
  v_mfma_f32_16x16x32_bf16 v[136:139], a[48:51], v[52:55], v[136:139]
  v_exp_f32 v44, v44
  v_mfma_f32_16x16x32_bf16 v[108:111], a[52:55], v[48:51], v[108:111]
  buffer_load_dwordx4 v242, s[8:11], s13 offen offset:1024  lds
  s_min_i32 s84, s84, s83
  v_mfma_f32_16x16x32_bf16 v[140:143], a[52:55], v[52:55], v[140:143]
  v_exp_f32 v45, v45
  s_add_u32 s83, s82, 12
  v_mfma_f32_16x16x32_bf16 v[112:115], a[56:59], v[48:51], v[112:115]
  buffer_load_dwordx4 v243, s[8:11], s13 offen offset:2048  lds
  v_cvt_pk_bf16_f32 v62, v44, v45
  v_mfma_f32_16x16x32_bf16 v[144:147], a[56:59], v[52:55], v[144:147]
  v_exp_f32 v46, v46
  s_max_i32 s84, s84, s83
  v_mfma_f32_16x16x32_bf16 v[116:119], a[60:63], v[48:51], v[116:119]
  buffer_load_dwordx4 v244, s[8:11], s13 offen offset:3072  lds
  v_mfma_f32_16x16x32_bf16 v[148:151], a[60:63], v[52:55], v[148:151]
  v_exp_f32 v47, v47
  s_lshl_b32 s84, s84, 8
  v_mfma_f32_16x16x32_bf16 v[216:219], a[192:195], v[48:51], v[216:219]
  s_add_u32 s13, s13, 81920
  v_cvt_pk_bf16_f32 v63, v46, v47
  v_mfma_f32_16x16x32_bf16 v[220:223], a[192:195], v[52:55], v[220:223]
  s_or_b32 s82, s82, s84
  v_mfma_f32_16x16x32_bf16 v[32:35], a[0:3], a[160:163], 0
  s_lshr_b32 s83, s82, 1
  v_mfma_f32_16x16x32_bf16 v[32:35], a[4:7], a[164:167], v[32:35]
  v_exp_f32 v16, v16
  s_and_b32 s83, s83, 0x7f7f
  v_mfma_f32_16x16x32_bf16 v[40:43], a[0:3], a[176:179], 0
  s_add_u32 m0, s41, 131072
  s_sub_u32 s82, s82, s83
  v_mfma_f32_16x16x32_bf16 v[40:43], a[4:7], a[180:183], v[40:43]
  v_exp_f32 v17, v17
  v_mfma_f32_16x16x32_bf16 v[44:47], a[16:19], a[176:179], 0
  ds_read_b128 a[0:3], v1 offset:0
  ds_read_b128 a[4:7], v1 offset:1024
  v_cvt_pk_bf16_f32 v48, v16, v17
  v_mfma_f32_16x16x32_bf16 v[44:47], a[20:23], a[180:183], v[44:47]
  v_exp_f32 v18, v18
  s_lshl_b32 s82, s82, 8
  v_mfma_f32_16x16x32_bf16 v[36:39], a[16:19], a[160:163], 0
  buffer_load_dwordx4 v10, s[32:35], s12 offen offset:0 sc1 lds
  s_lshl_b32 s83, s83, 8
  v_mfma_f32_16x16x32_bf16 v[36:39], a[20:23], a[164:167], v[36:39]
  v_exp_f32 v19, v19
  s_add_u32 s82, s82, 0x20000000
  v_mfma_f32_16x16x32_bf16 v[36:39], a[24:27], a[168:171], v[36:39]
  ds_read_b128 a[16:19], v1 offset:4096
  ds_read_b128 a[20:23], v1 offset:5120
  v_cvt_pk_bf16_f32 v49, v18, v19
  v_mfma_f32_16x16x32_bf16 v[36:39], a[28:31], a[172:175], v[36:39]
  v_exp_f32 v24, v24
  s_add_u32 s83, s83, 0x40202020
  v_mfma_f32_16x16x32_bf16 v[44:47], a[24:27], a[184:187], v[44:47]
  buffer_load_dwordx4 v10, s[32:35], s12 offen offset:1024 sc1 lds
  s_lshl_b32 s39, s28, 3
  v_mfma_f32_16x16x32_bf16 v[44:47], a[28:31], a[188:191], v[44:47]
  v_exp_f32 v25, v25
  ds_read_b128 a[24:27], v1 offset:6144
  v_mfma_f32_16x16x32_bf16 v[40:43], a[8:11], a[184:187], v[40:43]
  buffer_load_dwordx4 v240, s[32:35], s12 offen offset:2048 sc1 lds
  v_cvt_pk_bf16_f32 v52, v24, v25
  v_mfma_f32_16x16x32_bf16 v[40:43], a[12:15], a[188:191], v[40:43]
  v_exp_f32 v26, v26
  s_lshr_b32 s82, s82, s39
  v_mfma_f32_16x16x32_bf16 v[32:35], a[8:11], a[168:171], v[32:35]
  ds_read_b128 a[28:31], v1 offset:7168
  s_lshr_b32 s83, s83, s39
  s_bfe_u32 s84, s82, 0x80008
  v_mfma_f32_16x16x32_bf16 v[32:35], a[12:15], a[172:175], v[32:35]
  v_exp_f32 v27, v27
  ds_read_b128 a[8:11], v1 offset:2048
  v_mfma_f32_16x16x32_bf16 v[152:155], a[32:35], v[56:59], v[152:155]
  buffer_load_dwordx4 v240, s[32:35], s12 offen offset:3072 sc1 lds
  v_cvt_pk_bf16_f32 v53, v26, v27
  v_mfma_f32_16x16x32_bf16 v[184:187], a[32:35], v[60:63], v[184:187]
  v_exp_f32 v20, v20
  s_and_b32 s82, s82, 255
  v_mfma_f32_16x16x32_bf16 v[156:159], a[36:39], v[56:59], v[156:159]
  ds_read_b128 a[12:15], v1 offset:3072
  s_sub_u32 s84, s84, s82
  s_bfe_u32 s29, s83, 0x80008
  v_mfma_f32_16x16x32_bf16 v[188:191], a[36:39], v[60:63], v[188:191]
  v_exp_f32 v21, v21
  s_and_b32 s83, s83, 255
  v_mfma_f32_16x16x32_bf16 v[160:163], a[40:43], v[56:59], v[160:163]
  s_add_u32 m0, s41, 147456
  s_add_u32 s12, s12, 2048
  v_cvt_pk_bf16_f32 v50, v20, v21
  v_mfma_f32_16x16x32_bf16 v[192:195], a[40:43], v[60:63], v[192:195]
  v_exp_f32 v22, v22
  s_sub_u32 s29, s29, s83
  v_mfma_f32_16x16x32_bf16 v[164:167], a[44:47], v[56:59], v[164:167]
  buffer_load_dwordx4 v241, s[8:11], s13 offen offset:0  lds
  s_bfm_b32 s50, s84, s4
  v_mfma_f32_16x16x32_bf16 v[196:199], a[44:47], v[60:63], v[196:199]
  v_exp_f32 v23, v23
  s_sub_u32 s82, s82, s4
  v_mfma_f32_16x16x32_bf16 v[168:171], a[48:51], v[56:59], v[168:171]
  buffer_load_dwordx4 v242, s[8:11], s13 offen offset:1024  lds
  v_cvt_pk_bf16_f32 v51, v22, v23
  v_mfma_f32_16x16x32_bf16 v[200:203], a[48:51], v[60:63], v[200:203]
  v_exp_f32 v28, v28
  s_add_u32 s84, s84, s4
  v_mfma_f32_16x16x32_bf16 v[172:175], a[52:55], v[56:59], v[172:175]
  buffer_load_dwordx4 v243, s[8:11], s13 offen offset:2048  lds
  s_sub_u32 s83, s83, s84
  v_mfma_f32_16x16x32_bf16 v[204:207], a[52:55], v[60:63], v[204:207]
  v_exp_f32 v29, v29
  v_cmp_gt_u32 vcc, s84, v0
  v_mfma_f32_16x16x32_bf16 v[176:179], a[56:59], v[56:59], v[176:179]
  v_add_u32 v12, s82, v0
  v_cvt_pk_bf16_f32 v54, v28, v29
  v_mfma_f32_16x16x32_bf16 v[208:211], a[56:59], v[60:63], v[208:211]
  v_exp_f32 v30, v30
  v_mfma_f32_16x16x32_bf16 v[180:183], a[60:63], v[56:59], v[180:183]
  buffer_load_dwordx4 v244, s[8:11], s13 offen offset:3072  lds
  v_add_u32 v13, s83, v0
  v_mfma_f32_16x16x32_bf16 v[212:215], a[60:63], v[60:63], v[212:215]
  v_exp_f32 v31, v31
  v_xor_b32 v1, 8192, v1
  v_mfma_f32_16x16x32_bf16 v[224:227], a[192:195], v[56:59], v[224:227]
  v_cndmask_b32 v12, v13, v12, vcc
  s_add_u32 s13, s13, 81920
  v_cvt_pk_bf16_f32 v55, v30, v31
  v_mfma_f32_16x16x32_bf16 v[228:231], a[192:195], v[60:63], v[228:231]
  v_cmp_gt_u32 vcc, s4, v0
  s_waitcnt lgkmcnt(7)
  v_mfma_f32_16x16x32_bf16 v[24:27], a[0:3], a[112:115], v[80:83]
  ds_read_b128 a[32:35], v1 offset:16384
  ds_read_b128 a[36:39], v1 offset:17408
  v_lshrrev_b32 v13, 1, v12
  s_waitcnt lgkmcnt(8)
  v_mfma_f32_16x16x32_bf16 v[24:27], a[4:7], a[116:119], v[24:27]
  v_exp_f32 v32, v32
  ds_read_b128 a[40:43], v1 offset:18432
  v_and_b32 v13, 28, v13
  s_waitcnt lgkmcnt(8)
  v_mfma_f32_16x16x32_bf16 v[28:31], a[16:19], a[112:115], v[84:87]
  v_exp_f32 v33, v33
  ds_read_b128 a[44:47], v1 offset:19456
  v_bfe_u32 v13, s81, v13, 3
  s_waitcnt lgkmcnt(8)
  v_mfma_f32_16x16x32_bf16 v[28:31], a[20:23], a[116:119], v[28:31]
  ds_read_b128 a[48:51], v1 offset:20480
  v_and_b32 v12, 7, v12
  v_cvt_pk_bf16_f32 v56, v32, v33
  s_waitcnt lgkmcnt(8)
  v_mfma_f32_16x16x32_bf16 v[28:31], a[24:27], a[120:123], v[28:31]
  v_exp_f32 v34, v34
  ds_read_b128 a[52:55], v1 offset:21504
  s_waitcnt lgkmcnt(8)
  v_mfma_f32_16x16x32_bf16 v[28:31], a[28:31], a[124:127], v[28:31]
  v_exp_f32 v35, v35
  ds_read_b128 a[56:59], v1 offset:22528
  v_lshl_or_b32 v12, v13, 3, v12
  s_waitcnt lgkmcnt(8)
  v_mfma_f32_16x16x32_bf16 v[24:27], a[8:11], a[120:123], v[24:27]
  ds_read_b128 a[60:63], v1 offset:23552
  s_add_u32 s82, s5, 69
  v_cvt_pk_bf16_f32 v57, v34, v35
  s_waitcnt lgkmcnt(8)
  v_mfma_f32_16x16x32_bf16 v[24:27], a[12:15], a[124:127], v[24:27]
  v_exp_f32 v40, v40
  s_add_u32 m0, s74, 65536
  v_add_u32 v13, s82, v0
  s_waitcnt lgkmcnt(7)
  v_mfma_f32_16x16x32_bf16 v[88:91], a[32:35], v[48:51], v[88:91]
  v_exp_f32 v41, v41
  v_cndmask_b32 v12, v12, v13, vcc
  v_mfma_f32_16x16x32_bf16 v[120:123], a[32:35], v[52:55], v[120:123]
  v_cvt_pk_bf16_f32 v60, v40, v41
  s_waitcnt lgkmcnt(6)
  v_mfma_f32_16x16x32_bf16 v[92:95], a[36:39], v[48:51], v[92:95]
  v_exp_f32 v42, v42
  buffer_load_dwordx4 v10, s[32:35], s12 offen offset:0 sc1 lds
  v_mfma_f32_16x16x32_bf16 v[124:127], a[36:39], v[52:55], v[124:127]
  v_exp_f32 v43, v43
  s_add_u32 s82, s84, s29
  v_lshl_add_u32 v68, v12, 11, s20
  s_waitcnt lgkmcnt(5)
  v_mfma_f32_16x16x32_bf16 v[96:99], a[40:43], v[48:51], v[96:99]
  v_cmp_gt_u32 vcc, s82, v0
  v_cvt_pk_bf16_f32 v61, v42, v43
  v_mfma_f32_16x16x32_bf16 v[128:131], a[40:43], v[52:55], v[128:131]
  v_exp_f32 v36, v36
  buffer_load_dwordx4 v10, s[32:35], s12 offen offset:1024 sc1 lds
  s_waitcnt lgkmcnt(4)
  v_mfma_f32_16x16x32_bf16 v[100:103], a[44:47], v[48:51], v[100:103]
  v_exp_f32 v37, v37
  v_and_b32 v13, 63, v12
  v_mfma_f32_16x16x32_bf16 v[132:135], a[44:47], v[52:55], v[132:135]
  v_mul_u32_u24 v13, 81920, v13
  v_cvt_pk_bf16_f32 v58, v36, v37
  s_waitcnt lgkmcnt(3)
  v_mfma_f32_16x16x32_bf16 v[104:107], a[48:51], v[48:51], v[104:107]
  v_exp_f32 v38, v38
  v_add_u32 v69, s25, v13
  v_mfma_f32_16x16x32_bf16 v[136:139], a[48:51], v[52:55], v[136:139]
  v_exp_f32 v39, v39
  buffer_load_dwordx4 v240, s[32:35], s12 offen offset:2048 sc1 lds
  s_waitcnt lgkmcnt(2)
  v_mfma_f32_16x16x32_bf16 v[108:111], a[52:55], v[48:51], v[108:111]
  v_lshlrev_b32 v12, 1, v12
  v_and_b32 v70, 0x7c, v12
  v_cvt_pk_bf16_f32 v59, v38, v39
  v_mfma_f32_16x16x32_bf16 v[140:143], a[52:55], v[52:55], v[140:143]
  v_exp_f32 v44, v44
  s_waitcnt lgkmcnt(1)
  v_mfma_f32_16x16x32_bf16 v[112:115], a[56:59], v[48:51], v[112:115]
  v_exp_f32 v45, v45
  buffer_load_dwordx4 v240, s[32:35], s12 offen offset:3072 sc1 lds
  v_mfma_f32_16x16x32_bf16 v[144:147], a[56:59], v[52:55], v[144:147]
  v_cndmask_b32 v68, v245, v68, vcc
  v_cndmask_b32 v69, v245, v69, vcc
  v_cvt_pk_bf16_f32 v62, v44, v45
  s_waitcnt lgkmcnt(0)
  v_mfma_f32_16x16x32_bf16 v[116:119], a[60:63], v[48:51], v[116:119]
  v_exp_f32 v46, v46
  s_bfm_b32 s20, s29, s84
  v_mfma_f32_16x16x32_bf16 v[148:151], a[60:63], v[52:55], v[148:151]
  v_exp_f32 v47, v47
  s_sub_u32 s25, s84, 6
  v_mfma_f32_16x16x32_bf16 v[216:219], a[192:195], v[48:51], v[216:219]
  s_add_u32 m0, s74, 81920
  s_add_u32 s12, s12, 2048
  v_cvt_pk_bf16_f32 v63, v46, v47
  v_mfma_f32_16x16x32_bf16 v[220:223], a[192:195], v[52:55], v[220:223]
  s_sub_u32 s25, s25, s4
  v_mfma_f32_16x16x32_bf16 v[32:35], a[0:3], a[160:163], 0
  v_mfma_f32_16x16x32_bf16 v[32:35], a[4:7], a[164:167], v[32:35]
  v_exp_f32 v24, v24
  buffer_load_dwordx4 v241, s[8:11], s13 offen offset:0  lds
  v_mfma_f32_16x16x32_bf16 v[40:43], a[0:3], a[176:179], 0
  v_rcp_f32 v234, v216
  v_subrev_u32 v235, 0x1f800000, v216
  v_cmp_lt_u32 vcc, 0x40000000, v235
  v_mfma_f32_16x16x32_bf16 v[40:43], a[4:7], a[180:183], v[40:43]
  v_mul_f32 v234, v234, v3
  s_mov_b64 s[64:65], vcc
  v_mul_f32 v88, v88, v234
  v_mul_f32 v89, v89, v234
  v_mfma_f32_16x16x32_bf16 v[44:47], a[16:19], a[176:179], 0
  v_exp_f32 v25, v25
  ds_read_b128 a[0:3], v1 offset:0
  ds_read_b128 a[4:7], v1 offset:1024
  v_mfma_f32_16x16x32_bf16 v[44:47], a[20:23], a[180:183], v[44:47]
  v_mul_f32 v90, v90, v234
  v_mul_f32 v91, v91, v234
  v_mul_f32 v92, v92, v234
  v_cvt_pk_bf16_f32 v52, v24, v25
  v_mfma_f32_16x16x32_bf16 v[36:39], a[16:19], a[160:163], 0
  v_mul_f32 v93, v93, v234
  v_mul_f32 v94, v94, v234
  v_mfma_f32_16x16x32_bf16 v[36:39], a[20:23], a[164:167], v[36:39]
  v_exp_f32 v26, v26
  ds_read_b128 a[16:19], v1 offset:4096
  v_mul_f32 v95, v95, v234
  v_mfma_f32_16x16x32_bf16 v[36:39], a[24:27], a[168:171], v[36:39]
  v_cvt_pk_bf16_f32 v88, v88, v89
  ds_read_b128 a[20:23], v1 offset:5120
  buffer_load_dwordx4 v242, s[8:11], s13 offen offset:1024  lds
  v_mfma_f32_16x16x32_bf16 v[36:39], a[28:31], a[172:175], v[36:39]
  v_cvt_pk_bf16_f32 v89, v90, v91
  v_cvt_pk_bf16_f32 v90, v92, v93
  v_cvt_pk_bf16_f32 v91, v94, v95
  v_mfma_f32_16x16x32_bf16 v[44:47], a[24:27], a[184:187], v[44:47]
  v_exp_f32 v27, v27
  buffer_store_dwordx4 v[88:91], v10, s[32:35], s68 offen offset:0 sc1
  v_mfma_f32_16x16x32_bf16 v[44:47], a[28:31], a[188:191], v[44:47]
  v_mul_f32 v96, v96, v234
  ds_read_b128 a[24:27], v1 offset:6144
  v_mul_f32 v97, v97, v234
  v_cvt_pk_bf16_f32 v53, v26, v27
  v_mfma_f32_16x16x32_bf16 v[40:43], a[8:11], a[184:187], v[40:43]
  v_mul_f32 v98, v98, v234
  ds_read_b128 a[28:31], v1 offset:7168
  v_mul_f32 v99, v99, v234
  v_mul_f32 v100, v100, v234
  v_mfma_f32_16x16x32_bf16 v[40:43], a[12:15], a[188:191], v[40:43]
  v_exp_f32 v28, v28
  v_mul_f32 v101, v101, v234
  v_mul_f32 v102, v102, v234
  v_mfma_f32_16x16x32_bf16 v[32:35], a[8:11], a[168:171], v[32:35]
  v_mul_f32 v103, v103, v234
  v_mfma_f32_16x16x32_bf16 v[32:35], a[12:15], a[172:175], v[32:35]
  ds_read_b128 a[8:11], v1 offset:2048
  v_cvt_pk_bf16_f32 v96, v96, v97
  v_cvt_pk_bf16_f32 v97, v98, v99
  v_mfma_f32_16x16x32_bf16 v[152:155], a[32:35], v[56:59], v[152:155]
  v_exp_f32 v29, v29
  ds_read_b128 a[12:15], v1 offset:3072
  v_cvt_pk_bf16_f32 v98, v100, v101
  v_mfma_f32_16x16x32_bf16 v[184:187], a[32:35], v[60:63], v[184:187]
  buffer_load_dwordx4 v243, s[8:11], s13 offen offset:2048  lds
  v_cvt_pk_bf16_f32 v99, v102, v103
  v_cvt_pk_bf16_f32 v54, v28, v29
  v_mfma_f32_16x16x32_bf16 v[156:159], a[36:39], v[56:59], v[156:159]
  buffer_store_dwordx4 v[96:99], v10, s[32:35], s68 offen offset:1024 sc1
  v_mul_f32 v104, v104, v234
  v_mul_f32 v105, v105, v234
  v_mfma_f32_16x16x32_bf16 v[188:191], a[36:39], v[60:63], v[188:191]
  v_exp_f32 v30, v30
  v_mul_f32 v106, v106, v234
  v_mul_f32 v107, v107, v234
  v_mfma_f32_16x16x32_bf16 v[160:163], a[40:43], v[56:59], v[160:163]
  v_mul_f32 v108, v108, v234
  v_mul_f32 v109, v109, v234
  v_mfma_f32_16x16x32_bf16 v[192:195], a[40:43], v[60:63], v[192:195]
  v_mul_f32 v110, v110, v234
  v_mul_f32 v111, v111, v234
  v_mfma_f32_16x16x32_bf16 v[164:167], a[44:47], v[56:59], v[164:167]
  v_exp_f32 v31, v31
  v_cvt_pk_bf16_f32 v104, v104, v105
  v_cvt_pk_bf16_f32 v105, v106, v107
  v_mfma_f32_16x16x32_bf16 v[196:199], a[44:47], v[60:63], v[196:199]
  buffer_load_dwordx4 v244, s[8:11], s13 offen offset:3072  lds
  v_cvt_pk_bf16_f32 v106, v108, v109
  v_cvt_pk_bf16_f32 v55, v30, v31
  v_mfma_f32_16x16x32_bf16 v[168:171], a[48:51], v[56:59], v[168:171]
  v_cvt_pk_bf16_f32 v107, v110, v111
  buffer_store_dwordx4 v[104:107], v10, s[32:35], s68 offen offset:2048 sc1
  v_mfma_f32_16x16x32_bf16 v[200:203], a[48:51], v[60:63], v[200:203]
  v_mul_f32 v112, v112, v234
  v_mul_f32 v113, v113, v234
  v_mfma_f32_16x16x32_bf16 v[172:175], a[52:55], v[56:59], v[172:175]
  s_add_u32 s75, s75, 32768
  s_and_b32 s75, s75, 0x1ffff
  v_mul_f32 v114, v114, v234
  v_mul_f32 v115, v115, v234
  v_mfma_f32_16x16x32_bf16 v[204:207], a[52:55], v[60:63], v[204:207]
  v_mul_f32 v116, v116, v234
  v_mfma_f32_16x16x32_bf16 v[176:179], a[56:59], v[56:59], v[176:179]
  v_mul_f32 v117, v117, v234
  v_mul_f32 v118, v118, v234
  v_mfma_f32_16x16x32_bf16 v[208:211], a[56:59], v[60:63], v[208:211]
  v_mul_f32 v119, v119, v234
  v_cvt_pk_bf16_f32 v112, v112, v113
  v_mfma_f32_16x16x32_bf16 v[180:183], a[60:63], v[56:59], v[180:183]
  v_cvt_pk_bf16_f32 v113, v114, v115
  v_cvt_pk_bf16_f32 v114, v116, v117
  v_mfma_f32_16x16x32_bf16 v[212:215], a[60:63], v[60:63], v[212:215]
  v_add_u32 v1, s75, v2
  s_add_u32 s13, s13, 81920
  v_cvt_pk_bf16_f32 v115, v118, v119
  v_mfma_f32_16x16x32_bf16 v[224:227], a[192:195], v[56:59], v[224:227]
  buffer_store_dwordx4 v[112:115], v10, s[32:35], s68 offen offset:3072 sc1
  v_mfma_f32_16x16x32_bf16 v[228:231], a[192:195], v[60:63], v[228:231]
L_j_t2:
  s_waitcnt lgkmcnt(0)
  s_barrier
  v_mfma_f32_16x16x32_bf16 v[24:27], a[0:3], a[112:115], v[72:75]
  ds_read_b128 a[32:35], v1 offset:16384
  ds_read_b128 a[36:39], v1 offset:17408
  v_mfma_f32_16x16x32_bf16 v[24:27], a[4:7], a[116:119], v[24:27]
  v_exp_f32 v32, v32
  v_exp_f32 v33, v33
  v_mfma_f32_16x16x32_bf16 v[28:31], a[16:19], a[112:115], v[76:79]
  v_exp_f32 v34, v34
  ds_read_b128 a[40:43], v1 offset:18432
  ds_read_b128 a[44:47], v1 offset:19456
  v_mfma_f32_16x16x32_bf16 v[28:31], a[20:23], a[116:119], v[28:31]
  v_exp_f32 v35, v35
  ds_read_b128 a[48:51], v1 offset:20480
  v_mfma_f32_16x16x32_bf16 v[28:31], a[24:27], a[120:123], v[28:31]
  v_exp_f32 v40, v40
  ds_read_b128 a[52:55], v1 offset:21504
  s_add_u32 m0, s74, 98304
  v_mfma_f32_16x16x32_bf16 v[28:31], a[28:31], a[124:127], v[28:31]
  v_exp_f32 v41, v41
  ds_read_b128 a[56:59], v1 offset:22528
  v_mfma_f32_16x16x32_bf16 v[24:27], a[8:11], a[120:123], v[24:27]
  v_exp_f32 v42, v42
  ds_read_b128 a[60:63], v1 offset:23552
  v_mfma_f32_16x16x32_bf16 v[24:27], a[12:15], a[124:127], v[24:27]
  v_exp_f32 v43, v43
  s_waitcnt lgkmcnt(7)
  v_mfma_f32_16x16x32_bf16 v[120:123], a[32:35], v[52:55], v[120:123]
  v_exp_f32 v36, v36
  s_waitcnt lgkmcnt(6)
  v_mfma_f32_16x16x32_bf16 v[124:127], a[36:39], v[52:55], v[124:127]
  v_exp_f32 v37, v37
  s_waitcnt lgkmcnt(5)
  v_mfma_f32_16x16x32_bf16 v[128:131], a[40:43], v[52:55], v[128:131]
  v_exp_f32 v38, v38
  s_waitcnt lgkmcnt(4)
  v_mfma_f32_16x16x32_bf16 v[132:135], a[44:47], v[52:55], v[132:135]
  v_exp_f32 v39, v39
  s_waitcnt lgkmcnt(3)
  v_mfma_f32_16x16x32_bf16 v[136:139], a[48:51], v[52:55], v[136:139]
  v_exp_f32 v44, v44
  s_waitcnt lgkmcnt(2)
  v_mfma_f32_16x16x32_bf16 v[140:143], a[52:55], v[52:55], v[140:143]
  v_exp_f32 v45, v45
  s_waitcnt lgkmcnt(1)
  v_mfma_f32_16x16x32_bf16 v[144:147], a[56:59], v[52:55], v[144:147]
  v_exp_f32 v46, v46
  v_xor_b32 v1, 8192, v1
  s_waitcnt lgkmcnt(0)
  v_mfma_f32_16x16x32_bf16 v[148:151], a[60:63], v[52:55], v[148:151]
  v_exp_f32 v47, v47
  buffer_load_dwordx4 v10, s[32:35], s12 offen offset:0 sc1 lds
  v_mfma_f32_16x16x32_bf16 v[220:223], a[192:195], v[52:55], v[220:223]
  v_cvt_pk_bf16_f32 v56, v32, v33
  v_cvt_pk_bf16_f32 v57, v34, v35
  v_cvt_pk_bf16_f32 v60, v40, v41
  v_cvt_pk_bf16_f32 v61, v42, v43
  v_cvt_pk_bf16_f32 v58, v36, v37
  v_cvt_pk_bf16_f32 v59, v38, v39
  v_cvt_pk_bf16_f32 v62, v44, v45
  v_cvt_pk_bf16_f32 v63, v46, v47
  v_mfma_f32_16x16x32_bf16 v[32:35], a[0:3], a[160:163], 0
  v_mfma_f32_16x16x32_bf16 v[32:35], a[4:7], a[164:167], v[32:35]
  v_exp_f32 v24, v24
  v_mfma_f32_16x16x32_bf16 v[40:43], a[0:3], a[176:179], 0
  buffer_load_dwordx4 v10, s[32:35], s12 offen offset:1024 sc1 lds
  v_mfma_f32_16x16x32_bf16 v[40:43], a[4:7], a[180:183], v[40:43]
  buffer_load_dwordx4 v240, s[32:35], s12 offen offset:2048 sc1 lds
  v_mfma_f32_16x16x32_bf16 v[44:47], a[16:19], a[176:179], 0
  v_exp_f32 v25, v25
  v_mfma_f32_16x16x32_bf16 v[44:47], a[20:23], a[180:183], v[44:47]
  ds_read_b128 a[0:3], v1 offset:16384
  v_cvt_pk_bf16_f32 v52, v24, v25
  v_mfma_f32_16x16x32_bf16 v[36:39], a[16:19], a[160:163], 0
  ds_read_b128 a[4:7], v1 offset:17408
  v_mfma_f32_16x16x32_bf16 v[36:39], a[20:23], a[164:167], v[36:39]
  v_exp_f32 v26, v26
  v_mfma_f32_16x16x32_bf16 v[36:39], a[24:27], a[168:171], v[36:39]
  buffer_load_dwordx4 v240, s[32:35], s12 offen offset:3072 sc1 lds
  v_mfma_f32_16x16x32_bf16 v[36:39], a[28:31], a[172:175], v[36:39]
  s_add_u32 m0, s74, 114688
  s_add_u32 s12, s12, 2048
  v_mfma_f32_16x16x32_bf16 v[44:47], a[24:27], a[184:187], v[44:47]
  v_exp_f32 v27, v27
  v_mfma_f32_16x16x32_bf16 v[44:47], a[28:31], a[188:191], v[44:47]
  ds_read_b128 a[16:19], v1 offset:20480
  v_cvt_pk_bf16_f32 v53, v26, v27
  v_mfma_f32_16x16x32_bf16 v[40:43], a[8:11], a[184:187], v[40:43]
  buffer_load_dwordx4 v241, s[8:11], s13 offen offset:0  lds
  v_mfma_f32_16x16x32_bf16 v[40:43], a[12:15], a[188:191], v[40:43]
  v_exp_f32 v28, v28
  v_mfma_f32_16x16x32_bf16 v[32:35], a[8:11], a[168:171], v[32:35]
  ds_read_b128 a[20:23], v1 offset:21504
  ds_read_b128 a[24:27], v1 offset:22528
  v_mfma_f32_16x16x32_bf16 v[32:35], a[12:15], a[172:175], v[32:35]
  buffer_load_dwordx4 v242, s[8:11], s13 offen offset:1024  lds
  v_mfma_f32_16x16x32_bf16 v[152:155], a[32:35], v[56:59], v[152:155]
  v_exp_f32 v29, v29
  v_mfma_f32_16x16x32_bf16 v[184:187], a[32:35], v[60:63], v[184:187]
  ds_read_b128 a[28:31], v1 offset:23552
  v_cvt_pk_bf16_f32 v54, v28, v29
  v_mfma_f32_16x16x32_bf16 v[156:159], a[36:39], v[56:59], v[156:159]
  buffer_load_dwordx4 v243, s[8:11], s13 offen offset:2048  lds
  v_mfma_f32_16x16x32_bf16 v[188:191], a[36:39], v[60:63], v[188:191]
  v_exp_f32 v30, v30
  v_mfma_f32_16x16x32_bf16 v[160:163], a[40:43], v[56:59], v[160:163]
  buffer_load_dwordx4 v244, s[8:11], s13 offen offset:3072  lds
  v_mfma_f32_16x16x32_bf16 v[192:195], a[40:43], v[60:63], v[192:195]
  s_add_u32 s13, s13, 81920
  ds_read_b128 a[8:11], v1 offset:18432
  v_mfma_f32_16x16x32_bf16 v[164:167], a[44:47], v[56:59], v[164:167]
  v_exp_f32 v31, v31
  v_mfma_f32_16x16x32_bf16 v[196:199], a[44:47], v[60:63], v[196:199]
  ds_read_b128 a[12:15], v1 offset:19456
  v_cvt_pk_bf16_f32 v55, v30, v31
  v_mfma_f32_16x16x32_bf16 v[168:171], a[48:51], v[56:59], v[168:171]
  buffer_load_dword v248, v247, s[32:35], s59 offen offset:0 sc1
  v_mfma_f32_16x16x32_bf16 v[200:203], a[48:51], v[60:63], v[200:203]
  buffer_load_dword v249, v247, s[32:35], s59 offen offset:256 sc1
  v_mfma_f32_16x16x32_bf16 v[172:175], a[52:55], v[56:59], v[172:175]
  buffer_load_dword v250, v247, s[32:35], s59 offen offset:64 sc1
  v_mfma_f32_16x16x32_bf16 v[204:207], a[52:55], v[60:63], v[204:207]
  buffer_load_dword v251, v247, s[32:35], s59 offen offset:320 sc1
  v_mfma_f32_16x16x32_bf16 v[176:179], a[56:59], v[56:59], v[176:179]
  v_mfma_f32_16x16x32_bf16 v[208:211], a[56:59], v[60:63], v[208:211]
  v_mfma_f32_16x16x32_bf16 v[180:183], a[60:63], v[56:59], v[180:183]
  v_mfma_f32_16x16x32_bf16 v[212:215], a[60:63], v[60:63], v[212:215]
  v_mfma_f32_16x16x32_bf16 v[224:227], a[192:195], v[56:59], v[224:227]
  v_mfma_f32_16x16x32_bf16 v[228:231], a[192:195], v[60:63], v[228:231]
  s_waitcnt vmcnt(32) lgkmcnt(0)
  s_barrier
  v_mfma_f32_16x16x32_bf16 v[120:123], a[0:3], v[52:55], v[120:123]
  v_exp_f32 v32, v32
  v_mfma_f32_16x16x32_bf16 v[124:127], a[4:7], v[52:55], v[124:127]
  v_exp_f32 v33, v33
  v_mfma_f32_16x16x32_bf16 v[128:131], a[8:11], v[52:55], v[128:131]
  v_exp_f32 v34, v34
  v_mfma_f32_16x16x32_bf16 v[132:135], a[12:15], v[52:55], v[132:135]
  v_exp_f32 v35, v35
  v_mfma_f32_16x16x32_bf16 v[136:139], a[16:19], v[52:55], v[136:139]
  v_exp_f32 v36, v36
  v_mfma_f32_16x16x32_bf16 v[140:143], a[20:23], v[52:55], v[140:143]
  v_exp_f32 v37, v37
  v_mfma_f32_16x16x32_bf16 v[144:147], a[24:27], v[52:55], v[144:147]
  v_exp_f32 v38, v38
  v_mfma_f32_16x16x32_bf16 v[148:151], a[28:31], v[52:55], v[148:151]
  v_exp_f32 v39, v39
  v_mfma_f32_16x16x32_bf16 v[220:223], a[192:195], v[52:55], v[220:223]
  v_cvt_pk_bf16_f32 v56, v32, v33
  v_cvt_pk_bf16_f32 v57, v34, v35
  v_cvt_pk_bf16_f32 v58, v36, v37
  v_cvt_pk_bf16_f32 v59, v38, v39
  s_nop 1
  v_mfma_f32_16x16x32_bf16 v[152:155], a[0:3], v[56:59], v[152:155]
  v_exp_f32 v40, v40
  v_mfma_f32_16x16x32_bf16 v[156:159], a[4:7], v[56:59], v[156:159]
  v_exp_f32 v41, v41
  v_mfma_f32_16x16x32_bf16 v[160:163], a[8:11], v[56:59], v[160:163]
  v_exp_f32 v42, v42
  v_mfma_f32_16x16x32_bf16 v[164:167], a[12:15], v[56:59], v[164:167]
  v_exp_f32 v43, v43
  v_mfma_f32_16x16x32_bf16 v[168:171], a[16:19], v[56:59], v[168:171]
  v_exp_f32 v44, v44
  v_mfma_f32_16x16x32_bf16 v[172:175], a[20:23], v[56:59], v[172:175]
  v_exp_f32 v45, v45
  v_mfma_f32_16x16x32_bf16 v[176:179], a[24:27], v[56:59], v[176:179]
  v_exp_f32 v46, v46
  v_mfma_f32_16x16x32_bf16 v[180:183], a[28:31], v[56:59], v[180:183]
  v_exp_f32 v47, v47
  v_mfma_f32_16x16x32_bf16 v[224:227], a[192:195], v[56:59], v[224:227]
  v_cvt_pk_bf16_f32 v60, v40, v41
  v_cvt_pk_bf16_f32 v61, v42, v43
  v_cvt_pk_bf16_f32 v62, v44, v45
  v_cvt_pk_bf16_f32 v63, v46, v47
  s_nop 1
  v_mfma_f32_16x16x32_bf16 v[184:187], a[0:3], v[60:63], v[184:187]
  v_rcp_f32 v234, v220
  v_subrev_u32 v235, 0x1f800000, v220
  v_cmp_lt_u32 vcc, 0x40000000, v235
  v_mfma_f32_16x16x32_bf16 v[188:191], a[4:7], v[60:63], v[188:191]
  v_mul_f32 v234, v234, v4
  s_or_b64 s[64:65], s[64:65], vcc
  v_mfma_f32_16x16x32_bf16 v[192:195], a[8:11], v[60:63], v[192:195]
  v_mul_f32 v120, v120, v234
  v_mul_f32 v121, v121, v234
  v_mfma_f32_16x16x32_bf16 v[196:199], a[12:15], v[60:63], v[196:199]
  v_mul_f32 v122, v122, v234
  v_mul_f32 v123, v123, v234
  v_mfma_f32_16x16x32_bf16 v[200:203], a[16:19], v[60:63], v[200:203]
  v_mul_f32 v124, v124, v234
  v_mul_f32 v125, v125, v234
  v_mfma_f32_16x16x32_bf16 v[204:207], a[20:23], v[60:63], v[204:207]
  v_mul_f32 v126, v126, v234
  v_mul_f32 v127, v127, v234
  v_mfma_f32_16x16x32_bf16 v[208:211], a[24:27], v[60:63], v[208:211]
  v_cvt_pk_bf16_f32 v120, v120, v121
  v_cvt_pk_bf16_f32 v121, v122, v123
  v_mfma_f32_16x16x32_bf16 v[212:215], a[28:31], v[60:63], v[212:215]
  v_cvt_pk_bf16_f32 v122, v124, v125
  v_cvt_pk_bf16_f32 v123, v126, v127
  v_mfma_f32_16x16x32_bf16 v[228:231], a[192:195], v[60:63], v[228:231]
  buffer_store_dwordx4 v[120:123], v10, s[32:35], s69 offen offset:0 sc1
  v_pk_mul_f32 v[128:129], v[128:129], v[234:235] op_sel_hi:[1,0]
  ds_read_b64_tr_b16 a[212:213], v252 offset:16384
  v_pk_mul_f32 v[130:131], v[130:131], v[234:235] op_sel_hi:[1,0]
  ds_read_b64_tr_b16 a[214:215], v252 offset:20480
  v_pk_mul_f32 v[132:133], v[132:133], v[234:235] op_sel_hi:[1,0]
  ds_read_b128 a[196:199], v233 offset:0
  v_pk_mul_f32 v[134:135], v[134:135], v[234:235] op_sel_hi:[1,0]
  ds_read_b128 a[200:203], v233 offset:2048
  v_cvt_pk_bf16_f32 v128, v128, v129
  ds_read_b128 a[204:207], v233 offset:4096
  v_cvt_pk_bf16_f32 v129, v130, v131
  ds_read_b128 a[208:211], v233 offset:6144
  v_cvt_pk_bf16_f32 v130, v132, v133
  ds_read_b64_tr_b16 a[216:217], v253 offset:16384
  v_cvt_pk_bf16_f32 v131, v134, v135
  ds_read_b64_tr_b16 a[218:219], v253 offset:20480
  buffer_store_dwordx4 v[128:131], v10, s[32:35], s69 offen offset:1024 sc1
  ds_read_b64_tr_b16 a[220:221], v254 offset:16384
  v_pk_mul_f32 v[136:137], v[136:137], v[234:235] op_sel_hi:[1,0]
  ds_read_b64_tr_b16 a[222:223], v254 offset:20480
  v_pk_mul_f32 v[138:139], v[138:139], v[234:235] op_sel_hi:[1,0]
  ds_read_b64_tr_b16 a[224:225], v255 offset:16384
  v_pk_mul_f32 v[140:141], v[140:141], v[234:235] op_sel_hi:[1,0]
  ds_read_b64_tr_b16 a[226:227], v255 offset:20480
  v_pk_mul_f32 v[142:143], v[142:143], v[234:235] op_sel_hi:[1,0]
  v_cvt_pk_bf16_f32 v136, v136, v137
  v_cvt_pk_bf16_f32 v137, v138, v139
  v_cvt_pk_bf16_f32 v138, v140, v141
  v_cvt_pk_bf16_f32 v139, v142, v143
  buffer_store_dwordx4 v[136:139], v10, s[32:35], s69 offen offset:2048 sc1
  v_pk_mul_f32 v[144:145], v[144:145], v[234:235] op_sel_hi:[1,0]
  v_pk_mul_f32 v[146:147], v[146:147], v[234:235] op_sel_hi:[1,0]
  v_pk_mul_f32 v[148:149], v[148:149], v[234:235] op_sel_hi:[1,0]
  v_pk_mul_f32 v[150:151], v[150:151], v[234:235] op_sel_hi:[1,0]
  v_cvt_pk_bf16_f32 v144, v144, v145
  v_cvt_pk_bf16_f32 v145, v146, v147
  v_cvt_pk_bf16_f32 v146, v148, v149
  v_cvt_pk_bf16_f32 v147, v150, v151
  buffer_store_dwordx4 v[144:147], v10, s[32:35], s69 offen offset:3072 sc1
  v_rcp_f32 v234, v224
  v_subrev_u32 v235, 0x1f800000, v224
  v_cmp_lt_u32 vcc, 0x40000000, v235
  v_mul_f32 v234, v234, v5
  s_mov_b64 s[66:67], vcc
  v_pk_mul_f32 v[152:153], v[152:153], v[234:235] op_sel_hi:[1,0]
  v_pk_mul_f32 v[154:155], v[154:155], v[234:235] op_sel_hi:[1,0]
  v_pk_mul_f32 v[156:157], v[156:157], v[234:235] op_sel_hi:[1,0]
  v_pk_mul_f32 v[158:159], v[158:159], v[234:235] op_sel_hi:[1,0]
  v_cvt_pk_bf16_f32 v152, v152, v153
  v_cvt_pk_bf16_f32 v153, v154, v155
  v_cvt_pk_bf16_f32 v154, v156, v157
  v_cvt_pk_bf16_f32 v155, v158, v159
  buffer_store_dwordx4 v[152:155], v10, s[32:35], s70 offen offset:0 sc1
  v_pk_mul_f32 v[160:161], v[160:161], v[234:235] op_sel_hi:[1,0]
  v_pk_mul_f32 v[162:163], v[162:163], v[234:235] op_sel_hi:[1,0]
  v_pk_mul_f32 v[164:165], v[164:165], v[234:235] op_sel_hi:[1,0]
  v_pk_mul_f32 v[166:167], v[166:167], v[234:235] op_sel_hi:[1,0]
  v_cvt_pk_bf16_f32 v160, v160, v161
  v_cvt_pk_bf16_f32 v161, v162, v163
  v_cvt_pk_bf16_f32 v162, v164, v165
  v_cvt_pk_bf16_f32 v163, v166, v167
  buffer_store_dwordx4 v[160:163], v10, s[32:35], s70 offen offset:1024 sc1
  v_pk_mul_f32 v[168:169], v[168:169], v[234:235] op_sel_hi:[1,0]
  v_pk_mul_f32 v[170:171], v[170:171], v[234:235] op_sel_hi:[1,0]
  v_pk_mul_f32 v[172:173], v[172:173], v[234:235] op_sel_hi:[1,0]
  v_pk_mul_f32 v[174:175], v[174:175], v[234:235] op_sel_hi:[1,0]
  v_cvt_pk_bf16_f32 v168, v168, v169
  v_cvt_pk_bf16_f32 v169, v170, v171
  v_cvt_pk_bf16_f32 v170, v172, v173
  v_cvt_pk_bf16_f32 v171, v174, v175
  buffer_store_dwordx4 v[168:171], v10, s[32:35], s70 offen offset:2048 sc1
  v_pk_mul_f32 v[176:177], v[176:177], v[234:235] op_sel_hi:[1,0]
  v_pk_mul_f32 v[178:179], v[178:179], v[234:235] op_sel_hi:[1,0]
  v_pk_mul_f32 v[180:181], v[180:181], v[234:235] op_sel_hi:[1,0]
  v_pk_mul_f32 v[182:183], v[182:183], v[234:235] op_sel_hi:[1,0]
  v_cvt_pk_bf16_f32 v176, v176, v177
  v_cvt_pk_bf16_f32 v177, v178, v179
  v_cvt_pk_bf16_f32 v178, v180, v181
  v_cvt_pk_bf16_f32 v179, v182, v183
  buffer_store_dwordx4 v[176:179], v10, s[32:35], s70 offen offset:3072 sc1
  v_rcp_f32 v234, v228
  v_subrev_u32 v235, 0x1f800000, v228
  v_cmp_lt_u32 vcc, 0x40000000, v235
  v_mul_f32 v234, v234, v6
  s_or_b64 s[66:67], s[66:67], vcc
  v_pk_mul_f32 v[184:185], v[184:185], v[234:235] op_sel_hi:[1,0]
  v_pk_mul_f32 v[186:187], v[186:187], v[234:235] op_sel_hi:[1,0]
  v_pk_mul_f32 v[188:189], v[188:189], v[234:235] op_sel_hi:[1,0]
  v_pk_mul_f32 v[190:191], v[190:191], v[234:235] op_sel_hi:[1,0]
  v_cvt_pk_bf16_f32 v184, v184, v185
  v_cvt_pk_bf16_f32 v185, v186, v187
  v_cvt_pk_bf16_f32 v186, v188, v189
  v_cvt_pk_bf16_f32 v187, v190, v191
  buffer_store_dwordx4 v[184:187], v10, s[32:35], s71 offen offset:0 sc1
  v_pk_mul_f32 v[192:193], v[192:193], v[234:235] op_sel_hi:[1,0]
  v_pk_mul_f32 v[194:195], v[194:195], v[234:235] op_sel_hi:[1,0]
  v_pk_mul_f32 v[196:197], v[196:197], v[234:235] op_sel_hi:[1,0]
  v_pk_mul_f32 v[198:199], v[198:199], v[234:235] op_sel_hi:[1,0]
  v_cvt_pk_bf16_f32 v192, v192, v193
  v_cvt_pk_bf16_f32 v193, v194, v195
  v_cvt_pk_bf16_f32 v194, v196, v197
  v_cvt_pk_bf16_f32 v195, v198, v199
  buffer_store_dwordx4 v[192:195], v10, s[32:35], s71 offen offset:1024 sc1
  v_pk_mul_f32 v[200:201], v[200:201], v[234:235] op_sel_hi:[1,0]
  v_pk_mul_f32 v[202:203], v[202:203], v[234:235] op_sel_hi:[1,0]
  v_pk_mul_f32 v[204:205], v[204:205], v[234:235] op_sel_hi:[1,0]
  v_pk_mul_f32 v[206:207], v[206:207], v[234:235] op_sel_hi:[1,0]
  v_cvt_pk_bf16_f32 v200, v200, v201
  v_cvt_pk_bf16_f32 v201, v202, v203
  v_cvt_pk_bf16_f32 v202, v204, v205
  v_cvt_pk_bf16_f32 v203, v206, v207
  buffer_store_dwordx4 v[200:203], v10, s[32:35], s71 offen offset:2048 sc1
  v_pk_mul_f32 v[208:209], v[208:209], v[234:235] op_sel_hi:[1,0]
  v_pk_mul_f32 v[210:211], v[210:211], v[234:235] op_sel_hi:[1,0]
  v_pk_mul_f32 v[212:213], v[212:213], v[234:235] op_sel_hi:[1,0]
  v_pk_mul_f32 v[214:215], v[214:215], v[234:235] op_sel_hi:[1,0]
  v_cvt_pk_bf16_f32 v208, v208, v209
  v_cvt_pk_bf16_f32 v209, v210, v211
  v_cvt_pk_bf16_f32 v210, v212, v213
  v_cvt_pk_bf16_f32 v211, v214, v215
  buffer_store_dwordx4 v[208:211], v10, s[32:35], s71 offen offset:3072 sc1
  s_or_b64 vcc, s[64:65], s[66:67]
  s_cbranch_scc1 L_at_slow0
L_o_start:
  v_writelane_b32 v245, s86, 0
  v_writelane_b32 v245, s87, 1
  s_cmp_eq_u32 s28, 3
  s_cbranch_scc1 L_o_idle
  s_waitcnt lgkmcnt(0)
  v_mfma_f32_16x16x32_bf16 v[88:91], a[212:215], a[196:199], 0
  ds_read_b64_tr_b16 a[16:17], v252 offset:24576
  ds_read_b64_tr_b16 a[18:19], v252 offset:28672
  v_mfma_f32_16x16x32_bf16 v[92:95], a[216:219], a[196:199], 0
  ds_read_b128 a[0:3], v233 offset:1024
  ds_read_b128 a[4:7], v233 offset:3072
  v_mfma_f32_16x16x32_bf16 v[104:107], a[212:215], a[200:203], 0
  ds_read_b128 a[8:11], v233 offset:5120
  ds_read_b128 a[12:15], v233 offset:7168
  v_mfma_f32_16x16x32_bf16 v[108:111], a[216:219], a[200:203], 0
  ds_read_b64_tr_b16 a[20:21], v253 offset:24576
  v_mfma_f32_16x16x32_bf16 v[120:123], a[212:215], a[204:207], 0
  ds_read_b64_tr_b16 a[22:23], v253 offset:28672
  ds_read_b64_tr_b16 a[24:25], v254 offset:24576
  v_mfma_f32_16x16x32_bf16 v[124:127], a[216:219], a[204:207], 0
  ds_read_b64_tr_b16 a[26:27], v254 offset:28672
  ds_read_b64_tr_b16 a[28:29], v255 offset:24576
  v_mfma_f32_16x16x32_bf16 v[136:139], a[212:215], a[208:211], 0
  ds_read_b64_tr_b16 a[30:31], v255 offset:28672
  s_mov_b32 s44, s73
  v_mfma_f32_16x16x32_bf16 v[140:143], a[216:219], a[208:211], 0
  s_mov_b32 s61, 32768
  v_mfma_f32_16x16x32_bf16 v[144:147], a[220:223], a[208:211], 0
  s_mov_b32 s45, 32768
  s_lshr_b32 s46, s73, 15
  v_mfma_f32_16x16x32_bf16 v[148:151], a[224:227], a[208:211], 0
  s_add_u32 s46, s46, 1
  s_mov_b32 s47, 0
  v_mfma_f32_16x16x32_bf16 v[128:131], a[220:223], a[204:207], 0
  s_mov_b32 s48, 0
  s_mov_b32 s21, -1
  v_mfma_f32_16x16x32_bf16 v[132:135], a[224:227], a[204:207], 0
  v_add_u32 v252, s45, v252
  v_mfma_f32_16x16x32_bf16 v[112:115], a[220:223], a[200:203], 0
  v_add_u32 v233, s45, v233
  v_add_u32 v253, s45, v253
  v_mfma_f32_16x16x32_bf16 v[116:119], a[224:227], a[200:203], 0
  v_add_u32 v254, s45, v254
  v_add_u32 v255, s45, v255
  v_mfma_f32_16x16x32_bf16 v[96:99], a[220:223], a[196:199], 0
  v_mfma_f32_16x16x32_bf16 v[100:103], a[224:227], a[196:199], 0
.p2align 6
L_o_loop:
  s_waitcnt vmcnt(16) lgkmcnt(0)
  s_barrier
  v_mfma_f32_16x16x32_bf16 v[88:91], a[16:19], a[0:3], v[88:91]
  s_mov_b32 m0, s44
  ds_read_b64_tr_b16 a[212:213], v252 offset:16384
  v_mfma_f32_16x16x32_bf16 v[92:95], a[20:23], a[0:3], v[92:95]
  buffer_load_dwordx4 v10, s[32:35], s12 offen offset:0 sc1 lds
  v_mfma_f32_16x16x32_bf16 v[104:107], a[16:19], a[4:7], v[104:107]
  ds_read_b64_tr_b16 a[214:215], v252 offset:20480
  ds_read_b128 a[196:199], v233 offset:0
  v_mfma_f32_16x16x32_bf16 v[108:111], a[20:23], a[4:7], v[108:111]
  ds_read_b128 a[200:203], v233 offset:2048
  ds_read_b128 a[204:207], v233 offset:4096
  v_mfma_f32_16x16x32_bf16 v[120:123], a[16:19], a[8:11], v[120:123]
  ds_read_b128 a[208:211], v233 offset:6144
  ds_read_b64_tr_b16 a[216:217], v253 offset:16384
  v_mfma_f32_16x16x32_bf16 v[124:127], a[20:23], a[8:11], v[124:127]
  buffer_load_dwordx4 v10, s[32:35], s12 offen offset:1024 sc1 lds
  v_mfma_f32_16x16x32_bf16 v[136:139], a[16:19], a[12:15], v[136:139]
  ds_read_b64_tr_b16 a[218:219], v253 offset:20480
  ds_read_b64_tr_b16 a[220:221], v254 offset:16384
  v_mfma_f32_16x16x32_bf16 v[140:143], a[20:23], a[12:15], v[140:143]
  ds_read_b64_tr_b16 a[222:223], v254 offset:20480
  ds_read_b64_tr_b16 a[224:225], v255 offset:16384
  v_mfma_f32_16x16x32_bf16 v[144:147], a[24:27], a[12:15], v[144:147]
  ds_read_b64_tr_b16 a[226:227], v255 offset:20480
  v_mfma_f32_16x16x32_bf16 v[148:151], a[28:31], a[12:15], v[148:151]
  buffer_load_dwordx4 v240, s[32:35], s12 offen offset:2048 sc1 lds
  v_mfma_f32_16x16x32_bf16 v[128:131], a[24:27], a[8:11], v[128:131]
  s_add_u32 s46, s46, 1
  s_cmp_eq_u32 s46, 4
  v_mfma_f32_16x16x32_bf16 v[132:135], a[28:31], a[8:11], v[132:135]
  s_cselect_b32 s45, 4294836224, s61
  s_cselect_b32 s46, -1, s46
  v_mfma_f32_16x16x32_bf16 v[112:115], a[24:27], a[4:7], v[112:115]
  s_add_u32 s21, s21, 1
  v_mfma_f32_16x16x32_bf16 v[116:119], a[28:31], a[4:7], v[116:119]
  buffer_load_dwordx4 v240, s[32:35], s12 offen offset:3072 sc1 lds
  v_mfma_f32_16x16x32_bf16 v[96:99], a[24:27], a[0:3], v[96:99]
  v_readlane_b32 s12, v68, s21
  v_mfma_f32_16x16x32_bf16 v[100:103], a[28:31], a[0:3], v[100:103]
  s_add_u32 m0, s44, 16384
  s_waitcnt lgkmcnt(0)
  v_mfma_f32_16x16x32_bf16 v[88:91], a[212:215], a[196:199], v[88:91]
  ds_read_b64_tr_b16 a[16:17], v252 offset:24576
  v_mfma_f32_16x16x32_bf16 v[92:95], a[216:219], a[196:199], v[92:95]
  buffer_load_dwordx4 v241, s[8:11], s13 offen offset:0  lds
  v_mfma_f32_16x16x32_bf16 v[104:107], a[212:215], a[200:203], v[104:107]
  ds_read_b64_tr_b16 a[18:19], v252 offset:28672
  ds_read_b128 a[0:3], v233 offset:1024
  v_mfma_f32_16x16x32_bf16 v[108:111], a[216:219], a[200:203], v[108:111]
  ds_read_b128 a[4:7], v233 offset:3072
  ds_read_b128 a[8:11], v233 offset:5120
  v_mfma_f32_16x16x32_bf16 v[120:123], a[212:215], a[204:207], v[120:123]
  ds_read_b128 a[12:15], v233 offset:7168
  ds_read_b64_tr_b16 a[20:21], v253 offset:24576
  v_mfma_f32_16x16x32_bf16 v[124:127], a[216:219], a[204:207], v[124:127]
  buffer_load_dwordx4 v242, s[8:11], s13 offen offset:1024  lds
  v_mfma_f32_16x16x32_bf16 v[136:139], a[212:215], a[208:211], v[136:139]
  ds_read_b64_tr_b16 a[22:23], v253 offset:28672
  ds_read_b64_tr_b16 a[24:25], v254 offset:24576
  v_mfma_f32_16x16x32_bf16 v[140:143], a[216:219], a[208:211], v[140:143]
  ds_read_b64_tr_b16 a[26:27], v254 offset:28672
  ds_read_b64_tr_b16 a[28:29], v255 offset:24576
  v_mfma_f32_16x16x32_bf16 v[144:147], a[220:223], a[208:211], v[144:147]
  ds_read_b64_tr_b16 a[30:31], v255 offset:28672
  v_mfma_f32_16x16x32_bf16 v[148:151], a[224:227], a[208:211], v[148:151]
  buffer_load_dwordx4 v243, s[8:11], s13 offen offset:2048  lds
  v_mfma_f32_16x16x32_bf16 v[128:131], a[220:223], a[204:207], v[128:131]
  s_add_u32 s44, s44, 32768
  s_cmp_ge_u32 s44, 163840
  v_mfma_f32_16x16x32_bf16 v[132:135], a[224:227], a[204:207], v[132:135]
  s_cselect_b32 s44, s41, s44
  v_add_u32 v252, s45, v252
  v_mfma_f32_16x16x32_bf16 v[112:115], a[220:223], a[200:203], v[112:115]
  v_add_u32 v233, s45, v233
  v_add_u32 v253, s45, v253
  v_mfma_f32_16x16x32_bf16 v[116:119], a[224:227], a[200:203], v[116:119]
  buffer_load_dwordx4 v244, s[8:11], s13 offen offset:3072  lds
  v_mfma_f32_16x16x32_bf16 v[96:99], a[220:223], a[196:199], v[96:99]
  v_add_u32 v254, s45, v254
  v_add_u32 v255, s45, v255
  v_readlane_b32 s13, v69, s21
  v_mfma_f32_16x16x32_bf16 v[100:103], a[224:227], a[196:199], v[100:103]
  s_sub_u32 s48, s48, 1
  s_cbranch_scc0 L_o_loop
  s_add_u32 s47, s47, 1
  s_cmp_eq_u32 s47, 7
  s_cbranch_scc1 L_o_ev7
  s_cmp_eq_u32 s47, 6
  s_cbranch_scc1 L_o_ev6
  s_cmp_eq_u32 s47, 5
  s_cbranch_scc1 L_o_ev5
  s_cmp_eq_u32 s47, 4
  s_cbranch_scc1 L_o_ev4
  s_cmp_eq_u32 s47, 3
  s_cbranch_scc1 L_o_ev3
  s_cmp_eq_u32 s47, 2
  s_cbranch_scc1 L_o_ev2
  s_lshr_b32 s49, s30, 2
  s_mul_i32 s49, s49, 384
  s_add_u32 s49, s49, 84951040
  s_mul_i32 s39, s30, 49152
  s_add_u32 s39, s39, 33554432
  s_lshl_b32 s52, s28, 14
  s_add_u32 s52, s52, s39
  s_cmp_eq_u32 s28, 3
  s_cselect_b32 s52, 1073741824, s52
  s_cmp_eq_u32 s28, 0
  s_cselect_b32 s53, 16384, 0
  s_add_u32 s53, s53, s39
  s_cmp_eq_u32 s28, 2
  s_cselect_b32 s54, 1, 2
  s_lshl_b32 s54, s54, 14
  s_add_u32 s54, s54, s39
  s_cmp_eq_u32 s36, 3
  s_cselect_b32 s39, 0, s36
  s_sub_i32 s60, s28, s39
  s_cmp_lt_i32 s60, 0
  s_cselect_b32 s39, 3, 0
  s_add_i32 s60, s60, s39
  s_waitcnt vmcnt(8)
  buffer_store_dword v232, v245, s[32:35], 0 offen sc1
  s_sub_u32 s48, s4, 2
  s_branch L_o_loop
L_o_ev2:
L_o_ev5:
  buffer_load_dword v246, v70, s[32:35], s55 offen sc1
  s_mov_b32 s48, 0
  s_branch L_o_loop
L_o_ev3:
  s_mov_b32 s8, s14
  s_mov_b32 s9, s15
  s_mov_b32 s10, 5242880
  v_sub_f32 v248, 1.0, v248
  v_sub_f32 v249, 1.0, v249
  v_sub_f32 v250, 1.0, v250
  v_sub_f32 v251, 1.0, v251
  s_mov_b32 s48, 2
  s_waitcnt vmcnt(8)
L_chk_c:
  v_cmp_ne_u32 vcc, 0, v246
  s_andn2_b64 vcc, s[50:51], vcc
  s_cbranch_scc1 L_spin_c
L_go_c:
  s_branch L_o_loop
L_o_ev4:
  s_waitcnt vmcnt(16) lgkmcnt(0)
  s_barrier
  v_mfma_f32_16x16x32_bf16 v[88:91], a[16:19], a[0:3], v[88:91]
  s_mov_b32 m0, s44
  ds_read_b64_tr_b16 a[212:213], v252 offset:16384
  v_mfma_f32_16x16x32_bf16 v[92:95], a[20:23], a[0:3], v[92:95]
  buffer_load_dwordx4 v10, s[32:35], s12 offen offset:0 sc1 lds
  v_mfma_f32_16x16x32_bf16 v[104:107], a[16:19], a[4:7], v[104:107]
  ds_read_b64_tr_b16 a[214:215], v252 offset:20480
  ds_read_b128 a[196:199], v233 offset:0
  v_mfma_f32_16x16x32_bf16 v[108:111], a[20:23], a[4:7], v[108:111]
  ds_read_b128 a[200:203], v233 offset:2048
  ds_read_b128 a[204:207], v233 offset:4096
  v_mfma_f32_16x16x32_bf16 v[120:123], a[16:19], a[8:11], v[120:123]
  ds_read_b128 a[208:211], v233 offset:6144
  ds_read_b64_tr_b16 a[216:217], v253 offset:16384
  v_mul_f32 v88, v88, v248
  v_mul_f32 v89, v89, v248
  v_mul_f32 v90, v90, v248
  v_mfma_f32_16x16x32_bf16 v[124:127], a[20:23], a[8:11], v[124:127]
  buffer_load_dwordx4 v10, s[32:35], s12 offen offset:1024 sc1 lds
  v_mul_f32 v91, v91, v248
  v_mul_f32 v92, v92, v248
  v_mfma_f32_16x16x32_bf16 v[136:139], a[16:19], a[12:15], v[136:139]
  ds_read_b64_tr_b16 a[218:219], v253 offset:20480
  ds_read_b64_tr_b16 a[220:221], v254 offset:16384
  v_mul_f32 v93, v93, v248
  v_mul_f32 v94, v94, v248
  v_mul_f32 v95, v95, v248
  v_mfma_f32_16x16x32_bf16 v[140:143], a[20:23], a[12:15], v[140:143]
  ds_read_b64_tr_b16 a[222:223], v254 offset:20480
  ds_read_b64_tr_b16 a[224:225], v255 offset:16384
  v_mul_f32 v104, v104, v249
  v_mul_f32 v105, v105, v249
  v_mfma_f32_16x16x32_bf16 v[144:147], a[24:27], a[12:15], v[144:147]
  ds_read_b64_tr_b16 a[226:227], v255 offset:20480
  v_mul_f32 v106, v106, v249
  v_mul_f32 v107, v107, v249
  v_mul_f32 v108, v108, v249
  v_mfma_f32_16x16x32_bf16 v[148:151], a[28:31], a[12:15], v[148:151]
  buffer_load_dwordx4 v240, s[32:35], s12 offen offset:2048 sc1 lds
  v_mul_f32 v109, v109, v249
  v_mul_f32 v110, v110, v249
  v_mfma_f32_16x16x32_bf16 v[128:131], a[24:27], a[8:11], v[128:131]
  s_add_u32 s46, s46, 1
  s_cmp_eq_u32 s46, 4
  v_mul_f32 v111, v111, v249
  v_mul_f32 v120, v120, v250
  v_mul_f32 v121, v121, v250
  v_mfma_f32_16x16x32_bf16 v[132:135], a[28:31], a[8:11], v[132:135]
  s_cselect_b32 s45, 4294836224, s61
  s_cselect_b32 s46, -1, s46
  v_mul_f32 v122, v122, v250
  v_mul_f32 v123, v123, v250
  v_mfma_f32_16x16x32_bf16 v[112:115], a[24:27], a[4:7], v[112:115]
  s_add_u32 s21, s21, 1
  v_mul_f32 v124, v124, v250
  v_mul_f32 v125, v125, v250
  v_mul_f32 v126, v126, v250
  v_mfma_f32_16x16x32_bf16 v[116:119], a[28:31], a[4:7], v[116:119]
  buffer_load_dwordx4 v240, s[32:35], s12 offen offset:3072 sc1 lds
  v_mul_f32 v127, v127, v250
  v_mul_f32 v136, v136, v251
  v_mfma_f32_16x16x32_bf16 v[96:99], a[24:27], a[0:3], v[96:99]
  v_readlane_b32 s12, v68, s21
  v_mul_f32 v137, v137, v251
  v_mul_f32 v138, v138, v251
  v_mul_f32 v139, v139, v251
  v_mfma_f32_16x16x32_bf16 v[100:103], a[28:31], a[0:3], v[100:103]
  s_add_u32 m0, s44, 16384
  v_mul_f32 v140, v140, v251
  v_mul_f32 v141, v141, v251
  s_waitcnt lgkmcnt(0)
  v_mfma_f32_16x16x32_bf16 v[88:91], a[212:215], a[196:199], v[88:91]
  ds_read_b64_tr_b16 a[16:17], v252 offset:24576
  v_mul_f32 v142, v142, v251
  v_mul_f32 v143, v143, v251
  v_mfma_f32_16x16x32_bf16 v[92:95], a[216:219], a[196:199], v[92:95]
  buffer_load_dwordx4 v241, s[8:11], s13 offen offset:0  lds
  v_mul_f32 v144, v144, v251
  v_mul_f32 v145, v145, v251
  v_mul_f32 v146, v146, v251
  v_mfma_f32_16x16x32_bf16 v[104:107], a[212:215], a[200:203], v[104:107]
  ds_read_b64_tr_b16 a[18:19], v252 offset:28672
  ds_read_b128 a[0:3], v233 offset:1024
  v_mul_f32 v147, v147, v251
  v_mul_f32 v148, v148, v251
  v_mfma_f32_16x16x32_bf16 v[108:111], a[216:219], a[200:203], v[108:111]
  ds_read_b128 a[4:7], v233 offset:3072
  ds_read_b128 a[8:11], v233 offset:5120
  v_mul_f32 v149, v149, v251
  v_mul_f32 v150, v150, v251
  v_mul_f32 v151, v151, v251
  v_mfma_f32_16x16x32_bf16 v[120:123], a[212:215], a[204:207], v[120:123]
  ds_read_b128 a[12:15], v233 offset:7168
  ds_read_b64_tr_b16 a[20:21], v253 offset:24576
  v_mul_f32 v128, v128, v250
  v_mul_f32 v129, v129, v250
  v_mfma_f32_16x16x32_bf16 v[124:127], a[216:219], a[204:207], v[124:127]
  buffer_load_dwordx4 v242, s[8:11], s13 offen offset:1024  lds
  v_mul_f32 v130, v130, v250
  v_mul_f32 v131, v131, v250
  v_mul_f32 v132, v132, v250
  v_mfma_f32_16x16x32_bf16 v[136:139], a[212:215], a[208:211], v[136:139]
  ds_read_b64_tr_b16 a[22:23], v253 offset:28672
  ds_read_b64_tr_b16 a[24:25], v254 offset:24576
  v_mul_f32 v133, v133, v250
  v_mul_f32 v134, v134, v250
  v_mfma_f32_16x16x32_bf16 v[140:143], a[216:219], a[208:211], v[140:143]
  ds_read_b64_tr_b16 a[26:27], v254 offset:28672
  ds_read_b64_tr_b16 a[28:29], v255 offset:24576
  v_mul_f32 v135, v135, v250
  v_mul_f32 v112, v112, v249
  v_mul_f32 v113, v113, v249
  v_mfma_f32_16x16x32_bf16 v[144:147], a[220:223], a[208:211], v[144:147]
  ds_read_b64_tr_b16 a[30:31], v255 offset:28672
  v_mul_f32 v114, v114, v249
  v_mul_f32 v115, v115, v249
  v_mfma_f32_16x16x32_bf16 v[148:151], a[224:227], a[208:211], v[148:151]
  buffer_load_dwordx4 v243, s[8:11], s13 offen offset:2048  lds
  v_mul_f32 v116, v116, v249
  v_mul_f32 v117, v117, v249
  v_mul_f32 v118, v118, v249
  v_mfma_f32_16x16x32_bf16 v[128:131], a[220:223], a[204:207], v[128:131]
  s_add_u32 s44, s44, 32768
  s_cmp_ge_u32 s44, 163840
  v_mul_f32 v119, v119, v249
  v_mul_f32 v96, v96, v248
  v_mfma_f32_16x16x32_bf16 v[132:135], a[224:227], a[204:207], v[132:135]
  s_cselect_b32 s44, s41, s44
  v_add_u32 v252, s45, v252
  v_mul_f32 v97, v97, v248
  v_mul_f32 v98, v98, v248
  v_mul_f32 v99, v99, v248
  v_mfma_f32_16x16x32_bf16 v[112:115], a[220:223], a[200:203], v[112:115]
  v_add_u32 v233, s45, v233
  v_add_u32 v253, s45, v253
  v_mul_f32 v100, v100, v248
  v_mul_f32 v101, v101, v248
  v_mfma_f32_16x16x32_bf16 v[116:119], a[224:227], a[200:203], v[116:119]
  buffer_load_dwordx4 v244, s[8:11], s13 offen offset:3072  lds
  v_mul_f32 v102, v102, v248
  v_mul_f32 v103, v103, v248
  v_mfma_f32_16x16x32_bf16 v[96:99], a[220:223], a[196:199], v[96:99]
  v_add_u32 v254, s45, v254
  v_add_u32 v255, s45, v255
  v_readlane_b32 s13, v69, s21
  v_mfma_f32_16x16x32_bf16 v[100:103], a[224:227], a[196:199], v[100:103]
  s_mov_b32 s48, s25
  s_mov_b32 s56, s20
  s_mov_b32 s57, 0
  s_lshl_b32 s39, s28, 2
  s_add_u32 s39, s39, s49
  s_mov_b32 s50, 7
  s_bitset0_b32 s50, s28
  s_lshl_b32 s40, s36, 4
  s_add_u32 s39, s39, s40
  s_lshr_b32 s40, s40, 2
  s_lshl_b32 s50, s50, s40
  s_cmp_eq_u32 s28, 0
  s_cselect_b32 s40, 128, 0
  s_add_u32 s40, s40, s39
  v_writelane_b32 v245, s40, 0
  s_cmp_eq_u32 s28, 2
  s_cselect_b32 s40, 0, 128
  s_add_u32 s40, s40, s39
  s_add_u32 s40, s40, 128
  v_writelane_b32 v245, s40, 1
  s_lshl_b32 s40, s28, 7
  s_add_u32 s49, s49, s40
  s_branch L_o_loop
L_o_ev6:
  s_waitcnt vmcnt(8)
L_chk_d:
  v_cmp_ne_u32 vcc, 0, v246
  s_andn2_b64 vcc, s[56:57], vcc
  s_cbranch_scc1 L_spin_d
L_go_d:
  s_mov_b32 s56, 0x3f80
  s_mov_b32 s57, 0x3f800000
  s_add_u32 s48, s29, 2
  s_branch L_o_loop
L_o_ev7:
  s_cmp_eq_u32 s60, 1
  s_cbranch_scc1 L_o_v1
  s_cmp_eq_u32 s60, 2
  s_cbranch_scc1 L_o_v2
L_o_v0:
  s_waitcnt lgkmcnt(0)
  v_mfma_f32_16x16x32_bf16 v[104:107], a[16:19], a[4:7], v[104:107]
  v_mfma_f32_16x16x32_bf16 v[108:111], a[20:23], a[4:7], v[108:111]
  s_nop 0
  v_mfma_f32_16x16x32_bf16 v[112:115], a[24:27], a[4:7], v[112:115]
  s_nop 0
  v_mfma_f32_16x16x32_bf16 v[116:119], a[28:31], a[4:7], v[116:119]
  s_nop 0
  v_mfma_f32_16x16x32_bf16 v[120:123], a[16:19], a[8:11], v[120:123]
  s_add_u32 s39, s52, 4096
  v_cvt_pk_bf16_f32 v104, v104, v105
  v_cvt_pk_bf16_f32 v105, v106, v107
  v_mfma_f32_16x16x32_bf16 v[124:127], a[20:23], a[8:11], v[124:127]
  v_cvt_pk_bf16_f32 v106, v108, v109
  v_cvt_pk_bf16_f32 v107, v110, v111
  buffer_store_dwordx4 v[104:107], v10, s[32:35], s39 offen offset:0 sc1
  v_mfma_f32_16x16x32_bf16 v[128:131], a[24:27], a[8:11], v[128:131]
  v_cvt_pk_bf16_f32 v112, v112, v113
  v_cvt_pk_bf16_f32 v113, v114, v115
  v_mfma_f32_16x16x32_bf16 v[132:135], a[28:31], a[8:11], v[132:135]
  v_cvt_pk_bf16_f32 v114, v116, v117
  v_cvt_pk_bf16_f32 v115, v118, v119
  buffer_store_dwordx4 v[112:115], v10, s[32:35], s39 offen offset:1024 sc1
  v_mfma_f32_16x16x32_bf16 v[88:91], a[16:19], a[0:3], v[88:91]
  s_add_u32 s39, s52, 8192
  v_cvt_pk_bf16_f32 v120, v120, v121
  v_cvt_pk_bf16_f32 v121, v122, v123
  v_mfma_f32_16x16x32_bf16 v[92:95], a[20:23], a[0:3], v[92:95]
  v_cvt_pk_bf16_f32 v122, v124, v125
  v_cvt_pk_bf16_f32 v123, v126, v127
  buffer_store_dwordx4 v[120:123], v10, s[32:35], s39 offen offset:0 sc1
  v_mfma_f32_16x16x32_bf16 v[96:99], a[24:27], a[0:3], v[96:99]
  v_cvt_pk_bf16_f32 v128, v128, v129
  v_cvt_pk_bf16_f32 v129, v130, v131
  v_mfma_f32_16x16x32_bf16 v[100:103], a[28:31], a[0:3], v[100:103]
  v_cvt_pk_bf16_f32 v130, v132, v133
  v_cvt_pk_bf16_f32 v131, v134, v135
  buffer_store_dwordx4 v[128:131], v10, s[32:35], s39 offen offset:1024 sc1
  v_mfma_f32_16x16x32_bf16 v[136:139], a[16:19], a[12:15], v[136:139]
  v_mfma_f32_16x16x32_bf16 v[140:143], a[20:23], a[12:15], v[140:143]
  v_mfma_f32_16x16x32_bf16 v[144:147], a[24:27], a[12:15], v[144:147]
  v_mfma_f32_16x16x32_bf16 v[148:151], a[28:31], a[12:15], v[148:151]
  s_waitcnt vmcnt(0)
  buffer_store_dword v232, v245, s[32:35], 0 offen sc1
  buffer_load_dword v246, v247, s[32:35], s49 offen sc1
  s_waitcnt vmcnt(0)
L_chk_x0:
  v_cmp_ne_u32 vcc, 0, v246
  s_andn2_b64 vcc, s[50:51], vcc
  s_cbranch_scc1 L_spin_x0
L_go_x0:
  s_add_u32 s39, s53, 0
  s_add_u32 s40, s54, 0
  buffer_load_dwordx4 v[152:155], v10, s[32:35], s39 offen offset:0 sc1
  buffer_load_dwordx4 v[168:171], v10, s[32:35], s40 offen offset:0 sc1
  buffer_load_dwordx4 v[156:159], v10, s[32:35], s39 offen offset:1024 sc1
  buffer_load_dwordx4 v[172:175], v10, s[32:35], s40 offen offset:1024 sc1
  s_add_u32 s39, s53, 12288
  s_add_u32 s40, s54, 12288
  buffer_load_dwordx4 v[184:187], v10, s[32:35], s39 offen offset:0 sc1
  buffer_load_dwordx4 v[200:203], v10, s[32:35], s40 offen offset:0 sc1
  buffer_load_dwordx4 v[188:191], v10, s[32:35], s39 offen offset:1024 sc1
  buffer_load_dwordx4 v[204:207], v10, s[32:35], s40 offen offset:1024 sc1
  s_add_u32 s39, s31, 0
  s_waitcnt vmcnt(6)
  v_dot2c_f32_bf16 v88, s56, v152
  v_dot2c_f32_bf16 v89, s57, v152
  v_dot2c_f32_bf16 v90, s56, v153
  v_dot2c_f32_bf16 v91, s57, v153
  v_dot2c_f32_bf16 v92, s56, v154
  v_dot2c_f32_bf16 v93, s57, v154
  v_dot2c_f32_bf16 v94, s56, v155
  v_dot2c_f32_bf16 v95, s57, v155
  v_dot2c_f32_bf16 v88, s56, v168
  v_dot2c_f32_bf16 v89, s57, v168
  v_dot2c_f32_bf16 v90, s56, v169
  v_dot2c_f32_bf16 v91, s57, v169
  v_dot2c_f32_bf16 v92, s56, v170
  v_dot2c_f32_bf16 v93, s57, v170
  v_dot2c_f32_bf16 v94, s56, v171
  v_dot2c_f32_bf16 v95, s57, v171
  v_cvt_pk_bf16_f32 v88, v88, v89
  v_cvt_pk_bf16_f32 v89, v90, v91
  v_cvt_pk_bf16_f32 v90, v92, v93
  v_cvt_pk_bf16_f32 v91, v94, v95
  s_nop 1
  v_permlane16_swap_b32 v88, v90
  v_permlane16_swap_b32 v89, v91
  buffer_store_dwordx4 v[88:91], v66, s[16:19], s39 offen offset:0
  s_waitcnt vmcnt(5)
  v_dot2c_f32_bf16 v96, s56, v156
  v_dot2c_f32_bf16 v97, s57, v156
  v_dot2c_f32_bf16 v98, s56, v157
  v_dot2c_f32_bf16 v99, s57, v157
  v_dot2c_f32_bf16 v100, s56, v158
  v_dot2c_f32_bf16 v101, s57, v158
  v_dot2c_f32_bf16 v102, s56, v159
  v_dot2c_f32_bf16 v103, s57, v159
  v_dot2c_f32_bf16 v96, s56, v172
  v_dot2c_f32_bf16 v97, s57, v172
  v_dot2c_f32_bf16 v98, s56, v173
  v_dot2c_f32_bf16 v99, s57, v173
  v_dot2c_f32_bf16 v100, s56, v174
  v_dot2c_f32_bf16 v101, s57, v174
  v_dot2c_f32_bf16 v102, s56, v175
  v_dot2c_f32_bf16 v103, s57, v175
  v_cvt_pk_bf16_f32 v96, v96, v97
  v_cvt_pk_bf16_f32 v97, v98, v99
  v_cvt_pk_bf16_f32 v98, v100, v101
  v_cvt_pk_bf16_f32 v99, v102, v103
  s_nop 1
  v_permlane16_swap_b32 v96, v98
  v_permlane16_swap_b32 v97, v99
  buffer_store_dwordx4 v[96:99], v66, s[16:19], s39 offen offset:64
  s_add_u32 s39, s31, 102400
  s_waitcnt vmcnt(4)
  v_dot2c_f32_bf16 v136, s56, v184
  v_dot2c_f32_bf16 v137, s57, v184
  v_dot2c_f32_bf16 v138, s56, v185
  v_dot2c_f32_bf16 v139, s57, v185
  v_dot2c_f32_bf16 v140, s56, v186
  v_dot2c_f32_bf16 v141, s57, v186
  v_dot2c_f32_bf16 v142, s56, v187
  v_dot2c_f32_bf16 v143, s57, v187
  v_dot2c_f32_bf16 v136, s56, v200
  v_dot2c_f32_bf16 v137, s57, v200
  v_dot2c_f32_bf16 v138, s56, v201
  v_dot2c_f32_bf16 v139, s57, v201
  v_dot2c_f32_bf16 v140, s56, v202
  v_dot2c_f32_bf16 v141, s57, v202
  v_dot2c_f32_bf16 v142, s56, v203
  v_dot2c_f32_bf16 v143, s57, v203
  v_cvt_pk_bf16_f32 v136, v136, v137
  v_cvt_pk_bf16_f32 v137, v138, v139
  v_cvt_pk_bf16_f32 v138, v140, v141
  v_cvt_pk_bf16_f32 v139, v142, v143
  s_nop 1
  v_permlane16_swap_b32 v136, v138
  v_permlane16_swap_b32 v137, v139
  buffer_store_dwordx4 v[136:139], v66, s[16:19], s39 offen offset:0
  s_waitcnt vmcnt(3)
  v_dot2c_f32_bf16 v144, s56, v188
  v_dot2c_f32_bf16 v145, s57, v188
  v_dot2c_f32_bf16 v146, s56, v189
  v_dot2c_f32_bf16 v147, s57, v189
  v_dot2c_f32_bf16 v148, s56, v190
  v_dot2c_f32_bf16 v149, s57, v190
  v_dot2c_f32_bf16 v150, s56, v191
  v_dot2c_f32_bf16 v151, s57, v191
  v_dot2c_f32_bf16 v144, s56, v204
  v_dot2c_f32_bf16 v145, s57, v204
  v_dot2c_f32_bf16 v146, s56, v205
  v_dot2c_f32_bf16 v147, s57, v205
  v_dot2c_f32_bf16 v148, s56, v206
  v_dot2c_f32_bf16 v149, s57, v206
  v_dot2c_f32_bf16 v150, s56, v207
  v_dot2c_f32_bf16 v151, s57, v207
  v_cvt_pk_bf16_f32 v144, v144, v145
  v_cvt_pk_bf16_f32 v145, v146, v147
  v_cvt_pk_bf16_f32 v146, v148, v149
  v_cvt_pk_bf16_f32 v147, v150, v151
  s_nop 1
  v_permlane16_swap_b32 v144, v146
  v_permlane16_swap_b32 v145, v147
  buffer_store_dwordx4 v[144:147], v66, s[16:19], s39 offen offset:64
  s_branch L_at_end
L_o_v1:
  s_waitcnt lgkmcnt(0)
  v_mfma_f32_16x16x32_bf16 v[88:91], a[16:19], a[0:3], v[88:91]
  v_mfma_f32_16x16x32_bf16 v[92:95], a[20:23], a[0:3], v[92:95]
  s_nop 0
  v_mfma_f32_16x16x32_bf16 v[96:99], a[24:27], a[0:3], v[96:99]
  s_nop 0
  v_mfma_f32_16x16x32_bf16 v[100:103], a[28:31], a[0:3], v[100:103]
  s_nop 0
  v_mfma_f32_16x16x32_bf16 v[120:123], a[16:19], a[8:11], v[120:123]
  s_add_u32 s39, s52, 0
  v_cvt_pk_bf16_f32 v88, v88, v89
  v_cvt_pk_bf16_f32 v89, v90, v91
  v_mfma_f32_16x16x32_bf16 v[124:127], a[20:23], a[8:11], v[124:127]
  v_cvt_pk_bf16_f32 v90, v92, v93
  v_cvt_pk_bf16_f32 v91, v94, v95
  buffer_store_dwordx4 v[88:91], v10, s[32:35], s39 offen offset:0 sc1
  v_mfma_f32_16x16x32_bf16 v[128:131], a[24:27], a[8:11], v[128:131]
  v_cvt_pk_bf16_f32 v96, v96, v97
  v_cvt_pk_bf16_f32 v97, v98, v99
  v_mfma_f32_16x16x32_bf16 v[132:135], a[28:31], a[8:11], v[132:135]
  v_cvt_pk_bf16_f32 v98, v100, v101
  v_cvt_pk_bf16_f32 v99, v102, v103
  buffer_store_dwordx4 v[96:99], v10, s[32:35], s39 offen offset:1024 sc1
  v_mfma_f32_16x16x32_bf16 v[136:139], a[16:19], a[12:15], v[136:139]
  s_add_u32 s39, s52, 8192
  v_cvt_pk_bf16_f32 v120, v120, v121
  v_cvt_pk_bf16_f32 v121, v122, v123
  v_mfma_f32_16x16x32_bf16 v[140:143], a[20:23], a[12:15], v[140:143]
  v_cvt_pk_bf16_f32 v122, v124, v125
  v_cvt_pk_bf16_f32 v123, v126, v127
  buffer_store_dwordx4 v[120:123], v10, s[32:35], s39 offen offset:0 sc1
  v_mfma_f32_16x16x32_bf16 v[144:147], a[24:27], a[12:15], v[144:147]
  v_cvt_pk_bf16_f32 v128, v128, v129
  v_cvt_pk_bf16_f32 v129, v130, v131
  v_mfma_f32_16x16x32_bf16 v[148:151], a[28:31], a[12:15], v[148:151]
  v_cvt_pk_bf16_f32 v130, v132, v133
  v_cvt_pk_bf16_f32 v131, v134, v135
  buffer_store_dwordx4 v[128:131], v10, s[32:35], s39 offen offset:1024 sc1
  v_mfma_f32_16x16x32_bf16 v[104:107], a[16:19], a[4:7], v[104:107]
  s_add_u32 s39, s52, 12288
  v_cvt_pk_bf16_f32 v136, v136, v137
  v_cvt_pk_bf16_f32 v137, v138, v139
  v_mfma_f32_16x16x32_bf16 v[108:111], a[20:23], a[4:7], v[108:111]
  v_cvt_pk_bf16_f32 v138, v140, v141
  v_cvt_pk_bf16_f32 v139, v142, v143
  buffer_store_dwordx4 v[136:139], v10, s[32:35], s39 offen offset:0 sc1
  v_mfma_f32_16x16x32_bf16 v[112:115], a[24:27], a[4:7], v[112:115]
  v_cvt_pk_bf16_f32 v144, v144, v145
  v_cvt_pk_bf16_f32 v145, v146, v147
  v_mfma_f32_16x16x32_bf16 v[116:119], a[28:31], a[4:7], v[116:119]
  v_cvt_pk_bf16_f32 v146, v148, v149
  v_cvt_pk_bf16_f32 v147, v150, v151
  buffer_store_dwordx4 v[144:147], v10, s[32:35], s39 offen offset:1024 sc1
  s_waitcnt vmcnt(0)
  buffer_store_dword v232, v245, s[32:35], 0 offen sc1
  buffer_load_dword v246, v247, s[32:35], s49 offen sc1
  s_waitcnt vmcnt(0)
L_chk_x1:
  v_cmp_ne_u32 vcc, 0, v246
  s_andn2_b64 vcc, s[50:51], vcc
  s_cbranch_scc1 L_spin_x1
L_go_x1:
  s_add_u32 s39, s53, 4096
  s_add_u32 s40, s54, 4096
  buffer_load_dwordx4 v[152:155], v10, s[32:35], s39 offen offset:0 sc1
  buffer_load_dwordx4 v[168:171], v10, s[32:35], s40 offen offset:0 sc1
  buffer_load_dwordx4 v[156:159], v10, s[32:35], s39 offen offset:1024 sc1
  buffer_load_dwordx4 v[172:175], v10, s[32:35], s40 offen offset:1024 sc1
  s_add_u32 s39, s31, 81920
  s_waitcnt vmcnt(2)
  v_dot2c_f32_bf16 v104, s56, v152
  v_dot2c_f32_bf16 v105, s57, v152
  v_dot2c_f32_bf16 v106, s56, v153
  v_dot2c_f32_bf16 v107, s57, v153
  v_dot2c_f32_bf16 v108, s56, v154
  v_dot2c_f32_bf16 v109, s57, v154
  v_dot2c_f32_bf16 v110, s56, v155
  v_dot2c_f32_bf16 v111, s57, v155
  v_dot2c_f32_bf16 v104, s56, v168
  v_dot2c_f32_bf16 v105, s57, v168
  v_dot2c_f32_bf16 v106, s56, v169
  v_dot2c_f32_bf16 v107, s57, v169
  v_dot2c_f32_bf16 v108, s56, v170
  v_dot2c_f32_bf16 v109, s57, v170
  v_dot2c_f32_bf16 v110, s56, v171
  v_dot2c_f32_bf16 v111, s57, v171
  v_cvt_pk_bf16_f32 v104, v104, v105
  v_cvt_pk_bf16_f32 v105, v106, v107
  v_cvt_pk_bf16_f32 v106, v108, v109
  v_cvt_pk_bf16_f32 v107, v110, v111
  s_nop 1
  v_permlane16_swap_b32 v104, v106
  v_permlane16_swap_b32 v105, v107
  buffer_store_dwordx4 v[104:107], v66, s[16:19], s39 offen offset:0
  s_waitcnt vmcnt(1)
  v_dot2c_f32_bf16 v112, s56, v156
  v_dot2c_f32_bf16 v113, s57, v156
  v_dot2c_f32_bf16 v114, s56, v157
  v_dot2c_f32_bf16 v115, s57, v157
  v_dot2c_f32_bf16 v116, s56, v158
  v_dot2c_f32_bf16 v117, s57, v158
  v_dot2c_f32_bf16 v118, s56, v159
  v_dot2c_f32_bf16 v119, s57, v159
  v_dot2c_f32_bf16 v112, s56, v172
  v_dot2c_f32_bf16 v113, s57, v172
  v_dot2c_f32_bf16 v114, s56, v173
  v_dot2c_f32_bf16 v115, s57, v173
  v_dot2c_f32_bf16 v116, s56, v174
  v_dot2c_f32_bf16 v117, s57, v174
  v_dot2c_f32_bf16 v118, s56, v175
  v_dot2c_f32_bf16 v119, s57, v175
  v_cvt_pk_bf16_f32 v112, v112, v113
  v_cvt_pk_bf16_f32 v113, v114, v115
  v_cvt_pk_bf16_f32 v114, v116, v117
  v_cvt_pk_bf16_f32 v115, v118, v119
  s_nop 1
  v_permlane16_swap_b32 v112, v114
  v_permlane16_swap_b32 v113, v115
  buffer_store_dwordx4 v[112:115], v66, s[16:19], s39 offen offset:64
  s_branch L_at_end
L_o_v2:
  s_waitcnt lgkmcnt(0)
  v_mfma_f32_16x16x32_bf16 v[88:91], a[16:19], a[0:3], v[88:91]
  v_mfma_f32_16x16x32_bf16 v[92:95], a[20:23], a[0:3], v[92:95]
  s_nop 0
  v_mfma_f32_16x16x32_bf16 v[96:99], a[24:27], a[0:3], v[96:99]
  s_nop 0
  v_mfma_f32_16x16x32_bf16 v[100:103], a[28:31], a[0:3], v[100:103]
  s_nop 0
  v_mfma_f32_16x16x32_bf16 v[104:107], a[16:19], a[4:7], v[104:107]
  s_add_u32 s39, s52, 0
  v_cvt_pk_bf16_f32 v88, v88, v89
  v_cvt_pk_bf16_f32 v89, v90, v91
  v_mfma_f32_16x16x32_bf16 v[108:111], a[20:23], a[4:7], v[108:111]
  v_cvt_pk_bf16_f32 v90, v92, v93
  v_cvt_pk_bf16_f32 v91, v94, v95
  buffer_store_dwordx4 v[88:91], v10, s[32:35], s39 offen offset:0 sc1
  v_mfma_f32_16x16x32_bf16 v[112:115], a[24:27], a[4:7], v[112:115]
  v_cvt_pk_bf16_f32 v96, v96, v97
  v_cvt_pk_bf16_f32 v97, v98, v99
  v_mfma_f32_16x16x32_bf16 v[116:119], a[28:31], a[4:7], v[116:119]
  v_cvt_pk_bf16_f32 v98, v100, v101
  v_cvt_pk_bf16_f32 v99, v102, v103
  buffer_store_dwordx4 v[96:99], v10, s[32:35], s39 offen offset:1024 sc1
  v_mfma_f32_16x16x32_bf16 v[136:139], a[16:19], a[12:15], v[136:139]
  s_add_u32 s39, s52, 4096
  v_cvt_pk_bf16_f32 v104, v104, v105
  v_cvt_pk_bf16_f32 v105, v106, v107
  v_mfma_f32_16x16x32_bf16 v[140:143], a[20:23], a[12:15], v[140:143]
  v_cvt_pk_bf16_f32 v106, v108, v109
  v_cvt_pk_bf16_f32 v107, v110, v111
  buffer_store_dwordx4 v[104:107], v10, s[32:35], s39 offen offset:0 sc1
  v_mfma_f32_16x16x32_bf16 v[144:147], a[24:27], a[12:15], v[144:147]
  v_cvt_pk_bf16_f32 v112, v112, v113
  v_cvt_pk_bf16_f32 v113, v114, v115
  v_mfma_f32_16x16x32_bf16 v[148:151], a[28:31], a[12:15], v[148:151]
  v_cvt_pk_bf16_f32 v114, v116, v117
  v_cvt_pk_bf16_f32 v115, v118, v119
  buffer_store_dwordx4 v[112:115], v10, s[32:35], s39 offen offset:1024 sc1
  v_mfma_f32_16x16x32_bf16 v[120:123], a[16:19], a[8:11], v[120:123]
  s_add_u32 s39, s52, 12288
  v_cvt_pk_bf16_f32 v136, v136, v137
  v_cvt_pk_bf16_f32 v137, v138, v139
  v_mfma_f32_16x16x32_bf16 v[124:127], a[20:23], a[8:11], v[124:127]
  v_cvt_pk_bf16_f32 v138, v140, v141
  v_cvt_pk_bf16_f32 v139, v142, v143
  buffer_store_dwordx4 v[136:139], v10, s[32:35], s39 offen offset:0 sc1
  v_mfma_f32_16x16x32_bf16 v[128:131], a[24:27], a[8:11], v[128:131]
  v_cvt_pk_bf16_f32 v144, v144, v145
  v_cvt_pk_bf16_f32 v145, v146, v147
  v_mfma_f32_16x16x32_bf16 v[132:135], a[28:31], a[8:11], v[132:135]
  v_cvt_pk_bf16_f32 v146, v148, v149
  v_cvt_pk_bf16_f32 v147, v150, v151
  buffer_store_dwordx4 v[144:147], v10, s[32:35], s39 offen offset:1024 sc1
  s_waitcnt vmcnt(0)
  buffer_store_dword v232, v245, s[32:35], 0 offen sc1
  buffer_load_dword v246, v247, s[32:35], s49 offen sc1
  s_waitcnt vmcnt(0)
L_chk_x2:
  v_cmp_ne_u32 vcc, 0, v246
  s_andn2_b64 vcc, s[50:51], vcc
  s_cbranch_scc1 L_spin_x2
L_go_x2:
  s_add_u32 s39, s53, 8192
  s_add_u32 s40, s54, 8192
  buffer_load_dwordx4 v[152:155], v10, s[32:35], s39 offen offset:0 sc1
  buffer_load_dwordx4 v[168:171], v10, s[32:35], s40 offen offset:0 sc1
  buffer_load_dwordx4 v[156:159], v10, s[32:35], s39 offen offset:1024 sc1
  buffer_load_dwordx4 v[172:175], v10, s[32:35], s40 offen offset:1024 sc1
  s_add_u32 s39, s31, 20480
  s_waitcnt vmcnt(2)
  v_dot2c_f32_bf16 v120, s56, v152
  v_dot2c_f32_bf16 v121, s57, v152
  v_dot2c_f32_bf16 v122, s56, v153
  v_dot2c_f32_bf16 v123, s57, v153
  v_dot2c_f32_bf16 v124, s56, v154
  v_dot2c_f32_bf16 v125, s57, v154
  v_dot2c_f32_bf16 v126, s56, v155
  v_dot2c_f32_bf16 v127, s57, v155
  v_dot2c_f32_bf16 v120, s56, v168
  v_dot2c_f32_bf16 v121, s57, v168
  v_dot2c_f32_bf16 v122, s56, v169
  v_dot2c_f32_bf16 v123, s57, v169
  v_dot2c_f32_bf16 v124, s56, v170
  v_dot2c_f32_bf16 v125, s57, v170
  v_dot2c_f32_bf16 v126, s56, v171
  v_dot2c_f32_bf16 v127, s57, v171
  v_cvt_pk_bf16_f32 v120, v120, v121
  v_cvt_pk_bf16_f32 v121, v122, v123
  v_cvt_pk_bf16_f32 v122, v124, v125
  v_cvt_pk_bf16_f32 v123, v126, v127
  s_nop 1
  v_permlane16_swap_b32 v120, v122
  v_permlane16_swap_b32 v121, v123
  buffer_store_dwordx4 v[120:123], v66, s[16:19], s39 offen offset:0
  s_waitcnt vmcnt(1)
  v_dot2c_f32_bf16 v128, s56, v156
  v_dot2c_f32_bf16 v129, s57, v156
  v_dot2c_f32_bf16 v130, s56, v157
  v_dot2c_f32_bf16 v131, s57, v157
  v_dot2c_f32_bf16 v132, s56, v158
  v_dot2c_f32_bf16 v133, s57, v158
  v_dot2c_f32_bf16 v134, s56, v159
  v_dot2c_f32_bf16 v135, s57, v159
  v_dot2c_f32_bf16 v128, s56, v172
  v_dot2c_f32_bf16 v129, s57, v172
  v_dot2c_f32_bf16 v130, s56, v173
  v_dot2c_f32_bf16 v131, s57, v173
  v_dot2c_f32_bf16 v132, s56, v174
  v_dot2c_f32_bf16 v133, s57, v174
  v_dot2c_f32_bf16 v134, s56, v175
  v_dot2c_f32_bf16 v135, s57, v175
  v_cvt_pk_bf16_f32 v128, v128, v129
  v_cvt_pk_bf16_f32 v129, v130, v131
  v_cvt_pk_bf16_f32 v130, v132, v133
  v_cvt_pk_bf16_f32 v131, v134, v135
  s_nop 1
  v_permlane16_swap_b32 v128, v130
  v_permlane16_swap_b32 v129, v131
  buffer_store_dwordx4 v[128:131], v66, s[16:19], s39 offen offset:64
  s_branch L_at_end
L_o_idle:
  s_waitcnt vmcnt(0)
  buffer_store_dword v232, v245, s[32:35], 0 offen sc1
L_at_end:
L_f_exit:
  s_endpgm
L_spin_c:
  s_add_u32 s3, s3, 1
  s_cmp_gt_u32 s3, 0x10000
  s_cbranch_scc1 L_go_c
  buffer_load_dword v246, v70, s[32:35], s55 offen sc1
  s_waitcnt vmcnt(0)
  s_branch L_chk_c
L_spin_d:
  s_add_u32 s3, s3, 1
  s_cmp_gt_u32 s3, 0x10000
  s_cbranch_scc1 L_go_d
  buffer_load_dword v246, v70, s[32:35], s55 offen sc1
  s_waitcnt vmcnt(0)
  s_branch L_chk_d
L_spin_x0:
  s_add_u32 s3, s3, 1
  s_cmp_gt_u32 s3, 0x10000
  s_cbranch_scc1 L_go_x0
  buffer_load_dword v246, v247, s[32:35], s49 offen sc1
  s_waitcnt vmcnt(0)
  s_branch L_chk_x0
L_spin_x1:
  s_add_u32 s3, s3, 1
  s_cmp_gt_u32 s3, 0x10000
  s_cbranch_scc1 L_go_x1
  buffer_load_dword v246, v247, s[32:35], s49 offen sc1
  s_waitcnt vmcnt(0)
  s_branch L_chk_x1
L_spin_x2:
  s_add_u32 s3, s3, 1
  s_cmp_gt_u32 s3, 0x10000
  s_cbranch_scc1 L_go_x2
  buffer_load_dword v246, v247, s[32:35], s49 offen sc1
  s_waitcnt vmcnt(0)
  s_branch L_chk_x2
L_at_slow0:
  s_mov_b32 s81, 0
L_at_slow:
  s_cmp_eq_u32 s81, 0
  s_cselect_b64 vcc, s[64:65], s[66:67]
  s_cselect_b32 s77, s62, s63
  s_cselect_b32 s83, s68, s70
  s_cselect_b32 s84, s69, s71
  s_cmp_eq_u64 vcc, 0
  s_cbranch_scc1 L_at_slownext
  s_waitcnt vmcnt(0)
  v_mov_b64 v[88:89], 0
  v_mov_b64 v[90:91], 0
  v_mov_b64 v[92:93], 0
  v_mov_b64 v[94:95], 0
  v_mov_b64 v[96:97], 0
  v_mov_b64 v[98:99], 0
  v_mov_b64 v[100:101], 0
  v_mov_b64 v[102:103], 0
  v_mov_b64 v[104:105], 0
  v_mov_b64 v[106:107], 0
  v_mov_b64 v[108:109], 0
  v_mov_b64 v[110:111], 0
  v_mov_b64 v[112:113], 0
  v_mov_b64 v[114:115], 0
  v_mov_b64 v[116:117], 0
  v_mov_b64 v[118:119], 0
  v_mov_b64 v[120:121], 0
  v_mov_b64 v[122:123], 0
  v_mov_b64 v[124:125], 0
  v_mov_b64 v[126:127], 0
  v_mov_b64 v[128:129], 0
  v_mov_b64 v[130:131], 0
  v_mov_b64 v[132:133], 0
  v_mov_b64 v[134:135], 0
  v_mov_b64 v[136:137], 0
  v_mov_b64 v[138:139], 0
  v_mov_b64 v[140:141], 0
  v_mov_b64 v[142:143], 0
  v_mov_b64 v[144:145], 0
  v_mov_b64 v[146:147], 0
  v_mov_b64 v[148:149], 0
  v_mov_b64 v[150:151], 0
  v_mov_b64 v[216:217], 0
  v_mov_b64 v[218:219], 0
  v_mov_b64 v[220:221], 0
  v_mov_b64 v[222:223], 0
  s_lshl_b32 s77, s77, 4
  v_and_b32 v64, 15, v0
  v_lshrrev_b32 v65, 4, v0
  v_lshlrev_b32 v65, 2, v65
  v_sub_u32 v64, v64, v65
  v_add_u32 v64, s77, v64
  v_cvt_f32_i32 v64, v64
  v_mul_f32 v64, 0x6f800000, v64
  v_mov_b32 v234, 0xff61b1e6
  v_mov_b32 v235, 0xff61b1e6
  s_mov_b32 s82, s78
L_at_sloop:
  buffer_load_dwordx4 a[0:3], v10, s[32:35], s82 offen offset:0 sc1
  buffer_load_dwordx4 a[4:7], v10, s[32:35], s82 offen offset:1024 sc1
  buffer_load_dwordx4 a[8:11], v10, s[32:35], s82 offen offset:2048 sc1
  buffer_load_dwordx4 a[12:15], v10, s[32:35], s82 offen offset:3072 sc1
  buffer_load_dwordx4 a[16:19], v11, s[32:35], s82 offen offset:0 sc1
  buffer_load_dwordx4 a[20:23], v11, s[32:35], s82 offen offset:1024 sc1
  buffer_load_dwordx4 a[24:27], v11, s[32:35], s82 offen offset:2048 sc1
  buffer_load_dwordx4 a[28:31], v11, s[32:35], s82 offen offset:3072 sc1
  s_add_u32 s39, s82, 16777216
  buffer_load_dwordx4 a[32:35], v10, s[32:35], s39 offen offset:0 sc1
  buffer_load_dwordx4 a[36:39], v10, s[32:35], s39 offen offset:1024 sc1
  buffer_load_dwordx4 a[40:43], v10, s[32:35], s39 offen offset:2048 sc1
  buffer_load_dwordx4 a[44:47], v10, s[32:35], s39 offen offset:3072 sc1
  buffer_load_dwordx4 a[48:51], v11, s[32:35], s39 offen offset:0 sc1
  buffer_load_dwordx4 a[52:55], v11, s[32:35], s39 offen offset:1024 sc1
  buffer_load_dwordx4 a[56:59], v11, s[32:35], s39 offen offset:2048 sc1
  buffer_load_dwordx4 a[60:63], v11, s[32:35], s39 offen offset:3072 sc1
  s_add_u32 s82, s82, 8192
  v_add_f32 v16, 0x0, v64
  v_add_f32 v17, 0xef800000, v64
  v_add_f32 v18, 0xf0000000, v64
  v_add_f32 v19, 0xf0400000, v64
  v_add_f32 v20, 0xf1800000, v64
  v_add_f32 v21, 0xf1880000, v64
  v_add_f32 v22, 0xf1900000, v64
  v_add_f32 v23, 0xf1980000, v64
  v_add_f32 v24, 0x72800000, v64
  v_add_f32 v25, 0x727c0000, v64
  v_add_f32 v26, 0x72780000, v64
  v_add_f32 v27, 0x72740000, v64
  v_add_f32 v28, 0x72400000, v64
  v_add_f32 v29, 0x723c0000, v64
  v_add_f32 v30, 0x72380000, v64
  v_add_f32 v31, 0x72340000, v64
  v_min_f32 v16, 0, v16
  v_min_f32 v17, 0, v17
  v_min_f32 v18, 0, v18
  v_min_f32 v19, 0, v19
  v_min_f32 v20, 0, v20
  v_min_f32 v21, 0, v21
  v_min_f32 v22, 0, v22
  v_min_f32 v23, 0, v23
  v_min_f32 v24, 0, v24
  v_min_f32 v25, 0, v25
  v_min_f32 v26, 0, v26
  v_min_f32 v27, 0, v27
  v_min_f32 v28, 0, v28
  v_min_f32 v29, 0, v29
  v_min_f32 v30, 0, v30
  v_min_f32 v31, 0, v31
  v_add_f32 v64, 0xf2000000, v64
  s_sub_i32 s77, s77, 32
  s_waitcnt vmcnt(0)
  s_nop 0
  v_mfma_f32_16x16x32_bf16 v[16:19], a[0:3], a[96:99], v[16:19]
  v_mfma_f32_16x16x32_bf16 v[16:19], a[4:7], a[100:103], v[16:19]
  v_mfma_f32_16x16x32_bf16 v[24:27], a[0:3], a[112:115], v[24:27]
  v_mfma_f32_16x16x32_bf16 v[24:27], a[4:7], a[116:119], v[24:27]
  v_mfma_f32_16x16x32_bf16 v[28:31], a[16:19], a[112:115], v[28:31]
  v_mfma_f32_16x16x32_bf16 v[28:31], a[20:23], a[116:119], v[28:31]
  v_mfma_f32_16x16x32_bf16 v[20:23], a[16:19], a[96:99], v[20:23]
  v_mfma_f32_16x16x32_bf16 v[20:23], a[20:23], a[100:103], v[20:23]
  v_mfma_f32_16x16x32_bf16 v[20:23], a[24:27], a[104:107], v[20:23]
  v_mfma_f32_16x16x32_bf16 v[20:23], a[28:31], a[108:111], v[20:23]
  v_mfma_f32_16x16x32_bf16 v[28:31], a[24:27], a[120:123], v[28:31]
  v_mfma_f32_16x16x32_bf16 v[28:31], a[28:31], a[124:127], v[28:31]
  v_mfma_f32_16x16x32_bf16 v[24:27], a[8:11], a[120:123], v[24:27]
  v_mfma_f32_16x16x32_bf16 v[24:27], a[12:15], a[124:127], v[24:27]
  v_mfma_f32_16x16x32_bf16 v[16:19], a[8:11], a[104:107], v[16:19]
  v_mfma_f32_16x16x32_bf16 v[16:19], a[12:15], a[108:111], v[16:19]
  s_nop 7
  v_max3_f32 v12, v16, v17, v18
  v_max3_f32 v13, v24, v25, v26
  v_max3_f32 v12, v12, v19, v20
  v_max3_f32 v13, v13, v27, v28
  v_max3_f32 v12, v12, v21, v22
  v_max3_f32 v13, v13, v29, v30
  v_max_f32 v12, v12, v23
  v_max_f32 v13, v13, v31
  v_mov_b32 v14, v12
  v_mov_b32 v15, v13
  s_nop 0
  v_permlane32_swap_b32 v12, v14
  v_permlane32_swap_b32 v13, v15
  v_max_f32 v12, v12, v14
  v_max_f32 v13, v13, v15
  v_mov_b32 v14, v12
  v_mov_b32 v15, v13
  s_nop 0
  v_permlane16_swap_b32 v12, v14
  v_permlane16_swap_b32 v13, v15
  v_max_f32 v12, v12, v14
  v_max_f32 v13, v13, v15
  v_max_f32 v12, v12, v234
  v_max_f32 v13, v13, v235
  v_sub_f32 v236, v234, v12
  v_sub_f32 v237, v235, v13
  v_exp_f32 v236, v236
  v_exp_f32 v237, v237
  v_mov_b32 v234, v12
  v_mov_b32 v235, v13
  v_sub_f32 v16, v16, v234
  v_sub_f32 v17, v17, v234
  v_sub_f32 v18, v18, v234
  v_sub_f32 v19, v19, v234
  v_sub_f32 v20, v20, v234
  v_sub_f32 v21, v21, v234
  v_sub_f32 v22, v22, v234
  v_sub_f32 v23, v23, v234
  v_sub_f32 v24, v24, v235
  v_sub_f32 v25, v25, v235
  v_sub_f32 v26, v26, v235
  v_sub_f32 v27, v27, v235
  v_sub_f32 v28, v28, v235
  v_sub_f32 v29, v29, v235
  v_sub_f32 v30, v30, v235
  v_sub_f32 v31, v31, v235
  v_exp_f32 v16, v16
  v_exp_f32 v17, v17
  v_exp_f32 v18, v18
  v_exp_f32 v19, v19
  v_exp_f32 v20, v20
  v_exp_f32 v21, v21
  v_exp_f32 v22, v22
  v_exp_f32 v23, v23
  v_exp_f32 v24, v24
  v_exp_f32 v25, v25
  v_exp_f32 v26, v26
  v_exp_f32 v27, v27
  v_exp_f32 v28, v28
  v_exp_f32 v29, v29
  v_exp_f32 v30, v30
  v_exp_f32 v31, v31
  v_mul_f32 v88, v88, v236
  v_mul_f32 v89, v89, v236
  v_mul_f32 v90, v90, v236
  v_mul_f32 v91, v91, v236
  v_mul_f32 v92, v92, v236
  v_mul_f32 v93, v93, v236
  v_mul_f32 v94, v94, v236
  v_mul_f32 v95, v95, v236
  v_mul_f32 v96, v96, v236
  v_mul_f32 v97, v97, v236
  v_mul_f32 v98, v98, v236
  v_mul_f32 v99, v99, v236
  v_mul_f32 v100, v100, v236
  v_mul_f32 v101, v101, v236
  v_mul_f32 v102, v102, v236
  v_mul_f32 v103, v103, v236
  v_mul_f32 v104, v104, v236
  v_mul_f32 v105, v105, v236
  v_mul_f32 v106, v106, v236
  v_mul_f32 v107, v107, v236
  v_mul_f32 v108, v108, v236
  v_mul_f32 v109, v109, v236
  v_mul_f32 v110, v110, v236
  v_mul_f32 v111, v111, v236
  v_mul_f32 v112, v112, v236
  v_mul_f32 v113, v113, v236
  v_mul_f32 v114, v114, v236
  v_mul_f32 v115, v115, v236
  v_mul_f32 v116, v116, v236
  v_mul_f32 v117, v117, v236
  v_mul_f32 v118, v118, v236
  v_mul_f32 v119, v119, v236
  v_mul_f32 v120, v120, v237
  v_mul_f32 v121, v121, v237
  v_mul_f32 v122, v122, v237
  v_mul_f32 v123, v123, v237
  v_mul_f32 v124, v124, v237
  v_mul_f32 v125, v125, v237
  v_mul_f32 v126, v126, v237
  v_mul_f32 v127, v127, v237
  v_mul_f32 v128, v128, v237
  v_mul_f32 v129, v129, v237
  v_mul_f32 v130, v130, v237
  v_mul_f32 v131, v131, v237
  v_mul_f32 v132, v132, v237
  v_mul_f32 v133, v133, v237
  v_mul_f32 v134, v134, v237
  v_mul_f32 v135, v135, v237
  v_mul_f32 v136, v136, v237
  v_mul_f32 v137, v137, v237
  v_mul_f32 v138, v138, v237
  v_mul_f32 v139, v139, v237
  v_mul_f32 v140, v140, v237
  v_mul_f32 v141, v141, v237
  v_mul_f32 v142, v142, v237
  v_mul_f32 v143, v143, v237
  v_mul_f32 v144, v144, v237
  v_mul_f32 v145, v145, v237
  v_mul_f32 v146, v146, v237
  v_mul_f32 v147, v147, v237
  v_mul_f32 v148, v148, v237
  v_mul_f32 v149, v149, v237
  v_mul_f32 v150, v150, v237
  v_mul_f32 v151, v151, v237
  v_mul_f32 v216, v216, v236
  v_mul_f32 v217, v217, v236
  v_mul_f32 v218, v218, v236
  v_mul_f32 v219, v219, v236
  v_mul_f32 v220, v220, v237
  v_mul_f32 v221, v221, v237
  v_mul_f32 v222, v222, v237
  v_mul_f32 v223, v223, v237
  v_cvt_pk_bf16_f32 v48, v16, v17
  v_cvt_pk_bf16_f32 v49, v18, v19
  v_cvt_pk_bf16_f32 v50, v20, v21
  v_cvt_pk_bf16_f32 v51, v22, v23
  v_cvt_pk_bf16_f32 v52, v24, v25
  v_cvt_pk_bf16_f32 v53, v26, v27
  v_cvt_pk_bf16_f32 v54, v28, v29
  v_cvt_pk_bf16_f32 v55, v30, v31
  s_nop 1
  v_mfma_f32_16x16x32_bf16 v[88:91], a[32:35], v[48:51], v[88:91]
  v_mfma_f32_16x16x32_bf16 v[120:123], a[32:35], v[52:55], v[120:123]
  v_mfma_f32_16x16x32_bf16 v[92:95], a[36:39], v[48:51], v[92:95]
  v_mfma_f32_16x16x32_bf16 v[124:127], a[36:39], v[52:55], v[124:127]
  v_mfma_f32_16x16x32_bf16 v[96:99], a[40:43], v[48:51], v[96:99]
  v_mfma_f32_16x16x32_bf16 v[128:131], a[40:43], v[52:55], v[128:131]
  v_mfma_f32_16x16x32_bf16 v[100:103], a[44:47], v[48:51], v[100:103]
  v_mfma_f32_16x16x32_bf16 v[132:135], a[44:47], v[52:55], v[132:135]
  v_mfma_f32_16x16x32_bf16 v[104:107], a[48:51], v[48:51], v[104:107]
  v_mfma_f32_16x16x32_bf16 v[136:139], a[48:51], v[52:55], v[136:139]
  v_mfma_f32_16x16x32_bf16 v[108:111], a[52:55], v[48:51], v[108:111]
  v_mfma_f32_16x16x32_bf16 v[140:143], a[52:55], v[52:55], v[140:143]
  v_mfma_f32_16x16x32_bf16 v[112:115], a[56:59], v[48:51], v[112:115]
  v_mfma_f32_16x16x32_bf16 v[144:147], a[56:59], v[52:55], v[144:147]
  v_mfma_f32_16x16x32_bf16 v[116:119], a[60:63], v[48:51], v[116:119]
  v_mfma_f32_16x16x32_bf16 v[148:151], a[60:63], v[52:55], v[148:151]
  v_mfma_f32_16x16x32_bf16 v[216:219], a[192:195], v[48:51], v[216:219]
  v_mfma_f32_16x16x32_bf16 v[220:223], a[192:195], v[52:55], v[220:223]
  s_nop 7
  s_cmp_ge_i32 s77, -79
  s_cbranch_scc1 L_at_sloop
  s_cmp_eq_u32 s81, 0
  s_cselect_b64 vcc, -1, 0
  v_cndmask_b32 v238, v5, v3, vcc
  v_cndmask_b32 v239, v6, v4, vcc
  v_rcp_f32 v234, v216
  s_nop 0
  v_mul_f32 v234, v234, v238
  v_pk_mul_f32 v[88:89], v[88:89], v[234:235] op_sel_hi:[1,0]
  v_pk_mul_f32 v[90:91], v[90:91], v[234:235] op_sel_hi:[1,0]
  v_pk_mul_f32 v[92:93], v[92:93], v[234:235] op_sel_hi:[1,0]
  v_pk_mul_f32 v[94:95], v[94:95], v[234:235] op_sel_hi:[1,0]
  v_cvt_pk_bf16_f32 v88, v88, v89
  v_cvt_pk_bf16_f32 v89, v90, v91
  v_cvt_pk_bf16_f32 v90, v92, v93
  v_cvt_pk_bf16_f32 v91, v94, v95
  buffer_store_dwordx4 v[88:91], v10, s[32:35], s83 offen offset:0 sc1
  v_pk_mul_f32 v[96:97], v[96:97], v[234:235] op_sel_hi:[1,0]
  v_pk_mul_f32 v[98:99], v[98:99], v[234:235] op_sel_hi:[1,0]
  v_pk_mul_f32 v[100:101], v[100:101], v[234:235] op_sel_hi:[1,0]
  v_pk_mul_f32 v[102:103], v[102:103], v[234:235] op_sel_hi:[1,0]
  v_cvt_pk_bf16_f32 v96, v96, v97
  v_cvt_pk_bf16_f32 v97, v98, v99
  v_cvt_pk_bf16_f32 v98, v100, v101
  v_cvt_pk_bf16_f32 v99, v102, v103
  buffer_store_dwordx4 v[96:99], v10, s[32:35], s83 offen offset:1024 sc1
  v_pk_mul_f32 v[104:105], v[104:105], v[234:235] op_sel_hi:[1,0]
  v_pk_mul_f32 v[106:107], v[106:107], v[234:235] op_sel_hi:[1,0]
  v_pk_mul_f32 v[108:109], v[108:109], v[234:235] op_sel_hi:[1,0]
  v_pk_mul_f32 v[110:111], v[110:111], v[234:235] op_sel_hi:[1,0]
  v_cvt_pk_bf16_f32 v104, v104, v105
  v_cvt_pk_bf16_f32 v105, v106, v107
  v_cvt_pk_bf16_f32 v106, v108, v109
  v_cvt_pk_bf16_f32 v107, v110, v111
  buffer_store_dwordx4 v[104:107], v10, s[32:35], s83 offen offset:2048 sc1
  v_pk_mul_f32 v[112:113], v[112:113], v[234:235] op_sel_hi:[1,0]
  v_pk_mul_f32 v[114:115], v[114:115], v[234:235] op_sel_hi:[1,0]
  v_pk_mul_f32 v[116:117], v[116:117], v[234:235] op_sel_hi:[1,0]
  v_pk_mul_f32 v[118:119], v[118:119], v[234:235] op_sel_hi:[1,0]
  v_cvt_pk_bf16_f32 v112, v112, v113
  v_cvt_pk_bf16_f32 v113, v114, v115
  v_cvt_pk_bf16_f32 v114, v116, v117
  v_cvt_pk_bf16_f32 v115, v118, v119
  buffer_store_dwordx4 v[112:115], v10, s[32:35], s83 offen offset:3072 sc1
  v_rcp_f32 v234, v220
  s_nop 0
  v_mul_f32 v234, v234, v239
  v_pk_mul_f32 v[120:121], v[120:121], v[234:235] op_sel_hi:[1,0]
  v_pk_mul_f32 v[122:123], v[122:123], v[234:235] op_sel_hi:[1,0]
  v_pk_mul_f32 v[124:125], v[124:125], v[234:235] op_sel_hi:[1,0]
  v_pk_mul_f32 v[126:127], v[126:127], v[234:235] op_sel_hi:[1,0]
  v_cvt_pk_bf16_f32 v120, v120, v121
  v_cvt_pk_bf16_f32 v121, v122, v123
  v_cvt_pk_bf16_f32 v122, v124, v125
  v_cvt_pk_bf16_f32 v123, v126, v127
  buffer_store_dwordx4 v[120:123], v10, s[32:35], s84 offen offset:0 sc1
  v_pk_mul_f32 v[128:129], v[128:129], v[234:235] op_sel_hi:[1,0]
  v_pk_mul_f32 v[130:131], v[130:131], v[234:235] op_sel_hi:[1,0]
  v_pk_mul_f32 v[132:133], v[132:133], v[234:235] op_sel_hi:[1,0]
  v_pk_mul_f32 v[134:135], v[134:135], v[234:235] op_sel_hi:[1,0]
  v_cvt_pk_bf16_f32 v128, v128, v129
  v_cvt_pk_bf16_f32 v129, v130, v131
  v_cvt_pk_bf16_f32 v130, v132, v133
  v_cvt_pk_bf16_f32 v131, v134, v135
  buffer_store_dwordx4 v[128:131], v10, s[32:35], s84 offen offset:1024 sc1
  v_pk_mul_f32 v[136:137], v[136:137], v[234:235] op_sel_hi:[1,0]
  v_pk_mul_f32 v[138:139], v[138:139], v[234:235] op_sel_hi:[1,0]
  v_pk_mul_f32 v[140:141], v[140:141], v[234:235] op_sel_hi:[1,0]
  v_pk_mul_f32 v[142:143], v[142:143], v[234:235] op_sel_hi:[1,0]
  v_cvt_pk_bf16_f32 v136, v136, v137
  v_cvt_pk_bf16_f32 v137, v138, v139
  v_cvt_pk_bf16_f32 v138, v140, v141
  v_cvt_pk_bf16_f32 v139, v142, v143
  buffer_store_dwordx4 v[136:139], v10, s[32:35], s84 offen offset:2048 sc1
  v_pk_mul_f32 v[144:145], v[144:145], v[234:235] op_sel_hi:[1,0]
  v_pk_mul_f32 v[146:147], v[146:147], v[234:235] op_sel_hi:[1,0]
  v_pk_mul_f32 v[148:149], v[148:149], v[234:235] op_sel_hi:[1,0]
  v_pk_mul_f32 v[150:151], v[150:151], v[234:235] op_sel_hi:[1,0]
  v_cvt_pk_bf16_f32 v144, v144, v145
  v_cvt_pk_bf16_f32 v145, v146, v147
  v_cvt_pk_bf16_f32 v146, v148, v149
  v_cvt_pk_bf16_f32 v147, v150, v151
  buffer_store_dwordx4 v[144:147], v10, s[32:35], s84 offen offset:3072 sc1
L_at_slownext:
  v_accvgpr_mov_b32 a96, a160
  v_accvgpr_mov_b32 a97, a161
  v_accvgpr_mov_b32 a98, a162
  v_accvgpr_mov_b32 a99, a163
  v_accvgpr_mov_b32 a100, a164
  v_accvgpr_mov_b32 a101, a165
  v_accvgpr_mov_b32 a102, a166
  v_accvgpr_mov_b32 a103, a167
  v_accvgpr_mov_b32 a104, a168
  v_accvgpr_mov_b32 a105, a169
  v_accvgpr_mov_b32 a106, a170
  v_accvgpr_mov_b32 a107, a171
  v_accvgpr_mov_b32 a108, a172
  v_accvgpr_mov_b32 a109, a173
  v_accvgpr_mov_b32 a110, a174
  v_accvgpr_mov_b32 a111, a175
  v_accvgpr_mov_b32 a112, a176
  v_accvgpr_mov_b32 a113, a177
  v_accvgpr_mov_b32 a114, a178
  v_accvgpr_mov_b32 a115, a179
  v_accvgpr_mov_b32 a116, a180
  v_accvgpr_mov_b32 a117, a181
  v_accvgpr_mov_b32 a118, a182
  v_accvgpr_mov_b32 a119, a183
  v_accvgpr_mov_b32 a120, a184
  v_accvgpr_mov_b32 a121, a185
  v_accvgpr_mov_b32 a122, a186
  v_accvgpr_mov_b32 a123, a187
  v_accvgpr_mov_b32 a124, a188
  v_accvgpr_mov_b32 a125, a189
  v_accvgpr_mov_b32 a126, a190
  v_accvgpr_mov_b32 a127, a191
  s_add_u32 s81, s81, 1
  s_cmp_lt_u32 s81, 2
  s_cbranch_scc1 L_at_slow
  s_branch L_o_start
L_f_spin:
  s_add_u32 s3, s3, 1
  s_cmp_gt_u32 s3, 0x10000
  s_cbranch_scc1 L_f_go
  s_sleep 2
  buffer_load_dword v4, v13, s[16:19], 0 offen sc1
  s_waitcnt vmcnt(0)
  s_branch L_f_chk
L_code_end:
.section .rodata,"a"
.p2align 6
.amdhsa_kernel gated_mix__compressed_kv_cla__swiglu_ffn__prompt_kernel
  .amdhsa_next_free_vgpr 512
  .amdhsa_next_free_sgpr 102
  .amdhsa_accum_offset 256
  .amdhsa_group_segment_fixed_size 0
  .amdhsa_kernarg_size 112
  .amdhsa_user_sgpr_count 2
  .amdhsa_user_sgpr_kernarg_segment_ptr 1
  .amdhsa_system_sgpr_workgroup_id_x 1
.end_amdhsa_kernel
```
